```python
import torch

def _softmax(x, axis=-1):
    return torch.softmax(x, dim=axis)

def _gelu(x):
    return torch.nn.functional.gelu(x, approximate='tanh')

def _silu(x):
    return torch.nn.functional.silu(x)

def _sigmoid(x):
    return torch.sigmoid(x)

def _layernorm(x, axis=-1, eps=1e-05):
    m = x.mean(dim=axis, keepdim=True)
    v = x.var(dim=axis, keepdim=True, unbiased=False)
    return (x - m) / torch.sqrt(v + eps)

def _scatter_add(tgt, idx, src, axis=0):
    return tgt.clone().index_add_(axis, idx, src)

def _segment_sum(src, seg, n):
    out = torch.zeros((n,) + src.shape[1:], dtype=src.dtype)
    return out.index_add_(0, seg, src)

def _pad(x, pw):
    flat = tuple((v for pair in reversed(pw) for v in pair))
    return torch.nn.functional.pad(x, flat)
kernel_name = 'standalone__video_video_swin__vision'

def setup_inputs():

    _w = lambda a: (lambda t: t.to(torch.bfloat16) if t.is_floating_point() else t)(torch.as_tensor(a))
    T = 4
    H = W = 224 // 7 * 7
    C, win = (96, 7)
    return {'x': _w((lambda *s: torch.randn(*s, dtype=torch.bfloat16) * 0.1)(1, T, H, W, C)), 'wqkv_t': _w((lambda *s: torch.randn(*s, dtype=torch.bfloat16) * 0.1)(C, 3 * C)), 'wo_t': _w((lambda *s: torch.randn(*s, dtype=torch.bfloat16) * 0.1)(C, C)), 'wqkv_s': _w((lambda *s: torch.randn(*s, dtype=torch.bfloat16) * 0.1)(C, 3 * C)), 'wo_s': _w((lambda *s: torch.randn(*s, dtype=torch.bfloat16) * 0.05)(C, C))}

def reference(x, wqkv_t, wo_t, wqkv_s, wo_s):
    B, T, H, W, C = x.shape
    win = 7
    scale = C ** (-0.5)
    h = _layernorm(x, axis=-1)
    ht = (lambda x, *d: x.permute(*d))(h, 0, 2, 3, 1, 4).reshape(B * H * W, T, C)
    qkv = ht @ wqkv_t
    q, k, v = (qkv[..., :C].clone(), qkv[..., C:2 * C].clone(), qkv[..., 2 * C:].clone())
    p = _softmax(torch.einsum('btc,bsc->bts', q, k) * scale, axis=-1)
    ot = torch.einsum('bts,bsc->btc', p, v) @ wo_t
    ot = (lambda x, *d: x.permute(*d))(ot.reshape(B, H, W, T, C), 0, 3, 1, 2, 4)
    x = x + ot
    h = _layernorm(x, axis=-1)
    nh, nw = (H // win, W // win)
    hs = h.reshape(B * T, nh, win, nw, win, C)
    hw = (lambda x, *d: x.permute(*d))(hs, 0, 1, 3, 2, 4, 5).reshape(B * T * nh * nw, win * win, C)
    qkv = hw @ wqkv_s
    q, k, v = (qkv[..., :C].clone(), qkv[..., C:2 * C].clone(), qkv[..., 2 * C:].clone())
    p = _softmax(torch.einsum('bqc,bkc->bqk', q, k) * scale, axis=-1)
    os = torch.einsum('bqk,bkc->bqc', p, v) @ wo_s
    os = (lambda x, *d: x.permute(*d))(os.reshape(B * T, nh, nw, win, win, C), 0, 1, 3, 2, 4, 5)
    os = os.reshape(B, T, H, W, C)
    return x + os
```

```asm
; @launch grid=(256,1,1) block=(256,1,1) lds=163840
.amdgcn_target "amdgcn-amd-amdhsa--gfx950"
.text
.globl standalone__video_video_swin__vision_kernel
.p2align 8
.type standalone__video_video_swin__vision_kernel,@function
standalone__video_video_swin__vision_kernel:
  s_load_dwordx8 s[84:91], s[0:1], 0
  s_load_dwordx4 s[92:95], s[0:1], 32
  s_cmp_ge_u32 s2, 256
  s_cbranch_scc1 L_END
  s_getpc_b64 s[4:5]
L_PC:
  s_lshr_b32 s6, s2, 3
  s_and_b32 s6, s6, 3
  s_lshl_b32 s6, s6, 14
  v_lshlrev_b32 v2, 6, v0
  v_add_u32 v2, s6, v2
  s_mov_b32 s7, L_END-L_PC
  v_min_u32 v2, s7, v2
  v_mov_b32 v3, s5
  v_add_co_u32 v2, vcc, s4, v2
  s_nop 1
  v_addc_co_u32 v3, vcc, 0, v3, vcc
  global_load_dword v255, v[2:3], off
  v_lshrrev_b32 v20, 6, v0
  v_and_b32 v1, 63, v0
  v_readfirstlane_b32 s20, v20
  v_and_b32 v2, 15, v0
  v_lshrrev_b32 v3, 4, v1
  v_lshlrev_b32 v14, 4, v3
  s_mul_i32 s22, s20, 39936
  s_mov_b32 s24, 0
  s_mov_b32 s25, 9216
  s_mov_b32 s26, 18432
  s_mov_b32 s27, 27648
  s_mov_b32 s28, 36864
  s_mov_b32 s29, 46080
  s_and_b32 s65, s20, 1
  s_cmp_eq_u32 s65, 1
  s_cbranch_scc1 L_FOLDW
  s_mov_b32 s71, 4608
  v_add_u32 v20, 0, v1
  v_mul_u32_u24 v24, 0xaab, v20
  v_lshrrev_b32 v24, 16, v24
  v_mul_u32_u24 v25, 24, v24
  v_sub_u32 v25, v20, v25
  v_bfe_u32 v26, v24, 1, 2
  v_and_b32 v27, 4, v24
  v_or_b32 v26, v26, v27
  v_xor_b32 v25, v25, v26
  v_lshlrev_b32 v25, 4, v25
  v_mul_u32_u24 v24, 0x240, v24
  v_add_u32 v232, v24, v25
  v_xor_b32 v25, 64, v25
  v_add3_u32 v235, v24, v25, s71
  v_add_u32 v20, 64, v1
  v_mul_u32_u24 v24, 0xaab, v20
  v_lshrrev_b32 v24, 16, v24
  v_mul_u32_u24 v25, 24, v24
  v_sub_u32 v25, v20, v25
  v_bfe_u32 v26, v24, 1, 2
  v_and_b32 v27, 4, v24
  v_or_b32 v26, v26, v27
  v_xor_b32 v25, v25, v26
  v_lshlrev_b32 v25, 4, v25
  v_mul_u32_u24 v24, 0x240, v24
  v_subrev_u32 v24, 0x400, v24
  v_add_u32 v233, v24, v25
  v_xor_b32 v25, 64, v25
  v_add3_u32 v236, v24, v25, s71
  v_add_u32 v20, 0x80, v1
  v_mul_u32_u24 v24, 0xaab, v20
  v_lshrrev_b32 v24, 16, v24
  v_mul_u32_u24 v25, 24, v24
  v_sub_u32 v25, v20, v25
  v_bfe_u32 v26, v24, 1, 2
  v_and_b32 v27, 4, v24
  v_or_b32 v26, v26, v27
  v_xor_b32 v25, v25, v26
  v_lshlrev_b32 v25, 4, v25
  v_mul_u32_u24 v24, 0x240, v24
  v_subrev_u32 v24, 0x800, v24
  v_add_u32 v234, v24, v25
  v_xor_b32 v25, 64, v25
  v_add3_u32 v237, v24, v25, s71
  s_lshr_b32 s69, s2, 3
  s_and_b32 s69, s69, 15
  s_lshl_b32 s69, s69, 12
  v_lshlrev_b32 v20, 6, v1
  v_lshlrev_b32 v22, 4, v1
  s_cmp_lt_u32 s20, 2
  s_waitcnt lgkmcnt(0)
  s_cselect_b32 s12, s86, s90
  s_cselect_b32 s13, s87, s91
  s_mov_b32 s14, 55296
  s_mov_b32 s15, 0x20000
  s_cselect_b32 s16, s88, s92
  s_cselect_b32 s17, s89, s93
  s_mov_b32 s18, 18432
  s_mov_b32 s19, 0x20000
  buffer_load_dword v254, v20, s[12:15], s69 offen
  s_mov_b32 s4, s84
  s_mov_b32 s5, s85
  s_mov_b32 s6, 38535168
  s_mov_b32 s7, 0x20000
  s_mov_b32 s8, s94
  s_mov_b32 s9, s95
  s_mov_b32 s10, 38535168
  s_mov_b32 s11, 0x20000
  s_lshl_b32 s23, s2, 2
  s_add_u32 s23, s23, s20
  s_lshr_b32 s65, s23, 5
  s_and_b32 s66, s23, 31
  s_mul_i32 s65, s65, 301056
  s_mul_i32 s66, s66, 1344
  s_add_u32 s21, s65, s66
  s_add_u32 m0, s22, 0x0
  v_lshrrev_b32 v240, 2, v2
  buffer_load_dwordx4 v232, s[12:15], s24 offen lds
  v_and_b32 v242, 1, v3
  v_lshl_add_u32 v243, v242, 3, v240
  v_mul_u32_u24 v224, 0x180, v243
  buffer_load_dwordx4 v233, s[12:15], s24 offen offset:1024 lds
  v_lshrrev_b32 v243, 1, v3
  v_mul_u32_u24 v243, 0x1800, v243
  v_and_b32 v241, 3, v2
  v_add3_u32 v224, v224, v243, s22
  v_lshrrev_b32 v244, 1, v240
  v_lshl_add_u32 v244, v242, 2, v244
  v_lshrrev_b32 v243, 1, v241
  v_xor_b32 v244, v244, v243
  v_lshl_add_u32 v224, v244, 4, v224
  v_and_b32 v243, 1, v241
  v_lshl_add_u32 v224, v243, 3, v224
  buffer_load_dwordx4 v234, s[12:15], s24 offen offset:2048 lds
  s_add_u32 m0, s22, 0xc00
  v_xor_b32 v227, 96, v224
  v_xor_b32 v225, 32, v224
  v_xor_b32 v226, 64, v224
  s_mov_b32 s67, 43691
  v_add_u32 v200, 0, v1
  v_mul_u32_u24 v201, s67, v200
  v_lshrrev_b32 v201, 19, v201
  v_mul_u32_u24 v202, 12, v201
  v_sub_u32 v202, v200, v202
  v_lshrrev_b32 v203, 2, v201
  v_mov_b32 v16, 0x3f803f80
  buffer_load_dwordx4 v235, s[12:15], s24 offen lds
  v_mov_b32 v17, 0x3f803f80
  v_mov_b32 v18, 0x3f803f80
  v_mov_b32 v19, 0x3f803f80
  s_mov_b32 s68, 9633792
  v_xor_b32 v205, v202, v203
  v_and_b32 v204, 3, v201
  v_lshlrev_b32 v205, 4, v205
  v_mul_lo_u32 v206, v203, s68
  v_add_u32 v200, 64, v1
  v_add_u32 v205, v205, v206
  v_mul_u32_u24 v201, s67, v200
  buffer_load_dwordx4 v236, s[12:15], s24 offen offset:1024 lds
  v_mul_u32_u24 v206, 0xc0, v204
  v_lshrrev_b32 v201, 19, v201
  v_add_u32 v205, v205, v206
  v_mul_u32_u24 v202, 12, v201
  v_mov_b32 v7, v205
  v_sub_u32 v202, v200, v202
  v_lshrrev_b32 v203, 2, v201
  v_cmp_le_u32_e64 s[40:41], 1, v204
  v_cmp_le_u32_e64 s[42:43], 2, v204
  v_cmp_le_u32_e64 s[44:45], 3, v204
  v_xor_b32 v205, v202, v203
  v_and_b32 v204, 3, v201
  buffer_load_dwordx4 v237, s[12:15], s24 offen offset:2048 lds
  s_add_u32 m0, s22, 0x1800
  v_lshlrev_b32 v205, 4, v205
  v_mul_lo_u32 v206, v203, s68
  v_add_u32 v200, 0x80, v1
  v_and_b32 v208, 3, v2
  v_lshrrev_b32 v209, 2, v2
  v_add_u32 v205, v205, v206
  v_mul_u32_u24 v201, s67, v200
  v_lshl_add_u32 v212, v208, 2, v209
  v_mul_u32_u24 v206, 0xc0, v204
  v_lshrrev_b32 v201, 19, v201
  buffer_load_dwordx4 v232, s[12:15], s25 offen lds
  v_mul_u32_u24 v212, 0xc0, v212
  v_xor_b32 v213, v3, v208
  v_add_u32 v205, v205, v206
  v_mul_u32_u24 v202, 12, v201
  v_lshl_add_u32 v212, v213, 4, v212
  v_subrev_u32 v8, 0x400, v205
  v_sub_u32 v202, v200, v202
  v_lshrrev_b32 v203, 2, v201
  v_add_u32 v4, s22, v212
  v_lshrrev_b32 v210, 2, v2
  v_xor_b32 v205, v202, v203
  v_and_b32 v211, 3, v2
  buffer_load_dwordx4 v233, s[12:15], s25 offen offset:1024 lds
  v_lshl_add_u32 v212, v210, 2, v3
  v_cmp_le_u32_e64 s[46:47], 1, v204
  v_cmp_le_u32_e64 s[48:49], 2, v204
  v_cmp_le_u32_e64 s[50:51], 3, v204
  v_lshlrev_b32 v205, 4, v205
  v_mul_lo_u32 v206, v203, s68
  v_mul_u32_u24 v212, 0xc0, v212
  v_xor_b32 v213, v211, v210
  v_and_b32 v204, 3, v201
  v_add_u32 v205, v205, v206
  v_lshl_add_u32 v212, v213, 4, v212
  buffer_load_dwordx4 v234, s[12:15], s25 offen offset:2048 lds
  s_add_u32 m0, s22, 0x2400
  v_mul_u32_u24 v206, 0xc0, v204
  v_add_u32 v5, s22, v212
  v_add_u32 v205, v205, v206
  v_mul_u32_u24 v212, 0x300, v208
  v_subrev_u32 v9, 0x800, v205
  v_cmp_le_u32_e64 s[52:53], 1, v204
  v_cmp_le_u32_e64 s[54:55], 2, v204
  v_cmp_le_u32_e64 s[56:57], 3, v204
  v_lshl_add_u32 v212, v209, 2, v212
  v_add_u32 v212, s22, v212
  v_lshlrev_b32 v213, 2, v1
  buffer_load_dwordx4 v235, s[12:15], s25 offen lds
  v_cmp_eq_u32_e64 s[30:31], 1, v208
  v_cmp_eq_u32_e64 s[32:33], 2, v208
  v_cmp_eq_u32_e64 s[34:35], 3, v208
  v_cmp_eq_u32_e64 s[36:37], v3, v209
  v_add_u32 v212, 0x180, v212
  v_add_u32 v213, 0x27000, v213
  v_cndmask_b32_e64 v6, v213, v212, s[36:37]
  v_lshrrev_b32 v249, 1, v2
  v_bfe_u32 v248, v2, 1, 2
  v_xor_b32 v249, v249, v2
  v_xor_b32 v248, v248, v3
  buffer_load_dwordx4 v236, s[12:15], s25 offen offset:1024 lds
  v_and_b32 v249, 4, v249
  v_or_b32 v248, v248, v249
  v_mul_u32_u24 v246, 0x180, v2
  v_lshl_add_u32 v246, v248, 4, v246
  v_add_u32 v246, s22, v246
  v_xor_b32 v247, 64, v246
  v_add_u32 v248, 0x80, v247
  v_add_u32 v249, 0x100, v246
  s_mul_i32 s73, s20, 768
  v_lshlrev_b32 v228, 1, v2
  v_add_u32 v10, 0xa2c0, v7
  v_add_u32 v11, 0xa2c0, v8
  buffer_load_dwordx4 v237, s[12:15], s25 offen offset:2048 lds
  s_add_u32 m0, s22, 0x3000
  v_add_u32 v12, 0xa2c0, v9
  v_bfe_u32 v24, v2, 2, 1
  v_mul_u32_u24 v22, 0xc00, v24
  v_lshrrev_b32 v24, 3, v2
  v_lshlrev_b32 v24, 6, v24
  v_add_u32 v22, v22, v24
  v_and_b32 v24, 3, v2
  v_lshl_add_u32 v22, v24, 4, v22
  v_lshrrev_b32 v24, 1, v3
  v_lshl_add_u32 v22, v24, 8, v22
  buffer_load_dwordx4 v232, s[12:15], s26 offen lds
  v_and_b32 v24, 1, v3
  v_lshl_add_u32 v22, v24, 3, v22
  v_lshrrev_b32 v27, 2, v2
  v_lshl_add_u32 v24, v3, 2, v27
  s_mov_b32 s72, 0xbc2aaaab
  v_cmp_eq_u32_e64 s[38:39], 0, v3
  v_and_b32 v28, 3, v2
  v_lshlrev_b32 v23, 4, v24
  v_lshrrev_b32 v24, 1, v28
  v_lshl_add_u32 v23, v24, 8, v23
  v_and_b32 v24, 1, v28
  v_lshl_add_u32 v23, v24, 3, v23
  buffer_load_dwordx4 v233, s[12:15], s26 offen offset:1024 lds
  s_mov_b32 s77, 0x38e38e39
  v_accvgpr_write_b32 a145, 0
  v_accvgpr_write_b32 a146, 0
  v_accvgpr_write_b32 a147, 0
  v_accvgpr_write_b32 a169, 0
  v_accvgpr_write_b32 a170, 0
  v_accvgpr_write_b32 a171, 0
  v_accvgpr_write_b32 a149, 0
  v_accvgpr_write_b32 a150, 0
  v_accvgpr_write_b32 a151, 0
  v_accvgpr_write_b32 a153, 0
  buffer_load_dwordx4 v234, s[12:15], s26 offen offset:2048 lds
  s_add_u32 m0, s22, 0x3c00
  v_accvgpr_write_b32 a154, 0
  v_accvgpr_write_b32 a155, 0
  v_accvgpr_write_b32 a157, 0
  v_accvgpr_write_b32 a158, 0
  v_accvgpr_write_b32 a159, 0
  v_accvgpr_write_b32 a161, 0
  v_accvgpr_write_b32 a162, 0
  v_accvgpr_write_b32 a163, 0
  v_add_u32 v22, s22, v22
  v_accvgpr_write_b32 a165, 0
  v_accvgpr_write_b32 a166, 0
  buffer_load_dwordx4 v235, s[12:15], s26 offen lds
  v_accvgpr_write_b32 a167, 0
  v_add_u32 v22, 0x5400, v22
  v_accvgpr_write_b32 a173, 0
  v_accvgpr_write_b32 a174, 0
  v_accvgpr_write_b32 a175, 0
  v_accvgpr_write_b32 a177, 0
  v_accvgpr_write_b32 a178, 0
  v_accvgpr_write_b32 a179, 0
  v_accvgpr_write_b32 a181, 0
  v_accvgpr_write_b32 a182, 0
  v_accvgpr_write_b32 a183, 0
  buffer_load_dwordx4 v236, s[12:15], s26 offen offset:1024 lds
  v_accvgpr_write_b32 a185, 0
  v_accvgpr_write_b32 a186, 0
  v_accvgpr_write_b32 a187, 0
  v_accvgpr_write_b32 a189, 0
  v_accvgpr_write_b32 a190, 0
  v_accvgpr_write_b32 a191, 0
  v_add_u32 v23, s22, v23
  v_mov_b32 v15, 0
  s_mov_b32 s58, 0x3c2aaaab
  s_mov_b32 s59, 0x3e16c740
  s_mov_b32 s60, 41664
  v_mov_b32 v13, 0x3727c5ac
  buffer_load_dwordx4 v237, s[12:15], s26 offen offset:2048 lds
  s_add_u32 m0, s22, 0x4800
  v_add_u32 v23, 0x5400, v23
  buffer_load_dwordx4 v232, s[12:15], s27 offen lds
  buffer_load_dwordx4 v233, s[12:15], s27 offen offset:1024 lds
  buffer_load_dwordx4 v234, s[12:15], s27 offen offset:2048 lds
  s_add_u32 m0, s22, 0x5400
  s_nop 0
  buffer_load_dwordx4 v235, s[12:15], s27 offen lds
  buffer_load_dwordx4 v236, s[12:15], s27 offen offset:1024 lds
  buffer_load_dwordx4 v237, s[12:15], s27 offen offset:2048 lds
  s_add_u32 m0, s22, 0x6000
  s_nop 0
  buffer_load_dwordx4 v232, s[12:15], s28 offen lds
  buffer_load_dwordx4 v233, s[12:15], s28 offen offset:1024 lds
  buffer_load_dwordx4 v234, s[12:15], s28 offen offset:2048 lds
  s_add_u32 m0, s22, 0x6c00
  s_nop 0
  buffer_load_dwordx4 v235, s[12:15], s28 offen lds
  buffer_load_dwordx4 v236, s[12:15], s28 offen offset:1024 lds
  buffer_load_dwordx4 v237, s[12:15], s28 offen offset:2048 lds
  s_add_u32 m0, s22, 0x7800
  s_nop 0
  buffer_load_dwordx4 v232, s[12:15], s29 offen lds
  buffer_load_dwordx4 v233, s[12:15], s29 offen offset:1024 lds
  buffer_load_dwordx4 v234, s[12:15], s29 offen offset:2048 lds
  s_add_u32 m0, s22, 0x8400
  s_cmp_eq_u32 s20, 2
  s_cselect_b64 s[82:83], -1, 0
  v_cndmask_b32_e64 v250, v246, v248, s[82:83]
  v_cndmask_b32_e64 v251, v248, v246, s[82:83]
  v_cndmask_b32_e64 v252, v247, v249, s[82:83]
  v_cndmask_b32_e64 v253, v249, v247, s[82:83]
  s_add_u32 s73, s73, 0x27200
  s_cmp_eq_u32 s20, 2
  s_cselect_b32 s74, 192, 0
  v_add_u32 v228, s73, v228
  v_add_u32 v229, s73, v14
  buffer_load_dwordx4 v235, s[12:15], s29 offen lds
  s_sub_u32 s75, 192, s74
  v_add_u32 v230, s74, v229
  v_add_u32 v231, s75, v229
  buffer_load_dwordx4 v236, s[12:15], s29 offen offset:1024 lds
  buffer_load_dwordx4 v237, s[12:15], s29 offen offset:2048 lds
  s_waitcnt vmcnt(24)
  ds_read_b64_tr_b16 a[192:193], v224
  ds_read_b64_tr_b16 a[194:195], v227 offset:1536
  ds_read_b64_tr_b16 a[196:197], v225
  ds_read_b64_tr_b16 a[198:199], v226 offset:1536
  ds_read_b64_tr_b16 a[200:201], v226
  ds_read_b64_tr_b16 a[202:203], v225 offset:1536
  ds_read_b64_tr_b16 a[204:205], v227
  ds_read_b64_tr_b16 a[206:207], v224 offset:1536
  ds_read_b64_tr_b16 a[208:209], v224 offset:128
  ds_read_b64_tr_b16 a[210:211], v227 offset:1664
  ds_read_b64_tr_b16 a[212:213], v225 offset:128
  ds_read_b64_tr_b16 a[214:215], v226 offset:1664
  ds_read_b64_tr_b16 a[216:217], v226 offset:128
  ds_read_b64_tr_b16 a[218:219], v225 offset:1664
  ds_read_b64_tr_b16 a[220:221], v227 offset:128
  ds_read_b64_tr_b16 a[222:223], v224 offset:1664
  ds_read_b64_tr_b16 a[224:225], v224 offset:256
  ds_read_b64_tr_b16 a[226:227], v227 offset:1792
  ds_read_b64_tr_b16 a[228:229], v225 offset:256
  ds_read_b64_tr_b16 a[230:231], v226 offset:1792
  ds_read_b128 a[72:75], v251
  ds_read_b128 a[0:3], v250
  ds_read_b128 a[76:79], v253
  ds_read_b128 a[4:7], v252
  ds_read_b128 a[80:83], v251 offset:128
  ds_read_b128 a[8:11], v250 offset:128
  ds_read_b128 a[84:87], v251 offset:6144
  ds_read_b128 a[12:15], v250 offset:6144
  ds_read_b128 a[88:91], v253 offset:6144
  ds_read_b128 a[16:19], v252 offset:6144
  ds_read_b128 a[92:95], v251 offset:6272
  ds_read_b128 a[20:23], v250 offset:6272
  s_waitcnt vmcnt(18)
  ds_read_b128 a[96:99], v251 offset:12288
  s_waitcnt lgkmcnt(15)
  v_mfma_f32_16x16x32_bf16 v[176:179], v[16:19], a[192:195], 0
  ds_read_b64_tr_b16 a[192:193], v226 offset:256
  ds_read_b64_tr_b16 a[194:195], v225 offset:1792
  v_mfma_f32_16x16x32_bf16 v[180:183], v[16:19], a[196:199], 0
  ds_read_b64_tr_b16 a[196:197], v227 offset:256
  ds_read_b64_tr_b16 a[198:199], v224 offset:1792
  v_mfma_f32_16x16x32_bf16 v[184:187], v[16:19], a[200:203], 0
  s_waitcnt vmcnt(12)
  ds_read_b64_tr_b16 a[200:201], v224 offset:12288
  ds_read_b64_tr_b16 a[202:203], v227 offset:13824
  v_mfma_f32_16x16x32_bf16 v[188:191], v[16:19], a[204:207], 0
  ds_read_b64_tr_b16 a[204:205], v225 offset:12288
  ds_read_b64_tr_b16 a[206:207], v226 offset:13824
  v_mfma_f32_16x16x32_bf16 v[192:195], v[16:19], a[208:211], 0
  ds_read_b64_tr_b16 a[208:209], v226 offset:12288
  ds_read_b64_tr_b16 a[210:211], v225 offset:13824
  v_mfma_f32_16x16x32_bf16 v[196:199], v[16:19], a[212:215], 0
  ds_read_b64_tr_b16 a[212:213], v227 offset:12288
  ds_read_b64_tr_b16 a[214:215], v224 offset:13824
  v_mfma_f32_16x16x32_bf16 v[200:203], v[16:19], a[216:219], 0
  ds_read_b64_tr_b16 a[216:217], v224 offset:12416
  ds_read_b64_tr_b16 a[218:219], v227 offset:13952
  v_mfma_f32_16x16x32_bf16 v[204:207], v[16:19], a[220:223], 0
  ds_read_b64_tr_b16 a[220:221], v225 offset:12416
  ds_read_b64_tr_b16 a[222:223], v226 offset:13952
  v_mfma_f32_16x16x32_bf16 v[208:211], v[16:19], a[224:227], 0
  ds_read_b64_tr_b16 a[224:225], v226 offset:12416
  ds_read_b64_tr_b16 a[226:227], v225 offset:13952
  s_waitcnt lgkmcnt(11)
  v_mfma_f32_16x16x32_bf16 v[212:215], v[16:19], a[228:231], 0
  ds_read_b64_tr_b16 a[228:229], v227 offset:12416
  ds_read_b64_tr_b16 a[230:231], v224 offset:13952
  v_mfma_f32_16x16x32_bf16 v[216:219], v[16:19], a[192:195], 0
  ds_read_b64_tr_b16 a[192:193], v224 offset:12544
  ds_read_b64_tr_b16 a[194:195], v227 offset:14080
  v_mfma_f32_16x16x32_bf16 v[176:179], v[16:19], a[200:203], v[176:179]
  ds_read_b64_tr_b16 a[200:201], v226 offset:12544
  ds_read_b64_tr_b16 a[202:203], v225 offset:14080
  v_mfma_f32_16x16x32_bf16 v[220:223], v[16:19], a[196:199], 0
  ds_read_b64_tr_b16 a[196:197], v225 offset:12544
  ds_read_b64_tr_b16 a[198:199], v226 offset:14080
  s_waitcnt lgkmcnt(10)
  v_mfma_f32_16x16x32_bf16 v[180:183], v[16:19], a[204:207], v[180:183]
  ds_read_b64_tr_b16 a[204:205], v227 offset:12544
  ds_read_b64_tr_b16 a[206:207], v224 offset:14080
  v_mfma_f32_16x16x32_bf16 v[184:187], v[16:19], a[208:211], v[184:187]
  ds_read_b128 a[24:27], v250 offset:12288
  ds_read_b128 a[100:103], v253 offset:12288
  v_mfma_f32_16x16x32_bf16 v[188:191], v[16:19], a[212:215], v[188:191]
  ds_read_b128 a[28:31], v252 offset:12288
  ds_read_b128 a[104:107], v251 offset:12416
  v_mfma_f32_16x16x32_bf16 v[192:195], v[16:19], a[216:219], v[192:195]
  ds_read_b128 a[32:35], v250 offset:12416
  ds_read_b128 a[108:111], v251 offset:18432
  v_mfma_f32_16x16x32_bf16 v[196:199], v[16:19], a[220:223], v[196:199]
  ds_read_b128 a[36:39], v250 offset:18432
  ds_read_b128 a[112:115], v253 offset:18432
  s_waitcnt lgkmcnt(10)
  v_mfma_f32_16x16x32_bf16 v[200:203], v[16:19], a[224:227], v[200:203]
  ds_read_b128 a[40:43], v252 offset:18432
  ds_read_b128 a[116:119], v251 offset:18560
  v_mfma_f32_16x16x32_bf16 v[204:207], v[16:19], a[228:231], v[204:207]
  ds_read_b128 a[44:47], v250 offset:18560
  v_mfma_f32_16x16x32_bf16 v[208:211], v[16:19], a[192:195], v[208:211]
  s_waitcnt vmcnt(6)
  ds_read_b128 a[120:123], v251 offset:24576
  ds_read_b128 a[48:51], v250 offset:24576
  v_mfma_f32_16x16x32_bf16 v[212:215], v[16:19], a[196:199], v[212:215]
  ds_read_b128 a[124:127], v253 offset:24576
  ds_read_b128 a[52:55], v252 offset:24576
  v_mfma_f32_16x16x32_bf16 v[216:219], v[16:19], a[200:203], v[216:219]
  ds_read_b128 a[128:131], v251 offset:24704
  ds_read_b128 a[56:59], v250 offset:24704
  s_waitcnt lgkmcnt(9)
  v_mfma_f32_16x16x32_bf16 v[220:223], v[16:19], a[204:207], v[220:223]
  v_mfma_f32_16x16x32_bf16 v[32:35], a[0:3], a[72:75], 0
  v_mfma_f32_16x16x32_bf16 v[56:59], a[12:15], a[72:75], 0
  v_mfma_f32_16x16x32_bf16 v[32:35], a[4:7], a[76:79], v[32:35]
  v_mfma_f32_16x16x32_bf16 v[80:83], a[24:27], a[72:75], 0
  v_mfma_f32_16x16x32_bf16 v[56:59], a[16:19], a[76:79], v[56:59]
  v_mfma_f32_16x16x32_bf16 v[104:107], a[36:39], a[72:75], 0
  v_mfma_f32_16x16x32_bf16 v[32:35], a[8:11], a[80:83], v[32:35]
  v_mfma_f32_16x16x32_bf16 v[80:83], a[28:31], a[76:79], v[80:83]
  s_waitcnt lgkmcnt(3)
  v_mfma_f32_16x16x32_bf16 v[128:131], a[48:51], a[72:75], 0
  v_mfma_f32_16x16x32_bf16 v[56:59], a[20:23], a[80:83], v[56:59]
  v_mfma_f32_16x16x32_bf16 v[104:107], a[40:43], a[76:79], v[104:107]
  v_mfma_f32_16x16x32_bf16 v[80:83], a[32:35], a[80:83], v[80:83]
  s_waitcnt lgkmcnt(0)
  v_mfma_f32_16x16x32_bf16 v[128:131], a[52:55], a[76:79], v[128:131]
  v_mfma_f32_16x16x32_bf16 v[36:39], a[0:3], a[84:87], 0
  v_mfma_f32_16x16x32_bf16 v[104:107], a[44:47], a[80:83], v[104:107]
  v_mfma_f32_16x16x32_bf16 v[60:63], a[12:15], a[84:87], 0
  v_mfma_f32_16x16x32_bf16 v[128:131], a[56:59], a[80:83], v[128:131]
  v_mfma_f32_16x16x32_bf16 v[36:39], a[4:7], a[88:91], v[36:39]
  v_mfma_f32_16x16x32_bf16 v[84:87], a[24:27], a[84:87], 0
  v_mfma_f32_16x16x32_bf16 v[60:63], a[16:19], a[88:91], v[60:63]
  v_mfma_f32_16x16x32_bf16 v[108:111], a[36:39], a[84:87], 0
  v_mfma_f32_16x16x32_bf16 v[36:39], a[8:11], a[92:95], v[36:39]
  v_mfma_f32_16x16x32_bf16 v[84:87], a[28:31], a[88:91], v[84:87]
  s_waitcnt vmcnt(0)
  ds_read_b64_tr_b16 a[208:209], v224 offset:24576
  ds_read_b64_tr_b16 a[210:211], v227 offset:26112
  v_mfma_f32_16x16x32_bf16 v[132:135], a[48:51], a[84:87], 0
  ds_read_b64_tr_b16 a[212:213], v225 offset:24576
  ds_read_b64_tr_b16 a[214:215], v226 offset:26112
  v_mfma_f32_16x16x32_bf16 v[60:63], a[20:23], a[92:95], v[60:63]
  ds_read_b128 a[132:135], v251 offset:30720
  ds_read_b128 a[60:63], v250 offset:30720
  v_mfma_f32_16x16x32_bf16 v[108:111], a[40:43], a[88:91], v[108:111]
  ds_read_b128 a[136:139], v253 offset:30720
  ds_read_b128 a[64:67], v252 offset:30720
  v_mfma_f32_16x16x32_bf16 v[84:87], a[32:35], a[92:95], v[84:87]
  ds_read_b128 a[140:143], v251 offset:30848
  ds_read_b128 a[68:71], v250 offset:30848
  v_mfma_f32_16x16x32_bf16 v[132:135], a[52:55], a[88:91], v[132:135]
  ds_read_b64_tr_b16 a[216:217], v226 offset:24576
  ds_read_b64_tr_b16 a[218:219], v225 offset:26112
  v_mfma_f32_16x16x32_bf16 v[40:43], a[0:3], a[96:99], 0
  ds_read_b64_tr_b16 a[220:221], v227 offset:24576
  ds_read_b64_tr_b16 a[222:223], v224 offset:26112
  v_mfma_f32_16x16x32_bf16 v[108:111], a[44:47], a[92:95], v[108:111]
  ds_read_b64_tr_b16 a[224:225], v224 offset:24704
  ds_read_b64_tr_b16 a[226:227], v227 offset:26240
  v_mfma_f32_16x16x32_bf16 v[64:67], a[12:15], a[96:99], 0
  ds_read_b64_tr_b16 a[228:229], v225 offset:24704
  ds_read_b64_tr_b16 a[230:231], v226 offset:26240
  s_waitcnt lgkmcnt(11)
  v_mfma_f32_16x16x32_bf16 v[176:179], v[16:19], a[208:211], v[176:179]
  ds_read_b64_tr_b16 a[192:193], v226 offset:24704
  ds_read_b64_tr_b16 a[194:195], v225 offset:26240
  v_mfma_f32_16x16x32_bf16 v[180:183], v[16:19], a[212:215], v[180:183]
  ds_read_b64_tr_b16 a[196:197], v227 offset:24704
  ds_read_b64_tr_b16 a[198:199], v224 offset:26240
  v_mfma_f32_16x16x32_bf16 v[152:155], a[60:63], a[72:75], 0
  ds_read_b64_tr_b16 a[200:201], v224 offset:24832
  ds_read_b64_tr_b16 a[202:203], v227 offset:26368
  s_waitcnt lgkmcnt(10)
  v_mfma_f32_16x16x32_bf16 v[152:155], a[64:67], a[76:79], v[152:155]
  ds_read_b64_tr_b16 a[204:205], v225 offset:24832
  ds_read_b64_tr_b16 a[206:207], v226 offset:26368
  v_mfma_f32_16x16x32_bf16 v[152:155], a[68:71], a[80:83], v[152:155]
  ds_read_b64_tr_b16 a[208:209], v226 offset:24832
  ds_read_b64_tr_b16 a[210:211], v225 offset:26368
  v_mfma_f32_16x16x32_bf16 v[184:187], v[16:19], a[216:219], v[184:187]
  ds_read_b64_tr_b16 a[212:213], v227 offset:24832
  ds_read_b64_tr_b16 a[214:215], v224 offset:26368
  v_mfma_f32_16x16x32_bf16 v[188:191], v[16:19], a[220:223], v[188:191]
  v_cvt_pk_bf16_f32 v177, v176, v176
  ds_write_b16 v228, v177
  s_waitcnt lgkmcnt(9)
  v_mfma_f32_16x16x32_bf16 v[192:195], v[16:19], a[224:227], v[192:195]
  v_cvt_pk_bf16_f32 v181, v180, v180
  ds_write_b16 v228, v181 offset:32
  v_mfma_f32_16x16x32_bf16 v[196:199], v[16:19], a[228:231], v[196:199]
  v_cvt_pk_bf16_f32 v185, v184, v184
  ds_write_b16 v228, v185 offset:64
  v_mfma_f32_16x16x32_bf16 v[200:203], v[16:19], a[192:195], v[200:203]
  v_cvt_pk_bf16_f32 v189, v188, v188
  ds_write_b16 v228, v189 offset:96
  v_mfma_f32_16x16x32_bf16 v[204:207], v[16:19], a[196:199], v[204:207]
  v_cvt_pk_bf16_f32 v193, v192, v192
  ds_write_b16 v228, v193 offset:128
  s_waitcnt lgkmcnt(5)
  v_mfma_f32_16x16x32_bf16 v[208:211], v[16:19], a[200:203], v[208:211]
  v_cvt_pk_bf16_f32 v197, v196, v196
  ds_write_b16 v228, v197 offset:160
  v_mfma_f32_16x16x32_bf16 v[212:215], v[16:19], a[204:207], v[212:215]
  v_cvt_pk_bf16_f32 v201, v200, v200
  ds_write_b16 v228, v201 offset:192
  v_mfma_f32_16x16x32_bf16 v[216:219], v[16:19], a[208:211], v[216:219]
  v_cvt_pk_bf16_f32 v205, v204, v204
  ds_write_b16 v228, v205 offset:224
  v_mfma_f32_16x16x32_bf16 v[220:223], v[16:19], a[212:215], v[220:223]
  v_cvt_pk_bf16_f32 v209, v208, v208
  ds_write_b16 v228, v209 offset:256
  v_mfma_f32_16x16x32_bf16 v[156:159], a[60:63], a[84:87], 0
  v_cvt_pk_bf16_f32 v213, v212, v212
  ds_write_b16 v228, v213 offset:288
  v_mfma_f32_16x16x32_bf16 v[156:159], a[64:67], a[88:91], v[156:159]
  v_cvt_pk_bf16_f32 v217, v216, v216
  ds_write_b16 v228, v217 offset:320
  v_mfma_f32_16x16x32_bf16 v[132:135], a[56:59], a[92:95], v[132:135]
  v_cvt_pk_bf16_f32 v221, v220, v220
  ds_write_b16 v228, v221 offset:352
  v_mfma_f32_16x16x32_bf16 v[40:43], a[4:7], a[100:103], v[40:43]
  ds_read_b128 a[232:235], v230
  ds_read_b128 a[236:239], v230 offset:64
  v_mfma_f32_16x16x32_bf16 v[88:91], a[24:27], a[96:99], 0
  ds_read_b128 a[240:243], v230 offset:128
  ds_read_b128 a[244:247], v231
  v_mfma_f32_16x16x32_bf16 v[156:159], a[68:71], a[92:95], v[156:159]
  ds_read_b128 a[248:251], v231 offset:64
  ds_read_b128 a[252:255], v231 offset:128
  v_mfma_f32_16x16x32_bf16 v[64:67], a[16:19], a[100:103], v[64:67]
  v_mfma_f32_16x16x32_bf16 v[112:115], a[36:39], a[96:99], 0
  v_mfma_f32_16x16x32_bf16 v[40:43], a[8:11], a[104:107], v[40:43]
  v_mfma_f32_16x16x32_bf16 v[88:91], a[28:31], a[100:103], v[88:91]
  v_mfma_f32_16x16x32_bf16 v[136:139], a[48:51], a[96:99], 0
  v_mfma_f32_16x16x32_bf16 v[64:67], a[20:23], a[104:107], v[64:67]
  s_waitcnt lgkmcnt(5)
  v_mfma_f32_16x16x32_bf16 v[248:251], a[232:235], a[72:75], 0
  v_mfma_f32_16x16x32_bf16 v[252:255], a[232:235], a[84:87], 0
  s_waitcnt lgkmcnt(4)
  v_mfma_f32_16x16x32_bf16 v[248:251], a[236:239], a[76:79], v[248:251]
  v_mfma_f32_16x16x32_bf16 v[252:255], a[236:239], a[88:91], v[252:255]
  s_waitcnt lgkmcnt(2)
  v_mfma_f32_16x16x32_bf16 v[248:251], a[240:243], a[80:83], v[248:251]
  v_mfma_f32_16x16x32_bf16 v[252:255], a[240:243], a[92:95], v[252:255]
  v_mfma_f32_16x16x32_bf16 v[232:235], a[232:235], a[244:247], 0
  s_waitcnt lgkmcnt(0)
  v_mfma_f32_16x16x32_bf16 v[232:235], a[236:239], a[248:251], v[232:235]
  v_mfma_f32_16x16x32_bf16 v[232:235], a[240:243], a[252:255], v[232:235]
  v_mfma_f32_16x16x32_bf16 v[112:115], a[40:43], a[100:103], v[112:115]
  v_mfma_f32_16x16x32_bf16 v[160:163], a[60:63], a[96:99], 0
  s_nop 0
  v_mov_b32 v240, v248
  v_mfma_f32_16x16x32_bf16 v[248:251], a[232:235], a[96:99], 0
  v_mov_b32 v241, v252
  v_mfma_f32_16x16x32_bf16 v[252:255], a[232:235], a[108:111], 0
  s_nop 0
  v_mov_b32 v24, v232
  v_mul_f32 v24, s77, v24
  v_mfma_f32_16x16x32_bf16 v[248:251], a[236:239], a[100:103], v[248:251]
  v_fma_f32 v240, v240, s72, v24
  v_cvt_pk_bf16_f32 v240, v240, 1.0
  v_mfma_f32_16x16x32_bf16 v[252:255], a[236:239], a[112:115], v[252:255]
  v_accvgpr_write_b32 a168, v240
  v_fma_f32 v241, v241, s72, v24
  v_mfma_f32_16x16x32_bf16 v[248:251], a[240:243], a[104:107], v[248:251]
  v_cvt_pk_bf16_f32 v241, v241, 1.0
  v_accvgpr_write_b32 a172, v241
  v_mfma_f32_16x16x32_bf16 v[252:255], a[240:243], a[116:119], v[252:255]
  v_mfma_f32_16x16x32_bf16 v[88:91], a[32:35], a[104:107], v[88:91]
  v_mfma_f32_16x16x32_bf16 v[136:139], a[52:55], a[100:103], v[136:139]
  v_mfma_f32_16x16x32_bf16 v[44:47], a[0:3], a[108:111], 0
  s_nop 1
  v_mov_b32 v242, v248
  v_mfma_f32_16x16x32_bf16 v[248:251], a[232:235], a[120:123], 0
  v_fma_f32 v242, v242, s72, v24
  v_mov_b32 v243, v252
  v_mfma_f32_16x16x32_bf16 v[252:255], a[232:235], a[132:135], 0
  v_cvt_pk_bf16_f32 v242, v242, 1.0
  v_accvgpr_write_b32 a176, v242
  v_mfma_f32_16x16x32_bf16 v[248:251], a[236:239], a[124:127], v[248:251]
  v_fma_f32 v243, v243, s72, v24
  v_cvt_pk_bf16_f32 v243, v243, 1.0
  v_mfma_f32_16x16x32_bf16 v[252:255], a[236:239], a[136:139], v[252:255]
  v_accvgpr_write_b32 a180, v243
  v_mfma_f32_16x16x32_bf16 v[248:251], a[240:243], a[128:131], v[248:251]
  v_mfma_f32_16x16x32_bf16 v[252:255], a[240:243], a[140:143], v[252:255]
  v_mfma_f32_16x16x32_bf16 v[112:115], a[44:47], a[104:107], v[112:115]
  v_mfma_f32_16x16x32_bf16 v[160:163], a[64:67], a[100:103], v[160:163]
  v_mfma_f32_16x16x32_bf16 v[68:71], a[12:15], a[108:111], 0
  v_mfma_f32_16x16x32_bf16 v[136:139], a[56:59], a[104:107], v[136:139]
  v_mfma_f32_16x16x32_bf16 v[44:47], a[4:7], a[112:115], v[44:47]
  s_nop 1
  v_mov_b32 v244, v248
  v_mfma_f32_16x16x32_bf16 v[248:251], a[244:247], a[0:3], 0
  v_mov_b32 v245, v252
  v_fma_f32 v244, v244, s72, v24
  v_mfma_f32_16x16x32_bf16 v[252:255], a[244:247], a[12:15], 0
  v_cvt_pk_bf16_f32 v244, v244, 1.0
  v_accvgpr_write_b32 a184, v244
  v_mfma_f32_16x16x32_bf16 v[248:251], a[248:251], a[4:7], v[248:251]
  v_fma_f32 v245, v245, s72, v24
  v_cvt_pk_bf16_f32 v245, v245, 1.0
  v_mfma_f32_16x16x32_bf16 v[252:255], a[248:251], a[16:19], v[252:255]
  v_accvgpr_write_b32 a188, v245
  v_mfma_f32_16x16x32_bf16 v[248:251], a[252:255], a[8:11], v[248:251]
  v_mfma_f32_16x16x32_bf16 v[252:255], a[252:255], a[20:23], v[252:255]
  v_mfma_f32_16x16x32_bf16 v[92:95], a[24:27], a[108:111], 0
  v_mfma_f32_16x16x32_bf16 v[160:163], a[68:71], a[104:107], v[160:163]
  v_mfma_f32_16x16x32_bf16 v[68:71], a[16:19], a[112:115], v[68:71]
  v_mfma_f32_16x16x32_bf16 v[116:119], a[36:39], a[108:111], 0
  v_mfma_f32_16x16x32_bf16 v[44:47], a[8:11], a[116:119], v[44:47]
  s_add_u32 s73, s21, 0x3f480
  v_mfma_f32_16x16x32_bf16 v[92:95], a[28:31], a[112:115], v[92:95]
  s_add_u32 m0, s22, 0x0
  v_mul_f32 v27, s72, v248
  v_mfma_f32_16x16x32_bf16 v[248:251], a[244:247], a[24:27], 0
  buffer_load_dwordx4 v7, s[4:7], s73 offen nt lds
  v_mfma_f32_16x16x32_bf16 v[248:251], a[248:251], a[28:31], v[248:251]
  v_mul_f32 v25, s72, v252
  v_cvt_pk_bf16_f32 v27, 1.0, v27
  v_mfma_f32_16x16x32_bf16 v[252:255], a[244:247], a[36:39], 0
  v_cndmask_b32_e64 v27, 0, v27, s[38:39]
  v_cvt_pk_bf16_f32 v25, 1.0, v25
  v_mfma_f32_16x16x32_bf16 v[252:255], a[248:251], a[40:43], v[252:255]
  v_accvgpr_write_b32 a144, v27
  v_cndmask_b32_e64 v25, 0, v25, s[38:39]
  v_mfma_f32_16x16x32_bf16 v[248:251], a[252:255], a[32:35], v[248:251]
  v_accvgpr_write_b32 a148, v25
  v_mfma_f32_16x16x32_bf16 v[252:255], a[252:255], a[44:47], v[252:255]
  v_mfma_f32_16x16x32_bf16 v[32:35], a[144:147], a[168:171], v[32:35]
  v_mfma_f32_16x16x32_bf16 v[56:59], a[148:151], a[168:171], v[56:59]
  v_mfma_f32_16x16x32_bf16 v[36:39], a[144:147], a[172:175], v[36:39]
  buffer_load_dwordx4 v8, s[4:7], s73 offen offset:1024 nt lds
  v_mfma_f32_16x16x32_bf16 v[60:63], a[148:151], a[172:175], v[60:63]
  s_nop 0
  v_mul_f32 v27, s72, v248
  v_mfma_f32_16x16x32_bf16 v[248:251], a[244:247], a[48:51], 0
  v_mul_f32 v25, s72, v252
  v_cvt_pk_bf16_f32 v27, 1.0, v27
  v_mfma_f32_16x16x32_bf16 v[252:255], a[244:247], a[60:63], 0
  v_cndmask_b32_e64 v27, 0, v27, s[38:39]
  v_cvt_pk_bf16_f32 v25, 1.0, v25
  v_mfma_f32_16x16x32_bf16 v[248:251], a[248:251], a[52:55], v[248:251]
  v_accvgpr_write_b32 a152, v27
  v_cndmask_b32_e64 v25, 0, v25, s[38:39]
  v_mfma_f32_16x16x32_bf16 v[252:255], a[248:251], a[64:67], v[252:255]
  v_accvgpr_write_b32 a156, v25
  v_cvt_pk_bf16_f32 v176, v32, v33
  v_mfma_f32_16x16x32_bf16 v[248:251], a[252:255], a[56:59], v[248:251]
  v_cvt_pk_bf16_f32 v177, v34, v35
  ds_write_b64 v22, v[176:177]
  v_mfma_f32_16x16x32_bf16 v[252:255], a[252:255], a[68:71], v[252:255]
  v_cvt_pk_bf16_f32 v178, v56, v57
  v_cvt_pk_bf16_f32 v179, v58, v59
  v_mfma_f32_16x16x32_bf16 v[80:83], a[152:155], a[168:171], v[80:83]
  ds_write_b64 v22, v[178:179] offset:512
  v_cvt_pk_bf16_f32 v188, v36, v37
  v_mfma_f32_16x16x32_bf16 v[104:107], a[156:159], a[168:171], v[104:107]
  v_mul_f32 v27, s72, v248
  v_cvt_pk_bf16_f32 v27, 1.0, v27
  v_mfma_f32_16x16x32_bf16 v[84:87], a[152:155], a[172:175], v[84:87]
  buffer_load_dwordx4 v9, s[4:7], s73 offen offset:2048 nt lds
  v_mfma_f32_16x16x32_bf16 v[108:111], a[156:159], a[172:175], v[108:111]
  v_mul_f32 v25, s72, v252
  v_cndmask_b32_e64 v27, 0, v27, s[38:39]
  v_mfma_f32_16x16x32_bf16 v[40:43], a[144:147], a[176:179], v[40:43]
  v_cvt_pk_bf16_f32 v25, 1.0, v25
  v_accvgpr_write_b32 a160, v27
  v_mfma_f32_16x16x32_bf16 v[64:67], a[148:151], a[176:179], v[64:67]
  v_cndmask_b32_e64 v25, 0, v25, s[38:39]
  v_accvgpr_write_b32 a164, v25
  v_mfma_f32_16x16x32_bf16 v[128:131], a[160:163], a[168:171], v[128:131]
  v_cvt_pk_bf16_f32 v180, v80, v81
  v_cvt_pk_bf16_f32 v181, v82, v83
  v_mfma_f32_16x16x32_bf16 v[152:155], a[164:167], a[168:171], v[152:155]
  ds_write_b64 v22, v[180:181] offset:1024
  v_cvt_pk_bf16_f32 v182, v104, v105
  v_mfma_f32_16x16x32_bf16 v[132:135], a[160:163], a[172:175], v[132:135]
  v_cvt_pk_bf16_f32 v183, v106, v107
  ds_write_b64 v22, v[182:183] offset:1536
  v_mfma_f32_16x16x32_bf16 v[156:159], a[164:167], a[172:175], v[156:159]
  v_cvt_pk_bf16_f32 v184, v128, v129
  v_cvt_pk_bf16_f32 v185, v130, v131
  v_mfma_f32_16x16x32_bf16 v[88:91], a[152:155], a[176:179], v[88:91]
  ds_write_b64 v22, v[184:185] offset:2048
  v_cvt_pk_bf16_f32 v186, v152, v153
  v_mfma_f32_16x16x32_bf16 v[112:115], a[156:159], a[176:179], v[112:115]
  v_cvt_pk_bf16_f32 v187, v154, v155
  ds_write_b64 v22, v[186:187] offset:2560
  v_mfma_f32_16x16x32_bf16 v[140:143], a[48:51], a[108:111], 0
  s_add_u32 s74, s21, 0x0
  s_add_u32 m0, s22, 0xc00
  v_mfma_f32_16x16x32_bf16 v[136:139], a[160:163], a[176:179], v[136:139]
  buffer_load_dwordx4 v7, s[4:7], s74 offen nt lds
  v_mfma_f32_16x16x32_bf16 v[68:71], a[20:23], a[116:119], v[68:71]
  v_cvt_pk_bf16_f32 v189, v38, v39
  ds_write_b64 v22, v[188:189] offset:128
  v_mfma_f32_16x16x32_bf16 v[116:119], a[40:43], a[112:115], v[116:119]
  v_cvt_pk_bf16_f32 v190, v60, v61
  v_cvt_pk_bf16_f32 v191, v62, v63
  v_mfma_f32_16x16x32_bf16 v[164:167], a[60:63], a[108:111], 0
  ds_write_b64 v22, v[190:191] offset:640
  v_cvt_pk_bf16_f32 v192, v84, v85
  v_mfma_f32_16x16x32_bf16 v[160:163], a[164:167], a[176:179], v[160:163]
  v_cvt_pk_bf16_f32 v193, v86, v87
  ds_write_b64 v22, v[192:193] offset:1152
  v_mfma_f32_16x16x32_bf16 v[92:95], a[32:35], a[116:119], v[92:95]
  v_cvt_pk_bf16_f32 v194, v108, v109
  v_cvt_pk_bf16_f32 v195, v110, v111
  v_mfma_f32_16x16x32_bf16 v[140:143], a[52:55], a[112:115], v[140:143]
  ds_write_b64 v22, v[194:195] offset:1664
  v_cvt_pk_bf16_f32 v196, v132, v133
  v_mfma_f32_16x16x32_bf16 v[48:51], a[0:3], a[120:123], 0
  v_cvt_pk_bf16_f32 v197, v134, v135
  ds_write_b64 v22, v[196:197] offset:2176
  v_mfma_f32_16x16x32_bf16 v[44:47], a[144:147], a[180:183], v[44:47]
  v_cvt_pk_bf16_f32 v198, v156, v157
  v_cvt_pk_bf16_f32 v199, v158, v159
  v_mfma_f32_16x16x32_bf16 v[116:119], a[44:47], a[116:119], v[116:119]
  buffer_load_dwordx4 v8, s[4:7], s74 offen offset:1024 nt lds
  v_mfma_f32_16x16x32_bf16 v[164:167], a[64:67], a[112:115], v[164:167]
  ds_write_b64 v22, v[198:199] offset:2688
  v_cvt_pk_bf16_f32 v200, v40, v41
  v_mfma_f32_16x16x32_bf16 v[72:75], a[12:15], a[120:123], 0
  v_cvt_pk_bf16_f32 v201, v42, v43
  ds_write_b64 v22, v[200:201] offset:6144
  v_mfma_f32_16x16x32_bf16 v[68:71], a[148:151], a[180:183], v[68:71]
  v_cvt_pk_bf16_f32 v202, v64, v65
  v_cvt_pk_bf16_f32 v203, v66, v67
  v_mfma_f32_16x16x32_bf16 v[140:143], a[56:59], a[116:119], v[140:143]
  ds_write_b64 v22, v[202:203] offset:6656
  v_cvt_pk_bf16_f32 v204, v88, v89
  v_mfma_f32_16x16x32_bf16 v[48:51], a[4:7], a[124:127], v[48:51]
  v_cvt_pk_bf16_f32 v205, v90, v91
  ds_write_b64 v22, v[204:205] offset:7168
  v_mfma_f32_16x16x32_bf16 v[96:99], a[24:27], a[120:123], 0
  v_cvt_pk_bf16_f32 v206, v112, v113
  v_cvt_pk_bf16_f32 v207, v114, v115
  v_mfma_f32_16x16x32_bf16 v[92:95], a[152:155], a[180:183], v[92:95]
  ds_write_b64 v22, v[206:207] offset:7680
  v_cvt_pk_bf16_f32 v208, v136, v137
  v_mfma_f32_16x16x32_bf16 v[164:167], a[68:71], a[116:119], v[164:167]
  v_cvt_pk_bf16_f32 v209, v138, v139
  ds_write_b64 v22, v[208:209] offset:8192
  v_mfma_f32_16x16x32_bf16 v[72:75], a[16:19], a[124:127], v[72:75]
  v_cvt_pk_bf16_f32 v210, v160, v161
  v_cvt_pk_bf16_f32 v211, v162, v163
  v_mfma_f32_16x16x32_bf16 v[120:123], a[36:39], a[120:123], 0
  buffer_load_dwordx4 v9, s[4:7], s74 offen offset:2048 nt lds
  v_mfma_f32_16x16x32_bf16 v[116:119], a[156:159], a[180:183], v[116:119]
  ds_write_b64 v22, v[210:211] offset:8704
  v_cvt_pk_bf16_f32 v212, v44, v45
  v_mfma_f32_16x16x32_bf16 v[48:51], a[8:11], a[128:131], v[48:51]
  v_cvt_pk_bf16_f32 v213, v46, v47
  ds_write_b64 v22, v[212:213] offset:6272
  v_mfma_f32_16x16x32_bf16 v[96:99], a[28:31], a[124:127], v[96:99]
  v_cvt_pk_bf16_f32 v214, v68, v69
  v_cvt_pk_bf16_f32 v215, v70, v71
  v_mfma_f32_16x16x32_bf16 v[144:147], a[48:51], a[120:123], 0
  ds_write_b64 v22, v[214:215] offset:6784
  v_cvt_pk_bf16_f32 v216, v92, v93
  v_mfma_f32_16x16x32_bf16 v[140:143], a[160:163], a[180:183], v[140:143]
  v_cvt_pk_bf16_f32 v217, v94, v95
  ds_write_b64 v22, v[216:217] offset:7296
  v_mfma_f32_16x16x32_bf16 v[72:75], a[20:23], a[128:131], v[72:75]
  v_cvt_pk_bf16_f32 v218, v116, v117
  v_cvt_pk_bf16_f32 v219, v118, v119
  v_mfma_f32_16x16x32_bf16 v[120:123], a[40:43], a[124:127], v[120:123]
  ds_write_b64 v22, v[218:219] offset:7808
  v_mfma_f32_16x16x32_bf16 v[168:171], a[60:63], a[120:123], 0
  v_cvt_pk_bf16_f32 v220, v140, v141
  v_cvt_pk_bf16_f32 v221, v142, v143
  v_mfma_f32_16x16x32_bf16 v[164:167], a[164:167], a[180:183], v[164:167]
  ds_write_b64 v22, v[220:221] offset:8320
  v_mfma_f32_16x16x32_bf16 v[96:99], a[32:35], a[128:131], v[96:99]
  s_add_u32 s75, s21, 0x300
  s_add_u32 m0, s22, 0x1800
  v_mfma_f32_16x16x32_bf16 v[144:147], a[52:55], a[124:127], v[144:147]
  v_cndmask_b32_e64 v29, v7, v10, s[44:45]
  buffer_load_dwordx4 v29, s[4:7], s75 offen nt lds
  v_mfma_f32_16x16x32_bf16 v[52:55], a[0:3], a[132:135], 0
  v_cvt_pk_bf16_f32 v222, v164, v165
  v_cvt_pk_bf16_f32 v223, v166, v167
  v_mfma_f32_16x16x32_bf16 v[48:51], a[144:147], a[184:187], v[48:51]
  ds_write_b64 v22, v[222:223] offset:8832
  v_mfma_f32_16x16x32_bf16 v[120:123], a[44:47], a[128:131], v[120:123]
  v_mfma_f32_16x16x32_bf16 v[168:171], a[64:67], a[124:127], v[168:171]
  v_mfma_f32_16x16x32_bf16 v[76:79], a[12:15], a[132:135], 0
  v_mfma_f32_16x16x32_bf16 v[72:75], a[148:151], a[184:187], v[72:75]
  v_mfma_f32_16x16x32_bf16 v[144:147], a[56:59], a[128:131], v[144:147]
  v_mfma_f32_16x16x32_bf16 v[52:55], a[4:7], a[136:139], v[52:55]
  s_nop 0
  v_cvt_pk_bf16_f32 v224, v48, v49
  v_mfma_f32_16x16x32_bf16 v[100:103], a[24:27], a[132:135], 0
  v_cndmask_b32_e64 v30, v8, v11, s[50:51]
  buffer_load_dwordx4 v30, s[4:7], s75 offen offset:1024 nt lds
  v_mfma_f32_16x16x32_bf16 v[96:99], a[152:155], a[184:187], v[96:99]
  v_cvt_pk_bf16_f32 v225, v50, v51
  ds_write_b64 v22, v[224:225] offset:12288
  v_mfma_f32_16x16x32_bf16 v[168:171], a[68:71], a[128:131], v[168:171]
  v_cvt_pk_bf16_f32 v226, v72, v73
  v_cvt_pk_bf16_f32 v227, v74, v75
  v_mfma_f32_16x16x32_bf16 v[76:79], a[16:19], a[136:139], v[76:79]
  ds_write_b64 v22, v[226:227] offset:12800
  v_mfma_f32_16x16x32_bf16 v[124:127], a[36:39], a[132:135], 0
  v_cvt_pk_bf16_f32 v228, v96, v97
  v_cvt_pk_bf16_f32 v229, v98, v99
  v_mfma_f32_16x16x32_bf16 v[120:123], a[156:159], a[184:187], v[120:123]
  ds_write_b64 v22, v[228:229] offset:13312
  v_mfma_f32_16x16x32_bf16 v[52:55], a[8:11], a[140:143], v[52:55]
  v_mfma_f32_16x16x32_bf16 v[100:103], a[28:31], a[136:139], v[100:103]
  v_mfma_f32_16x16x32_bf16 v[148:151], a[48:51], a[132:135], 0
  v_mfma_f32_16x16x32_bf16 v[144:147], a[160:163], a[184:187], v[144:147]
  v_cndmask_b32_e64 v31, v9, v12, s[56:57]
  v_mfma_f32_16x16x32_bf16 v[76:79], a[20:23], a[140:143], v[76:79]
  buffer_load_dwordx4 v31, s[4:7], s75 offen offset:2048 nt lds
  v_mfma_f32_16x16x32_bf16 v[124:127], a[40:43], a[136:139], v[124:127]
  v_cvt_pk_bf16_f32 v230, v120, v121
  v_cvt_pk_bf16_f32 v231, v122, v123
  v_mfma_f32_16x16x32_bf16 v[172:175], a[60:63], a[132:135], 0
  ds_write_b64 v22, v[230:231] offset:13824
  v_cvt_pk_bf16_f32 v232, v144, v145
  v_mfma_f32_16x16x32_bf16 v[168:171], a[164:167], a[184:187], v[168:171]
  v_cvt_pk_bf16_f32 v233, v146, v147
  ds_write_b64 v22, v[232:233] offset:14336
  v_mfma_f32_16x16x32_bf16 v[100:103], a[32:35], a[140:143], v[100:103]
  v_mfma_f32_16x16x32_bf16 v[148:151], a[52:55], a[136:139], v[148:151]
  v_mfma_f32_16x16x32_bf16 v[52:55], a[144:147], a[188:191], v[52:55]
  v_mfma_f32_16x16x32_bf16 v[124:127], a[44:47], a[140:143], v[124:127]
  v_mfma_f32_16x16x32_bf16 v[172:175], a[64:67], a[136:139], v[172:175]
  s_nop 0
  v_cvt_pk_bf16_f32 v234, v168, v169
  v_mfma_f32_16x16x32_bf16 v[76:79], a[148:151], a[188:191], v[76:79]
  v_cvt_pk_bf16_f32 v235, v170, v171
  ds_write_b64 v22, v[234:235] offset:14848
  v_mfma_f32_16x16x32_bf16 v[148:151], a[56:59], a[140:143], v[148:151]
  v_cvt_pk_bf16_f32 v236, v52, v53
  v_cvt_pk_bf16_f32 v237, v54, v55
  v_mfma_f32_16x16x32_bf16 v[100:103], a[152:155], a[188:191], v[100:103]
  ds_write_b64 v22, v[236:237] offset:12416
  v_mfma_f32_16x16x32_bf16 v[172:175], a[68:71], a[140:143], v[172:175]
  v_cvt_pk_bf16_f32 v238, v76, v77
  v_cvt_pk_bf16_f32 v239, v78, v79
  v_mfma_f32_16x16x32_bf16 v[124:127], a[156:159], a[188:191], v[124:127]
  ds_write_b64 v22, v[238:239] offset:12928
  v_mfma_f32_16x16x32_bf16 v[148:151], a[160:163], a[188:191], v[148:151]
  s_nop 0
  v_cvt_pk_bf16_f32 v240, v100, v101
  v_mfma_f32_16x16x32_bf16 v[172:175], a[164:167], a[188:191], v[172:175]
  v_cvt_pk_bf16_f32 v241, v102, v103
  ds_write_b64 v22, v[240:241] offset:13440
  s_nop 0
  v_cvt_pk_bf16_f32 v242, v124, v125
  v_cvt_pk_bf16_f32 v243, v126, v127
  ds_write_b64 v22, v[242:243] offset:13952
  v_cvt_pk_bf16_f32 v244, v148, v149
  v_cvt_pk_bf16_f32 v245, v150, v151
  ds_write_b64 v22, v[244:245] offset:14464
  v_cvt_pk_bf16_f32 v246, v172, v173
  v_cvt_pk_bf16_f32 v247, v174, v175
  ds_write_b64 v22, v[246:247] offset:14976
  s_waitcnt lgkmcnt(0)
  s_branch L_JOIN
L_FOLDW:
  s_mov_b32 s71, 384
  v_add_u32 v20, 0, v1
  v_mul_u32_u24 v24, 0x1556, v20
  v_lshrrev_b32 v24, 16, v24
  v_mul_u32_u24 v25, 12, v24
  v_sub_u32 v25, v20, v25
  v_lshrrev_b32 v26, 2, v24
  v_sub_u32 v26, 0, v26
  v_and_b32 v26, 3, v26
  v_xor_b32 v25, v25, v26
  v_lshlrev_b32 v25, 4, v25
  v_mul_u32_u24 v24, 0x240, v24
  v_add3_u32 v232, v24, v25, s71
  s_sub_u32 s71, s71, 1024
  v_add_u32 v20, 64, v1
  v_mul_u32_u24 v24, 0x1556, v20
  v_lshrrev_b32 v24, 16, v24
  v_mul_u32_u24 v25, 12, v24
  v_sub_u32 v25, v20, v25
  v_lshrrev_b32 v26, 2, v24
  v_sub_u32 v26, 0, v26
  v_and_b32 v26, 3, v26
  v_xor_b32 v25, v25, v26
  v_lshlrev_b32 v25, 4, v25
  v_mul_u32_u24 v24, 0x240, v24
  v_add3_u32 v233, v24, v25, s71
  s_sub_u32 s71, s71, 1024
  v_add_u32 v20, 0x80, v1
  v_mul_u32_u24 v24, 0x1556, v20
  v_lshrrev_b32 v24, 16, v24
  v_mul_u32_u24 v25, 12, v24
  v_sub_u32 v25, v20, v25
  v_lshrrev_b32 v26, 2, v24
  v_sub_u32 v26, 0, v26
  v_and_b32 v26, 3, v26
  v_xor_b32 v25, v25, v26
  v_lshlrev_b32 v25, 4, v25
  v_mul_u32_u24 v24, 0x240, v24
  v_add3_u32 v234, v24, v25, s71
  s_lshr_b32 s69, s2, 3
  s_and_b32 s69, s69, 15
  s_lshl_b32 s69, s69, 12
  v_lshlrev_b32 v20, 6, v1
  v_lshlrev_b32 v22, 4, v1
  s_cmp_lt_u32 s20, 2
  s_waitcnt lgkmcnt(0)
  s_cselect_b32 s12, s86, s90
  s_cselect_b32 s13, s87, s91
  s_mov_b32 s14, 55296
  s_mov_b32 s15, 0x20000
  s_cselect_b32 s16, s88, s92
  s_cselect_b32 s17, s89, s93
  s_mov_b32 s18, 18432
  s_mov_b32 s19, 0x20000
  buffer_load_dword v254, v20, s[16:19], s69 offen
  s_mov_b32 s4, s84
  s_mov_b32 s5, s85
  s_mov_b32 s6, 38535168
  s_mov_b32 s7, 0x20000
  s_mov_b32 s8, s94
  s_mov_b32 s9, s95
  s_mov_b32 s10, 38535168
  s_mov_b32 s11, 0x20000
  s_lshl_b32 s23, s2, 2
  s_add_u32 s23, s23, s20
  s_lshr_b32 s65, s23, 5
  s_and_b32 s66, s23, 31
  s_mul_i32 s65, s65, 301056
  s_mul_i32 s66, s66, 1344
  s_add_u32 s21, s65, s66
  s_mov_b32 s70, 0x0
  s_add_u32 m0, s22, 0x5400
  s_mov_b32 s71, 0x1000
  buffer_load_dwordx4 v22, s[16:19], s70 offen lds
  v_lshrrev_b32 v240, 2, v2
  v_and_b32 v242, 1, v3
  buffer_load_dwordx4 v22, s[16:19], s70 offen offset:1024 lds
  v_lshl_add_u32 v243, v242, 3, v240
  v_mul_u32_u24 v224, 0xc0, v243
  v_lshrrev_b32 v243, 1, v3
  v_mul_u32_u24 v243, 0xc00, v243
  v_and_b32 v241, 3, v2
  v_add3_u32 v224, v224, v243, s22
  v_lshlrev_b32 v244, 1, v242
  v_lshrrev_b32 v243, 1, v241
  v_xor_b32 v244, v244, v243
  v_lshl_add_u32 v224, v244, 4, v224
  v_and_b32 v243, 1, v241
  buffer_load_dwordx4 v22, s[16:19], s70 offen offset:2048 lds
  v_lshl_add_u32 v224, v243, 3, v224
  v_xor_b32 v227, 48, v224
  v_xor_b32 v225, 16, v224
  v_xor_b32 v226, 32, v224
  v_lshrrev_b32 v248, 2, v2
  v_sub_u32 v248, 0, v248
  v_and_b32 v248, 3, v248
  v_xor_b32 v248, v248, v3
  v_mul_u32_u24 v246, 0xc0, v2
  v_lshl_add_u32 v246, v248, 4, v246
  v_add_u32 v246, s22, v246
  v_mov_b32 v16, 0x3f803f80
  buffer_load_dwordx4 v22, s[16:19], s70 offen offset:3072 lds
  s_add_u32 m0, s22, 0x6400
  s_mov_b32 s70, 0x2000
  v_mov_b32 v17, 0x3f803f80
  v_mov_b32 v18, 0x3f803f80
  v_mov_b32 v19, 0x3f803f80
  s_mov_b32 s67, 43691
  v_add_u32 v200, 0, v1
  v_mul_u32_u24 v201, s67, v200
  v_lshrrev_b32 v201, 19, v201
  v_mul_u32_u24 v202, 12, v201
  v_sub_u32 v202, v200, v202
  buffer_load_dwordx4 v22, s[16:19], s71 offen lds
  v_lshrrev_b32 v203, 2, v201
  s_mov_b32 s68, 9633792
  v_xor_b32 v205, v202, v203
  v_lshlrev_b32 v205, 4, v205
  v_mul_lo_u32 v206, v203, s68
  s_mul_i32 s73, s20, 768
  v_and_b32 v204, 3, v201
  v_add_u32 v205, v205, v206
  v_lshlrev_b32 v228, 1, v2
  v_mul_u32_u24 v206, 0xc0, v204
  v_add_u32 v205, v205, v206
  v_mov_b32 v7, v205
  buffer_load_dwordx4 v22, s[16:19], s71 offen offset:1024 lds
  v_add_u32 v200, 64, v1
  v_mul_u32_u24 v201, s67, v200
  v_lshrrev_b32 v201, 19, v201
  v_mul_u32_u24 v202, 12, v201
  v_sub_u32 v202, v200, v202
  v_lshrrev_b32 v203, 2, v201
  v_xor_b32 v205, v202, v203
  v_cmp_le_u32_e64 s[40:41], 1, v204
  v_cmp_le_u32_e64 s[42:43], 2, v204
  v_cmp_le_u32_e64 s[44:45], 3, v204
  v_lshlrev_b32 v205, 4, v205
  buffer_load_dwordx4 v22, s[16:19], s71 offen offset:2048 lds
  v_mul_lo_u32 v206, v203, s68
  v_and_b32 v204, 3, v201
  v_add_u32 v205, v205, v206
  v_mul_u32_u24 v206, 0xc0, v204
  v_add_u32 v205, v205, v206
  v_subrev_u32 v8, 0x400, v205
  v_add_u32 v200, 0x80, v1
  v_mul_u32_u24 v201, s67, v200
  v_lshrrev_b32 v201, 19, v201
  v_mul_u32_u24 v202, 12, v201
  v_sub_u32 v202, v200, v202
  v_lshrrev_b32 v203, 2, v201
  buffer_load_dwordx4 v22, s[16:19], s71 offen offset:3072 lds
  s_add_u32 m0, s22, 0x7400
  s_mov_b32 s71, 0x3000
  v_xor_b32 v205, v202, v203
  v_cmp_le_u32_e64 s[46:47], 1, v204
  v_cmp_le_u32_e64 s[48:49], 2, v204
  v_cmp_le_u32_e64 s[50:51], 3, v204
  v_lshlrev_b32 v205, 4, v205
  v_mul_lo_u32 v206, v203, s68
  v_and_b32 v204, 3, v201
  v_add_u32 v205, v205, v206
  v_mul_u32_u24 v206, 0xc0, v204
  buffer_load_dwordx4 v22, s[16:19], s70 offen lds
  v_add_u32 v205, v205, v206
  v_subrev_u32 v9, 0x800, v205
  v_add_u32 v10, 0xa2c0, v7
  v_add_u32 v11, 0xa2c0, v8
  v_add_u32 v12, 0xa2c0, v9
  v_cmp_le_u32_e64 s[56:57], 3, v204
  v_bfe_u32 v24, v2, 2, 1
  v_lshrrev_b32 v27, 2, v2
  v_and_b32 v28, 3, v2
  s_mov_b32 s72, 0xbc2aaaab
  v_mov_b32 v15, 0
  v_cmp_eq_u32_e64 s[38:39], 0, v3
  buffer_load_dwordx4 v22, s[16:19], s70 offen offset:1024 lds
  v_mov_b32 v25, 0x3f80
  v_cndmask_b32_e64 v25, 0, v25, s[38:39]
  v_accvgpr_write_b32 a145, 0
  v_accvgpr_write_b32 a146, 0
  v_accvgpr_write_b32 a147, 0
  v_accvgpr_write_b32 a169, 0
  v_accvgpr_write_b32 a170, 0
  v_accvgpr_write_b32 a171, 0
  v_accvgpr_write_b32 a144, v25
  v_accvgpr_write_b32 a173, 0
  v_accvgpr_write_b32 a174, 0
  buffer_load_dwordx4 v22, s[16:19], s70 offen offset:2048 lds
  v_accvgpr_write_b32 a175, 0
  v_and_b32 v208, 3, v2
  v_lshrrev_b32 v209, 2, v2
  v_lshl_add_u32 v212, v208, 2, v209
  v_mul_u32_u24 v212, 0xc0, v212
  v_xor_b32 v213, v3, v208
  v_accvgpr_write_b32 a177, 0
  v_accvgpr_write_b32 a178, 0
  v_accvgpr_write_b32 a179, 0
  v_lshl_add_u32 v212, v213, 4, v212
  v_add_u32 v4, s22, v212
  v_lshrrev_b32 v210, 2, v2
  buffer_load_dwordx4 v22, s[16:19], s70 offen offset:3072 lds
  s_add_u32 m0, s22, 0x8400
  s_mov_b32 s70, 0x4000
  v_and_b32 v211, 3, v2
  v_lshl_add_u32 v212, v210, 2, v3
  v_mul_u32_u24 v212, 0xc0, v212
  v_xor_b32 v213, v211, v210
  v_lshl_add_u32 v212, v213, 4, v212
  v_add_u32 v5, s22, v212
  v_accvgpr_write_b32 a181, 0
  v_accvgpr_write_b32 a182, 0
  v_accvgpr_write_b32 a183, 0
  buffer_load_dwordx4 v22, s[16:19], s71 offen lds
  v_cmp_le_u32_e64 s[52:53], 1, v204
  v_cmp_le_u32_e64 s[54:55], 2, v204
  v_mul_u32_u24 v212, 0x300, v208
  v_lshl_add_u32 v212, v209, 2, v212
  v_cmp_eq_u32_e64 s[30:31], 1, v208
  v_cmp_eq_u32_e64 s[32:33], 2, v208
  v_cmp_eq_u32_e64 s[34:35], 3, v208
  v_cmp_eq_u32_e64 s[36:37], v3, v209
  v_add_u32 v212, s22, v212
  v_lshlrev_b32 v213, 2, v1
  v_add_u32 v212, 0x180, v212
  v_add_u32 v213, 0x27000, v213
  buffer_load_dwordx4 v22, s[16:19], s71 offen offset:1024 lds
  v_cndmask_b32_e64 v6, v213, v212, s[36:37]
  v_accvgpr_write_b32 a185, 0
  v_accvgpr_write_b32 a186, 0
  v_accvgpr_write_b32 a187, 0
  v_accvgpr_write_b32 a189, 0
  v_accvgpr_write_b32 a190, 0
  v_accvgpr_write_b32 a191, 0
  s_mov_b32 s58, 0x3c2aaaab
  s_mov_b32 s59, 0x3e16c740
  s_mov_b32 s60, 41664
  v_mov_b32 v13, 0x3727c5ac
  buffer_load_dwordx4 v22, s[16:19], s71 offen offset:2048 lds
  v_accvgpr_write_b32 a149, 0
  v_accvgpr_write_b32 a150, 0
  v_accvgpr_write_b32 a151, 0
  v_accvgpr_write_b32 a153, 0
  v_accvgpr_write_b32 a154, 0
  v_accvgpr_write_b32 a155, 0
  v_accvgpr_write_b32 a157, 0
  v_accvgpr_write_b32 a158, 0
  v_accvgpr_write_b32 a159, 0
  v_accvgpr_write_b32 a161, 0
  v_accvgpr_write_b32 a162, 0
  v_accvgpr_write_b32 a163, 0
  buffer_load_dwordx4 v22, s[16:19], s71 offen offset:3072 lds
  s_add_u32 m0, s22, 0x9400
  v_accvgpr_write_b32 a165, 0
  v_accvgpr_write_b32 a166, 0
  v_accvgpr_write_b32 a167, 0
  buffer_load_dwordx4 v22, s[16:19], s70 offen lds
  buffer_load_dwordx4 v22, s[16:19], s70 offen offset:1024 lds
  s_add_u32 m0, s22, 0x0
  v_mul_u32_u24 v22, 0xc00, v24
  v_lshrrev_b32 v24, 3, v2
  v_lshlrev_b32 v24, 6, v24
  v_add_u32 v22, v22, v24
  v_and_b32 v24, 3, v2
  v_lshl_add_u32 v22, v24, 4, v22
  v_lshrrev_b32 v24, 1, v3
  v_lshl_add_u32 v22, v24, 8, v22
  v_and_b32 v24, 1, v3
  v_lshl_add_u32 v22, v24, 3, v22
  v_lshl_add_u32 v24, v3, 3, v27
  buffer_load_dwordx4 v232, s[12:15], s24 offen lds
  v_mul_u32_u24 v24, 0xc0, v24
  v_lshl_add_u32 v23, v28, 3, v24
  v_add_u32 v23, s22, v23
  v_add_u32 v23, 0x5400, v23
  s_waitcnt vmcnt(13)
  ds_read_b64_tr_b16 a[72:73], v23
  ds_read_b64_tr_b16 a[74:75], v23 offset:768
  ds_read_b64_tr_b16 a[84:85], v23 offset:32
  ds_read_b64_tr_b16 a[86:87], v23 offset:800
  ds_read_b64_tr_b16 a[96:97], v23 offset:64
  ds_read_b64_tr_b16 a[98:99], v23 offset:832
  ds_read_b64_tr_b16 a[108:109], v23 offset:96
  buffer_load_dwordx4 v233, s[12:15], s24 offen offset:1024 lds
  ds_read_b64_tr_b16 a[110:111], v23 offset:864
  ds_read_b64_tr_b16 a[120:121], v23 offset:128
  ds_read_b64_tr_b16 a[122:123], v23 offset:896
  ds_read_b64_tr_b16 a[132:133], v23 offset:160
  ds_read_b64_tr_b16 a[134:135], v23 offset:928
  v_add_u32 v22, s22, v22
  v_add_u32 v22, 0x5400, v22
  buffer_load_dwordx4 v234, s[12:15], s24 offen offset:2048 lds
  s_add_u32 m0, s22, 0xc00
  s_nop 0
  buffer_load_dwordx4 v232, s[12:15], s25 offen lds
  buffer_load_dwordx4 v233, s[12:15], s25 offen offset:1024 lds
  buffer_load_dwordx4 v234, s[12:15], s25 offen offset:2048 lds
  s_add_u32 m0, s22, 0x1800
  s_waitcnt vmcnt(12)
  ds_read_b64_tr_b16 a[76:77], v23 offset:6144
  ds_read_b64_tr_b16 a[78:79], v23 offset:6912
  buffer_load_dwordx4 v232, s[12:15], s26 offen lds
  ds_read_b64_tr_b16 a[88:89], v23 offset:6176
  ds_read_b64_tr_b16 a[90:91], v23 offset:6944
  ds_read_b64_tr_b16 a[100:101], v23 offset:6208
  ds_read_b64_tr_b16 a[102:103], v23 offset:6976
  ds_read_b64_tr_b16 a[112:113], v23 offset:6240
  ds_read_b64_tr_b16 a[114:115], v23 offset:7008
  ds_read_b64_tr_b16 a[124:125], v23 offset:6272
  ds_read_b64_tr_b16 a[126:127], v23 offset:7040
  ds_read_b64_tr_b16 a[136:137], v23 offset:6304
  ds_read_b64_tr_b16 a[138:139], v23 offset:7072
  buffer_load_dwordx4 v233, s[12:15], s26 offen offset:1024 lds
  buffer_load_dwordx4 v234, s[12:15], s26 offen offset:2048 lds
  s_add_u32 m0, s22, 0x2400
  s_nop 0
  buffer_load_dwordx4 v232, s[12:15], s27 offen lds
  buffer_load_dwordx4 v233, s[12:15], s27 offen offset:1024 lds
  buffer_load_dwordx4 v234, s[12:15], s27 offen offset:2048 lds
  s_add_u32 m0, s22, 0x3000
  s_waitcnt vmcnt(12)
  ds_read_b64_tr_b16 a[80:81], v23 offset:12288
  ds_read_b64_tr_b16 a[82:83], v23 offset:13056
  ds_read_b64_tr_b16 a[92:93], v23 offset:12320
  buffer_load_dwordx4 v232, s[12:15], s28 offen lds
  ds_read_b64_tr_b16 a[94:95], v23 offset:13088
  ds_read_b64_tr_b16 a[104:105], v23 offset:12352
  ds_read_b64_tr_b16 a[106:107], v23 offset:13120
  ds_read_b64_tr_b16 a[116:117], v23 offset:12384
  ds_read_b64_tr_b16 a[118:119], v23 offset:13152
  ds_read_b64_tr_b16 a[128:129], v23 offset:12416
  ds_read_b64_tr_b16 a[130:131], v23 offset:13184
  ds_read_b64_tr_b16 a[140:141], v23 offset:12448
  ds_read_b64_tr_b16 a[142:143], v23 offset:13216
  buffer_load_dwordx4 v233, s[12:15], s28 offen offset:1024 lds
  buffer_load_dwordx4 v234, s[12:15], s28 offen offset:2048 lds
  s_add_u32 m0, s22, 0x3c00
  s_add_u32 s73, s73, 0x27200
  v_add_u32 v228, s73, v228
  v_add_u32 v229, s73, v14
  buffer_load_dwordx4 v232, s[12:15], s29 offen lds
  buffer_load_dwordx4 v233, s[12:15], s29 offen offset:1024 lds
  buffer_load_dwordx4 v234, s[12:15], s29 offen offset:2048 lds
  s_waitcnt vmcnt(15)
  ds_read_b128 a[0:3], v246
  ds_read_b128 a[4:7], v246 offset:64
  ds_read_b128 a[8:11], v246 offset:128
  s_waitcnt vmcnt(12)
  ds_read_b64_tr_b16 a[192:193], v224
  ds_read_b64_tr_b16 a[194:195], v227 offset:768
  ds_read_b64_tr_b16 a[196:197], v226
  ds_read_b64_tr_b16 a[198:199], v225 offset:768
  ds_read_b64_tr_b16 a[200:201], v224 offset:64
  ds_read_b64_tr_b16 a[202:203], v227 offset:832
  ds_read_b64_tr_b16 a[204:205], v226 offset:64
  ds_read_b64_tr_b16 a[206:207], v225 offset:832
  ds_read_b64_tr_b16 a[208:209], v224 offset:128
  ds_read_b64_tr_b16 a[210:211], v227 offset:896
  ds_read_b64_tr_b16 a[212:213], v226 offset:128
  ds_read_b64_tr_b16 a[214:215], v225 offset:896
  ds_read_b128 a[12:15], v246 offset:3072
  ds_read_b128 a[16:19], v246 offset:3136
  ds_read_b128 a[20:23], v246 offset:3200
  s_waitcnt lgkmcnt(15)
  v_mfma_f32_16x16x32_bf16 v[32:35], a[0:3], a[72:75], 0
  v_mfma_f32_16x16x32_bf16 v[32:35], a[4:7], a[76:79], v[32:35]
  v_mfma_f32_16x16x32_bf16 v[32:35], a[8:11], a[80:83], v[32:35]
  s_waitcnt lgkmcnt(13)
  v_mfma_f32_16x16x32_bf16 v[176:179], v[16:19], a[192:195], 0
  s_waitcnt lgkmcnt(11)
  v_mfma_f32_16x16x32_bf16 v[180:183], v[16:19], a[196:199], 0
  s_waitcnt lgkmcnt(9)
  v_mfma_f32_16x16x32_bf16 v[184:187], v[16:19], a[200:203], 0
  s_waitcnt lgkmcnt(7)
  v_mfma_f32_16x16x32_bf16 v[188:191], v[16:19], a[204:207], 0
  s_waitcnt lgkmcnt(5)
  v_mfma_f32_16x16x32_bf16 v[192:195], v[16:19], a[208:211], 0
  s_waitcnt vmcnt(9)
  ds_read_b128 a[24:27], v246 offset:6144
  ds_read_b128 a[28:31], v246 offset:6208
  s_waitcnt lgkmcnt(2)
  v_mfma_f32_16x16x32_bf16 v[196:199], v[16:19], a[212:215], 0
  ds_read_b128 a[32:35], v246 offset:6272
  v_mfma_f32_16x16x32_bf16 v[56:59], a[12:15], a[72:75], 0
  v_mfma_f32_16x16x32_bf16 v[56:59], a[16:19], a[76:79], v[56:59]
  v_mfma_f32_16x16x32_bf16 v[56:59], a[20:23], a[80:83], v[56:59]
  v_mfma_f32_16x16x32_bf16 v[36:39], a[0:3], a[84:87], 0
  v_mfma_f32_16x16x32_bf16 v[60:63], a[12:15], a[84:87], 0
  v_mfma_f32_16x16x32_bf16 v[36:39], a[4:7], a[88:91], v[36:39]
  v_mfma_f32_16x16x32_bf16 v[60:63], a[16:19], a[88:91], v[60:63]
  s_waitcnt lgkmcnt(2)
  v_mfma_f32_16x16x32_bf16 v[80:83], a[24:27], a[72:75], 0
  s_waitcnt lgkmcnt(1)
  v_mfma_f32_16x16x32_bf16 v[80:83], a[28:31], a[76:79], v[80:83]
  s_waitcnt lgkmcnt(0)
  v_mfma_f32_16x16x32_bf16 v[80:83], a[32:35], a[80:83], v[80:83]
  v_mfma_f32_16x16x32_bf16 v[84:87], a[24:27], a[84:87], 0
  v_mfma_f32_16x16x32_bf16 v[36:39], a[8:11], a[92:95], v[36:39]
  s_waitcnt vmcnt(6)
  ds_read_b64_tr_b16 a[216:217], v224 offset:6144
  ds_read_b64_tr_b16 a[218:219], v227 offset:6912
  v_mfma_f32_16x16x32_bf16 v[84:87], a[28:31], a[88:91], v[84:87]
  ds_read_b64_tr_b16 a[220:221], v226 offset:6144
  ds_read_b64_tr_b16 a[222:223], v225 offset:6912
  v_mfma_f32_16x16x32_bf16 v[60:63], a[20:23], a[92:95], v[60:63]
  ds_read_b128 a[36:39], v246 offset:9216
  ds_read_b128 a[40:43], v246 offset:9280
  v_mfma_f32_16x16x32_bf16 v[84:87], a[32:35], a[92:95], v[84:87]
  ds_read_b128 a[44:47], v246 offset:9344
  ds_read_b64_tr_b16 a[224:225], v224 offset:6208
  v_mfma_f32_16x16x32_bf16 v[40:43], a[0:3], a[96:99], 0
  ds_read_b64_tr_b16 a[226:227], v227 offset:6976
  ds_read_b64_tr_b16 a[228:229], v226 offset:6208
  v_mfma_f32_16x16x32_bf16 v[64:67], a[12:15], a[96:99], 0
  ds_read_b64_tr_b16 a[230:231], v225 offset:6976
  ds_read_b64_tr_b16 a[192:193], v224 offset:6272
  v_mfma_f32_16x16x32_bf16 v[40:43], a[4:7], a[100:103], v[40:43]
  ds_read_b64_tr_b16 a[194:195], v227 offset:7040
  ds_read_b64_tr_b16 a[196:197], v226 offset:6272
  v_mfma_f32_16x16x32_bf16 v[88:91], a[24:27], a[96:99], 0
  ds_read_b64_tr_b16 a[198:199], v225 offset:7040
  v_mfma_f32_16x16x32_bf16 v[64:67], a[16:19], a[100:103], v[64:67]
  s_waitcnt lgkmcnt(9)
  v_mfma_f32_16x16x32_bf16 v[176:179], v[16:19], a[216:219], v[176:179]
  v_mfma_f32_16x16x32_bf16 v[180:183], v[16:19], a[220:223], v[180:183]
  v_mfma_f32_16x16x32_bf16 v[104:107], a[36:39], a[72:75], 0
  v_mfma_f32_16x16x32_bf16 v[104:107], a[40:43], a[76:79], v[104:107]
  s_waitcnt lgkmcnt(6)
  v_mfma_f32_16x16x32_bf16 v[184:187], v[16:19], a[224:227], v[184:187]
  s_waitcnt vmcnt(3)
  ds_read_b128 a[48:51], v246 offset:12288
  ds_read_b128 a[52:55], v246 offset:12352
  s_waitcnt lgkmcnt(5)
  v_mfma_f32_16x16x32_bf16 v[188:191], v[16:19], a[228:231], v[188:191]
  ds_read_b128 a[56:59], v246 offset:12416
  s_waitcnt lgkmcnt(4)
  v_mfma_f32_16x16x32_bf16 v[192:195], v[16:19], a[192:195], v[192:195]
  s_waitcnt lgkmcnt(3)
  v_mfma_f32_16x16x32_bf16 v[196:199], v[16:19], a[196:199], v[196:199]
  v_mfma_f32_16x16x32_bf16 v[104:107], a[44:47], a[80:83], v[104:107]
  v_mfma_f32_16x16x32_bf16 v[108:111], a[36:39], a[84:87], 0
  v_mfma_f32_16x16x32_bf16 v[108:111], a[40:43], a[88:91], v[108:111]
  v_mfma_f32_16x16x32_bf16 v[108:111], a[44:47], a[92:95], v[108:111]
  v_mfma_f32_16x16x32_bf16 v[112:115], a[36:39], a[96:99], 0
  s_waitcnt lgkmcnt(2)
  v_mfma_f32_16x16x32_bf16 v[128:131], a[48:51], a[72:75], 0
  s_waitcnt lgkmcnt(1)
  v_mfma_f32_16x16x32_bf16 v[128:131], a[52:55], a[76:79], v[128:131]
  s_waitcnt lgkmcnt(0)
  v_mfma_f32_16x16x32_bf16 v[128:131], a[56:59], a[80:83], v[128:131]
  v_mfma_f32_16x16x32_bf16 v[132:135], a[48:51], a[84:87], 0
  v_mfma_f32_16x16x32_bf16 v[132:135], a[52:55], a[88:91], v[132:135]
  s_waitcnt vmcnt(0)
  ds_read_b128 a[60:63], v246 offset:15360
  ds_read_b128 a[64:67], v246 offset:15424
  v_mfma_f32_16x16x32_bf16 v[132:135], a[56:59], a[92:95], v[132:135]
  ds_read_b128 a[68:71], v246 offset:15488
  ds_read_b64_tr_b16 a[200:201], v224 offset:12288
  v_mfma_f32_16x16x32_bf16 v[40:43], a[8:11], a[104:107], v[40:43]
  ds_read_b64_tr_b16 a[202:203], v227 offset:13056
  ds_read_b64_tr_b16 a[204:205], v226 offset:12288
  v_mfma_f32_16x16x32_bf16 v[88:91], a[28:31], a[100:103], v[88:91]
  ds_read_b64_tr_b16 a[206:207], v225 offset:13056
  ds_read_b64_tr_b16 a[208:209], v224 offset:12352
  v_mfma_f32_16x16x32_bf16 v[136:139], a[48:51], a[96:99], 0
  ds_read_b64_tr_b16 a[210:211], v227 offset:13120
  ds_read_b64_tr_b16 a[212:213], v226 offset:12352
  v_mfma_f32_16x16x32_bf16 v[64:67], a[20:23], a[104:107], v[64:67]
  ds_read_b64_tr_b16 a[214:215], v225 offset:13120
  ds_read_b64_tr_b16 a[216:217], v224 offset:12416
  v_mfma_f32_16x16x32_bf16 v[112:115], a[40:43], a[100:103], v[112:115]
  ds_read_b64_tr_b16 a[218:219], v227 offset:13184
  ds_read_b64_tr_b16 a[220:221], v226 offset:12416
  v_mfma_f32_16x16x32_bf16 v[88:91], a[32:35], a[104:107], v[88:91]
  ds_read_b64_tr_b16 a[222:223], v225 offset:13184
  v_mfma_f32_16x16x32_bf16 v[136:139], a[52:55], a[100:103], v[136:139]
  s_waitcnt lgkmcnt(9)
  v_mfma_f32_16x16x32_bf16 v[152:155], a[60:63], a[72:75], 0
  v_mfma_f32_16x16x32_bf16 v[152:155], a[64:67], a[76:79], v[152:155]
  v_mfma_f32_16x16x32_bf16 v[176:179], v[16:19], a[200:203], v[176:179]
  s_waitcnt lgkmcnt(7)
  v_mfma_f32_16x16x32_bf16 v[180:183], v[16:19], a[204:207], v[180:183]
  s_waitcnt lgkmcnt(5)
  v_mfma_f32_16x16x32_bf16 v[184:187], v[16:19], a[208:211], v[184:187]
  s_waitcnt lgkmcnt(4)
  v_mfma_f32_16x16x32_bf16 v[188:191], v[16:19], a[212:215], v[188:191]
  s_waitcnt lgkmcnt(2)
  v_mfma_f32_16x16x32_bf16 v[192:195], v[16:19], a[216:219], v[192:195]
  s_waitcnt lgkmcnt(0)
  v_mfma_f32_16x16x32_bf16 v[196:199], v[16:19], a[220:223], v[196:199]
  v_mfma_f32_16x16x32_bf16 v[152:155], a[68:71], a[80:83], v[152:155]
  v_cvt_pk_bf16_f32 v177, v176, v176
  v_mfma_f32_16x16x32_bf16 v[156:159], a[60:63], a[84:87], 0
  ds_write_b16 v228, v177
  v_cvt_pk_bf16_f32 v181, v180, v180
  v_mfma_f32_16x16x32_bf16 v[156:159], a[64:67], a[88:91], v[156:159]
  ds_write_b16 v228, v181 offset:32
  v_cvt_pk_bf16_f32 v185, v184, v184
  v_mfma_f32_16x16x32_bf16 v[156:159], a[68:71], a[92:95], v[156:159]
  ds_write_b16 v228, v185 offset:64
  v_cvt_pk_bf16_f32 v189, v188, v188
  v_mfma_f32_16x16x32_bf16 v[160:163], a[60:63], a[96:99], 0
  ds_write_b16 v228, v189 offset:96
  v_cvt_pk_bf16_f32 v193, v192, v192
  v_mfma_f32_16x16x32_bf16 v[44:47], a[0:3], a[108:111], 0
  ds_write_b16 v228, v193 offset:128
  v_cvt_pk_bf16_f32 v197, v196, v196
  v_mfma_f32_16x16x32_bf16 v[112:115], a[44:47], a[104:107], v[112:115]
  ds_write_b16 v228, v197 offset:160
  ds_read_b128 a[232:235], v229
  v_mfma_f32_16x16x32_bf16 v[160:163], a[64:67], a[100:103], v[160:163]
  ds_read_b128 a[236:239], v229 offset:64
  ds_read_b128 a[240:243], v229 offset:128
  v_mfma_f32_16x16x32_bf16 v[68:71], a[12:15], a[108:111], 0
  v_mfma_f32_16x16x32_bf16 v[136:139], a[56:59], a[104:107], v[136:139]
  v_mfma_f32_16x16x32_bf16 v[44:47], a[4:7], a[112:115], v[44:47]
  v_mfma_f32_16x16x32_bf16 v[92:95], a[24:27], a[108:111], 0
  v_mfma_f32_16x16x32_bf16 v[160:163], a[68:71], a[104:107], v[160:163]
  v_mfma_f32_16x16x32_bf16 v[68:71], a[16:19], a[112:115], v[68:71]
  v_mfma_f32_16x16x32_bf16 v[116:119], a[36:39], a[108:111], 0
  s_waitcnt lgkmcnt(2)
  v_mfma_f32_16x16x32_bf16 v[248:251], a[232:235], a[72:75], 0
  s_waitcnt lgkmcnt(1)
  v_mfma_f32_16x16x32_bf16 v[248:251], a[236:239], a[76:79], v[248:251]
  s_waitcnt lgkmcnt(0)
  v_mfma_f32_16x16x32_bf16 v[248:251], a[240:243], a[80:83], v[248:251]
  v_mfma_f32_16x16x32_bf16 v[252:255], a[232:235], a[84:87], 0
  v_mfma_f32_16x16x32_bf16 v[252:255], a[236:239], a[88:91], v[252:255]
  v_mfma_f32_16x16x32_bf16 v[252:255], a[240:243], a[92:95], v[252:255]
  v_mfma_f32_16x16x32_bf16 v[44:47], a[8:11], a[116:119], v[44:47]
  v_mfma_f32_16x16x32_bf16 v[92:95], a[28:31], a[112:115], v[92:95]
  v_mfma_f32_16x16x32_bf16 v[140:143], a[48:51], a[108:111], 0
  s_add_u32 s73, s21, 0x3f480
  v_mfma_f32_16x16x32_bf16 v[68:71], a[20:23], a[116:119], v[68:71]
  s_add_u32 m0, s22, 0x0
  s_add_u32 s74, s21, 0x0
  v_mfma_f32_16x16x32_bf16 v[116:119], a[40:43], a[112:115], v[116:119]
  buffer_load_dwordx4 v7, s[4:7], s73 offen nt lds
  v_mfma_f32_16x16x32_bf16 v[164:167], a[60:63], a[108:111], 0
  buffer_load_dwordx4 v8, s[4:7], s73 offen offset:1024 nt lds
  v_mfma_f32_16x16x32_bf16 v[92:95], a[32:35], a[116:119], v[92:95]
  buffer_load_dwordx4 v9, s[4:7], s73 offen offset:2048 nt lds
  v_mfma_f32_16x16x32_bf16 v[140:143], a[52:55], a[112:115], v[140:143]
  s_add_u32 m0, s22, 0xc00
  s_add_u32 s75, s21, 0x300
  v_mfma_f32_16x16x32_bf16 v[48:51], a[0:3], a[120:123], 0
  buffer_load_dwordx4 v7, s[4:7], s74 offen nt lds
  v_mfma_f32_16x16x32_bf16 v[116:119], a[44:47], a[116:119], v[116:119]
  buffer_load_dwordx4 v8, s[4:7], s74 offen offset:1024 nt lds
  v_mfma_f32_16x16x32_bf16 v[164:167], a[64:67], a[112:115], v[164:167]
  buffer_load_dwordx4 v9, s[4:7], s74 offen offset:2048 nt lds
  v_mfma_f32_16x16x32_bf16 v[72:75], a[12:15], a[120:123], 0
  s_add_u32 m0, s22, 0x1800
  v_cndmask_b32_e64 v29, v7, v10, s[44:45]
  v_mfma_f32_16x16x32_bf16 v[140:143], a[56:59], a[116:119], v[140:143]
  buffer_load_dwordx4 v29, s[4:7], s75 offen nt lds
  v_mfma_f32_16x16x32_bf16 v[48:51], a[4:7], a[124:127], v[48:51]
  v_mov_b32 v240, v248
  v_mul_f32 v240, s72, v240
  v_mfma_f32_16x16x32_bf16 v[248:251], a[232:235], a[96:99], 0
  v_cvt_pk_bf16_f32 v240, v240, v15
  v_accvgpr_write_b32 a168, v240
  v_mfma_f32_16x16x32_bf16 v[248:251], a[236:239], a[100:103], v[248:251]
  v_mov_b32 v241, v252
  v_mul_f32 v241, s72, v241
  v_mfma_f32_16x16x32_bf16 v[32:35], a[144:147], a[168:171], v[32:35]
  v_cvt_pk_bf16_f32 v241, v241, v15
  v_accvgpr_write_b32 a172, v241
  v_mfma_f32_16x16x32_bf16 v[56:59], a[144:147], a[168:171], v[56:59]
  v_mfma_f32_16x16x32_bf16 v[80:83], a[144:147], a[168:171], v[80:83]
  v_mfma_f32_16x16x32_bf16 v[248:251], a[240:243], a[104:107], v[248:251]
  v_mfma_f32_16x16x32_bf16 v[104:107], a[144:147], a[168:171], v[104:107]
  v_mfma_f32_16x16x32_bf16 v[128:131], a[144:147], a[168:171], v[128:131]
  s_nop 0
  v_cvt_pk_bf16_f32 v176, v32, v33
  v_mfma_f32_16x16x32_bf16 v[252:255], a[232:235], a[108:111], 0
  v_cvt_pk_bf16_f32 v177, v34, v35
  ds_write_b64 v22, v[176:177]
  v_mfma_f32_16x16x32_bf16 v[152:155], a[144:147], a[168:171], v[152:155]
  v_cvt_pk_bf16_f32 v178, v56, v57
  v_cvt_pk_bf16_f32 v179, v58, v59
  v_mfma_f32_16x16x32_bf16 v[36:39], a[144:147], a[172:175], v[36:39]
  ds_write_b64 v22, v[178:179] offset:512
  v_cvt_pk_bf16_f32 v180, v80, v81
  v_mfma_f32_16x16x32_bf16 v[252:255], a[236:239], a[112:115], v[252:255]
  v_cvt_pk_bf16_f32 v181, v82, v83
  v_mov_b32 v242, v248
  v_mfma_f32_16x16x32_bf16 v[60:63], a[144:147], a[172:175], v[60:63]
  ds_write_b64 v22, v[180:181] offset:1024
  v_cvt_pk_bf16_f32 v182, v104, v105
  v_mfma_f32_16x16x32_bf16 v[84:87], a[144:147], a[172:175], v[84:87]
  v_cvt_pk_bf16_f32 v183, v106, v107
  v_mul_f32 v242, s72, v242
  v_mfma_f32_16x16x32_bf16 v[252:255], a[240:243], a[116:119], v[252:255]
  ds_write_b64 v22, v[182:183] offset:1536
  v_cvt_pk_bf16_f32 v184, v128, v129
  v_mfma_f32_16x16x32_bf16 v[108:111], a[144:147], a[172:175], v[108:111]
  v_cvt_pk_bf16_f32 v185, v130, v131
  v_cvt_pk_bf16_f32 v242, v242, v15
  v_mfma_f32_16x16x32_bf16 v[132:135], a[144:147], a[172:175], v[132:135]
  ds_write_b64 v22, v[184:185] offset:2048
  v_cvt_pk_bf16_f32 v186, v152, v153
  v_mfma_f32_16x16x32_bf16 v[248:251], a[232:235], a[120:123], 0
  v_cvt_pk_bf16_f32 v187, v154, v155
  v_accvgpr_write_b32 a176, v242
  v_mfma_f32_16x16x32_bf16 v[156:159], a[144:147], a[172:175], v[156:159]
  ds_write_b64 v22, v[186:187] offset:2560
  v_cvt_pk_bf16_f32 v188, v36, v37
  v_mfma_f32_16x16x32_bf16 v[40:43], a[144:147], a[176:179], v[40:43]
  v_cvt_pk_bf16_f32 v189, v38, v39
  ds_write_b64 v22, v[188:189] offset:128
  v_mfma_f32_16x16x32_bf16 v[248:251], a[236:239], a[124:127], v[248:251]
  v_cvt_pk_bf16_f32 v190, v60, v61
  v_cvt_pk_bf16_f32 v191, v62, v63
  v_mfma_f32_16x16x32_bf16 v[64:67], a[144:147], a[176:179], v[64:67]
  ds_write_b64 v22, v[190:191] offset:640
  v_cvt_pk_bf16_f32 v192, v84, v85
  v_mfma_f32_16x16x32_bf16 v[88:91], a[144:147], a[176:179], v[88:91]
  v_cvt_pk_bf16_f32 v193, v86, v87
  v_mov_b32 v243, v252
  v_mfma_f32_16x16x32_bf16 v[248:251], a[240:243], a[128:131], v[248:251]
  ds_write_b64 v22, v[192:193] offset:1152
  v_cvt_pk_bf16_f32 v194, v108, v109
  v_mfma_f32_16x16x32_bf16 v[112:115], a[144:147], a[176:179], v[112:115]
  v_cvt_pk_bf16_f32 v195, v110, v111
  v_mul_f32 v243, s72, v243
  v_mfma_f32_16x16x32_bf16 v[136:139], a[144:147], a[176:179], v[136:139]
  ds_write_b64 v22, v[194:195] offset:1664
  v_cvt_pk_bf16_f32 v196, v132, v133
  v_mfma_f32_16x16x32_bf16 v[252:255], a[232:235], a[132:135], 0
  v_cvt_pk_bf16_f32 v197, v134, v135
  v_cndmask_b32_e64 v30, v8, v11, s[50:51]
  v_mfma_f32_16x16x32_bf16 v[160:163], a[144:147], a[176:179], v[160:163]
  buffer_load_dwordx4 v30, s[4:7], s75 offen offset:1024 nt lds
  v_mfma_f32_16x16x32_bf16 v[252:255], a[236:239], a[136:139], v[252:255]
  v_cvt_pk_bf16_f32 v243, v243, v15
  ds_write_b64 v22, v[196:197] offset:2176
  v_mfma_f32_16x16x32_bf16 v[96:99], a[24:27], a[120:123], 0
  v_cvt_pk_bf16_f32 v198, v156, v157
  v_cvt_pk_bf16_f32 v199, v158, v159
  v_mfma_f32_16x16x32_bf16 v[164:167], a[68:71], a[116:119], v[164:167]
  v_accvgpr_write_b32 a180, v243
  ds_write_b64 v22, v[198:199] offset:2688
  v_mfma_f32_16x16x32_bf16 v[72:75], a[16:19], a[124:127], v[72:75]
  v_cvt_pk_bf16_f32 v200, v40, v41
  v_cvt_pk_bf16_f32 v201, v42, v43
  v_mfma_f32_16x16x32_bf16 v[44:47], a[144:147], a[180:183], v[44:47]
  ds_write_b64 v22, v[200:201] offset:6144
  v_cvt_pk_bf16_f32 v202, v64, v65
  v_mfma_f32_16x16x32_bf16 v[68:71], a[144:147], a[180:183], v[68:71]
  v_cvt_pk_bf16_f32 v203, v66, v67
  ds_write_b64 v22, v[202:203] offset:6656
  v_mfma_f32_16x16x32_bf16 v[92:95], a[144:147], a[180:183], v[92:95]
  v_cvt_pk_bf16_f32 v204, v88, v89
  v_cvt_pk_bf16_f32 v205, v90, v91
  v_mfma_f32_16x16x32_bf16 v[120:123], a[36:39], a[120:123], 0
  v_mov_b32 v244, v248
  ds_write_b64 v22, v[204:205] offset:7168
  v_mfma_f32_16x16x32_bf16 v[252:255], a[240:243], a[140:143], v[252:255]
  v_cvt_pk_bf16_f32 v206, v112, v113
  v_cvt_pk_bf16_f32 v207, v114, v115
  v_mfma_f32_16x16x32_bf16 v[116:119], a[144:147], a[180:183], v[116:119]
  v_mul_f32 v244, s72, v244
  ds_write_b64 v22, v[206:207] offset:7680
  v_mfma_f32_16x16x32_bf16 v[48:51], a[8:11], a[128:131], v[48:51]
  v_cvt_pk_bf16_f32 v208, v136, v137
  v_cvt_pk_bf16_f32 v209, v138, v139
  v_mfma_f32_16x16x32_bf16 v[96:99], a[28:31], a[124:127], v[96:99]
  v_cvt_pk_bf16_f32 v244, v244, v15
  ds_write_b64 v22, v[208:209] offset:8192
  v_mfma_f32_16x16x32_bf16 v[144:147], a[48:51], a[120:123], 0
  v_cvt_pk_bf16_f32 v210, v160, v161
  v_cvt_pk_bf16_f32 v211, v162, v163
  v_mfma_f32_16x16x32_bf16 v[140:143], a[144:147], a[180:183], v[140:143]
  v_accvgpr_write_b32 a184, v244
  ds_write_b64 v22, v[210:211] offset:8704
  v_mfma_f32_16x16x32_bf16 v[72:75], a[20:23], a[128:131], v[72:75]
  v_cvt_pk_bf16_f32 v212, v44, v45
  v_cvt_pk_bf16_f32 v213, v46, v47
  v_mfma_f32_16x16x32_bf16 v[120:123], a[40:43], a[124:127], v[120:123]
  v_cndmask_b32_e64 v31, v9, v12, s[56:57]
  buffer_load_dwordx4 v31, s[4:7], s75 offen offset:2048 nt lds
  v_mfma_f32_16x16x32_bf16 v[168:171], a[60:63], a[120:123], 0
  ds_write_b64 v22, v[212:213] offset:6272
  v_cvt_pk_bf16_f32 v214, v68, v69
  v_mfma_f32_16x16x32_bf16 v[164:167], a[144:147], a[180:183], v[164:167]
  v_cvt_pk_bf16_f32 v215, v70, v71
  ds_write_b64 v22, v[214:215] offset:6784
  v_mfma_f32_16x16x32_bf16 v[96:99], a[32:35], a[128:131], v[96:99]
  v_cvt_pk_bf16_f32 v216, v92, v93
  v_cvt_pk_bf16_f32 v217, v94, v95
  v_mfma_f32_16x16x32_bf16 v[144:147], a[52:55], a[124:127], v[144:147]
  v_mov_b32 v245, v252
  ds_write_b64 v22, v[216:217] offset:7296
  v_mfma_f32_16x16x32_bf16 v[52:55], a[0:3], a[132:135], 0
  v_cvt_pk_bf16_f32 v218, v116, v117
  v_cvt_pk_bf16_f32 v219, v118, v119
  v_mfma_f32_16x16x32_bf16 v[48:51], a[144:147], a[184:187], v[48:51]
  v_mul_f32 v245, s72, v245
  ds_write_b64 v22, v[218:219] offset:7808
  v_mfma_f32_16x16x32_bf16 v[120:123], a[44:47], a[128:131], v[120:123]
  v_cvt_pk_bf16_f32 v220, v140, v141
  v_cvt_pk_bf16_f32 v221, v142, v143
  v_mfma_f32_16x16x32_bf16 v[168:171], a[64:67], a[124:127], v[168:171]
  v_cvt_pk_bf16_f32 v245, v245, v15
  ds_write_b64 v22, v[220:221] offset:8320
  v_mfma_f32_16x16x32_bf16 v[76:79], a[12:15], a[132:135], 0
  v_cvt_pk_bf16_f32 v222, v164, v165
  v_cvt_pk_bf16_f32 v223, v166, v167
  v_mfma_f32_16x16x32_bf16 v[72:75], a[144:147], a[184:187], v[72:75]
  v_accvgpr_write_b32 a188, v245
  ds_write_b64 v22, v[222:223] offset:8832
  v_mfma_f32_16x16x32_bf16 v[144:147], a[56:59], a[128:131], v[144:147]
  v_cvt_pk_bf16_f32 v224, v48, v49
  v_cvt_pk_bf16_f32 v225, v50, v51
  v_mfma_f32_16x16x32_bf16 v[52:55], a[4:7], a[136:139], v[52:55]
  ds_write_b64 v22, v[224:225] offset:12288
  v_mfma_f32_16x16x32_bf16 v[100:103], a[24:27], a[132:135], 0
  v_cvt_pk_bf16_f32 v226, v72, v73
  v_cvt_pk_bf16_f32 v227, v74, v75
  v_mfma_f32_16x16x32_bf16 v[96:99], a[144:147], a[184:187], v[96:99]
  ds_write_b64 v22, v[226:227] offset:12800
  v_mfma_f32_16x16x32_bf16 v[168:171], a[68:71], a[128:131], v[168:171]
  v_mfma_f32_16x16x32_bf16 v[76:79], a[16:19], a[136:139], v[76:79]
  v_mfma_f32_16x16x32_bf16 v[124:127], a[36:39], a[132:135], 0
  v_mfma_f32_16x16x32_bf16 v[120:123], a[144:147], a[184:187], v[120:123]
  v_mfma_f32_16x16x32_bf16 v[52:55], a[8:11], a[140:143], v[52:55]
  v_mfma_f32_16x16x32_bf16 v[100:103], a[28:31], a[136:139], v[100:103]
  s_nop 0
  v_cvt_pk_bf16_f32 v228, v96, v97
  v_mfma_f32_16x16x32_bf16 v[148:151], a[48:51], a[132:135], 0
  v_cvt_pk_bf16_f32 v229, v98, v99
  ds_write_b64 v22, v[228:229] offset:13312
  v_mfma_f32_16x16x32_bf16 v[144:147], a[144:147], a[184:187], v[144:147]
  v_cvt_pk_bf16_f32 v230, v120, v121
  v_cvt_pk_bf16_f32 v231, v122, v123
  v_mfma_f32_16x16x32_bf16 v[76:79], a[20:23], a[140:143], v[76:79]
  ds_write_b64 v22, v[230:231] offset:13824
  v_mfma_f32_16x16x32_bf16 v[124:127], a[40:43], a[136:139], v[124:127]
  v_mfma_f32_16x16x32_bf16 v[172:175], a[60:63], a[132:135], 0
  v_mfma_f32_16x16x32_bf16 v[168:171], a[144:147], a[184:187], v[168:171]
  s_nop 0
  v_cvt_pk_bf16_f32 v232, v144, v145
  v_mfma_f32_16x16x32_bf16 v[100:103], a[32:35], a[140:143], v[100:103]
  v_cvt_pk_bf16_f32 v233, v146, v147
  ds_write_b64 v22, v[232:233] offset:14336
  v_mfma_f32_16x16x32_bf16 v[148:151], a[52:55], a[136:139], v[148:151]
  v_mfma_f32_16x16x32_bf16 v[52:55], a[144:147], a[188:191], v[52:55]
  s_nop 0
  v_cvt_pk_bf16_f32 v234, v168, v169
  v_mfma_f32_16x16x32_bf16 v[124:127], a[44:47], a[140:143], v[124:127]
  v_cvt_pk_bf16_f32 v235, v170, v171
  ds_write_b64 v22, v[234:235] offset:14848
  v_mfma_f32_16x16x32_bf16 v[172:175], a[64:67], a[136:139], v[172:175]
  v_mfma_f32_16x16x32_bf16 v[76:79], a[144:147], a[188:191], v[76:79]
  s_nop 0
  v_cvt_pk_bf16_f32 v236, v52, v53
  v_mfma_f32_16x16x32_bf16 v[148:151], a[56:59], a[140:143], v[148:151]
  v_cvt_pk_bf16_f32 v237, v54, v55
  ds_write_b64 v22, v[236:237] offset:12416
  v_mfma_f32_16x16x32_bf16 v[100:103], a[144:147], a[188:191], v[100:103]
  v_mfma_f32_16x16x32_bf16 v[172:175], a[68:71], a[140:143], v[172:175]
  s_nop 0
  v_cvt_pk_bf16_f32 v238, v76, v77
  v_mfma_f32_16x16x32_bf16 v[124:127], a[144:147], a[188:191], v[124:127]
  v_cvt_pk_bf16_f32 v239, v78, v79
  ds_write_b64 v22, v[238:239] offset:12928
  v_mfma_f32_16x16x32_bf16 v[148:151], a[144:147], a[188:191], v[148:151]
  s_nop 0
  v_cvt_pk_bf16_f32 v240, v100, v101
  v_mfma_f32_16x16x32_bf16 v[172:175], a[144:147], a[188:191], v[172:175]
  v_cvt_pk_bf16_f32 v241, v102, v103
  ds_write_b64 v22, v[240:241] offset:13440
  v_cvt_pk_bf16_f32 v242, v124, v125
  v_cvt_pk_bf16_f32 v243, v126, v127
  ds_write_b64 v22, v[242:243] offset:13952
  v_cvt_pk_bf16_f32 v244, v148, v149
  v_cvt_pk_bf16_f32 v245, v150, v151
  ds_write_b64 v22, v[244:245] offset:14464
  v_cvt_pk_bf16_f32 v246, v172, v173
  v_cvt_pk_bf16_f32 v247, v174, v175
  ds_write_b64 v22, v[246:247] offset:14976
  s_waitcnt lgkmcnt(0)
L_JOIN:
  s_nop 7
  s_barrier
  v_lshlrev_b32 v212, 4, v1
  v_add_u32 v212, 0x5400, v212
  v_add_u32 v213, 0x9c00, v212
  v_add_u32 v214, 0x13800, v212
  v_add_u32 v215, 0x1d400, v212
  ds_read_b128 a[216:219], v212
  ds_read_b128 a[220:223], v212 offset:1024
  ds_read_b128 a[224:227], v212 offset:2048
  ds_read_b128 a[228:231], v212 offset:3072
  ds_read_b128 a[232:235], v212 offset:4096
  ds_read_b128 a[236:239], v212 offset:5120
  ds_read_b128 a[240:243], v212 offset:6144
  ds_read_b128 a[244:247], v212 offset:7168
  ds_read_b128 a[248:251], v212 offset:8192
  ds_read_b128 a[252:255], v212 offset:9216
  ds_read_b128 v[224:227], v212 offset:10240
  ds_read_b128 v[228:231], v212 offset:11264
  ds_read_b128 v[232:235], v212 offset:12288
  ds_read_b128 v[236:239], v212 offset:13312
  ds_read_b128 v[240:243], v212 offset:14336
  ds_read_b128 v[244:247], v212 offset:15360
  ds_read_b128 v[248:251], v212 offset:16384
  ds_read_b128 v[252:255], v212 offset:17408
  ds_read_b128 a[144:147], v213
  ds_read_b128 a[148:151], v213 offset:1024
  s_add_u32 s73, s21, 0xa8c0
  s_add_u32 m0, s22, 0x2400
  ds_read_b128 a[152:155], v213 offset:2048
  buffer_load_dwordx4 v7, s[4:7], s73 offen nt lds
  ds_read_b128 a[156:159], v213 offset:3072
  ds_read_b128 a[160:163], v213 offset:4096
  ds_read_b128 a[164:167], v213 offset:5120
  ds_read_b128 a[168:171], v213 offset:6144
  ds_read_b128 a[172:175], v213 offset:7168
  ds_read_b128 a[176:179], v213 offset:8192
  ds_read_b128 a[180:183], v213 offset:9216
  ds_read_b128 a[184:187], v213 offset:10240
  ds_read_b128 a[188:191], v213 offset:11264
  ds_read_b128 a[192:195], v213 offset:12288
  ds_read_b128 a[196:199], v213 offset:13312
  ds_read_b128 a[200:203], v213 offset:14336
  ds_read_b128 a[204:207], v213 offset:15360
  ds_read_b128 a[208:211], v213 offset:16384
  ds_read_b128 a[212:215], v213 offset:17408
  buffer_load_dwordx4 v8, s[4:7], s73 offen offset:1024 nt lds
  buffer_load_dwordx4 v9, s[4:7], s73 offen offset:2048 nt lds
  s_waitcnt vmcnt(9)
  ds_read_b128 v[20:23], v4
  ds_read_b128 v[24:27], v4 offset:64
  ds_read_b128 v[28:31], v4 offset:128
  v_lshlrev_b32 v220, 2, v3
  v_sub_u32 v220, v2, v220
  v_and_b32 v221, 1, v220
  v_mov_b32 v223, 0x3f80
  v_lshlrev_b32 v221, 4, v221
  v_ashrrev_i32 v222, 1, v220
  v_lshlrev_b32 v221, v221, v223
  v_cmp_eq_i32_e64 s[82:83], 0, v222
  v_ashrrev_i32 v222, 1, v220
  s_add_u32 s74, s21, 0xabc0
  v_cndmask_b32_e64 v178, 0, v221, s[82:83]
  v_and_b32 v221, 1, v220
  v_lshlrev_b32 v221, 4, v221
  v_lshlrev_b32 v221, v221, v223
  v_cmp_eq_i32_e64 s[82:83], 1, v222
  v_ashrrev_i32 v222, 1, v220
  s_waitcnt vmcnt(6)
  ds_read_b128 v[32:35], v4 offset:3072
  v_cndmask_b32_e64 v179, 0, v221, s[82:83]
  v_and_b32 v221, 1, v220
  v_lshlrev_b32 v221, 4, v221
  v_lshlrev_b32 v221, v221, v223
  v_cmp_eq_i32_e64 s[82:83], 0, v222
  v_ashrrev_i32 v222, 1, v220
  ds_read_b128 v[36:39], v4 offset:3136
  v_cndmask_b32_e64 v182, 0, v221, s[82:83]
  v_and_b32 v221, 1, v220
  v_cndmask_b32_e64 v220, v7, v10, s[42:43]
  ds_read_b128 v[40:43], v4 offset:3200
  v_lshlrev_b32 v221, 4, v221
  s_waitcnt lgkmcnt(3)
  v_mfma_f32_16x16x32_bf16 v[156:159], v[20:23], v[20:23], 0
  v_lshlrev_b32 v221, v221, v223
  v_cmp_eq_i32_e64 s[82:83], 1, v222
  v_mfma_f32_16x16x32_bf16 v[156:159], v[24:27], v[24:27], v[156:159]
  v_cndmask_b32_e64 v222, v9, v12, s[54:55]
  v_cndmask_b32_e64 v183, 0, v221, s[82:83]
  v_mfma_f32_16x16x32_bf16 v[156:159], v[28:31], v[28:31], v[156:159]
  s_add_u32 m0, s22, 0x3000
  v_cndmask_b32_e64 v221, v8, v11, s[48:49]
  v_mfma_f32_16x16x32_bf16 v[60:63], v[232:235], v[20:23], 0
  buffer_load_dwordx4 v220, s[4:7], s74 offen nt lds
  s_waitcnt lgkmcnt(2)
  v_mfma_f32_16x16x32_bf16 v[168:171], v[32:35], v[32:35], 0
  s_add_u32 s75, s21, 0x15180
  ds_read_b64_tr_b16 v[110:111], v5 offset:8
  s_waitcnt lgkmcnt(1)
  v_mfma_f32_16x16x32_bf16 v[168:171], v[36:39], v[36:39], v[168:171]
  v_cndmask_b32_e64 v196, v156, v157, s[30:31]
  v_cndmask_b32_e64 v196, v196, v158, s[32:33]
  v_mfma_f32_16x16x32_bf16 v[168:171], v[40:43], v[40:43], v[168:171]
  buffer_load_dwordx4 v221, s[4:7], s74 offen offset:1024 nt lds
  v_mfma_f32_16x16x32_bf16 v[60:63], v[236:239], v[24:27], v[60:63]
  v_cndmask_b32_e64 v196, v196, v159, s[34:35]
  v_cndmask_b32_e64 v220, v7, v10, s[40:41]
  v_mfma_f32_16x16x32_bf16 v[60:63], v[240:243], v[28:31], v[60:63]
  v_cndmask_b32_e64 v221, v8, v11, s[46:47]
  v_lshlrev_b32 v0, 4, v1
  v_mfma_f32_16x16x32_bf16 v[72:75], v[20:23], a[156:159], 0
  v_cndmask_b32_e64 v204, v168, v169, s[30:31]
  v_cndmask_b32_e64 v204, v204, v170, s[32:33]
  v_mfma_f32_16x16x32_bf16 v[72:75], v[24:27], a[160:163], v[72:75]
  v_cndmask_b32_e64 v204, v204, v171, s[34:35]
  v_add_u32 v0, 0x18c00, v0
  v_mfma_f32_16x16x32_bf16 v[72:75], v[28:31], a[164:167], v[72:75]
  v_cvt_pk_bf16_f32 v100, v60, v61
  v_cvt_pk_bf16_f32 v101, v62, v63
  v_mfma_f32_16x16x32_bf16 v[60:63], v[232:235], v[32:35], 0
  ds_read_b128 a[0:3], v0
  ds_read_b128 a[4:7], v0 offset:1024
  v_mfma_f32_16x16x32_bf16 v[60:63], v[236:239], v[36:39], v[60:63]
  ds_read_b128 a[8:11], v0 offset:2048
  ds_read_b128 a[12:15], v0 offset:3072
  v_mfma_f32_16x16x32_bf16 v[60:63], v[240:243], v[40:43], v[60:63]
  buffer_load_dwordx4 v222, s[4:7], s74 offen offset:2048 nt lds
  v_mfma_f32_16x16x32_bf16 v[44:47], a[216:219], v[20:23], 0
  v_cvt_pk_bf16_f32 v108, v72, v73
  v_cvt_pk_bf16_f32 v109, v74, v75
  v_mfma_f32_16x16x32_bf16 v[72:75], v[20:23], a[192:195], 0
  ds_read_b128 a[16:19], v0 offset:4096
  ds_read_b128 a[20:23], v0 offset:5120
  v_mfma_f32_16x16x32_bf16 v[72:75], v[24:27], a[196:199], v[72:75]
  ds_read_b128 a[24:27], v0 offset:6144
  ds_read_b128 a[28:31], v0 offset:7168
  v_mfma_f32_16x16x32_bf16 v[72:75], v[28:31], a[200:203], v[72:75]
  ds_read_b128 a[32:35], v0 offset:8192
  ds_read_b128 a[36:39], v0 offset:9216
  v_mfma_f32_16x16x32_bf16 v[48:51], a[228:231], v[20:23], 0
  ds_read_b128 a[40:43], v0 offset:10240
  ds_read_b128 a[44:47], v0 offset:11264
  v_mfma_f32_16x16x32_bf16 v[68:71], v[20:23], a[144:147], 0
  ds_read_b128 a[48:51], v0 offset:12288
  ds_read_b128 a[52:55], v0 offset:13312
  v_mfma_f32_16x16x32_bf16 v[76:79], v[20:23], a[168:171], 0
  v_cvt_pk_bf16_f32 v120, v72, v73
  v_cvt_pk_bf16_f32 v121, v74, v75
  v_mfma_f32_16x16x32_bf16 v[72:75], v[32:35], a[156:159], 0
  ds_read_b128 a[56:59], v0 offset:14336
  ds_read_b128 a[60:63], v0 offset:15360
  v_mfma_f32_16x16x32_bf16 v[72:75], v[36:39], a[160:163], v[72:75]
  ds_read_b128 a[64:67], v0 offset:16384
  ds_read_b128 a[68:71], v0 offset:17408
  v_mfma_f32_16x16x32_bf16 v[72:75], v[40:43], a[164:167], v[72:75]
  ds_read_b128 a[72:75], v0 offset:39936
  ds_read_b128 a[76:79], v0 offset:40960
  v_mfma_f32_16x16x32_bf16 v[44:47], a[220:223], v[24:27], v[44:47]
  ds_read_b128 a[80:83], v0 offset:41984
  ds_read_b128 a[84:87], v0 offset:43008
  v_mfma_f32_16x16x32_bf16 v[48:51], a[232:235], v[24:27], v[48:51]
  ds_read_b128 a[88:91], v0 offset:44032
  ds_read_b128 a[92:95], v0 offset:45056
  v_mfma_f32_16x16x32_bf16 v[52:55], a[240:243], v[20:23], 0
  v_cvt_pk_bf16_f32 v132, v72, v73
  v_cvt_pk_bf16_f32 v133, v74, v75
  v_mfma_f32_16x16x32_bf16 v[72:75], v[32:35], a[192:195], 0
  ds_read_b128 a[96:99], v0 offset:46080
  ds_read_b128 a[100:103], v0 offset:47104
  v_mfma_f32_16x16x32_bf16 v[72:75], v[36:39], a[196:199], v[72:75]
  ds_read_b128 a[104:107], v0 offset:48128
  ds_read_b128 a[108:111], v0 offset:49152
  v_mfma_f32_16x16x32_bf16 v[72:75], v[40:43], a[200:203], v[72:75]
  s_add_u32 m0, s22, 0x3c00
  s_add_u32 s73, s21, 0x15480
  v_mfma_f32_16x16x32_bf16 v[56:59], a[252:255], v[20:23], 0
  buffer_load_dwordx4 v7, s[4:7], s75 offen nt lds
  v_mfma_f32_16x16x32_bf16 v[68:71], v[24:27], a[148:151], v[68:71]
  ds_read_b128 a[112:115], v0 offset:50176
  ds_read_b128 a[116:119], v0 offset:51200
  v_mfma_f32_16x16x32_bf16 v[76:79], v[24:27], a[172:175], v[76:79]
  v_cvt_pk_bf16_f32 v144, v72, v73
  v_cvt_pk_bf16_f32 v145, v74, v75
  v_mfma_f32_16x16x32_bf16 v[44:47], a[224:227], v[28:31], v[44:47]
  ds_read_b128 a[120:123], v0 offset:52224
  ds_read_b128 a[124:127], v0 offset:53248
  v_mfma_f32_16x16x32_bf16 v[48:51], a[236:239], v[28:31], v[48:51]
  ds_read_b128 a[128:131], v0 offset:54272
  ds_read_b128 a[132:135], v0 offset:55296
  v_mfma_f32_16x16x32_bf16 v[52:55], a[244:247], v[24:27], v[52:55]
  ds_read_b128 a[136:139], v0 offset:56320
  ds_read_b128 a[140:143], v0 offset:57344
  v_mfma_f32_16x16x32_bf16 v[56:59], v[224:227], v[24:27], v[56:59]
  v_cvt_pk_bf16_f32 v92, v44, v45
  v_cvt_pk_bf16_f32 v93, v46, v47
  v_mfma_f32_16x16x32_bf16 v[64:67], v[244:247], v[20:23], 0
  v_cvt_pk_bf16_f32 v94, v48, v49
  v_cvt_pk_bf16_f32 v95, v50, v51
  v_mfma_f32_16x16x32_bf16 v[68:71], v[28:31], a[152:155], v[68:71]
  v_cndmask_b32_e64 v222, v9, v12, s[52:53]
  ds_read_b64_tr_b16 v[122:123], v5 offset:128
  v_mfma_f32_16x16x32_bf16 v[76:79], v[28:31], a[176:179], v[76:79]
  ds_read_b64_tr_b16 v[134:135], v5 offset:3080
  ds_read_b64_tr_b16 v[106:107], v5
  v_mfma_f32_16x16x32_bf16 v[52:55], a[248:251], v[28:31], v[52:55]
  ds_read_b64_tr_b16 v[114:115], v5 offset:64
  ds_read_b64_tr_b16 v[118:119], v5 offset:72
  v_mfma_f32_16x16x32_bf16 v[56:59], v[228:231], v[28:31], v[56:59]
  v_cvt_pk_bf16_f32 v104, v68, v69
  v_cvt_pk_bf16_f32 v105, v70, v71
  v_mfma_f32_16x16x32_bf16 v[64:67], v[248:251], v[24:27], v[64:67]
  v_cvt_pk_bf16_f32 v112, v76, v77
  v_cvt_pk_bf16_f32 v113, v78, v79
  v_mfma_f32_16x16x32_bf16 v[64:67], v[252:255], v[28:31], v[64:67]
  v_cvt_pk_bf16_f32 v96, v52, v53
  v_cvt_pk_bf16_f32 v97, v54, v55
  v_mfma_f32_16x16x32_bf16 v[160:163], v[16:19], v[20:23], 0
  v_cvt_pk_bf16_f32 v98, v56, v57
  v_cvt_pk_bf16_f32 v99, v58, v59
  v_mfma_f32_16x16x32_bf16 v[152:155], v[20:23], v[92:95], 0
  s_waitcnt lgkmcnt(4)
  s_barrier
  ds_read_b64_tr_b16 v[146:147], v5 offset:3200
  v_mfma_f32_16x16x32_bf16 v[68:71], v[20:23], a[180:183], 0
  v_cvt_pk_bf16_f32 v102, v64, v65
  v_cvt_pk_bf16_f32 v103, v66, v67
  v_mfma_f32_16x16x32_bf16 v[76:79], v[20:23], a[204:207], 0
  s_waitcnt vmcnt(7)
  ds_read_b128 v[20:23], v4 offset:6144
  ds_read_b64_tr_b16 v[126:127], v5 offset:136
  v_mfma_f32_16x16x32_bf16 v[160:163], v[16:19], v[24:27], v[160:163]
  ds_read_b64_tr_b16 v[130:131], v5 offset:3072
  ds_read_b64_tr_b16 v[138:139], v5 offset:3136
  v_mfma_f32_16x16x32_bf16 v[152:155], v[24:27], v[96:99], v[152:155]
  ds_read_b64_tr_b16 v[142:143], v5 offset:3144
  ds_read_b64_tr_b16 v[150:151], v5 offset:3208
  v_mfma_f32_16x16x32_bf16 v[68:71], v[24:27], a[184:187], v[68:71]
  v_mfma_f32_16x16x32_bf16 v[76:79], v[24:27], a[208:211], v[76:79]
  ds_read_b128 v[24:27], v4 offset:6208
  v_mfma_f32_16x16x32_bf16 v[160:163], v[16:19], v[28:31], v[160:163]
  v_mfma_f32_16x16x32_bf16 v[152:155], v[28:31], v[100:103], v[152:155]
  v_cvt_pk_bf16_f32 v100, v60, v61
  v_cvt_pk_bf16_f32 v101, v62, v63
  v_mfma_f32_16x16x32_bf16 v[68:71], v[28:31], a[188:191], v[68:71]
  v_mfma_f32_16x16x32_bf16 v[76:79], v[28:31], a[212:215], v[76:79]
  ds_read_b128 v[28:31], v4 offset:6272
  s_waitcnt lgkmcnt(6)
  v_mfma_f32_16x16x32_bf16 v[156:159], v[20:23], v[20:23], 0
  v_mul_f32 v197, s58, v160
  v_mfma_f32_16x16x32_bf16 v[60:63], v[232:235], v[20:23], 0
  v_fma_f32 v196, -v197, v160, v196
  v_fma_f32 v196, v196, s58, v13
  v_mfma_f32_16x16x32_bf16 v[72:75], v[20:23], a[156:159], 0
  v_rsq_f32 v196, v196
  v_mfma_f32_16x16x32_bf16 v[44:47], a[216:219], v[32:35], 0
  v_mul_f32 v199, s59, v196
  v_mul_f32_dpp v152, v196, v152 quad_perm:[0,0,0,0] row_mask:0xf bank_mask:0xf
  s_waitcnt lgkmcnt(1)
  v_mfma_f32_16x16x32_bf16 v[156:159], v[24:27], v[24:27], v[156:159]
  v_mul_f32_dpp v153, v196, v153 quad_perm:[1,1,1,1] row_mask:0xf bank_mask:0xf
  v_mul_f32_dpp v154, v196, v154 quad_perm:[2,2,2,2] row_mask:0xf bank_mask:0xf
  v_mfma_f32_16x16x32_bf16 v[60:63], v[236:239], v[24:27], v[60:63]
  v_mul_f32_dpp v155, v196, v155 quad_perm:[3,3,3,3] row_mask:0xf bank_mask:0xf
  v_max3_f32 v198, v152, v153, v154
  v_mfma_f32_16x16x32_bf16 v[72:75], v[24:27], a[160:163], v[72:75]
  v_max_f32 v198, v198, v155
  v_mul_f32_e64 v200, -v198, v199
  v_mfma_f32_16x16x32_bf16 v[48:51], a[228:231], v[32:35], 0
  v_fma_f32 v152, v152, v199, v200
  v_fma_f32 v153, v153, v199, v200
  s_waitcnt lgkmcnt(0)
  v_mfma_f32_16x16x32_bf16 v[156:159], v[28:31], v[28:31], v[156:159]
  buffer_load_dwordx4 v8, s[4:7], s75 offen offset:1024 nt lds
  v_mfma_f32_16x16x32_bf16 v[60:63], v[240:243], v[28:31], v[60:63]
  buffer_load_dwordx4 v9, s[4:7], s75 offen offset:2048 nt lds
  v_mfma_f32_16x16x32_bf16 v[72:75], v[28:31], a[164:167], v[72:75]
  v_fma_f32 v154, v154, v199, v200
  v_fma_f32 v155, v155, v199, v200
  v_mfma_f32_16x16x32_bf16 v[44:47], a[220:223], v[36:39], v[44:47]
  v_exp_f32 v152, v152
  v_mfma_f32_16x16x32_bf16 v[48:51], a[232:235], v[36:39], v[48:51]
  v_exp_f32 v153, v153
  v_mfma_f32_16x16x32_bf16 v[52:55], a[240:243], v[32:35], 0
  v_exp_f32 v154, v154
  v_mfma_f32_16x16x32_bf16 v[56:59], a[252:255], v[32:35], 0
  v_exp_f32 v155, v155
  v_mfma_f32_16x16x32_bf16 v[44:47], a[224:227], v[40:43], v[44:47]
  v_add_f32 v201, v152, v153
  v_add_f32 v202, v154, v155
  v_mfma_f32_16x16x32_bf16 v[48:51], a[236:239], v[40:43], v[48:51]
  v_add_f32 v201, v201, v202
  v_rcp_f32 v201, v201
  v_mfma_f32_16x16x32_bf16 v[52:55], a[244:247], v[36:39], v[52:55]
  v_mul_f32_dpp v152, v196, v152 quad_perm:[0,0,0,0] row_mask:0xf bank_mask:0xf
  v_mul_f32_dpp v153, v196, v153 quad_perm:[1,1,1,1] row_mask:0xf bank_mask:0xf
  v_mfma_f32_16x16x32_bf16 v[56:59], v[224:227], v[36:39], v[56:59]
  v_mul_f32_dpp v154, v196, v154 quad_perm:[2,2,2,2] row_mask:0xf bank_mask:0xf
  v_mul_f32_dpp v155, v196, v155 quad_perm:[3,3,3,3] row_mask:0xf bank_mask:0xf
  v_mfma_f32_16x16x32_bf16 v[64:67], v[244:247], v[32:35], 0
  v_mul_f32 v152, v152, v201
  v_mul_f32 v153, v153, v201
  v_mfma_f32_16x16x32_bf16 v[52:55], a[248:251], v[40:43], v[52:55]
  v_mul_f32 v154, v154, v201
  v_mul_f32 v155, v155, v201
  v_mfma_f32_16x16x32_bf16 v[56:59], v[228:231], v[40:43], v[56:59]
  v_cvt_pk_bf16_f32 v152, v152, v153
  v_cvt_pk_bf16_f32 v154, v154, v155
  v_mfma_f32_16x16x32_bf16 v[64:67], v[248:251], v[36:39], v[64:67]
  v_cndmask_b32_e64 v176, 0, v152, s[36:37]
  v_cndmask_b32_e64 v177, 0, v154, s[36:37]
  v_mfma_f32_16x16x32_bf16 v[64:67], v[252:255], v[40:43], v[64:67]
  v_cvt_pk_bf16_f32 v116, v68, v69
  v_cvt_pk_bf16_f32 v117, v70, v71
  v_mfma_f32_16x16x32_bf16 v[84:87], v[108:111], v[176:179], 0
  v_cvt_pk_bf16_f32 v108, v72, v73
  v_cvt_pk_bf16_f32 v109, v74, v75
  v_mfma_f32_16x16x32_bf16 v[72:75], v[20:23], a[192:195], 0
  v_cvt_pk_bf16_f32 v124, v76, v77
  v_cvt_pk_bf16_f32 v125, v78, v79
  v_mfma_f32_16x16x32_bf16 v[72:75], v[24:27], a[196:199], v[72:75]
  v_cvt_pk_bf16_f32 v92, v44, v45
  v_cvt_pk_bf16_f32 v93, v46, v47
  v_mfma_f32_16x16x32_bf16 v[72:75], v[28:31], a[200:203], v[72:75]
  s_add_u32 m0, s22, 0x4800
  v_cvt_pk_bf16_f32 v94, v48, v49
  v_mfma_f32_16x16x32_bf16 v[68:71], v[32:35], a[144:147], 0
  buffer_load_dwordx4 v220, s[4:7], s73 offen nt lds
  v_mfma_f32_16x16x32_bf16 v[76:79], v[32:35], a[168:171], 0
  v_cvt_pk_bf16_f32 v95, v50, v51
  v_cvt_pk_bf16_f32 v96, v52, v53
  v_mfma_f32_16x16x32_bf16 v[68:71], v[36:39], a[148:151], v[68:71]
  v_cvt_pk_bf16_f32 v97, v54, v55
  v_cvt_pk_bf16_f32 v98, v56, v57
  v_mfma_f32_16x16x32_bf16 v[76:79], v[36:39], a[172:175], v[76:79]
  v_cvt_pk_bf16_f32 v99, v58, v59
  v_cvt_pk_bf16_f32 v102, v64, v65
  v_mfma_f32_16x16x32_bf16 v[68:71], v[40:43], a[152:155], v[68:71]
  v_cvt_pk_bf16_f32 v103, v66, v67
  v_cvt_pk_bf16_f32 v186, v84, v85
  v_mfma_f32_16x16x32_bf16 v[76:79], v[40:43], a[176:179], v[76:79]
  v_cvt_pk_bf16_f32 v187, v86, v87
  s_add_u32 s74, s21, 0x1fa40
  v_mfma_f32_16x16x32_bf16 v[172:175], v[16:19], v[32:35], 0
  v_cndmask_b32_e64 v196, v156, v157, s[30:31]
  v_cndmask_b32_e64 v196, v196, v158, s[32:33]
  v_mfma_f32_16x16x32_bf16 v[164:167], v[32:35], v[92:95], 0
  v_cvt_pk_bf16_f32 v128, v68, v69
  v_cvt_pk_bf16_f32 v129, v70, v71
  v_mfma_f32_16x16x32_bf16 v[68:71], v[32:35], a[180:183], 0
  v_cvt_pk_bf16_f32 v136, v76, v77
  v_cvt_pk_bf16_f32 v137, v78, v79
  v_mfma_f32_16x16x32_bf16 v[76:79], v[32:35], a[204:207], 0
  s_waitcnt vmcnt(7)
  ds_read_b128 v[32:35], v4 offset:9216
  v_cndmask_b32_e64 v196, v196, v159, s[34:35]
  v_mfma_f32_16x16x32_bf16 v[172:175], v[16:19], v[36:39], v[172:175]
  ds_read_b64_tr_b16 v[110:111], v5 offset:6152
  v_mfma_f32_16x16x32_bf16 v[164:167], v[36:39], v[96:99], v[164:167]
  v_mfma_f32_16x16x32_bf16 v[68:71], v[36:39], a[184:187], v[68:71]
  v_mfma_f32_16x16x32_bf16 v[76:79], v[36:39], a[208:211], v[76:79]
  ds_read_b128 v[36:39], v4 offset:9280
  v_mfma_f32_16x16x32_bf16 v[172:175], v[16:19], v[40:43], v[172:175]
  v_mfma_f32_16x16x32_bf16 v[164:167], v[40:43], v[100:103], v[164:167]
  v_cvt_pk_bf16_f32 v100, v60, v61
  v_cvt_pk_bf16_f32 v101, v62, v63
  v_mfma_f32_16x16x32_bf16 v[68:71], v[40:43], a[188:191], v[68:71]
  v_mfma_f32_16x16x32_bf16 v[76:79], v[40:43], a[212:215], v[76:79]
  ds_read_b128 v[40:43], v4 offset:9344
  s_waitcnt lgkmcnt(3)
  v_mfma_f32_16x16x32_bf16 v[168:171], v[32:35], v[32:35], 0
  v_mul_f32 v205, s58, v172
  v_mfma_f32_16x16x32_bf16 v[60:63], v[232:235], v[32:35], 0
  v_fma_f32 v204, -v205, v172, v204
  v_fma_f32 v204, v204, s58, v13
  v_mfma_f32_16x16x32_bf16 v[84:87], v[120:123], v[176:179], 0
  v_rsq_f32 v204, v204
  v_mfma_f32_16x16x32_bf16 v[44:47], a[216:219], v[20:23], 0
  v_mul_f32 v207, s59, v204
  v_mul_f32_dpp v164, v204, v164 quad_perm:[0,0,0,0] row_mask:0xf bank_mask:0xf
  s_waitcnt lgkmcnt(1)
  v_mfma_f32_16x16x32_bf16 v[168:171], v[36:39], v[36:39], v[168:171]
  v_mul_f32_dpp v165, v204, v165 quad_perm:[1,1,1,1] row_mask:0xf bank_mask:0xf
  v_mul_f32_dpp v166, v204, v166 quad_perm:[2,2,2,2] row_mask:0xf bank_mask:0xf
  v_mfma_f32_16x16x32_bf16 v[60:63], v[236:239], v[36:39], v[60:63]
  v_mul_f32_dpp v167, v204, v167 quad_perm:[3,3,3,3] row_mask:0xf bank_mask:0xf
  v_max3_f32 v206, v164, v165, v166
  v_mfma_f32_16x16x32_bf16 v[48:51], a[228:231], v[20:23], 0
  v_max_f32 v206, v206, v167
  v_mul_f32_e64 v208, -v206, v207
  v_mfma_f32_16x16x32_bf16 v[44:47], a[220:223], v[24:27], v[44:47]
  v_fma_f32 v164, v164, v207, v208
  v_fma_f32 v165, v165, v207, v208
  s_waitcnt lgkmcnt(0)
  v_mfma_f32_16x16x32_bf16 v[168:171], v[40:43], v[40:43], v[168:171]
  buffer_load_dwordx4 v221, s[4:7], s73 offen offset:1024 nt lds
  v_mfma_f32_16x16x32_bf16 v[60:63], v[240:243], v[40:43], v[60:63]
  buffer_load_dwordx4 v222, s[4:7], s73 offen offset:2048 nt lds
  v_mfma_f32_16x16x32_bf16 v[48:51], a[232:235], v[24:27], v[48:51]
  v_fma_f32 v166, v166, v207, v208
  v_fma_f32 v167, v167, v207, v208
  v_mfma_f32_16x16x32_bf16 v[52:55], a[240:243], v[20:23], 0
  v_exp_f32 v164, v164
  v_mfma_f32_16x16x32_bf16 v[56:59], a[252:255], v[20:23], 0
  v_exp_f32 v165, v165
  v_mfma_f32_16x16x32_bf16 v[44:47], a[224:227], v[28:31], v[44:47]
  v_exp_f32 v166, v166
  v_mfma_f32_16x16x32_bf16 v[48:51], a[236:239], v[28:31], v[48:51]
  v_exp_f32 v167, v167
  v_mfma_f32_16x16x32_bf16 v[52:55], a[244:247], v[24:27], v[52:55]
  v_add_f32 v209, v164, v165
  v_add_f32 v210, v166, v167
  v_mfma_f32_16x16x32_bf16 v[56:59], v[224:227], v[24:27], v[56:59]
  v_cvt_pk_bf16_f32 v120, v72, v73
  v_cvt_pk_bf16_f32 v121, v74, v75
  v_mfma_f32_16x16x32_bf16 v[72:75], v[32:35], a[156:159], 0
  v_add_f32 v209, v209, v210
  v_rcp_f32 v209, v209
  v_mfma_f32_16x16x32_bf16 v[72:75], v[36:39], a[160:163], v[72:75]
  v_mul_f32_dpp v164, v204, v164 quad_perm:[0,0,0,0] row_mask:0xf bank_mask:0xf
  v_mul_f32_dpp v165, v204, v165 quad_perm:[1,1,1,1] row_mask:0xf bank_mask:0xf
  v_mfma_f32_16x16x32_bf16 v[72:75], v[40:43], a[164:167], v[72:75]
  v_mul_f32_dpp v166, v204, v166 quad_perm:[2,2,2,2] row_mask:0xf bank_mask:0xf
  v_mul_f32_dpp v167, v204, v167 quad_perm:[3,3,3,3] row_mask:0xf bank_mask:0xf
  v_mfma_f32_16x16x32_bf16 v[64:67], v[244:247], v[20:23], 0
  v_mul_f32 v164, v164, v209
  v_mul_f32 v165, v165, v209
  v_mfma_f32_16x16x32_bf16 v[52:55], a[248:251], v[28:31], v[52:55]
  v_mul_f32 v166, v166, v209
  v_mul_f32 v167, v167, v209
  v_mfma_f32_16x16x32_bf16 v[56:59], v[228:231], v[28:31], v[56:59]
  v_cvt_pk_bf16_f32 v164, v164, v165
  v_cvt_pk_bf16_f32 v166, v166, v167
  v_mfma_f32_16x16x32_bf16 v[64:67], v[248:251], v[24:27], v[64:67]
  v_cndmask_b32_e64 v180, 0, v164, s[36:37]
  v_cndmask_b32_e64 v181, 0, v166, s[36:37]
  v_mfma_f32_16x16x32_bf16 v[80:83], v[104:107], v[176:179], 0
  v_cvt_pk_bf16_f32 v192, v84, v85
  v_cvt_pk_bf16_f32 v193, v86, v87
  v_mfma_f32_16x16x32_bf16 v[84:87], v[132:135], v[180:183], 0
  v_cvt_pk_bf16_f32 v132, v72, v73
  v_cvt_pk_bf16_f32 v133, v74, v75
  v_mfma_f32_16x16x32_bf16 v[72:75], v[32:35], a[192:195], 0
  v_cvt_pk_bf16_f32 v140, v68, v69
  v_cvt_pk_bf16_f32 v141, v70, v71
  v_mfma_f32_16x16x32_bf16 v[72:75], v[36:39], a[196:199], v[72:75]
  v_cvt_pk_bf16_f32 v148, v76, v77
  v_cvt_pk_bf16_f32 v149, v78, v79
  v_mfma_f32_16x16x32_bf16 v[72:75], v[40:43], a[200:203], v[72:75]
  s_add_u32 m0, s22, 0x5400
  v_cvt_pk_bf16_f32 v92, v44, v45
  v_mfma_f32_16x16x32_bf16 v[68:71], v[20:23], a[144:147], 0
  buffer_load_dwordx4 v7, s[4:7], s74 offen nt lds
  v_mfma_f32_16x16x32_bf16 v[76:79], v[20:23], a[168:171], 0
  v_cvt_pk_bf16_f32 v93, v46, v47
  v_cvt_pk_bf16_f32 v94, v48, v49
  v_mfma_f32_16x16x32_bf16 v[68:71], v[24:27], a[148:151], v[68:71]
  v_cvt_pk_bf16_f32 v95, v50, v51
  v_cvt_pk_bf16_f32 v96, v52, v53
  v_mfma_f32_16x16x32_bf16 v[76:79], v[24:27], a[172:175], v[76:79]
  v_cvt_pk_bf16_f32 v97, v54, v55
  v_cvt_pk_bf16_f32 v98, v56, v57
  v_mfma_f32_16x16x32_bf16 v[68:71], v[28:31], a[152:155], v[68:71]
  v_cvt_pk_bf16_f32 v99, v58, v59
  v_cvt_pk_bf16_f32 v184, v80, v81
  v_mfma_f32_16x16x32_bf16 v[76:79], v[28:31], a[176:179], v[76:79]
  v_cvt_pk_bf16_f32 v185, v82, v83
  ds_write_b128 v4, v[184:187]
  v_mfma_f32_16x16x32_bf16 v[88:91], v[112:115], v[176:179], 0
  s_add_u32 s75, s21, 0x2a000
  v_cndmask_b32_e64 v204, v168, v169, s[30:31]
  v_mfma_f32_16x16x32_bf16 v[64:67], v[252:255], v[28:31], v[64:67]
  v_cvt_pk_bf16_f32 v104, v68, v69
  v_cvt_pk_bf16_f32 v105, v70, v71
  v_mfma_f32_16x16x32_bf16 v[160:163], v[16:19], v[20:23], 0
  v_cvt_pk_bf16_f32 v112, v76, v77
  v_cvt_pk_bf16_f32 v113, v78, v79
  v_mfma_f32_16x16x32_bf16 v[152:155], v[20:23], v[92:95], 0
  v_cvt_pk_bf16_f32 v188, v88, v89
  v_cvt_pk_bf16_f32 v189, v90, v91
  v_mfma_f32_16x16x32_bf16 v[68:71], v[20:23], a[180:183], 0
  v_cvt_pk_bf16_f32 v102, v64, v65
  v_cvt_pk_bf16_f32 v103, v66, v67
  v_mfma_f32_16x16x32_bf16 v[76:79], v[20:23], a[204:207], 0
  v_cndmask_b32_e64 v204, v204, v170, s[32:33]
  v_cndmask_b32_e64 v204, v204, v171, s[34:35]
  v_mfma_f32_16x16x32_bf16 v[160:163], v[16:19], v[24:27], v[160:163]
  ds_read_b64_tr_b16 v[122:123], v5 offset:6272
  ds_read_b64_tr_b16 v[134:135], v5 offset:9224
  v_mfma_f32_16x16x32_bf16 v[152:155], v[24:27], v[96:99], v[152:155]
  ds_read_b64_tr_b16 v[106:107], v5 offset:6144
  ds_read_b64_tr_b16 v[114:115], v5 offset:6208
  v_mfma_f32_16x16x32_bf16 v[68:71], v[24:27], a[184:187], v[68:71]
  v_mfma_f32_16x16x32_bf16 v[76:79], v[24:27], a[208:211], v[76:79]
  v_mfma_f32_16x16x32_bf16 v[160:163], v[16:19], v[28:31], v[160:163]
  v_mfma_f32_16x16x32_bf16 v[152:155], v[28:31], v[100:103], v[152:155]
  v_cvt_pk_bf16_f32 v100, v60, v61
  v_cvt_pk_bf16_f32 v101, v62, v63
  v_mfma_f32_16x16x32_bf16 v[68:71], v[28:31], a[188:191], v[68:71]
  v_mfma_f32_16x16x32_bf16 v[76:79], v[28:31], a[212:215], v[76:79]
  v_mfma_f32_16x16x32_bf16 v[212:215], v[184:187], v[184:187], 0
  s_nop 1
  v_mul_f32 v197, s58, v160
  v_mfma_f32_16x16x32_bf16 v[216:219], v[16:19], v[184:187], 0
  v_fma_f32 v196, -v197, v160, v196
  v_fma_f32 v196, v196, s58, v13
  v_mfma_f32_16x16x32_bf16 v[80:83], v[116:119], v[176:179], 0
  v_rsq_f32 v196, v196
  v_mfma_f32_16x16x32_bf16 v[88:91], v[124:127], v[176:179], 0
  v_mul_f32 v199, s59, v196
  v_mul_f32_dpp v152, v196, v152 quad_perm:[0,0,0,0] row_mask:0xf bank_mask:0xf
  v_mfma_f32_16x16x32_bf16 v[44:47], a[216:219], v[32:35], 0
  v_mul_f32_dpp v153, v196, v153 quad_perm:[1,1,1,1] row_mask:0xf bank_mask:0xf
  v_mul_f32_dpp v154, v196, v154 quad_perm:[2,2,2,2] row_mask:0xf bank_mask:0xf
  v_mfma_f32_16x16x32_bf16 v[48:51], a[228:231], v[32:35], 0
  v_mul_f32_dpp v155, v196, v155 quad_perm:[3,3,3,3] row_mask:0xf bank_mask:0xf
  v_max3_f32 v198, v152, v153, v154
  v_mfma_f32_16x16x32_bf16 v[44:47], a[220:223], v[36:39], v[44:47]
  v_max_f32 v198, v198, v155
  v_mul_f32_e64 v200, -v198, v199
  v_mfma_f32_16x16x32_bf16 v[48:51], a[232:235], v[36:39], v[48:51]
  v_cvt_pk_bf16_f32 v186, v84, v85
  v_cvt_pk_bf16_f32 v187, v86, v87
  v_mfma_f32_16x16x32_bf16 v[84:87], v[144:147], v[180:183], 0
  v_fma_f32 v152, v152, v199, v200
  v_fma_f32 v153, v153, v199, v200
  v_mfma_f32_16x16x32_bf16 v[52:55], a[240:243], v[32:35], 0
  v_fma_f32 v154, v154, v199, v200
  v_fma_f32 v155, v155, v199, v200
  v_mfma_f32_16x16x32_bf16 v[56:59], a[252:255], v[32:35], 0
  v_exp_f32 v152, v152
  v_mfma_f32_16x16x32_bf16 v[44:47], a[224:227], v[40:43], v[44:47]
  v_exp_f32 v153, v153
  v_mfma_f32_16x16x32_bf16 v[48:51], a[236:239], v[40:43], v[48:51]
  v_exp_f32 v154, v154
  v_mfma_f32_16x16x32_bf16 v[52:55], a[244:247], v[36:39], v[52:55]
  v_exp_f32 v155, v155
  v_mfma_f32_16x16x32_bf16 v[56:59], v[224:227], v[36:39], v[56:59]
  v_add_f32 v201, v152, v153
  v_add_f32 v202, v154, v155
  v_mfma_f32_16x16x32_bf16 v[64:67], v[244:247], v[32:35], 0
  v_cvt_pk_bf16_f32 v144, v72, v73
  v_cvt_pk_bf16_f32 v145, v74, v75
  v_mfma_f32_16x16x32_bf16 v[52:55], a[248:251], v[40:43], v[52:55]
  v_cvt_pk_bf16_f32 v190, v80, v81
  v_cvt_pk_bf16_f32 v191, v82, v83
  v_mfma_f32_16x16x32_bf16 v[56:59], v[228:231], v[40:43], v[56:59]
  v_add_f32 v201, v201, v202
  v_rcp_f32 v201, v201
  v_mfma_f32_16x16x32_bf16 v[212:215], v[188:191], v[188:191], v[212:215]
  v_cvt_pk_bf16_f32 v194, v88, v89
  v_cvt_pk_bf16_f32 v195, v90, v91
  v_mfma_f32_16x16x32_bf16 v[216:219], v[16:19], v[188:191], v[216:219]
  v_mul_f32_dpp v152, v196, v152 quad_perm:[0,0,0,0] row_mask:0xf bank_mask:0xf
  v_mul_f32_dpp v153, v196, v153 quad_perm:[1,1,1,1] row_mask:0xf bank_mask:0xf
  v_mfma_f32_16x16x32_bf16 v[212:215], v[192:195], v[192:195], v[212:215]
  v_mul_f32_dpp v154, v196, v154 quad_perm:[2,2,2,2] row_mask:0xf bank_mask:0xf
  v_mul_f32_dpp v155, v196, v155 quad_perm:[3,3,3,3] row_mask:0xf bank_mask:0xf
  v_mfma_f32_16x16x32_bf16 v[216:219], v[16:19], v[192:195], v[216:219]
  v_mul_f32 v152, v152, v201
  v_mul_f32 v153, v153, v201
  v_mfma_f32_16x16x32_bf16 v[64:67], v[248:251], v[36:39], v[64:67]
  v_mul_f32 v154, v154, v201
  v_mul_f32 v155, v155, v201
  v_mfma_f32_16x16x32_bf16 v[80:83], v[128:131], v[180:183], 0
  ds_write_b128 v4, v[188:191] offset:64
  v_cvt_pk_bf16_f32 v152, v152, v153
  v_mfma_f32_16x16x32_bf16 v[88:91], v[136:139], v[180:183], 0
  v_cvt_pk_bf16_f32 v154, v154, v155
  ds_write_b128 v4, v[192:195] offset:128
  v_mfma_f32_16x16x32_bf16 v[64:67], v[252:255], v[40:43], v[64:67]
  v_cndmask_b32_e64 v176, 0, v152, s[36:37]
  v_cndmask_b32_e64 v177, 0, v154, s[36:37]
  v_mfma_f32_16x16x32_bf16 v[172:175], v[16:19], v[32:35], 0
  v_cvt_pk_bf16_f32 v192, v84, v85
  v_cvt_pk_bf16_f32 v193, v86, v87
  v_mfma_f32_16x16x32_bf16 v[84:87], v[108:111], v[176:179], 0
  v_cvt_pk_bf16_f32 v116, v68, v69
  v_cvt_pk_bf16_f32 v117, v70, v71
  v_mfma_f32_16x16x32_bf16 v[68:71], v[32:35], a[144:147], 0
  v_cvt_pk_bf16_f32 v124, v76, v77
  v_cvt_pk_bf16_f32 v125, v78, v79
  v_mfma_f32_16x16x32_bf16 v[76:79], v[32:35], a[168:171], 0
  v_cvt_pk_bf16_f32 v92, v44, v45
  v_cvt_pk_bf16_f32 v93, v46, v47
  v_mfma_f32_16x16x32_bf16 v[68:71], v[36:39], a[148:151], v[68:71]
  v_cvt_pk_bf16_f32 v94, v48, v49
  v_cvt_pk_bf16_f32 v95, v50, v51
  v_mfma_f32_16x16x32_bf16 v[76:79], v[36:39], a[172:175], v[76:79]
  v_cvt_pk_bf16_f32 v96, v52, v53
  v_cvt_pk_bf16_f32 v97, v54, v55
  v_mfma_f32_16x16x32_bf16 v[68:71], v[40:43], a[152:155], v[68:71]
  v_cvt_pk_bf16_f32 v98, v56, v57
  v_cvt_pk_bf16_f32 v99, v58, v59
  v_mfma_f32_16x16x32_bf16 v[76:79], v[40:43], a[176:179], v[76:79]
  v_cvt_pk_bf16_f32 v102, v64, v65
  v_cvt_pk_bf16_f32 v103, v66, v67
  v_mfma_f32_16x16x32_bf16 v[164:167], v[32:35], v[92:95], 0
  v_cndmask_b32_e64 v217, v212, v213, s[30:31]
  v_cndmask_b32_e64 v217, v217, v214, s[32:33]
  v_mfma_f32_16x16x32_bf16 v[172:175], v[16:19], v[36:39], v[172:175]
  v_cvt_pk_bf16_f32 v128, v68, v69
  v_cvt_pk_bf16_f32 v129, v70, v71
  v_mfma_f32_16x16x32_bf16 v[68:71], v[32:35], a[180:183], 0
  v_cvt_pk_bf16_f32 v136, v76, v77
  v_cvt_pk_bf16_f32 v137, v78, v79
  v_mfma_f32_16x16x32_bf16 v[76:79], v[32:35], a[204:207], 0
  s_waitcnt vmcnt(7)
  ds_read_b128 v[20:23], v4 offset:12288
  ds_read_b128 v[24:27], v4 offset:12352
  v_mfma_f32_16x16x32_bf16 v[164:167], v[36:39], v[96:99], v[164:167]
  ds_read_b128 v[28:31], v4 offset:12416
  v_cndmask_b32_e64 v217, v217, v215, s[34:35]
  v_mfma_f32_16x16x32_bf16 v[68:71], v[36:39], a[184:187], v[68:71]
  v_mul_f32 v218, s58, v216
  v_fma_f32 v217, -v218, v216, v217
  v_mfma_f32_16x16x32_bf16 v[76:79], v[36:39], a[208:211], v[76:79]
  v_fma_f32 v217, v217, s58, v13
  v_rsq_f32 v217, v217
  v_mfma_f32_16x16x32_bf16 v[172:175], v[16:19], v[40:43], v[172:175]
  v_cvt_pk_bf16_f32 v184, v80, v81
  v_cvt_pk_bf16_f32 v185, v82, v83
  v_mfma_f32_16x16x32_bf16 v[164:167], v[40:43], v[100:103], v[164:167]
  ds_write_b32 v6, v217 offset:192
  ds_write_b128 v4, v[184:187] offset:3072
  v_mfma_f32_16x16x32_bf16 v[68:71], v[40:43], a[188:191], v[68:71]
  v_cvt_pk_bf16_f32 v188, v88, v89
  v_cvt_pk_bf16_f32 v189, v90, v91
  v_mfma_f32_16x16x32_bf16 v[76:79], v[40:43], a[212:215], v[76:79]
  v_mul_f32 v205, s58, v172
  v_fma_f32 v204, -v205, v172, v204
  v_mfma_f32_16x16x32_bf16 v[212:215], v[184:187], v[184:187], 0
  v_fma_f32 v204, v204, s58, v13
  v_rsq_f32 v204, v204
  s_waitcnt lgkmcnt(2)
  v_mfma_f32_16x16x32_bf16 v[156:159], v[20:23], v[20:23], 0
  v_mul_f32 v207, s59, v204
  v_mul_f32_dpp v164, v204, v164 quad_perm:[0,0,0,0] row_mask:0xf bank_mask:0xf
  v_mfma_f32_16x16x32_bf16 v[156:159], v[24:27], v[24:27], v[156:159]
  v_mul_f32_dpp v165, v204, v165 quad_perm:[1,1,1,1] row_mask:0xf bank_mask:0xf
  v_mul_f32_dpp v166, v204, v166 quad_perm:[2,2,2,2] row_mask:0xf bank_mask:0xf
  v_mfma_f32_16x16x32_bf16 v[156:159], v[28:31], v[28:31], v[156:159]
  buffer_load_dwordx4 v8, s[4:7], s74 offen offset:1024 nt lds
  v_mfma_f32_16x16x32_bf16 v[60:63], v[232:235], v[20:23], 0
  v_mul_f32_dpp v167, v204, v167 quad_perm:[3,3,3,3] row_mask:0xf bank_mask:0xf
  v_max3_f32 v206, v164, v165, v166
  v_mfma_f32_16x16x32_bf16 v[60:63], v[236:239], v[24:27], v[60:63]
  v_max_f32 v206, v206, v167
  v_mul_f32_e64 v208, -v206, v207
  v_mfma_f32_16x16x32_bf16 v[60:63], v[240:243], v[28:31], v[60:63]
  buffer_load_dwordx4 v9, s[4:7], s74 offen offset:2048 nt lds
  v_mfma_f32_16x16x32_bf16 v[72:75], v[20:23], a[156:159], 0
  v_fma_f32 v164, v164, v207, v208
  v_fma_f32 v165, v165, v207, v208
  v_mfma_f32_16x16x32_bf16 v[72:75], v[24:27], a[160:163], v[72:75]
  v_fma_f32 v166, v166, v207, v208
  v_fma_f32 v167, v167, v207, v208
  v_mfma_f32_16x16x32_bf16 v[72:75], v[28:31], a[164:167], v[72:75]
  v_cvt_pk_bf16_f32 v100, v60, v61
  v_cvt_pk_bf16_f32 v101, v62, v63
  v_mfma_f32_16x16x32_bf16 v[216:219], v[16:19], v[184:187], 0
  v_cvt_pk_bf16_f32 v186, v84, v85
  v_cvt_pk_bf16_f32 v187, v86, v87
  v_mfma_f32_16x16x32_bf16 v[80:83], v[140:143], v[180:183], 0
  v_exp_f32 v164, v164
  v_mfma_f32_16x16x32_bf16 v[84:87], v[120:123], v[176:179], 0
  v_cvt_pk_bf16_f32 v108, v72, v73
  v_cvt_pk_bf16_f32 v109, v74, v75
  v_mfma_f32_16x16x32_bf16 v[72:75], v[20:23], a[192:195], 0
  v_exp_f32 v165, v165
  v_mfma_f32_16x16x32_bf16 v[72:75], v[24:27], a[196:199], v[72:75]
  v_exp_f32 v166, v166
  v_mfma_f32_16x16x32_bf16 v[72:75], v[28:31], a[200:203], v[72:75]
  s_add_u32 m0, s22, 0x6000
  v_exp_f32 v167, v167
  v_mfma_f32_16x16x32_bf16 v[88:91], v[148:151], v[180:183], 0
  buffer_load_dwordx4 v7, s[4:7], s75 offen nt lds
  v_mfma_f32_16x16x32_bf16 v[44:47], a[216:219], v[20:23], 0
  v_add_f32 v209, v164, v165
  v_add_f32 v210, v166, v167
  v_mfma_f32_16x16x32_bf16 v[48:51], a[228:231], v[20:23], 0
  v_cvt_pk_bf16_f32 v120, v72, v73
  v_cvt_pk_bf16_f32 v121, v74, v75
  v_mfma_f32_16x16x32_bf16 v[44:47], a[220:223], v[24:27], v[44:47]
  v_cvt_pk_bf16_f32 v190, v80, v81
  v_cvt_pk_bf16_f32 v191, v82, v83
  v_mfma_f32_16x16x32_bf16 v[48:51], a[232:235], v[24:27], v[48:51]
  v_add_f32 v209, v209, v210
  v_rcp_f32 v209, v209
  v_mfma_f32_16x16x32_bf16 v[212:215], v[188:191], v[188:191], v[212:215]
  v_cvt_pk_bf16_f32 v194, v88, v89
  v_cvt_pk_bf16_f32 v195, v90, v91
  v_mfma_f32_16x16x32_bf16 v[216:219], v[16:19], v[188:191], v[216:219]
  v_mul_f32_dpp v164, v204, v164 quad_perm:[0,0,0,0] row_mask:0xf bank_mask:0xf
  v_mul_f32_dpp v165, v204, v165 quad_perm:[1,1,1,1] row_mask:0xf bank_mask:0xf
  v_mfma_f32_16x16x32_bf16 v[212:215], v[192:195], v[192:195], v[212:215]
  v_mul_f32_dpp v166, v204, v166 quad_perm:[2,2,2,2] row_mask:0xf bank_mask:0xf
  v_mul_f32_dpp v167, v204, v167 quad_perm:[3,3,3,3] row_mask:0xf bank_mask:0xf
  v_mfma_f32_16x16x32_bf16 v[216:219], v[16:19], v[192:195], v[216:219]
  v_mul_f32 v164, v164, v209
  v_mul_f32 v165, v165, v209
  v_mfma_f32_16x16x32_bf16 v[52:55], a[240:243], v[20:23], 0
  v_mul_f32 v166, v166, v209
  v_mul_f32 v167, v167, v209
  v_mfma_f32_16x16x32_bf16 v[56:59], a[252:255], v[20:23], 0
  ds_write_b128 v4, v[188:191] offset:3136
  v_cvt_pk_bf16_f32 v164, v164, v165
  v_mfma_f32_16x16x32_bf16 v[44:47], a[224:227], v[28:31], v[44:47]
  v_cvt_pk_bf16_f32 v166, v166, v167
  ds_write_b128 v4, v[192:195] offset:3200
  v_mfma_f32_16x16x32_bf16 v[48:51], a[236:239], v[28:31], v[48:51]
  v_cndmask_b32_e64 v180, 0, v164, s[36:37]
  v_cndmask_b32_e64 v181, 0, v166, s[36:37]
  v_mfma_f32_16x16x32_bf16 v[52:55], a[244:247], v[24:27], v[52:55]
  v_cvt_pk_bf16_f32 v192, v84, v85
  v_cvt_pk_bf16_f32 v193, v86, v87
  v_mfma_f32_16x16x32_bf16 v[84:87], v[132:135], v[180:183], 0
  s_add_u32 s73, s21, 0x2a300
  v_cndmask_b32_e64 v220, v7, v10, s[44:45]
  v_mfma_f32_16x16x32_bf16 v[56:59], v[224:227], v[24:27], v[56:59]
  v_cvt_pk_bf16_f32 v140, v68, v69
  v_cvt_pk_bf16_f32 v141, v70, v71
  v_mfma_f32_16x16x32_bf16 v[68:71], v[20:23], a[144:147], 0
  v_cvt_pk_bf16_f32 v148, v76, v77
  v_cvt_pk_bf16_f32 v149, v78, v79
  v_mfma_f32_16x16x32_bf16 v[76:79], v[20:23], a[168:171], 0
  v_cvt_pk_bf16_f32 v92, v44, v45
  v_cvt_pk_bf16_f32 v93, v46, v47
  v_mfma_f32_16x16x32_bf16 v[68:71], v[24:27], a[148:151], v[68:71]
  v_cvt_pk_bf16_f32 v94, v48, v49
  v_cvt_pk_bf16_f32 v95, v50, v51
  v_mfma_f32_16x16x32_bf16 v[76:79], v[24:27], a[172:175], v[76:79]
  v_cndmask_b32_e64 v196, v156, v157, s[30:31]
  v_cndmask_b32_e64 v196, v196, v158, s[32:33]
  v_mfma_f32_16x16x32_bf16 v[64:67], v[244:247], v[20:23], 0
  v_cndmask_b32_e64 v196, v196, v159, s[34:35]
  ds_read_b64_tr_b16 v[118:119], v5 offset:6216
  v_mfma_f32_16x16x32_bf16 v[68:71], v[28:31], a[152:155], v[68:71]
  ds_read_b64_tr_b16 v[146:147], v5 offset:9344
  ds_read_b64_tr_b16 v[126:127], v5 offset:6280
  v_mfma_f32_16x16x32_bf16 v[76:79], v[28:31], a[176:179], v[76:79]
  v_cndmask_b32_e64 v217, v212, v213, s[30:31]
  v_cndmask_b32_e64 v217, v217, v214, s[32:33]
  v_mfma_f32_16x16x32_bf16 v[52:55], a[248:251], v[28:31], v[52:55]
  v_cndmask_b32_e64 v217, v217, v215, s[34:35]
  v_mul_f32 v218, s58, v216
  v_mfma_f32_16x16x32_bf16 v[56:59], v[228:231], v[28:31], v[56:59]
  v_fma_f32 v217, -v218, v216, v217
  v_fma_f32 v217, v217, s58, v13
  v_mfma_f32_16x16x32_bf16 v[64:67], v[248:251], v[24:27], v[64:67]
  ds_read_b64_tr_b16 v[110:111], v5 offset:12296
  v_rsq_f32 v217, v217
  v_mfma_f32_16x16x32_bf16 v[80:83], v[104:107], v[176:179], 0
  v_cvt_pk_bf16_f32 v104, v68, v69
  s_waitcnt vmcnt(7)
  ds_read_b128 v[32:35], v4 offset:15360
  v_mfma_f32_16x16x32_bf16 v[88:91], v[112:115], v[176:179], 0
  ds_read_b128 v[36:39], v4 offset:15424
  ds_read_b128 v[40:43], v4 offset:15488
  v_mfma_f32_16x16x32_bf16 v[64:67], v[252:255], v[28:31], v[64:67]
  v_cvt_pk_bf16_f32 v105, v70, v71
  v_cvt_pk_bf16_f32 v112, v76, v77
  v_mfma_f32_16x16x32_bf16 v[160:163], v[16:19], v[20:23], 0
  v_cvt_pk_bf16_f32 v113, v78, v79
  v_cvt_pk_bf16_f32 v96, v52, v53
  v_mfma_f32_16x16x32_bf16 v[152:155], v[20:23], v[92:95], 0
  v_cvt_pk_bf16_f32 v97, v54, v55
  v_cvt_pk_bf16_f32 v98, v56, v57
  v_mfma_f32_16x16x32_bf16 v[68:71], v[20:23], a[180:183], 0
  v_cvt_pk_bf16_f32 v99, v58, v59
  v_cvt_pk_bf16_f32 v102, v64, v65
  v_mfma_f32_16x16x32_bf16 v[76:79], v[20:23], a[204:207], 0
  v_cvt_pk_bf16_f32 v103, v66, v67
  v_cvt_pk_bf16_f32 v184, v80, v81
  v_mfma_f32_16x16x32_bf16 v[160:163], v[16:19], v[24:27], v[160:163]
  v_cvt_pk_bf16_f32 v185, v82, v83
  ds_write_b32 v6, v217
  v_mfma_f32_16x16x32_bf16 v[152:155], v[24:27], v[96:99], v[152:155]
  v_cndmask_b32_e64 v221, v8, v11, s[50:51]
  v_cndmask_b32_e64 v222, v9, v12, s[56:57]
  s_waitcnt lgkmcnt(1)
  v_mfma_f32_16x16x32_bf16 v[168:171], v[32:35], v[32:35], 0
  ds_write_b128 v4, v[184:187] offset:6144
  v_cvt_pk_bf16_f32 v188, v88, v89
  v_mfma_f32_16x16x32_bf16 v[168:171], v[36:39], v[36:39], v[168:171]
  v_cvt_pk_bf16_f32 v189, v90, v91
  ds_read_b64_tr_b16 v[130:131], v5 offset:9216
  v_mfma_f32_16x16x32_bf16 v[168:171], v[40:43], v[40:43], v[168:171]
  buffer_load_dwordx4 v8, s[4:7], s75 offen offset:1024 nt lds
  v_mfma_f32_16x16x32_bf16 v[60:63], v[232:235], v[32:35], 0
  ds_read_b64_tr_b16 v[138:139], v5 offset:9280
  ds_read_b64_tr_b16 v[142:143], v5 offset:9288
  v_mfma_f32_16x16x32_bf16 v[60:63], v[236:239], v[36:39], v[60:63]
  ds_read_b64_tr_b16 v[122:123], v5 offset:12416
  ds_read_b64_tr_b16 v[150:151], v5 offset:9352
  v_mfma_f32_16x16x32_bf16 v[60:63], v[240:243], v[40:43], v[60:63]
  buffer_load_dwordx4 v9, s[4:7], s75 offen offset:2048 nt lds
  v_mfma_f32_16x16x32_bf16 v[72:75], v[32:35], a[156:159], 0
  v_cndmask_b32_e64 v204, v168, v169, s[30:31]
  v_cndmask_b32_e64 v204, v204, v170, s[32:33]
  v_mfma_f32_16x16x32_bf16 v[72:75], v[36:39], a[160:163], v[72:75]
  v_cndmask_b32_e64 v204, v204, v171, s[34:35]
  ds_read_b64_tr_b16 v[134:135], v5 offset:15368
  v_mfma_f32_16x16x32_bf16 v[72:75], v[40:43], a[164:167], v[72:75]
  ds_read_b64_tr_b16 v[106:107], v5 offset:12288
  ds_read_b64_tr_b16 v[114:115], v5 offset:12352
  v_mfma_f32_16x16x32_bf16 v[68:71], v[24:27], a[184:187], v[68:71]
  v_mfma_f32_16x16x32_bf16 v[76:79], v[24:27], a[208:211], v[76:79]
  v_mfma_f32_16x16x32_bf16 v[160:163], v[16:19], v[28:31], v[160:163]
  v_mfma_f32_16x16x32_bf16 v[152:155], v[28:31], v[100:103], v[152:155]
  v_cvt_pk_bf16_f32 v100, v60, v61
  v_cvt_pk_bf16_f32 v101, v62, v63
  v_mfma_f32_16x16x32_bf16 v[68:71], v[28:31], a[188:191], v[68:71]
  v_cvt_pk_bf16_f32 v132, v72, v73
  v_cvt_pk_bf16_f32 v133, v74, v75
  v_mfma_f32_16x16x32_bf16 v[72:75], v[32:35], a[192:195], 0
  s_nop 0
  v_mul_f32 v197, s58, v160
  v_mfma_f32_16x16x32_bf16 v[72:75], v[36:39], a[196:199], v[72:75]
  v_fma_f32 v196, -v197, v160, v196
  v_fma_f32 v196, v196, s58, v13
  v_mfma_f32_16x16x32_bf16 v[72:75], v[40:43], a[200:203], v[72:75]
  s_add_u32 m0, s22, 0x6c00
  v_rsq_f32 v196, v196
  v_mfma_f32_16x16x32_bf16 v[76:79], v[28:31], a[212:215], v[76:79]
  buffer_load_dwordx4 v220, s[4:7], s73 offen nt lds
  v_mfma_f32_16x16x32_bf16 v[212:215], v[184:187], v[184:187], 0
  v_mul_f32_dpp v152, v196, v152 quad_perm:[0,0,0,0] row_mask:0xf bank_mask:0xf
  v_mul_f32_dpp v153, v196, v153 quad_perm:[1,1,1,1] row_mask:0xf bank_mask:0xf
  v_mfma_f32_16x16x32_bf16 v[216:219], v[16:19], v[184:187], 0
  v_mul_f32_dpp v154, v196, v154 quad_perm:[2,2,2,2] row_mask:0xf bank_mask:0xf
  v_mul_f32_dpp v155, v196, v155 quad_perm:[3,3,3,3] row_mask:0xf bank_mask:0xf
  v_mfma_f32_16x16x32_bf16 v[80:83], v[116:119], v[176:179], 0
  v_max3_f32 v198, v152, v153, v154
  v_max_f32 v198, v198, v155
  v_mfma_f32_16x16x32_bf16 v[88:91], v[124:127], v[176:179], 0
  v_mul_f32 v199, s59, v196
  v_mul_f32_e64 v200, -v198, v199
  v_mfma_f32_16x16x32_bf16 v[44:47], a[216:219], v[32:35], 0
  v_cvt_pk_bf16_f32 v186, v84, v85
  v_cvt_pk_bf16_f32 v187, v86, v87
  v_mfma_f32_16x16x32_bf16 v[84:87], v[144:147], v[180:183], 0
  v_fma_f32 v152, v152, v199, v200
  v_fma_f32 v153, v153, v199, v200
  v_mfma_f32_16x16x32_bf16 v[48:51], a[228:231], v[32:35], 0
  v_fma_f32 v154, v154, v199, v200
  v_fma_f32 v155, v155, v199, v200
  v_mfma_f32_16x16x32_bf16 v[44:47], a[220:223], v[36:39], v[44:47]
  v_exp_f32 v152, v152
  v_mfma_f32_16x16x32_bf16 v[48:51], a[232:235], v[36:39], v[48:51]
  v_exp_f32 v153, v153
  v_mfma_f32_16x16x32_bf16 v[52:55], a[240:243], v[32:35], 0
  v_exp_f32 v154, v154
  v_mfma_f32_16x16x32_bf16 v[56:59], a[252:255], v[32:35], 0
  v_exp_f32 v155, v155
  v_mfma_f32_16x16x32_bf16 v[44:47], a[224:227], v[40:43], v[44:47]
  v_add_f32 v201, v152, v153
  v_add_f32 v202, v154, v155
  v_mfma_f32_16x16x32_bf16 v[48:51], a[236:239], v[40:43], v[48:51]
  v_cvt_pk_bf16_f32 v144, v72, v73
  v_cvt_pk_bf16_f32 v145, v74, v75
  v_mfma_f32_16x16x32_bf16 v[52:55], a[244:247], v[36:39], v[52:55]
  v_cvt_pk_bf16_f32 v190, v80, v81
  v_cvt_pk_bf16_f32 v191, v82, v83
  v_mfma_f32_16x16x32_bf16 v[56:59], v[224:227], v[36:39], v[56:59]
  v_add_f32 v201, v201, v202
  v_rcp_f32 v201, v201
  v_mfma_f32_16x16x32_bf16 v[212:215], v[188:191], v[188:191], v[212:215]
  v_cvt_pk_bf16_f32 v194, v88, v89
  v_cvt_pk_bf16_f32 v195, v90, v91
  v_mfma_f32_16x16x32_bf16 v[216:219], v[16:19], v[188:191], v[216:219]
  v_mul_f32_dpp v152, v196, v152 quad_perm:[0,0,0,0] row_mask:0xf bank_mask:0xf
  v_mul_f32_dpp v153, v196, v153 quad_perm:[1,1,1,1] row_mask:0xf bank_mask:0xf
  v_mfma_f32_16x16x32_bf16 v[212:215], v[192:195], v[192:195], v[212:215]
  v_mul_f32_dpp v154, v196, v154 quad_perm:[2,2,2,2] row_mask:0xf bank_mask:0xf
  v_mul_f32_dpp v155, v196, v155 quad_perm:[3,3,3,3] row_mask:0xf bank_mask:0xf
  v_mfma_f32_16x16x32_bf16 v[216:219], v[16:19], v[192:195], v[216:219]
  v_mul_f32 v152, v152, v201
  v_mul_f32 v153, v153, v201
  v_mfma_f32_16x16x32_bf16 v[64:67], v[244:247], v[32:35], 0
  s_waitcnt vmcnt(7)
  ds_read_b128 v[20:23], v4 offset:18432
  ds_read_b128 v[24:27], v4 offset:18496
  v_mfma_f32_16x16x32_bf16 v[52:55], a[248:251], v[40:43], v[52:55]
  ds_read_b128 v[28:31], v4 offset:18560
  v_mul_f32 v154, v154, v201
  v_mfma_f32_16x16x32_bf16 v[56:59], v[228:231], v[40:43], v[56:59]
  v_mul_f32 v155, v155, v201
  ds_write_b128 v4, v[188:191] offset:6208
  v_mfma_f32_16x16x32_bf16 v[64:67], v[248:251], v[36:39], v[64:67]
  v_cvt_pk_bf16_f32 v152, v152, v153
  v_cvt_pk_bf16_f32 v154, v154, v155
  s_waitcnt lgkmcnt(4)
  v_mfma_f32_16x16x32_bf16 v[80:83], v[128:131], v[180:183], 0
  ds_write_b128 v4, v[192:195] offset:6272
  v_cndmask_b32_e64 v176, 0, v152, s[36:37]
  v_mfma_f32_16x16x32_bf16 v[88:91], v[136:139], v[180:183], 0
  v_cndmask_b32_e64 v177, 0, v154, s[36:37]
  v_cvt_pk_bf16_f32 v192, v84, v85
  v_mfma_f32_16x16x32_bf16 v[64:67], v[252:255], v[40:43], v[64:67]
  v_cvt_pk_bf16_f32 v193, v86, v87
  s_add_u32 s74, s21, 0x348c0
  v_mfma_f32_16x16x32_bf16 v[84:87], v[108:111], v[176:179], 0
  v_cvt_pk_bf16_f32 v116, v68, v69
  v_cvt_pk_bf16_f32 v117, v70, v71
  v_mfma_f32_16x16x32_bf16 v[68:71], v[32:35], a[144:147], 0
  v_cvt_pk_bf16_f32 v124, v76, v77
  v_cvt_pk_bf16_f32 v125, v78, v79
  s_waitcnt lgkmcnt(1)
  v_mfma_f32_16x16x32_bf16 v[156:159], v[20:23], v[20:23], 0
  v_cvt_pk_bf16_f32 v92, v44, v45
  v_cvt_pk_bf16_f32 v93, v46, v47
  v_mfma_f32_16x16x32_bf16 v[156:159], v[24:27], v[24:27], v[156:159]
  v_cvt_pk_bf16_f32 v94, v48, v49
  v_cvt_pk_bf16_f32 v95, v50, v51
  v_mfma_f32_16x16x32_bf16 v[156:159], v[28:31], v[28:31], v[156:159]
  buffer_load_dwordx4 v221, s[4:7], s73 offen offset:1024 nt lds
  v_mfma_f32_16x16x32_bf16 v[60:63], v[232:235], v[20:23], 0
  v_cvt_pk_bf16_f32 v96, v52, v53
  v_cvt_pk_bf16_f32 v97, v54, v55
  v_mfma_f32_16x16x32_bf16 v[60:63], v[236:239], v[24:27], v[60:63]
  v_cvt_pk_bf16_f32 v98, v56, v57
  v_cvt_pk_bf16_f32 v99, v58, v59
  v_mfma_f32_16x16x32_bf16 v[60:63], v[240:243], v[28:31], v[60:63]
  buffer_load_dwordx4 v222, s[4:7], s73 offen offset:2048 nt lds
  v_mfma_f32_16x16x32_bf16 v[72:75], v[20:23], a[156:159], 0
  v_cvt_pk_bf16_f32 v102, v64, v65
  v_cvt_pk_bf16_f32 v103, v66, v67
  v_mfma_f32_16x16x32_bf16 v[72:75], v[24:27], a[160:163], v[72:75]
  v_cndmask_b32_e64 v217, v212, v213, s[30:31]
  v_cndmask_b32_e64 v217, v217, v214, s[32:33]
  v_mfma_f32_16x16x32_bf16 v[72:75], v[28:31], a[164:167], v[72:75]
  v_cndmask_b32_e64 v217, v217, v215, s[34:35]
  v_mul_f32 v218, s58, v216
  v_mfma_f32_16x16x32_bf16 v[76:79], v[32:35], a[168:171], 0
  v_fma_f32 v217, -v218, v216, v217
  v_fma_f32 v217, v217, s58, v13
  v_mfma_f32_16x16x32_bf16 v[68:71], v[36:39], a[148:151], v[68:71]
  v_rsq_f32 v217, v217
  v_mfma_f32_16x16x32_bf16 v[76:79], v[36:39], a[172:175], v[76:79]
  v_cvt_pk_bf16_f32 v108, v72, v73
  v_cvt_pk_bf16_f32 v109, v74, v75
  v_mfma_f32_16x16x32_bf16 v[72:75], v[20:23], a[192:195], 0
  v_cvt_pk_bf16_f32 v184, v80, v81
  v_cvt_pk_bf16_f32 v185, v82, v83
  v_mfma_f32_16x16x32_bf16 v[72:75], v[24:27], a[196:199], v[72:75]
  ds_write_b32 v6, v217 offset:16
  ds_write_b128 v4, v[184:187] offset:9216
  v_mfma_f32_16x16x32_bf16 v[72:75], v[28:31], a[200:203], v[72:75]
  s_add_u32 m0, s22, 0x7800
  v_cvt_pk_bf16_f32 v188, v88, v89
  v_mfma_f32_16x16x32_bf16 v[68:71], v[40:43], a[152:155], v[68:71]
  buffer_load_dwordx4 v7, s[4:7], s74 offen nt lds
  v_mfma_f32_16x16x32_bf16 v[76:79], v[40:43], a[176:179], v[76:79]
  v_cvt_pk_bf16_f32 v189, v90, v91
  s_add_u32 s75, s21, 0x34bc0
  v_mfma_f32_16x16x32_bf16 v[172:175], v[16:19], v[32:35], 0
  v_cndmask_b32_e64 v220, v7, v10, s[42:43]
  v_cndmask_b32_e64 v196, v156, v157, s[30:31]
  v_mfma_f32_16x16x32_bf16 v[164:167], v[32:35], v[92:95], 0
  v_cvt_pk_bf16_f32 v128, v68, v69
  v_cvt_pk_bf16_f32 v129, v70, v71
  v_mfma_f32_16x16x32_bf16 v[68:71], v[32:35], a[180:183], 0
  v_cvt_pk_bf16_f32 v136, v76, v77
  v_cvt_pk_bf16_f32 v137, v78, v79
  v_mfma_f32_16x16x32_bf16 v[76:79], v[32:35], a[204:207], 0
  v_cndmask_b32_e64 v196, v196, v158, s[32:33]
  v_cndmask_b32_e64 v196, v196, v159, s[34:35]
  v_mfma_f32_16x16x32_bf16 v[172:175], v[16:19], v[36:39], v[172:175]
  ds_read_b64_tr_b16 v[118:119], v5 offset:12360
  ds_read_b64_tr_b16 v[146:147], v5 offset:15488
  v_mfma_f32_16x16x32_bf16 v[164:167], v[36:39], v[96:99], v[164:167]
  ds_read_b64_tr_b16 v[126:127], v5 offset:12424
  ds_read_b64_tr_b16 v[110:111], v5 offset:18440
  v_mfma_f32_16x16x32_bf16 v[68:71], v[36:39], a[184:187], v[68:71]
  ds_read_b64_tr_b16 v[130:131], v5 offset:15360
  ds_read_b64_tr_b16 v[138:139], v5 offset:15424
  v_mfma_f32_16x16x32_bf16 v[76:79], v[36:39], a[208:211], v[76:79]
  v_mfma_f32_16x16x32_bf16 v[172:175], v[16:19], v[40:43], v[172:175]
  v_mfma_f32_16x16x32_bf16 v[164:167], v[40:43], v[100:103], v[164:167]
  v_cvt_pk_bf16_f32 v100, v60, v61
  v_cvt_pk_bf16_f32 v101, v62, v63
  v_mfma_f32_16x16x32_bf16 v[68:71], v[40:43], a[188:191], v[68:71]
  v_mfma_f32_16x16x32_bf16 v[76:79], v[40:43], a[212:215], v[76:79]
  v_mfma_f32_16x16x32_bf16 v[212:215], v[184:187], v[184:187], 0
  s_nop 1
  v_mul_f32 v205, s58, v172
  v_mfma_f32_16x16x32_bf16 v[216:219], v[16:19], v[184:187], 0
  v_fma_f32 v204, -v205, v172, v204
  v_fma_f32 v204, v204, s58, v13
  v_mfma_f32_16x16x32_bf16 v[80:83], v[140:143], v[180:183], 0
  v_rsq_f32 v204, v204
  v_mfma_f32_16x16x32_bf16 v[88:91], v[148:151], v[180:183], 0
  v_mul_f32 v207, s59, v204
  v_mul_f32_dpp v164, v204, v164 quad_perm:[0,0,0,0] row_mask:0xf bank_mask:0xf
  v_mfma_f32_16x16x32_bf16 v[44:47], a[216:219], v[20:23], 0
  v_mul_f32_dpp v165, v204, v165 quad_perm:[1,1,1,1] row_mask:0xf bank_mask:0xf
  v_mul_f32_dpp v166, v204, v166 quad_perm:[2,2,2,2] row_mask:0xf bank_mask:0xf
  v_mfma_f32_16x16x32_bf16 v[48:51], a[228:231], v[20:23], 0
  v_mul_f32_dpp v167, v204, v167 quad_perm:[3,3,3,3] row_mask:0xf bank_mask:0xf
  v_max3_f32 v206, v164, v165, v166
  v_mfma_f32_16x16x32_bf16 v[44:47], a[220:223], v[24:27], v[44:47]
  v_max_f32 v206, v206, v167
  v_mul_f32_e64 v208, -v206, v207
  v_mfma_f32_16x16x32_bf16 v[48:51], a[232:235], v[24:27], v[48:51]
  v_cvt_pk_bf16_f32 v186, v84, v85
  v_cvt_pk_bf16_f32 v187, v86, v87
  v_mfma_f32_16x16x32_bf16 v[84:87], v[120:123], v[176:179], 0
  v_fma_f32 v164, v164, v207, v208
  v_fma_f32 v165, v165, v207, v208
  v_mfma_f32_16x16x32_bf16 v[52:55], a[240:243], v[20:23], 0
  v_fma_f32 v166, v166, v207, v208
  v_fma_f32 v167, v167, v207, v208
  v_mfma_f32_16x16x32_bf16 v[56:59], a[252:255], v[20:23], 0
  v_exp_f32 v164, v164
  v_mfma_f32_16x16x32_bf16 v[44:47], a[224:227], v[28:31], v[44:47]
  v_exp_f32 v165, v165
  v_mfma_f32_16x16x32_bf16 v[48:51], a[236:239], v[28:31], v[48:51]
  v_exp_f32 v166, v166
  v_mfma_f32_16x16x32_bf16 v[52:55], a[244:247], v[24:27], v[52:55]
  v_exp_f32 v167, v167
  v_mfma_f32_16x16x32_bf16 v[56:59], v[224:227], v[24:27], v[56:59]
  v_add_f32 v209, v164, v165
  v_add_f32 v210, v166, v167
  v_mfma_f32_16x16x32_bf16 v[64:67], v[244:247], v[20:23], 0
  v_cvt_pk_bf16_f32 v120, v72, v73
  v_cvt_pk_bf16_f32 v121, v74, v75
  v_mfma_f32_16x16x32_bf16 v[52:55], a[248:251], v[28:31], v[52:55]
  v_cvt_pk_bf16_f32 v190, v80, v81
  v_cvt_pk_bf16_f32 v191, v82, v83
  v_mfma_f32_16x16x32_bf16 v[56:59], v[228:231], v[28:31], v[56:59]
  v_add_f32 v209, v209, v210
  v_rcp_f32 v209, v209
  v_mfma_f32_16x16x32_bf16 v[212:215], v[188:191], v[188:191], v[212:215]
  v_cvt_pk_bf16_f32 v194, v88, v89
  v_cvt_pk_bf16_f32 v195, v90, v91
  v_mfma_f32_16x16x32_bf16 v[216:219], v[16:19], v[188:191], v[216:219]
  v_mul_f32_dpp v164, v204, v164 quad_perm:[0,0,0,0] row_mask:0xf bank_mask:0xf
  v_mul_f32_dpp v165, v204, v165 quad_perm:[1,1,1,1] row_mask:0xf bank_mask:0xf
  v_mfma_f32_16x16x32_bf16 v[212:215], v[192:195], v[192:195], v[212:215]
  v_mul_f32_dpp v166, v204, v166 quad_perm:[2,2,2,2] row_mask:0xf bank_mask:0xf
  v_mul_f32_dpp v167, v204, v167 quad_perm:[3,3,3,3] row_mask:0xf bank_mask:0xf
  v_mfma_f32_16x16x32_bf16 v[216:219], v[16:19], v[192:195], v[216:219]
  v_mul_f32 v164, v164, v209
  v_mul_f32 v165, v165, v209
  v_mfma_f32_16x16x32_bf16 v[64:67], v[248:251], v[24:27], v[64:67]
  v_mul_f32 v166, v166, v209
  v_mul_f32 v167, v167, v209
  v_mfma_f32_16x16x32_bf16 v[80:83], v[104:107], v[176:179], 0
  ds_write_b128 v4, v[188:191] offset:9280
  v_cvt_pk_bf16_f32 v164, v164, v165
  v_mfma_f32_16x16x32_bf16 v[88:91], v[112:115], v[176:179], 0
  v_cvt_pk_bf16_f32 v166, v166, v167
  ds_write_b128 v4, v[192:195] offset:9344
  v_mfma_f32_16x16x32_bf16 v[64:67], v[252:255], v[28:31], v[64:67]
  v_cndmask_b32_e64 v180, 0, v164, s[36:37]
  v_cndmask_b32_e64 v181, 0, v166, s[36:37]
  v_mfma_f32_16x16x32_bf16 v[160:163], v[16:19], v[20:23], 0
  v_cvt_pk_bf16_f32 v192, v84, v85
  v_cvt_pk_bf16_f32 v193, v86, v87
  v_mfma_f32_16x16x32_bf16 v[84:87], v[132:135], v[180:183], 0
  v_cvt_pk_bf16_f32 v140, v68, v69
  v_cvt_pk_bf16_f32 v141, v70, v71
  v_mfma_f32_16x16x32_bf16 v[68:71], v[20:23], a[144:147], 0
  v_cvt_pk_bf16_f32 v148, v76, v77
  v_cvt_pk_bf16_f32 v149, v78, v79
  v_mfma_f32_16x16x32_bf16 v[76:79], v[20:23], a[168:171], 0
  v_cvt_pk_bf16_f32 v92, v44, v45
  v_cvt_pk_bf16_f32 v93, v46, v47
  v_mfma_f32_16x16x32_bf16 v[68:71], v[24:27], a[148:151], v[68:71]
  v_cvt_pk_bf16_f32 v94, v48, v49
  v_cvt_pk_bf16_f32 v95, v50, v51
  v_mfma_f32_16x16x32_bf16 v[76:79], v[24:27], a[172:175], v[76:79]
  v_cvt_pk_bf16_f32 v96, v52, v53
  v_cvt_pk_bf16_f32 v97, v54, v55
  v_mfma_f32_16x16x32_bf16 v[68:71], v[28:31], a[152:155], v[68:71]
  v_cvt_pk_bf16_f32 v98, v56, v57
  v_cvt_pk_bf16_f32 v99, v58, v59
  v_mfma_f32_16x16x32_bf16 v[76:79], v[28:31], a[176:179], v[76:79]
  v_cvt_pk_bf16_f32 v102, v64, v65
  v_cvt_pk_bf16_f32 v103, v66, v67
  v_mfma_f32_16x16x32_bf16 v[152:155], v[20:23], v[92:95], 0
  v_cndmask_b32_e64 v217, v212, v213, s[30:31]
  v_cndmask_b32_e64 v217, v217, v214, s[32:33]
  v_mfma_f32_16x16x32_bf16 v[160:163], v[16:19], v[24:27], v[160:163]
  v_cvt_pk_bf16_f32 v104, v68, v69
  v_cvt_pk_bf16_f32 v105, v70, v71
  v_mfma_f32_16x16x32_bf16 v[68:71], v[20:23], a[180:183], 0
  v_cvt_pk_bf16_f32 v112, v76, v77
  v_cvt_pk_bf16_f32 v113, v78, v79
  v_mfma_f32_16x16x32_bf16 v[76:79], v[20:23], a[204:207], 0
  v_cndmask_b32_e64 v217, v217, v215, s[34:35]
  v_mul_f32 v218, s58, v216
  v_mfma_f32_16x16x32_bf16 v[152:155], v[24:27], v[96:99], v[152:155]
  v_fma_f32 v217, -v218, v216, v217
  v_fma_f32 v217, v217, s58, v13
  v_mfma_f32_16x16x32_bf16 v[68:71], v[24:27], a[184:187], v[68:71]
  v_rsq_f32 v217, v217
  v_mfma_f32_16x16x32_bf16 v[76:79], v[24:27], a[208:211], v[76:79]
  v_cvt_pk_bf16_f32 v184, v80, v81
  v_cvt_pk_bf16_f32 v185, v82, v83
  v_mfma_f32_16x16x32_bf16 v[160:163], v[16:19], v[28:31], v[160:163]
  ds_write_b32 v6, v217 offset:32
  v_cndmask_b32_e64 v221, v8, v11, s[48:49]
  v_mfma_f32_16x16x32_bf16 v[152:155], v[28:31], v[100:103], v[152:155]
  v_cndmask_b32_e64 v222, v9, v12, s[54:55]
  ds_write_b128 v4, v[184:187] offset:12288
  v_mfma_f32_16x16x32_bf16 v[68:71], v[28:31], a[188:191], v[68:71]
  v_cvt_pk_bf16_f32 v188, v88, v89
  v_cvt_pk_bf16_f32 v189, v90, v91
  v_mfma_f32_16x16x32_bf16 v[76:79], v[28:31], a[212:215], v[76:79]
  v_mul_f32 v197, s58, v160
  v_fma_f32 v196, -v197, v160, v196
  v_mfma_f32_16x16x32_bf16 v[212:215], v[184:187], v[184:187], 0
  v_fma_f32 v196, v196, s58, v13
  v_rsq_f32 v196, v196
  v_mfma_f32_16x16x32_bf16 v[216:219], v[16:19], v[184:187], 0
  v_mul_f32 v199, s59, v196
  v_mul_f32_dpp v152, v196, v152 quad_perm:[0,0,0,0] row_mask:0xf bank_mask:0xf
  s_waitcnt lgkmcnt(2)
  v_mfma_f32_16x16x32_bf16 v[80:83], v[116:119], v[176:179], 0
  v_mul_f32_dpp v153, v196, v153 quad_perm:[1,1,1,1] row_mask:0xf bank_mask:0xf
  v_mul_f32_dpp v154, v196, v154 quad_perm:[2,2,2,2] row_mask:0xf bank_mask:0xf
  v_mfma_f32_16x16x32_bf16 v[88:91], v[124:127], v[176:179], 0
  v_mul_f32_dpp v155, v196, v155 quad_perm:[3,3,3,3] row_mask:0xf bank_mask:0xf
  v_max3_f32 v198, v152, v153, v154
  v_max_f32 v198, v198, v155
  v_mul_f32_e64 v200, -v198, v199
  v_cvt_pk_bf16_f32 v186, v84, v85
  v_cvt_pk_bf16_f32 v187, v86, v87
  v_mfma_f32_16x16x32_bf16 v[84:87], v[144:147], v[180:183], 0
  v_fma_f32 v152, v152, v199, v200
  v_fma_f32 v153, v153, v199, v200
  v_fma_f32 v154, v154, v199, v200
  v_fma_f32 v155, v155, v199, v200
  v_exp_f32 v152, v152
  v_exp_f32 v153, v153
  v_exp_f32 v154, v154
  v_exp_f32 v155, v155
  v_add_f32 v201, v152, v153
  v_add_f32 v202, v154, v155
  s_waitcnt vmcnt(7)
  ds_read_b128 v[32:35], v4 offset:21504
  ds_read_b128 v[36:39], v4 offset:21568
  ds_read_b128 v[40:43], v4 offset:21632
  v_cvt_pk_bf16_f32 v190, v80, v81
  v_cvt_pk_bf16_f32 v191, v82, v83
  v_mfma_f32_16x16x32_bf16 v[80:83], v[128:131], v[180:183], 0
  v_add_f32 v201, v201, v202
  v_rcp_f32 v201, v201
  v_mfma_f32_16x16x32_bf16 v[212:215], v[188:191], v[188:191], v[212:215]
  v_cvt_pk_bf16_f32 v194, v88, v89
  v_cvt_pk_bf16_f32 v195, v90, v91
  v_mfma_f32_16x16x32_bf16 v[216:219], v[16:19], v[188:191], v[216:219]
  v_mul_f32_dpp v152, v196, v152 quad_perm:[0,0,0,0] row_mask:0xf bank_mask:0xf
  v_mul_f32_dpp v153, v196, v153 quad_perm:[1,1,1,1] row_mask:0xf bank_mask:0xf
  v_mfma_f32_16x16x32_bf16 v[212:215], v[192:195], v[192:195], v[212:215]
  v_mul_f32_dpp v154, v196, v154 quad_perm:[2,2,2,2] row_mask:0xf bank_mask:0xf
  v_mul_f32_dpp v155, v196, v155 quad_perm:[3,3,3,3] row_mask:0xf bank_mask:0xf
  v_mfma_f32_16x16x32_bf16 v[216:219], v[16:19], v[192:195], v[216:219]
  v_mul_f32 v152, v152, v201
  v_mul_f32 v153, v153, v201
  v_mfma_f32_16x16x32_bf16 v[88:91], v[136:139], v[180:183], 0
  v_mul_f32 v154, v154, v201
  v_mul_f32 v155, v155, v201
  ds_write_b128 v4, v[188:191] offset:12352
  v_cvt_pk_bf16_f32 v152, v152, v153
  s_waitcnt lgkmcnt(1)
  v_mfma_f32_16x16x32_bf16 v[168:171], v[32:35], v[32:35], 0
  v_cvt_pk_bf16_f32 v154, v154, v155
  ds_write_b128 v4, v[192:195] offset:12416
  v_mfma_f32_16x16x32_bf16 v[168:171], v[36:39], v[36:39], v[168:171]
  v_cndmask_b32_e64 v176, 0, v152, s[36:37]
  v_cndmask_b32_e64 v177, 0, v154, s[36:37]
  v_mfma_f32_16x16x32_bf16 v[168:171], v[40:43], v[40:43], v[168:171]
  buffer_load_dwordx4 v8, s[4:7], s74 offen offset:1024 nt lds
  v_mfma_f32_16x16x32_bf16 v[60:63], v[232:235], v[32:35], 0
  v_cvt_pk_bf16_f32 v192, v84, v85
  v_cvt_pk_bf16_f32 v193, v86, v87
  v_mfma_f32_16x16x32_bf16 v[60:63], v[236:239], v[36:39], v[60:63]
  v_cvt_pk_bf16_f32 v116, v68, v69
  v_cvt_pk_bf16_f32 v117, v70, v71
  v_mfma_f32_16x16x32_bf16 v[60:63], v[240:243], v[40:43], v[60:63]
  buffer_load_dwordx4 v9, s[4:7], s74 offen offset:2048 nt lds
  v_mfma_f32_16x16x32_bf16 v[72:75], v[32:35], a[156:159], 0
  v_cvt_pk_bf16_f32 v124, v76, v77
  v_cvt_pk_bf16_f32 v125, v78, v79
  v_mfma_f32_16x16x32_bf16 v[72:75], v[36:39], a[160:163], v[72:75]
  v_cndmask_b32_e64 v204, v168, v169, s[30:31]
  v_cndmask_b32_e64 v204, v204, v170, s[32:33]
  v_mfma_f32_16x16x32_bf16 v[72:75], v[40:43], a[164:167], v[72:75]
  v_cvt_pk_bf16_f32 v100, v60, v61
  v_cvt_pk_bf16_f32 v101, v62, v63
  v_mfma_f32_16x16x32_bf16 v[84:87], v[108:111], v[176:179], 0
  v_cndmask_b32_e64 v204, v204, v171, s[34:35]
  ds_read_b64_tr_b16 v[142:143], v5 offset:15432
  v_mfma_f32_16x16x32_bf16 v[44:47], a[216:219], v[32:35], 0
  ds_read_b64_tr_b16 v[150:151], v5 offset:15496
  ds_read_b64_tr_b16 v[106:107], v5 offset:18432
  v_mfma_f32_16x16x32_bf16 v[48:51], a[228:231], v[32:35], 0
  v_cvt_pk_bf16_f32 v132, v72, v73
  v_cvt_pk_bf16_f32 v133, v74, v75
  v_mfma_f32_16x16x32_bf16 v[72:75], v[32:35], a[192:195], 0
  v_cndmask_b32_e64 v217, v212, v213, s[30:31]
  ds_read_b64_tr_b16 v[114:115], v5 offset:18496
  v_mfma_f32_16x16x32_bf16 v[72:75], v[36:39], a[196:199], v[72:75]
  v_cndmask_b32_e64 v217, v217, v214, s[32:33]
  v_cndmask_b32_e64 v217, v217, v215, s[34:35]
  v_mfma_f32_16x16x32_bf16 v[72:75], v[40:43], a[200:203], v[72:75]
  s_add_u32 m0, s22, 0x8400
  s_add_u32 s73, s21, 0x3f180
  v_mfma_f32_16x16x32_bf16 v[68:71], v[32:35], a[144:147], 0
  buffer_load_dwordx4 v220, s[4:7], s75 offen nt lds
  v_mfma_f32_16x16x32_bf16 v[76:79], v[32:35], a[168:171], 0
  v_mul_f32 v218, s58, v216
  v_fma_f32 v217, -v218, v216, v217
  v_mfma_f32_16x16x32_bf16 v[44:47], a[220:223], v[36:39], v[44:47]
  v_cvt_pk_bf16_f32 v144, v72, v73
  v_cvt_pk_bf16_f32 v145, v74, v75
  v_mfma_f32_16x16x32_bf16 v[48:51], a[232:235], v[36:39], v[48:51]
  v_cvt_pk_bf16_f32 v184, v80, v81
  v_cvt_pk_bf16_f32 v185, v82, v83
  v_mfma_f32_16x16x32_bf16 v[52:55], a[240:243], v[32:35], 0
  v_fma_f32 v217, v217, s58, v13
  ds_read_b64_tr_b16 v[118:119], v5 offset:18504
  v_mfma_f32_16x16x32_bf16 v[56:59], a[252:255], v[32:35], 0
  v_rsq_f32 v217, v217
  v_mfma_f32_16x16x32_bf16 v[68:71], v[36:39], a[148:151], v[68:71]
  v_cvt_pk_bf16_f32 v188, v88, v89
  v_cvt_pk_bf16_f32 v189, v90, v91
  v_mfma_f32_16x16x32_bf16 v[76:79], v[36:39], a[172:175], v[76:79]
  ds_read_b64_tr_b16 v[122:123], v5 offset:18560
  ds_read_b64_tr_b16 v[126:127], v5 offset:18568
  v_mfma_f32_16x16x32_bf16 v[44:47], a[224:227], v[40:43], v[44:47]
  ds_write_b32 v6, v217 offset:48
  ds_read_b64_tr_b16 v[130:131], v5 offset:21504
  v_mfma_f32_16x16x32_bf16 v[48:51], a[236:239], v[40:43], v[48:51]
  ds_read_b64_tr_b16 v[134:135], v5 offset:21512
  ds_read_b64_tr_b16 v[138:139], v5 offset:21568
  v_mfma_f32_16x16x32_bf16 v[52:55], a[244:247], v[36:39], v[52:55]
  ds_write_b128 v4, v[184:187] offset:15360
  ds_read_b64_tr_b16 v[146:147], v5 offset:21632
  v_mfma_f32_16x16x32_bf16 v[56:59], v[224:227], v[36:39], v[56:59]
  v_cvt_pk_bf16_f32 v92, v44, v45
  v_cvt_pk_bf16_f32 v93, v46, v47
  v_mfma_f32_16x16x32_bf16 v[64:67], v[244:247], v[32:35], 0
  v_cvt_pk_bf16_f32 v94, v48, v49
  v_cvt_pk_bf16_f32 v95, v50, v51
  v_mfma_f32_16x16x32_bf16 v[68:71], v[40:43], a[152:155], v[68:71]
  v_mfma_f32_16x16x32_bf16 v[76:79], v[40:43], a[176:179], v[76:79]
  v_mfma_f32_16x16x32_bf16 v[52:55], a[248:251], v[40:43], v[52:55]
  v_mfma_f32_16x16x32_bf16 v[56:59], v[228:231], v[40:43], v[56:59]
  v_mfma_f32_16x16x32_bf16 v[64:67], v[248:251], v[36:39], v[64:67]
  v_mfma_f32_16x16x32_bf16 v[64:67], v[252:255], v[40:43], v[64:67]
  v_mfma_f32_16x16x32_bf16 v[172:175], v[16:19], v[32:35], 0
  s_nop 1
  v_cvt_pk_bf16_f32 v128, v68, v69
  v_mfma_f32_16x16x32_bf16 v[164:167], v[32:35], v[92:95], 0
  v_cvt_pk_bf16_f32 v129, v70, v71
  v_cvt_pk_bf16_f32 v136, v76, v77
  v_mfma_f32_16x16x32_bf16 v[68:71], v[32:35], a[180:183], 0
  v_cvt_pk_bf16_f32 v137, v78, v79
  v_cvt_pk_bf16_f32 v96, v52, v53
  v_mfma_f32_16x16x32_bf16 v[76:79], v[32:35], a[204:207], 0
  v_cvt_pk_bf16_f32 v97, v54, v55
  v_cvt_pk_bf16_f32 v98, v56, v57
  v_mfma_f32_16x16x32_bf16 v[172:175], v[16:19], v[36:39], v[172:175]
  v_cvt_pk_bf16_f32 v99, v58, v59
  v_cvt_pk_bf16_f32 v102, v64, v65
  v_mfma_f32_16x16x32_bf16 v[68:71], v[36:39], a[184:187], v[68:71]
  v_cvt_pk_bf16_f32 v103, v66, v67
  v_mfma_f32_16x16x32_bf16 v[164:167], v[36:39], v[96:99], v[164:167]
  v_mfma_f32_16x16x32_bf16 v[76:79], v[36:39], a[208:211], v[76:79]
  v_mfma_f32_16x16x32_bf16 v[172:175], v[16:19], v[40:43], v[172:175]
  s_waitcnt vmcnt(7)
  ds_read_b128 v[20:23], v4 offset:24576
  ds_read_b128 v[24:27], v4 offset:24640
  v_mfma_f32_16x16x32_bf16 v[164:167], v[40:43], v[100:103], v[164:167]
  ds_read_b128 v[28:31], v4 offset:24704
  ds_read_b64_tr_b16 v[110:111], v5 offset:24584
  v_mfma_f32_16x16x32_bf16 v[68:71], v[40:43], a[188:191], v[68:71]
  v_mfma_f32_16x16x32_bf16 v[76:79], v[40:43], a[212:215], v[76:79]
  v_mul_f32 v205, s58, v172
  s_waitcnt lgkmcnt(4)
  v_mfma_f32_16x16x32_bf16 v[80:83], v[140:143], v[180:183], 0
  v_fma_f32 v204, -v205, v172, v204
  v_fma_f32 v204, v204, s58, v13
  v_mfma_f32_16x16x32_bf16 v[88:91], v[148:151], v[180:183], 0
  v_rsq_f32 v204, v204
  v_mfma_f32_16x16x32_bf16 v[212:215], v[184:187], v[184:187], 0
  v_cvt_pk_bf16_f32 v140, v68, v69
  v_cvt_pk_bf16_f32 v141, v70, v71
  v_mfma_f32_16x16x32_bf16 v[216:219], v[16:19], v[184:187], 0
  v_cvt_pk_bf16_f32 v190, v80, v81
  v_cvt_pk_bf16_f32 v191, v82, v83
  v_mfma_f32_16x16x32_bf16 v[80:83], v[104:107], v[176:179], 0
  v_cvt_pk_bf16_f32 v194, v88, v89
  v_cvt_pk_bf16_f32 v195, v90, v91
  s_waitcnt lgkmcnt(0)
  v_mfma_f32_16x16x32_bf16 v[156:159], v[20:23], v[20:23], 0
  v_cvt_pk_bf16_f32 v148, v76, v77
  v_cvt_pk_bf16_f32 v149, v78, v79
  v_mfma_f32_16x16x32_bf16 v[156:159], v[24:27], v[24:27], v[156:159]
  v_mul_f32_dpp v164, v204, v164 quad_perm:[0,0,0,0] row_mask:0xf bank_mask:0xf
  v_mul_f32_dpp v165, v204, v165 quad_perm:[1,1,1,1] row_mask:0xf bank_mask:0xf
  v_mfma_f32_16x16x32_bf16 v[156:159], v[28:31], v[28:31], v[156:159]
  buffer_load_dwordx4 v221, s[4:7], s75 offen offset:1024 nt lds
  v_mfma_f32_16x16x32_bf16 v[60:63], v[232:235], v[20:23], 0
  v_mul_f32_dpp v166, v204, v166 quad_perm:[2,2,2,2] row_mask:0xf bank_mask:0xf
  v_mul_f32_dpp v167, v204, v167 quad_perm:[3,3,3,3] row_mask:0xf bank_mask:0xf
  v_mfma_f32_16x16x32_bf16 v[60:63], v[236:239], v[24:27], v[60:63]
  v_max3_f32 v206, v164, v165, v166
  v_max_f32 v206, v206, v167
  v_mfma_f32_16x16x32_bf16 v[60:63], v[240:243], v[28:31], v[60:63]
  buffer_load_dwordx4 v222, s[4:7], s75 offen offset:2048 nt lds
  v_mfma_f32_16x16x32_bf16 v[72:75], v[20:23], a[156:159], 0
  v_mul_f32 v207, s59, v204
  v_cvt_pk_bf16_f32 v184, v80, v81
  v_mfma_f32_16x16x32_bf16 v[72:75], v[24:27], a[160:163], v[72:75]
  v_cvt_pk_bf16_f32 v185, v82, v83
  v_mul_f32_e64 v208, -v206, v207
  v_mfma_f32_16x16x32_bf16 v[72:75], v[28:31], a[164:167], v[72:75]
  v_cvt_pk_bf16_f32 v100, v60, v61
  v_cvt_pk_bf16_f32 v101, v62, v63
  v_mfma_f32_16x16x32_bf16 v[212:215], v[188:191], v[188:191], v[212:215]
  ds_write_b128 v4, v[188:191] offset:15424
  ds_read_b64_tr_b16 v[142:143], v5 offset:21576
  v_mfma_f32_16x16x32_bf16 v[216:219], v[16:19], v[188:191], v[216:219]
  v_fma_f32 v164, v164, v207, v208
  v_fma_f32 v165, v165, v207, v208
  v_mfma_f32_16x16x32_bf16 v[212:215], v[192:195], v[192:195], v[212:215]
  v_cvt_pk_bf16_f32 v108, v72, v73
  v_cvt_pk_bf16_f32 v109, v74, v75
  v_mfma_f32_16x16x32_bf16 v[72:75], v[20:23], a[192:195], 0
  v_fma_f32 v166, v166, v207, v208
  v_fma_f32 v167, v167, v207, v208
  v_mfma_f32_16x16x32_bf16 v[72:75], v[24:27], a[196:199], v[72:75]
  v_cvt_pk_bf16_f32 v186, v84, v85
  v_cvt_pk_bf16_f32 v187, v86, v87
  v_mfma_f32_16x16x32_bf16 v[72:75], v[28:31], a[200:203], v[72:75]
  s_add_u32 m0, s22, 0x9000
  v_exp_f32 v164, v164
  v_mfma_f32_16x16x32_bf16 v[216:219], v[16:19], v[192:195], v[216:219]
  buffer_load_dwordx4 v7, s[4:7], s73 offen nt lds
  v_mfma_f32_16x16x32_bf16 v[44:47], a[216:219], v[20:23], 0
  v_exp_f32 v165, v165
  v_mfma_f32_16x16x32_bf16 v[48:51], a[228:231], v[20:23], 0
  v_exp_f32 v166, v166
  v_mfma_f32_16x16x32_bf16 v[68:71], v[20:23], a[144:147], 0
  v_exp_f32 v167, v167
  v_mfma_f32_16x16x32_bf16 v[76:79], v[20:23], a[168:171], 0
  v_cndmask_b32_e64 v217, v212, v213, s[30:31]
  v_cndmask_b32_e64 v217, v217, v214, s[32:33]
  v_mfma_f32_16x16x32_bf16 v[88:91], v[112:115], v[176:179], 0
  v_cndmask_b32_e64 v217, v217, v215, s[34:35]
  v_mul_f32 v218, s58, v216
  v_mfma_f32_16x16x32_bf16 v[44:47], a[220:223], v[24:27], v[44:47]
  v_fma_f32 v217, -v218, v216, v217
  v_fma_f32 v217, v217, s58, v13
  v_mfma_f32_16x16x32_bf16 v[48:51], a[232:235], v[24:27], v[48:51]
  v_rsq_f32 v217, v217
  v_mfma_f32_16x16x32_bf16 v[52:55], a[240:243], v[20:23], 0
  v_cvt_pk_bf16_f32 v188, v88, v89
  v_cvt_pk_bf16_f32 v189, v90, v91
  v_mfma_f32_16x16x32_bf16 v[56:59], a[252:255], v[20:23], 0
  ds_read_b64_tr_b16 v[150:151], v5 offset:21640
  ds_write_b32 v6, v217 offset:64
  v_mfma_f32_16x16x32_bf16 v[68:71], v[24:27], a[148:151], v[68:71]
  v_add_f32 v209, v164, v165
  v_add_f32 v210, v166, v167
  v_mfma_f32_16x16x32_bf16 v[76:79], v[24:27], a[172:175], v[76:79]
  v_add_f32 v209, v209, v210
  ds_write_b128 v4, v[192:195] offset:15488
  v_mfma_f32_16x16x32_bf16 v[44:47], a[224:227], v[28:31], v[44:47]
  v_rcp_f32 v209, v209
  v_mfma_f32_16x16x32_bf16 v[48:51], a[236:239], v[28:31], v[48:51]
  v_cndmask_b32_e64 v196, v156, v157, s[30:31]
  v_mul_f32_dpp v164, v204, v164 quad_perm:[0,0,0,0] row_mask:0xf bank_mask:0xf
  v_mfma_f32_16x16x32_bf16 v[52:55], a[244:247], v[24:27], v[52:55]
  v_mul_f32_dpp v165, v204, v165 quad_perm:[1,1,1,1] row_mask:0xf bank_mask:0xf
  v_mul_f32_dpp v166, v204, v166 quad_perm:[2,2,2,2] row_mask:0xf bank_mask:0xf
  v_mfma_f32_16x16x32_bf16 v[56:59], v[224:227], v[24:27], v[56:59]
  v_cvt_pk_bf16_f32 v92, v44, v45
  v_cvt_pk_bf16_f32 v93, v46, v47
  v_mfma_f32_16x16x32_bf16 v[64:67], v[244:247], v[20:23], 0
  v_cvt_pk_bf16_f32 v94, v48, v49
  v_cvt_pk_bf16_f32 v95, v50, v51
  v_mfma_f32_16x16x32_bf16 v[68:71], v[28:31], a[152:155], v[68:71]
  v_mul_f32_dpp v167, v204, v167 quad_perm:[3,3,3,3] row_mask:0xf bank_mask:0xf
  v_cndmask_b32_e64 v196, v196, v158, s[32:33]
  v_mfma_f32_16x16x32_bf16 v[76:79], v[28:31], a[176:179], v[76:79]
  v_mul_f32 v164, v164, v209
  v_mul_f32 v165, v165, v209
  v_mfma_f32_16x16x32_bf16 v[160:163], v[16:19], v[20:23], 0
  v_mul_f32 v166, v166, v209
  v_mul_f32 v167, v167, v209
  v_mfma_f32_16x16x32_bf16 v[80:83], v[116:119], v[176:179], 0
  v_cvt_pk_bf16_f32 v104, v68, v69
  v_cvt_pk_bf16_f32 v105, v70, v71
  v_mfma_f32_16x16x32_bf16 v[52:55], a[248:251], v[28:31], v[52:55]
  v_cvt_pk_bf16_f32 v112, v76, v77
  v_cvt_pk_bf16_f32 v113, v78, v79
  v_mfma_f32_16x16x32_bf16 v[56:59], v[228:231], v[28:31], v[56:59]
  v_cndmask_b32_e64 v196, v196, v159, s[34:35]
  s_waitcnt vmcnt(7)
  ds_read_b128 v[32:35], v4 offset:27648
  v_mfma_f32_16x16x32_bf16 v[64:67], v[248:251], v[24:27], v[64:67]
  ds_read_b128 v[36:39], v4 offset:27712
  ds_read_b128 v[40:43], v4 offset:27776
  v_mfma_f32_16x16x32_bf16 v[160:163], v[16:19], v[24:27], v[160:163]
  v_cvt_pk_bf16_f32 v190, v80, v81
  v_cvt_pk_bf16_f32 v191, v82, v83
  v_mfma_f32_16x16x32_bf16 v[84:87], v[120:123], v[176:179], 0
  v_cvt_pk_bf16_f32 v96, v52, v53
  v_cvt_pk_bf16_f32 v97, v54, v55
  v_mfma_f32_16x16x32_bf16 v[88:91], v[124:127], v[176:179], 0
  v_cvt_pk_bf16_f32 v98, v56, v57
  v_cvt_pk_bf16_f32 v99, v58, v59
  v_mfma_f32_16x16x32_bf16 v[64:67], v[252:255], v[28:31], v[64:67]
  v_cvt_pk_bf16_f32 v164, v164, v165
  v_cvt_pk_bf16_f32 v166, v166, v167
  v_mfma_f32_16x16x32_bf16 v[160:163], v[16:19], v[28:31], v[160:163]
  v_cvt_pk_bf16_f32 v192, v84, v85
  v_cvt_pk_bf16_f32 v193, v86, v87
  v_mfma_f32_16x16x32_bf16 v[212:215], v[184:187], v[184:187], 0
  v_cvt_pk_bf16_f32 v194, v88, v89
  v_cvt_pk_bf16_f32 v195, v90, v91
  v_mfma_f32_16x16x32_bf16 v[216:219], v[16:19], v[184:187], 0
  v_cvt_pk_bf16_f32 v102, v64, v65
  v_cvt_pk_bf16_f32 v103, v66, v67
  s_waitcnt lgkmcnt(0)
  v_mfma_f32_16x16x32_bf16 v[168:171], v[32:35], v[32:35], 0
  v_mul_f32 v197, s58, v160
  v_fma_f32 v196, -v197, v160, v196
  v_mfma_f32_16x16x32_bf16 v[168:171], v[36:39], v[36:39], v[168:171]
  v_cndmask_b32_e64 v180, 0, v164, s[36:37]
  v_cndmask_b32_e64 v181, 0, v166, s[36:37]
  v_mfma_f32_16x16x32_bf16 v[168:171], v[40:43], v[40:43], v[168:171]
  buffer_load_dwordx4 v8, s[4:7], s73 offen offset:1024 nt lds
  v_mfma_f32_16x16x32_bf16 v[60:63], v[232:235], v[32:35], 0
  v_fma_f32 v196, v196, s58, v13
  ds_read_b64_tr_b16 v[106:107], v5 offset:24576
  v_mfma_f32_16x16x32_bf16 v[60:63], v[236:239], v[36:39], v[60:63]
  v_rsq_f32 v196, v196
  v_mfma_f32_16x16x32_bf16 v[60:63], v[240:243], v[40:43], v[60:63]
  buffer_load_dwordx4 v9, s[4:7], s73 offen offset:2048 nt lds
  v_mfma_f32_16x16x32_bf16 v[68:71], v[20:23], a[180:183], 0
  v_cvt_pk_bf16_f32 v120, v72, v73
  v_cvt_pk_bf16_f32 v121, v74, v75
  v_mfma_f32_16x16x32_bf16 v[76:79], v[20:23], a[204:207], 0
  ds_read_b64_tr_b16 v[114:115], v5 offset:24640
  ds_write_b128 v4, v[184:187] offset:18432
  v_mfma_f32_16x16x32_bf16 v[152:155], v[20:23], v[92:95], 0
  v_mul_f32 v199, s59, v196
  ds_write_b128 v4, v[188:191] offset:18496
  v_mfma_f32_16x16x32_bf16 v[212:215], v[188:191], v[188:191], v[212:215]
  ds_read_b64_tr_b16 v[118:119], v5 offset:24648
  ds_read_b64_tr_b16 v[122:123], v5 offset:24704
  v_mfma_f32_16x16x32_bf16 v[216:219], v[16:19], v[188:191], v[216:219]
  ds_read_b64_tr_b16 v[126:127], v5 offset:24712
  ds_write_b128 v4, v[192:195] offset:18560
  v_mfma_f32_16x16x32_bf16 v[68:71], v[24:27], a[184:187], v[68:71]
  v_cndmask_b32_e64 v204, v168, v169, s[30:31]
  v_cndmask_b32_e64 v204, v204, v170, s[32:33]
  v_mfma_f32_16x16x32_bf16 v[76:79], v[24:27], a[208:211], v[76:79]
  v_cndmask_b32_e64 v204, v204, v171, s[34:35]
  v_mfma_f32_16x16x32_bf16 v[152:155], v[24:27], v[96:99], v[152:155]
  v_mfma_f32_16x16x32_bf16 v[212:215], v[192:195], v[192:195], v[212:215]
  v_mfma_f32_16x16x32_bf16 v[216:219], v[16:19], v[192:195], v[216:219]
  v_mfma_f32_16x16x32_bf16 v[68:71], v[28:31], a[188:191], v[68:71]
  v_mfma_f32_16x16x32_bf16 v[76:79], v[28:31], a[212:215], v[76:79]
  v_mfma_f32_16x16x32_bf16 v[152:155], v[28:31], v[100:103], v[152:155]
  v_cvt_pk_bf16_f32 v100, v60, v61
  v_cvt_pk_bf16_f32 v101, v62, v63
  v_mfma_f32_16x16x32_bf16 v[80:83], v[128:131], v[180:183], 0
  ds_read_b64_tr_b16 v[130:131], v5 offset:27648
  v_mfma_f32_16x16x32_bf16 v[44:47], a[216:219], v[32:35], 0
  v_cndmask_b32_e64 v217, v212, v213, s[30:31]
  v_cvt_pk_bf16_f32 v116, v68, v69
  v_mfma_f32_16x16x32_bf16 v[48:51], a[228:231], v[32:35], 0
  v_cvt_pk_bf16_f32 v117, v70, v71
  v_cvt_pk_bf16_f32 v124, v76, v77
  v_mfma_f32_16x16x32_bf16 v[84:87], v[132:135], v[180:183], 0
  v_cvt_pk_bf16_f32 v125, v78, v79
  v_mul_f32_dpp v152, v196, v152 quad_perm:[0,0,0,0] row_mask:0xf bank_mask:0xf
  v_mfma_f32_16x16x32_bf16 v[88:91], v[136:139], v[180:183], 0
  v_mul_f32_dpp v153, v196, v153 quad_perm:[1,1,1,1] row_mask:0xf bank_mask:0xf
  v_mul_f32_dpp v154, v196, v154 quad_perm:[2,2,2,2] row_mask:0xf bank_mask:0xf
  v_mfma_f32_16x16x32_bf16 v[44:47], a[220:223], v[36:39], v[44:47]
  v_cndmask_b32_e64 v217, v217, v214, s[32:33]
  v_mul_f32_dpp v155, v196, v155 quad_perm:[3,3,3,3] row_mask:0xf bank_mask:0xf
  v_mfma_f32_16x16x32_bf16 v[48:51], a[232:235], v[36:39], v[48:51]
  v_max3_f32 v198, v152, v153, v154
  v_cndmask_b32_e64 v217, v217, v215, s[34:35]
  v_mfma_f32_16x16x32_bf16 v[52:55], a[240:243], v[32:35], 0
  v_mul_f32 v218, s58, v216
  v_max_f32 v198, v198, v155
  v_mfma_f32_16x16x32_bf16 v[56:59], a[252:255], v[32:35], 0
  v_fma_f32 v217, -v218, v216, v217
  v_cvt_pk_bf16_f32 v184, v80, v81
  v_mfma_f32_16x16x32_bf16 v[68:71], v[32:35], a[144:147], 0
  v_cvt_pk_bf16_f32 v185, v82, v83
  v_mul_f32_e64 v200, -v198, v199
  v_mfma_f32_16x16x32_bf16 v[72:75], v[32:35], a[156:159], 0
  v_fma_f32 v217, v217, s58, v13
  v_fma_f32 v152, v152, v199, v200
  v_mfma_f32_16x16x32_bf16 v[76:79], v[32:35], a[168:171], 0
  v_fma_f32 v153, v153, v199, v200
  v_fma_f32 v154, v154, v199, v200
  v_mfma_f32_16x16x32_bf16 v[44:47], a[224:227], v[40:43], v[44:47]
  v_fma_f32 v155, v155, v199, v200
  v_rsq_f32 v217, v217
  v_mfma_f32_16x16x32_bf16 v[48:51], a[236:239], v[40:43], v[48:51]
  v_cvt_pk_bf16_f32 v186, v84, v85
  v_cvt_pk_bf16_f32 v187, v86, v87
  v_mfma_f32_16x16x32_bf16 v[52:55], a[244:247], v[36:39], v[52:55]
  v_cvt_pk_bf16_f32 v188, v88, v89
  v_cvt_pk_bf16_f32 v189, v90, v91
  v_mfma_f32_16x16x32_bf16 v[56:59], v[224:227], v[36:39], v[56:59]
  v_exp_f32 v152, v152
  v_mfma_f32_16x16x32_bf16 v[64:67], v[244:247], v[32:35], 0
  v_exp_f32 v153, v153
  v_mfma_f32_16x16x32_bf16 v[68:71], v[36:39], a[148:151], v[68:71]
  v_exp_f32 v154, v154
  v_mfma_f32_16x16x32_bf16 v[72:75], v[36:39], a[160:163], v[72:75]
  v_exp_f32 v155, v155
  v_mfma_f32_16x16x32_bf16 v[76:79], v[36:39], a[172:175], v[76:79]
  ds_write_b32 v6, v217 offset:80
  v_cvt_pk_bf16_f32 v92, v44, v45
  v_mfma_f32_16x16x32_bf16 v[172:175], v[16:19], v[32:35], 0
  v_cvt_pk_bf16_f32 v93, v46, v47
  v_cvt_pk_bf16_f32 v94, v48, v49
  v_mfma_f32_16x16x32_bf16 v[80:83], v[140:143], v[180:183], 0
  v_cvt_pk_bf16_f32 v95, v50, v51
  v_add_f32 v201, v152, v153
  v_mfma_f32_16x16x32_bf16 v[52:55], a[248:251], v[40:43], v[52:55]
  v_add_f32 v202, v154, v155
  v_add_f32 v201, v201, v202
  v_mfma_f32_16x16x32_bf16 v[56:59], v[228:231], v[40:43], v[56:59]
  v_rcp_f32 v201, v201
  v_mfma_f32_16x16x32_bf16 v[64:67], v[248:251], v[36:39], v[64:67]
  v_cvt_pk_bf16_f32 v190, v80, v81
  v_cvt_pk_bf16_f32 v191, v82, v83
  v_mfma_f32_16x16x32_bf16 v[68:71], v[40:43], a[152:155], v[68:71]
  v_cvt_pk_bf16_f32 v96, v52, v53
  v_cvt_pk_bf16_f32 v97, v54, v55
  v_mfma_f32_16x16x32_bf16 v[72:75], v[40:43], a[164:167], v[72:75]
  v_cvt_pk_bf16_f32 v98, v56, v57
  v_cvt_pk_bf16_f32 v99, v58, v59
  v_mfma_f32_16x16x32_bf16 v[76:79], v[40:43], a[176:179], v[76:79]
  v_mul_f32_dpp v152, v196, v152 quad_perm:[0,0,0,0] row_mask:0xf bank_mask:0xf
  v_mul_f32_dpp v153, v196, v153 quad_perm:[1,1,1,1] row_mask:0xf bank_mask:0xf
  v_mfma_f32_16x16x32_bf16 v[172:175], v[16:19], v[36:39], v[172:175]
  v_cvt_pk_bf16_f32 v128, v68, v69
  v_cvt_pk_bf16_f32 v129, v70, v71
  v_mfma_f32_16x16x32_bf16 v[84:87], v[144:147], v[180:183], 0
  v_cvt_pk_bf16_f32 v132, v72, v73
  v_cvt_pk_bf16_f32 v133, v74, v75
  v_mfma_f32_16x16x32_bf16 v[88:91], v[148:151], v[180:183], 0
  v_cvt_pk_bf16_f32 v136, v76, v77
  v_cvt_pk_bf16_f32 v137, v78, v79
  v_mfma_f32_16x16x32_bf16 v[64:67], v[252:255], v[40:43], v[64:67]
  v_mul_f32_dpp v154, v196, v154 quad_perm:[2,2,2,2] row_mask:0xf bank_mask:0xf
  v_mul_f32_dpp v155, v196, v155 quad_perm:[3,3,3,3] row_mask:0xf bank_mask:0xf
  v_mfma_f32_16x16x32_bf16 v[172:175], v[16:19], v[40:43], v[172:175]
  v_cvt_pk_bf16_f32 v192, v84, v85
  v_cvt_pk_bf16_f32 v193, v86, v87
  v_mfma_f32_16x16x32_bf16 v[212:215], v[184:187], v[184:187], 0
  v_cvt_pk_bf16_f32 v194, v88, v89
  v_cvt_pk_bf16_f32 v195, v90, v91
  v_mfma_f32_16x16x32_bf16 v[216:219], v[16:19], v[184:187], 0
  v_cvt_pk_bf16_f32 v102, v64, v65
  v_cvt_pk_bf16_f32 v103, v66, v67
  v_mfma_f32_16x16x32_bf16 v[164:167], v[32:35], v[92:95], 0
  v_mul_f32 v152, v152, v201
  v_mul_f32 v153, v153, v201
  v_mfma_f32_16x16x32_bf16 v[212:215], v[188:191], v[188:191], v[212:215]
  v_mul_f32 v154, v154, v201
  v_mul_f32 v155, v155, v201
  v_mfma_f32_16x16x32_bf16 v[216:219], v[16:19], v[188:191], v[216:219]
  v_mul_f32 v205, s58, v172
  v_cvt_pk_bf16_f32 v152, v152, v153
  v_mfma_f32_16x16x32_bf16 v[164:167], v[36:39], v[96:99], v[164:167]
  v_cvt_pk_bf16_f32 v154, v154, v155
  v_fma_f32 v204, -v205, v172, v204
  v_mfma_f32_16x16x32_bf16 v[68:71], v[32:35], a[180:183], 0
  v_cndmask_b32_e64 v176, 0, v152, s[36:37]
  v_cndmask_b32_e64 v177, 0, v154, s[36:37]
  v_mfma_f32_16x16x32_bf16 v[72:75], v[32:35], a[192:195], 0
  v_fma_f32 v204, v204, s58, v13
  v_rsq_f32 v204, v204
  v_mfma_f32_16x16x32_bf16 v[76:79], v[32:35], a[204:207], 0
  ds_read_b64_tr_b16 v[134:135], v5 offset:27656
  ds_read_b64_tr_b16 v[138:139], v5 offset:27712
  v_mfma_f32_16x16x32_bf16 v[212:215], v[192:195], v[192:195], v[212:215]
  ds_write_b128 v4, v[184:187] offset:21504
  v_mul_f32 v207, s59, v204
  v_mfma_f32_16x16x32_bf16 v[216:219], v[16:19], v[192:195], v[216:219]
  ds_write_b128 v4, v[188:191] offset:21568
  ds_read_b64_tr_b16 v[142:143], v5 offset:27720
  v_mfma_f32_16x16x32_bf16 v[164:167], v[40:43], v[100:103], v[164:167]
  ds_read_b64_tr_b16 v[146:147], v5 offset:27776
  ds_read_b64_tr_b16 v[150:151], v5 offset:27784
  v_mfma_f32_16x16x32_bf16 v[68:71], v[36:39], a[184:187], v[68:71]
  ds_write_b128 v4, v[192:195] offset:21632
  v_mfma_f32_16x16x32_bf16 v[72:75], v[36:39], a[196:199], v[72:75]
  v_cndmask_b32_e64 v217, v212, v213, s[30:31]
  v_cndmask_b32_e64 v217, v217, v214, s[32:33]
  v_mfma_f32_16x16x32_bf16 v[76:79], v[36:39], a[208:211], v[76:79]
  v_mul_f32_dpp v164, v204, v164 quad_perm:[0,0,0,0] row_mask:0xf bank_mask:0xf
  v_mul_f32_dpp v165, v204, v165 quad_perm:[1,1,1,1] row_mask:0xf bank_mask:0xf
  v_mfma_f32_16x16x32_bf16 v[68:71], v[40:43], a[188:191], v[68:71]
  v_mul_f32_dpp v166, v204, v166 quad_perm:[2,2,2,2] row_mask:0xf bank_mask:0xf
  v_mul_f32_dpp v167, v204, v167 quad_perm:[3,3,3,3] row_mask:0xf bank_mask:0xf
  v_mfma_f32_16x16x32_bf16 v[72:75], v[40:43], a[200:203], v[72:75]
  v_max3_f32 v206, v164, v165, v166
  v_cndmask_b32_e64 v217, v217, v215, s[34:35]
  v_mfma_f32_16x16x32_bf16 v[76:79], v[40:43], a[212:215], v[76:79]
  v_mul_f32 v218, s58, v216
  v_max_f32 v206, v206, v167
  s_waitcnt lgkmcnt(2)
  v_mfma_f32_16x16x32_bf16 v[80:83], v[104:107], v[176:179], 0
  v_cvt_pk_bf16_f32 v140, v68, v69
  v_cvt_pk_bf16_f32 v141, v70, v71
  v_mfma_f32_16x16x32_bf16 v[84:87], v[108:111], v[176:179], 0
  v_cvt_pk_bf16_f32 v144, v72, v73
  v_cvt_pk_bf16_f32 v145, v74, v75
  v_mfma_f32_16x16x32_bf16 v[88:91], v[112:115], v[176:179], 0
  v_cvt_pk_bf16_f32 v148, v76, v77
  v_cvt_pk_bf16_f32 v149, v78, v79
  v_fma_f32 v217, -v218, v216, v217
  v_cvt_pk_bf16_f32 v184, v80, v81
  v_cvt_pk_bf16_f32 v185, v82, v83
  v_mfma_f32_16x16x32_bf16 v[80:83], v[116:119], v[176:179], 0
  v_mul_f32_e64 v208, -v206, v207
  v_fma_f32 v217, v217, s58, v13
  v_fma_f32 v164, v164, v207, v208
  v_fma_f32 v165, v165, v207, v208
  v_fma_f32 v166, v166, v207, v208
  v_fma_f32 v167, v167, v207, v208
  v_rsq_f32 v217, v217
  v_cvt_pk_bf16_f32 v186, v84, v85
  v_cvt_pk_bf16_f32 v187, v86, v87
  v_mfma_f32_16x16x32_bf16 v[84:87], v[120:123], v[176:179], 0
  v_cvt_pk_bf16_f32 v188, v88, v89
  v_cvt_pk_bf16_f32 v189, v90, v91
  v_mfma_f32_16x16x32_bf16 v[88:91], v[124:127], v[176:179], 0
  v_exp_f32 v164, v164
  v_mfma_f32_16x16x32_bf16 v[212:215], v[184:187], v[184:187], 0
  v_exp_f32 v165, v165
  v_exp_f32 v166, v166
  v_exp_f32 v167, v167
  ds_write_b32 v6, v217 offset:96
  v_mfma_f32_16x16x32_bf16 v[216:219], v[16:19], v[184:187], 0
  v_add_f32 v209, v164, v165
  v_add_f32 v210, v166, v167
  v_cvt_pk_bf16_f32 v190, v80, v81
  v_cvt_pk_bf16_f32 v191, v82, v83
  v_add_f32 v209, v209, v210
  v_rcp_f32 v209, v209
  v_mfma_f32_16x16x32_bf16 v[212:215], v[188:191], v[188:191], v[212:215]
  v_cvt_pk_bf16_f32 v192, v84, v85
  v_cvt_pk_bf16_f32 v193, v86, v87
  v_mfma_f32_16x16x32_bf16 v[216:219], v[16:19], v[188:191], v[216:219]
  s_waitcnt vmcnt(6)
  ds_read_b128 v[20:23], v4 offset:30720
  ds_read_b128 v[24:27], v4 offset:30784
  ds_read_b128 v[28:31], v4 offset:30848
  v_cvt_pk_bf16_f32 v194, v88, v89
  v_cvt_pk_bf16_f32 v195, v90, v91
  v_mul_f32_dpp v164, v204, v164 quad_perm:[0,0,0,0] row_mask:0xf bank_mask:0xf
  v_mul_f32_dpp v165, v204, v165 quad_perm:[1,1,1,1] row_mask:0xf bank_mask:0xf
  v_mfma_f32_16x16x32_bf16 v[212:215], v[192:195], v[192:195], v[212:215]
  v_mul_f32_dpp v166, v204, v166 quad_perm:[2,2,2,2] row_mask:0xf bank_mask:0xf
  v_mul_f32_dpp v167, v204, v167 quad_perm:[3,3,3,3] row_mask:0xf bank_mask:0xf
  v_mfma_f32_16x16x32_bf16 v[216:219], v[16:19], v[192:195], v[216:219]
  v_mul_f32 v164, v164, v209
  v_mul_f32 v165, v165, v209
  v_mul_f32 v166, v166, v209
  v_mul_f32 v167, v167, v209
  v_cvt_pk_bf16_f32 v164, v164, v165
  v_cvt_pk_bf16_f32 v166, v166, v167
  v_cndmask_b32_e64 v180, 0, v164, s[36:37]
  v_cndmask_b32_e64 v181, 0, v166, s[36:37]
  ds_read_b64_tr_b16 v[106:107], v5 offset:30720
  v_cndmask_b32_e64 v217, v212, v213, s[30:31]
  v_mfma_f32_16x16x32_bf16 v[80:83], v[128:131], v[180:183], 0
  ds_read_b64_tr_b16 v[110:111], v5 offset:30728
  ds_read_b64_tr_b16 v[114:115], v5 offset:30784
  v_mfma_f32_16x16x32_bf16 v[84:87], v[132:135], v[180:183], 0
  v_cndmask_b32_e64 v217, v217, v214, s[32:33]
  ds_write_b128 v4, v[184:187] offset:24576
  v_mfma_f32_16x16x32_bf16 v[88:91], v[136:139], v[180:183], 0
  v_cndmask_b32_e64 v217, v217, v215, s[34:35]
  v_mul_f32 v218, s58, v216
  s_waitcnt lgkmcnt(4)
  v_mfma_f32_16x16x32_bf16 v[44:47], a[216:219], v[20:23], 0
  v_fma_f32 v217, -v218, v216, v217
  v_cvt_pk_bf16_f32 v184, v80, v81
  v_mfma_f32_16x16x32_bf16 v[48:51], a[228:231], v[20:23], 0
  v_cvt_pk_bf16_f32 v185, v82, v83
  ds_write_b128 v4, v[188:191] offset:24640
  v_mfma_f32_16x16x32_bf16 v[44:47], a[220:223], v[24:27], v[44:47]
  v_fma_f32 v217, v217, s58, v13
  ds_read_b64_tr_b16 v[118:119], v5 offset:30792
  v_mfma_f32_16x16x32_bf16 v[48:51], a[232:235], v[24:27], v[48:51]
  v_rsq_f32 v217, v217
  v_mfma_f32_16x16x32_bf16 v[52:55], a[240:243], v[20:23], 0
  v_cvt_pk_bf16_f32 v186, v84, v85
  v_cvt_pk_bf16_f32 v187, v86, v87
  v_mfma_f32_16x16x32_bf16 v[56:59], a[252:255], v[20:23], 0
  v_cvt_pk_bf16_f32 v188, v88, v89
  v_cvt_pk_bf16_f32 v189, v90, v91
  v_mfma_f32_16x16x32_bf16 v[156:159], v[20:23], v[20:23], 0
  ds_read_b64_tr_b16 v[122:123], v5 offset:30848
  ds_read_b64_tr_b16 v[126:127], v5 offset:30856
  v_mfma_f32_16x16x32_bf16 v[44:47], a[224:227], v[28:31], v[44:47]
  ds_write_b32 v6, v217 offset:112
  ds_write_b128 v4, v[192:195] offset:24704
  v_mfma_f32_16x16x32_bf16 v[48:51], a[236:239], v[28:31], v[48:51]
  ds_write_b128 v4, v[184:187] offset:27648
  v_cmp_le_u32_e64 s[82:83], 12, v2
  v_mfma_f32_16x16x32_bf16 v[52:55], a[244:247], v[24:27], v[52:55]
  s_mul_i32 s65, s20, 768
  s_add_u32 s65, s65, 0x27200
  v_mfma_f32_16x16x32_bf16 v[56:59], v[224:227], v[24:27], v[56:59]
  v_cvt_pk_bf16_f32 v92, v44, v45
  v_cvt_pk_bf16_f32 v93, v46, v47
  v_mfma_f32_16x16x32_bf16 v[60:63], v[232:235], v[20:23], 0
  v_cvt_pk_bf16_f32 v94, v48, v49
  v_cvt_pk_bf16_f32 v95, v50, v51
  v_mfma_f32_16x16x32_bf16 v[64:67], v[244:247], v[20:23], 0
  v_mov_b32 v11, 0
  v_mov_b32 v12, 0
  v_mfma_f32_16x16x32_bf16 v[156:159], v[24:27], v[24:27], v[156:159]
  s_add_u32 s61, s21, 0x0
  s_add_u32 s62, s21, 0x930000
  v_mfma_f32_16x16x32_bf16 v[160:163], v[16:19], v[20:23], 0
  s_add_u32 s63, s21, 0x1260000
  s_add_u32 s64, s21, 0x1b90000
  v_mfma_f32_16x16x32_bf16 v[68:71], v[20:23], a[144:147], 0
  v_mfma_f32_16x16x32_bf16 v[72:75], v[20:23], a[156:159], 0
  v_mfma_f32_16x16x32_bf16 v[76:79], v[20:23], a[168:171], 0
  v_mfma_f32_16x16x32_bf16 v[52:55], a[248:251], v[28:31], v[52:55]
  v_mfma_f32_16x16x32_bf16 v[56:59], v[228:231], v[28:31], v[56:59]
  v_mfma_f32_16x16x32_bf16 v[60:63], v[236:239], v[24:27], v[60:63]
  v_mfma_f32_16x16x32_bf16 v[64:67], v[248:251], v[24:27], v[64:67]
  v_mfma_f32_16x16x32_bf16 v[156:159], v[28:31], v[28:31], v[156:159]
  v_mfma_f32_16x16x32_bf16 v[160:163], v[16:19], v[24:27], v[160:163]
  v_mfma_f32_16x16x32_bf16 v[68:71], v[24:27], a[148:151], v[68:71]
  v_mfma_f32_16x16x32_bf16 v[72:75], v[24:27], a[160:163], v[72:75]
  s_nop 0
  v_cvt_pk_bf16_f32 v96, v52, v53
  v_mfma_f32_16x16x32_bf16 v[76:79], v[24:27], a[172:175], v[76:79]
  v_cvt_pk_bf16_f32 v97, v54, v55
  v_cvt_pk_bf16_f32 v98, v56, v57
  v_mfma_f32_16x16x32_bf16 v[60:63], v[240:243], v[28:31], v[60:63]
  v_cvt_pk_bf16_f32 v99, v58, v59
  v_cndmask_b32_e64 v196, v156, v157, s[30:31]
  v_mfma_f32_16x16x32_bf16 v[64:67], v[252:255], v[28:31], v[64:67]
  v_cndmask_b32_e64 v196, v196, v158, s[32:33]
  v_cndmask_b32_e64 v196, v196, v159, s[34:35]
  v_mfma_f32_16x16x32_bf16 v[160:163], v[16:19], v[28:31], v[160:163]
  v_mfma_f32_16x16x32_bf16 v[68:71], v[28:31], a[152:155], v[68:71]
  s_nop 0
  v_cvt_pk_bf16_f32 v100, v60, v61
  v_mfma_f32_16x16x32_bf16 v[72:75], v[28:31], a[164:167], v[72:75]
  v_cvt_pk_bf16_f32 v101, v62, v63
  v_cvt_pk_bf16_f32 v102, v64, v65
  v_mfma_f32_16x16x32_bf16 v[76:79], v[28:31], a[176:179], v[76:79]
  v_cvt_pk_bf16_f32 v103, v66, v67
  v_mul_f32 v197, s58, v160
  v_mfma_f32_16x16x32_bf16 v[152:155], v[20:23], v[92:95], 0
  v_cvt_pk_bf16_f32 v104, v68, v69
  v_cvt_pk_bf16_f32 v105, v70, v71
  v_mfma_f32_16x16x32_bf16 v[152:155], v[24:27], v[96:99], v[152:155]
  v_cvt_pk_bf16_f32 v108, v72, v73
  v_cvt_pk_bf16_f32 v109, v74, v75
  v_mfma_f32_16x16x32_bf16 v[152:155], v[28:31], v[100:103], v[152:155]
  v_cvt_pk_bf16_f32 v112, v76, v77
  v_cvt_pk_bf16_f32 v113, v78, v79
  v_mfma_f32_16x16x32_bf16 v[68:71], v[20:23], a[180:183], 0
  v_fma_f32 v196, -v197, v160, v196
  v_fma_f32 v196, v196, s58, v13
  v_mfma_f32_16x16x32_bf16 v[72:75], v[20:23], a[192:195], 0
  v_rsq_f32 v196, v196
  v_mfma_f32_16x16x32_bf16 v[76:79], v[20:23], a[204:207], 0
  v_mul_f32 v199, s59, v196
  v_mul_f32_dpp v152, v196, v152 quad_perm:[0,0,0,0] row_mask:0xf bank_mask:0xf
  v_mfma_f32_16x16x32_bf16 v[68:71], v[24:27], a[184:187], v[68:71]
  v_mul_f32_dpp v153, v196, v153 quad_perm:[1,1,1,1] row_mask:0xf bank_mask:0xf
  v_mul_f32_dpp v154, v196, v154 quad_perm:[2,2,2,2] row_mask:0xf bank_mask:0xf
  v_mfma_f32_16x16x32_bf16 v[72:75], v[24:27], a[196:199], v[72:75]
  v_mul_f32_dpp v155, v196, v155 quad_perm:[3,3,3,3] row_mask:0xf bank_mask:0xf
  v_max3_f32 v198, v152, v153, v154
  v_mfma_f32_16x16x32_bf16 v[76:79], v[24:27], a[208:211], v[76:79]
  v_max_f32 v198, v198, v155
  v_mul_f32_e64 v200, -v198, v199
  v_mfma_f32_16x16x32_bf16 v[68:71], v[28:31], a[188:191], v[68:71]
  v_fma_f32 v152, v152, v199, v200
  v_fma_f32 v153, v153, v199, v200
  v_mfma_f32_16x16x32_bf16 v[72:75], v[28:31], a[200:203], v[72:75]
  v_fma_f32 v154, v154, v199, v200
  v_fma_f32 v155, v155, v199, v200
  v_mfma_f32_16x16x32_bf16 v[76:79], v[28:31], a[212:215], v[76:79]
  v_exp_f32 v152, v152
  v_mfma_f32_16x16x32_bf16 v[80:83], v[140:143], v[180:183], 0
  v_exp_f32 v153, v153
  v_mfma_f32_16x16x32_bf16 v[84:87], v[144:147], v[180:183], 0
  v_exp_f32 v154, v154
  v_mfma_f32_16x16x32_bf16 v[88:91], v[148:151], v[180:183], 0
  s_waitcnt vmcnt(3)
  ds_read_b128 v[32:35], v4 offset:33792
  ds_read_b128 v[36:39], v4 offset:33856
  v_mfma_f32_16x16x32_bf16 v[212:215], v[184:187], v[184:187], 0
  ds_read_b128 v[40:43], v4 offset:33920
  v_exp_f32 v155, v155
  v_mfma_f32_16x16x32_bf16 v[216:219], v[16:19], v[184:187], 0
  v_add_f32 v201, v152, v153
  v_add_f32 v202, v154, v155
  v_cvt_pk_bf16_f32 v190, v80, v81
  v_cvt_pk_bf16_f32 v191, v82, v83
  v_add_f32 v201, v201, v202
  v_rcp_f32 v201, v201
  v_mfma_f32_16x16x32_bf16 v[212:215], v[188:191], v[188:191], v[212:215]
  v_cvt_pk_bf16_f32 v192, v84, v85
  v_cvt_pk_bf16_f32 v193, v86, v87
  v_mfma_f32_16x16x32_bf16 v[216:219], v[16:19], v[188:191], v[216:219]
  v_cvt_pk_bf16_f32 v194, v88, v89
  v_cvt_pk_bf16_f32 v195, v90, v91
  v_mul_f32_dpp v152, v196, v152 quad_perm:[0,0,0,0] row_mask:0xf bank_mask:0xf
  v_mul_f32_dpp v153, v196, v153 quad_perm:[1,1,1,1] row_mask:0xf bank_mask:0xf
  v_mfma_f32_16x16x32_bf16 v[212:215], v[192:195], v[192:195], v[212:215]
  v_mul_f32_dpp v154, v196, v154 quad_perm:[2,2,2,2] row_mask:0xf bank_mask:0xf
  v_mul_f32_dpp v155, v196, v155 quad_perm:[3,3,3,3] row_mask:0xf bank_mask:0xf
  v_mfma_f32_16x16x32_bf16 v[216:219], v[16:19], v[192:195], v[216:219]
  v_mul_f32 v152, v152, v201
  v_mul_f32 v153, v153, v201
  s_waitcnt lgkmcnt(0)
  v_mfma_f32_16x16x32_bf16 v[44:47], a[216:219], v[32:35], 0
  v_mul_f32 v154, v154, v201
  v_mul_f32 v155, v155, v201
  v_mfma_f32_16x16x32_bf16 v[48:51], a[228:231], v[32:35], 0
  v_cvt_pk_bf16_f32 v152, v152, v153
  v_cvt_pk_bf16_f32 v154, v154, v155
  v_mfma_f32_16x16x32_bf16 v[44:47], a[220:223], v[36:39], v[44:47]
  v_cndmask_b32_e64 v176, 0, v152, s[36:37]
  v_cndmask_b32_e64 v177, 0, v154, s[36:37]
  v_mfma_f32_16x16x32_bf16 v[48:51], a[232:235], v[36:39], v[48:51]
  v_cvt_pk_bf16_f32 v116, v68, v69
  v_cvt_pk_bf16_f32 v117, v70, v71
  v_mfma_f32_16x16x32_bf16 v[52:55], a[240:243], v[32:35], 0
  ds_read_b64_tr_b16 v[130:131], v5 offset:33792
  v_cvt_pk_bf16_f32 v120, v72, v73
  v_mfma_f32_16x16x32_bf16 v[56:59], a[252:255], v[32:35], 0
  v_cvt_pk_bf16_f32 v121, v74, v75
  v_cvt_pk_bf16_f32 v124, v76, v77
  v_mfma_f32_16x16x32_bf16 v[168:171], v[32:35], v[32:35], 0
  v_cvt_pk_bf16_f32 v125, v78, v79
  v_cndmask_b32_e64 v217, v212, v213, s[30:31]
  v_mfma_f32_16x16x32_bf16 v[44:47], a[224:227], v[40:43], v[44:47]
  ds_read_b64_tr_b16 v[134:135], v5 offset:33800
  ds_read_b64_tr_b16 v[138:139], v5 offset:33856
  v_mfma_f32_16x16x32_bf16 v[48:51], a[236:239], v[40:43], v[48:51]
  v_cndmask_b32_e64 v217, v217, v214, s[32:33]
  v_cndmask_b32_e64 v217, v217, v215, s[34:35]
  v_mfma_f32_16x16x32_bf16 v[52:55], a[244:247], v[36:39], v[52:55]
  v_mul_f32 v218, s58, v216
  v_fma_f32 v217, -v218, v216, v217
  v_mfma_f32_16x16x32_bf16 v[56:59], v[224:227], v[36:39], v[56:59]
  v_cvt_pk_bf16_f32 v92, v44, v45
  v_cvt_pk_bf16_f32 v93, v46, v47
  v_mfma_f32_16x16x32_bf16 v[60:63], v[232:235], v[32:35], 0
  v_cvt_pk_bf16_f32 v94, v48, v49
  v_cvt_pk_bf16_f32 v95, v50, v51
  v_mfma_f32_16x16x32_bf16 v[64:67], v[244:247], v[32:35], 0
  ds_write_b128 v4, v[188:191] offset:27712
  v_fma_f32 v217, v217, s58, v13
  v_mfma_f32_16x16x32_bf16 v[168:171], v[36:39], v[36:39], v[168:171]
  ds_read_b64_tr_b16 v[142:143], v5 offset:33864
  v_rsq_f32 v217, v217
  v_mfma_f32_16x16x32_bf16 v[172:175], v[16:19], v[32:35], 0
  ds_read_b64_tr_b16 v[146:147], v5 offset:33920
  ds_read_b64_tr_b16 v[150:151], v5 offset:33928
  v_mfma_f32_16x16x32_bf16 v[52:55], a[248:251], v[40:43], v[52:55]
  ds_write_b32 v6, v217 offset:128
  ds_write_b128 v4, v[192:195] offset:27776
  v_mfma_f32_16x16x32_bf16 v[56:59], v[228:231], v[40:43], v[56:59]
  v_mfma_f32_16x16x32_bf16 v[60:63], v[236:239], v[36:39], v[60:63]
  v_mfma_f32_16x16x32_bf16 v[64:67], v[248:251], v[36:39], v[64:67]
  v_mfma_f32_16x16x32_bf16 v[168:171], v[40:43], v[40:43], v[168:171]
  v_mfma_f32_16x16x32_bf16 v[172:175], v[16:19], v[36:39], v[172:175]
  s_nop 0
  v_cvt_pk_bf16_f32 v96, v52, v53
  v_mfma_f32_16x16x32_bf16 v[60:63], v[240:243], v[40:43], v[60:63]
  v_cvt_pk_bf16_f32 v97, v54, v55
  v_cvt_pk_bf16_f32 v98, v56, v57
  v_mfma_f32_16x16x32_bf16 v[64:67], v[252:255], v[40:43], v[64:67]
  v_cvt_pk_bf16_f32 v99, v58, v59
  v_cndmask_b32_e64 v204, v168, v169, s[30:31]
  v_mfma_f32_16x16x32_bf16 v[172:175], v[16:19], v[40:43], v[172:175]
  v_cndmask_b32_e64 v204, v204, v170, s[32:33]
  v_cndmask_b32_e64 v204, v204, v171, s[34:35]
  v_mfma_f32_16x16x32_bf16 v[164:167], v[32:35], v[92:95], 0
  v_cvt_pk_bf16_f32 v100, v60, v61
  v_cvt_pk_bf16_f32 v101, v62, v63
  v_mfma_f32_16x16x32_bf16 v[164:167], v[36:39], v[96:99], v[164:167]
  v_cvt_pk_bf16_f32 v102, v64, v65
  v_cvt_pk_bf16_f32 v103, v66, v67
  v_mfma_f32_16x16x32_bf16 v[80:83], v[104:107], v[176:179], 0
  v_mul_f32 v205, s58, v172
  v_fma_f32 v204, -v205, v172, v204
  v_mfma_f32_16x16x32_bf16 v[164:167], v[40:43], v[100:103], v[164:167]
  v_fma_f32 v204, v204, s58, v13
  v_rsq_f32 v204, v204
  v_mfma_f32_16x16x32_bf16 v[68:71], v[32:35], a[144:147], 0
  v_mul_f32 v207, s59, v204
  v_mfma_f32_16x16x32_bf16 v[84:87], v[108:111], v[176:179], 0
  v_cvt_pk_bf16_f32 v184, v80, v81
  v_cvt_pk_bf16_f32 v185, v82, v83
  v_mfma_f32_16x16x32_bf16 v[88:91], v[112:115], v[176:179], 0
  v_mul_f32_dpp v164, v204, v164 quad_perm:[0,0,0,0] row_mask:0xf bank_mask:0xf
  v_mul_f32_dpp v165, v204, v165 quad_perm:[1,1,1,1] row_mask:0xf bank_mask:0xf
  v_mfma_f32_16x16x32_bf16 v[68:71], v[36:39], a[148:151], v[68:71]
  v_mul_f32_dpp v166, v204, v166 quad_perm:[2,2,2,2] row_mask:0xf bank_mask:0xf
  v_mul_f32_dpp v167, v204, v167 quad_perm:[3,3,3,3] row_mask:0xf bank_mask:0xf
  v_mfma_f32_16x16x32_bf16 v[72:75], v[32:35], a[156:159], 0
  v_max3_f32 v206, v164, v165, v166
  v_max_f32 v206, v206, v167
  v_mfma_f32_16x16x32_bf16 v[76:79], v[32:35], a[168:171], 0
  v_mul_f32_e64 v208, -v206, v207
  v_fma_f32 v164, v164, v207, v208
  v_mfma_f32_16x16x32_bf16 v[68:71], v[40:43], a[152:155], v[68:71]
  v_fma_f32 v165, v165, v207, v208
  v_fma_f32 v166, v166, v207, v208
  v_mfma_f32_16x16x32_bf16 v[72:75], v[36:39], a[160:163], v[72:75]
  v_fma_f32 v167, v167, v207, v208
  v_cvt_pk_bf16_f32 v186, v84, v85
  v_mfma_f32_16x16x32_bf16 v[76:79], v[36:39], a[172:175], v[76:79]
  v_cvt_pk_bf16_f32 v187, v86, v87
  v_cvt_pk_bf16_f32 v188, v88, v89
  v_mfma_f32_16x16x32_bf16 v[80:83], v[116:119], v[176:179], 0
  v_cvt_pk_bf16_f32 v189, v90, v91
  v_exp_f32 v164, v164
  v_mfma_f32_16x16x32_bf16 v[72:75], v[40:43], a[164:167], v[72:75]
  v_exp_f32 v165, v165
  v_mfma_f32_16x16x32_bf16 v[76:79], v[40:43], a[176:179], v[76:79]
  v_exp_f32 v166, v166
  v_mfma_f32_16x16x32_bf16 v[84:87], v[120:123], v[176:179], 0
  v_exp_f32 v167, v167
  v_mfma_f32_16x16x32_bf16 v[88:91], v[124:127], v[176:179], 0
  s_waitcnt vmcnt(0)
  ds_read_b128 v[20:23], v4 offset:36864
  ds_read_b128 v[24:27], v4 offset:36928
  v_mfma_f32_16x16x32_bf16 v[212:215], v[184:187], v[184:187], 0
  ds_read_b128 v[28:31], v4 offset:36992
  v_cvt_pk_bf16_f32 v128, v68, v69
  v_mfma_f32_16x16x32_bf16 v[216:219], v[16:19], v[184:187], 0
  v_cvt_pk_bf16_f32 v129, v70, v71
  v_add_f32 v209, v164, v165
  v_mfma_f32_16x16x32_bf16 v[68:71], v[32:35], a[180:183], 0
  v_add_f32 v210, v166, v167
  v_cvt_pk_bf16_f32 v190, v80, v81
  v_mfma_f32_16x16x32_bf16 v[68:71], v[36:39], a[184:187], v[68:71]
  v_cvt_pk_bf16_f32 v191, v82, v83
  v_add_f32 v209, v209, v210
  v_mfma_f32_16x16x32_bf16 v[68:71], v[40:43], a[188:191], v[68:71]
  v_cvt_pk_bf16_f32 v132, v72, v73
  v_cvt_pk_bf16_f32 v133, v74, v75
  v_mfma_f32_16x16x32_bf16 v[212:215], v[188:191], v[188:191], v[212:215]
  v_cvt_pk_bf16_f32 v136, v76, v77
  v_cvt_pk_bf16_f32 v137, v78, v79
  v_mfma_f32_16x16x32_bf16 v[216:219], v[16:19], v[188:191], v[216:219]
  v_rcp_f32 v209, v209
  v_mfma_f32_16x16x32_bf16 v[72:75], v[32:35], a[192:195], 0
  v_cvt_pk_bf16_f32 v192, v84, v85
  v_cvt_pk_bf16_f32 v193, v86, v87
  s_waitcnt lgkmcnt(0)
  v_mfma_f32_16x16x32_bf16 v[44:47], a[216:219], v[20:23], 0
  v_cvt_pk_bf16_f32 v194, v88, v89
  v_cvt_pk_bf16_f32 v195, v90, v91
  v_mfma_f32_16x16x32_bf16 v[48:51], a[228:231], v[20:23], 0
  v_mul_f32_dpp v164, v204, v164 quad_perm:[0,0,0,0] row_mask:0xf bank_mask:0xf
  v_mul_f32_dpp v165, v204, v165 quad_perm:[1,1,1,1] row_mask:0xf bank_mask:0xf
  v_mfma_f32_16x16x32_bf16 v[44:47], a[220:223], v[24:27], v[44:47]
  v_mul_f32_dpp v166, v204, v166 quad_perm:[2,2,2,2] row_mask:0xf bank_mask:0xf
  v_mul_f32_dpp v167, v204, v167 quad_perm:[3,3,3,3] row_mask:0xf bank_mask:0xf
  v_mfma_f32_16x16x32_bf16 v[48:51], a[232:235], v[24:27], v[48:51]
  v_mul_f32 v164, v164, v209
  v_mul_f32 v165, v165, v209
  v_mfma_f32_16x16x32_bf16 v[52:55], a[240:243], v[20:23], 0
  v_mul_f32 v166, v166, v209
  v_mul_f32 v167, v167, v209
  v_mfma_f32_16x16x32_bf16 v[56:59], a[252:255], v[20:23], 0
  v_cvt_pk_bf16_f32 v164, v164, v165
  v_cvt_pk_bf16_f32 v166, v166, v167
  v_mfma_f32_16x16x32_bf16 v[156:159], v[20:23], v[20:23], 0
  v_cndmask_b32_e64 v180, 0, v164, s[36:37]
  v_cndmask_b32_e64 v181, 0, v166, s[36:37]
  v_mfma_f32_16x16x32_bf16 v[44:47], a[224:227], v[28:31], v[44:47]
  ds_read_b64_tr_b16 v[106:107], v5 offset:36864
  v_cvt_pk_bf16_f32 v140, v68, v69
  v_mfma_f32_16x16x32_bf16 v[48:51], a[236:239], v[28:31], v[48:51]
  v_cvt_pk_bf16_f32 v141, v70, v71
  ds_read_b64_tr_b16 v[110:111], v5 offset:36872
  v_mfma_f32_16x16x32_bf16 v[52:55], a[244:247], v[24:27], v[52:55]
  ds_read_b64_tr_b16 v[114:115], v5 offset:36928
  ds_write_b128 v4, v[184:187] offset:30720
  v_mfma_f32_16x16x32_bf16 v[56:59], v[224:227], v[24:27], v[56:59]
  v_cvt_pk_bf16_f32 v92, v44, v45
  v_cvt_pk_bf16_f32 v93, v46, v47
  v_mfma_f32_16x16x32_bf16 v[60:63], v[232:235], v[20:23], 0
  v_cvt_pk_bf16_f32 v94, v48, v49
  v_cvt_pk_bf16_f32 v95, v50, v51
  v_mfma_f32_16x16x32_bf16 v[64:67], v[244:247], v[20:23], 0
  ds_write_b128 v4, v[188:191] offset:30784
  ds_read_b64_tr_b16 v[118:119], v5 offset:36936
  v_mfma_f32_16x16x32_bf16 v[156:159], v[24:27], v[24:27], v[156:159]
  ds_read_b64_tr_b16 v[122:123], v5 offset:36992
  ds_read_b64_tr_b16 v[126:127], v5 offset:37000
  v_mfma_f32_16x16x32_bf16 v[160:163], v[16:19], v[20:23], 0
  ds_write_b128 v4, v[192:195] offset:30848
  v_and_b32 v5, 3, v2
  v_mfma_f32_16x16x32_bf16 v[52:55], a[248:251], v[28:31], v[52:55]
  v_mul_u32_u24 v7, 0xc0, v5
  v_mov_b32 v245, 0
  v_mfma_f32_16x16x32_bf16 v[56:59], v[228:231], v[28:31], v[56:59]
  v_mov_b32 v246, 0
  v_mov_b32 v247, 0
  v_mfma_f32_16x16x32_bf16 v[60:63], v[236:239], v[24:27], v[60:63]
  v_mfma_f32_16x16x32_bf16 v[64:67], v[248:251], v[24:27], v[64:67]
  v_add_u32 v250, s65, v14
  v_cvt_pk_bf16_f32 v96, v52, v53
  v_mfma_f32_16x16x32_bf16 v[156:159], v[28:31], v[28:31], v[156:159]
  v_cvt_pk_bf16_f32 v97, v54, v55
  v_cvt_pk_bf16_f32 v98, v56, v57
  v_mfma_f32_16x16x32_bf16 v[160:163], v[16:19], v[24:27], v[160:163]
  v_cvt_pk_bf16_f32 v99, v58, v59
  v_mfma_f32_16x16x32_bf16 v[60:63], v[240:243], v[28:31], v[60:63]
  v_mov_b32 v240, s22
  v_add_u32 v241, v240, v14
  v_mfma_f32_16x16x32_bf16 v[64:67], v[252:255], v[28:31], v[64:67]
  v_cndmask_b32_e64 v196, v156, v157, s[30:31]
  v_cndmask_b32_e64 v196, v196, v158, s[32:33]
  v_mfma_f32_16x16x32_bf16 v[160:163], v[16:19], v[28:31], v[160:163]
  v_cndmask_b32_e64 v196, v196, v159, s[34:35]
  v_lshl_add_u32 v5, v5, 4, v240
  v_mfma_f32_16x16x32_bf16 v[152:155], v[20:23], v[92:95], 0
  v_cvt_pk_bf16_f32 v100, v60, v61
  v_cvt_pk_bf16_f32 v101, v62, v63
  v_mfma_f32_16x16x32_bf16 v[76:79], v[32:35], a[204:207], 0
  v_cvt_pk_bf16_f32 v102, v64, v65
  v_cvt_pk_bf16_f32 v103, v66, v67
  v_mfma_f32_16x16x32_bf16 v[152:155], v[24:27], v[96:99], v[152:155]
  v_mul_f32 v197, s58, v160
  v_fma_f32 v196, -v197, v160, v196
  v_mfma_f32_16x16x32_bf16 v[212:215], v[192:195], v[192:195], v[212:215]
  v_fma_f32 v196, v196, s58, v13
  v_rsq_f32 v196, v196
  v_mfma_f32_16x16x32_bf16 v[216:219], v[16:19], v[192:195], v[216:219]
  v_mul_f32 v199, s59, v196
  v_and_b32 v252, 3, v2
  v_mfma_f32_16x16x32_bf16 v[72:75], v[36:39], a[196:199], v[72:75]
  v_add_u32 v238, 0x180, v241
  v_mfma_f32_16x16x32_bf16 v[76:79], v[36:39], a[208:211], v[76:79]
  v_mfma_f32_16x16x32_bf16 v[152:155], v[28:31], v[100:103], v[152:155]
  v_mfma_f32_16x16x32_bf16 v[72:75], v[40:43], a[200:203], v[72:75]
  s_nop 0
  v_cndmask_b32_e64 v217, v212, v213, s[30:31]
  v_mfma_f32_16x16x32_bf16 v[76:79], v[40:43], a[212:215], v[76:79]
  v_cndmask_b32_e64 v217, v217, v214, s[32:33]
  v_cndmask_b32_e64 v217, v217, v215, s[34:35]
  v_mfma_f32_16x16x32_bf16 v[80:83], v[128:131], v[180:183], 0
  v_mul_f32 v218, s58, v216
  v_mul_f32_dpp v152, v196, v152 quad_perm:[0,0,0,0] row_mask:0xf bank_mask:0xf
  v_mfma_f32_16x16x32_bf16 v[84:87], v[132:135], v[180:183], 0
  v_mul_f32_dpp v153, v196, v153 quad_perm:[1,1,1,1] row_mask:0xf bank_mask:0xf
  v_mul_f32_dpp v154, v196, v154 quad_perm:[2,2,2,2] row_mask:0xf bank_mask:0xf
  v_mfma_f32_16x16x32_bf16 v[88:91], v[136:139], v[180:183], 0
  v_mul_f32_dpp v155, v196, v155 quad_perm:[3,3,3,3] row_mask:0xf bank_mask:0xf
  v_max3_f32 v198, v152, v153, v154
  v_mfma_f32_16x16x32_bf16 v[68:71], v[20:23], a[144:147], 0
  v_cvt_pk_bf16_f32 v144, v72, v73
  v_cvt_pk_bf16_f32 v145, v74, v75
  v_mfma_f32_16x16x32_bf16 v[68:71], v[24:27], a[148:151], v[68:71]
  v_cvt_pk_bf16_f32 v148, v76, v77
  v_cvt_pk_bf16_f32 v149, v78, v79
  v_mfma_f32_16x16x32_bf16 v[72:75], v[20:23], a[156:159], 0
  v_max_f32 v198, v198, v155
  v_fma_f32 v217, -v218, v216, v217
  v_mfma_f32_16x16x32_bf16 v[76:79], v[20:23], a[168:171], 0
  v_cvt_pk_bf16_f32 v184, v80, v81
  v_cvt_pk_bf16_f32 v185, v82, v83
  v_mfma_f32_16x16x32_bf16 v[80:83], v[140:143], v[180:183], 0
  v_mul_f32_e64 v200, -v198, v199
  v_fma_f32 v217, v217, s58, v13
  v_mfma_f32_16x16x32_bf16 v[68:71], v[28:31], a[152:155], v[68:71]
  v_fma_f32 v152, v152, v199, v200
  v_fma_f32 v153, v153, v199, v200
  v_mfma_f32_16x16x32_bf16 v[72:75], v[24:27], a[160:163], v[72:75]
  v_fma_f32 v154, v154, v199, v200
  v_fma_f32 v155, v155, v199, v200
  v_mfma_f32_16x16x32_bf16 v[76:79], v[24:27], a[172:175], v[76:79]
  v_rsq_f32 v217, v217
  v_mfma_f32_16x16x32_bf16 v[72:75], v[28:31], a[164:167], v[72:75]
  v_cvt_pk_bf16_f32 v186, v84, v85
  v_cvt_pk_bf16_f32 v187, v86, v87
  v_mfma_f32_16x16x32_bf16 v[84:87], v[144:147], v[180:183], 0
  v_cvt_pk_bf16_f32 v188, v88, v89
  v_cvt_pk_bf16_f32 v189, v90, v91
  v_mfma_f32_16x16x32_bf16 v[88:91], v[148:151], v[180:183], 0
  v_exp_f32 v152, v152
  v_mfma_f32_16x16x32_bf16 v[76:79], v[28:31], a[176:179], v[76:79]
  v_exp_f32 v153, v153
  v_mfma_f32_16x16x32_bf16 v[212:215], v[184:187], v[184:187], 0
  v_exp_f32 v154, v154
  v_exp_f32 v155, v155
  ds_write_b32 v6, v217 offset:144
  v_mfma_f32_16x16x32_bf16 v[216:219], v[16:19], v[184:187], 0
  v_add_f32 v201, v152, v153
  v_add_f32 v202, v154, v155
  v_cvt_pk_bf16_f32 v190, v80, v81
  v_cvt_pk_bf16_f32 v191, v82, v83
  v_add_f32 v201, v201, v202
  v_cvt_pk_bf16_f32 v104, v68, v69
  v_mfma_f32_16x16x32_bf16 v[212:215], v[188:191], v[188:191], v[212:215]
  v_cvt_pk_bf16_f32 v105, v70, v71
  v_rcp_f32 v201, v201
  v_mfma_f32_16x16x32_bf16 v[216:219], v[16:19], v[188:191], v[216:219]
  v_cvt_pk_bf16_f32 v192, v84, v85
  v_cvt_pk_bf16_f32 v193, v86, v87
  v_mfma_f32_16x16x32_bf16 v[68:71], v[20:23], a[180:183], 0
  v_cvt_pk_bf16_f32 v194, v88, v89
  v_cvt_pk_bf16_f32 v195, v90, v91
  v_mfma_f32_16x16x32_bf16 v[68:71], v[24:27], a[184:187], v[68:71]
  v_mul_f32_dpp v152, v196, v152 quad_perm:[0,0,0,0] row_mask:0xf bank_mask:0xf
  v_mul_f32_dpp v153, v196, v153 quad_perm:[1,1,1,1] row_mask:0xf bank_mask:0xf
  v_mfma_f32_16x16x32_bf16 v[212:215], v[192:195], v[192:195], v[212:215]
  v_mul_f32_dpp v154, v196, v154 quad_perm:[2,2,2,2] row_mask:0xf bank_mask:0xf
  v_mul_f32_dpp v155, v196, v155 quad_perm:[3,3,3,3] row_mask:0xf bank_mask:0xf
  v_mfma_f32_16x16x32_bf16 v[216:219], v[16:19], v[192:195], v[216:219]
  v_cvt_pk_bf16_f32 v108, v72, v73
  v_cvt_pk_bf16_f32 v109, v74, v75
  v_mfma_f32_16x16x32_bf16 v[72:75], v[20:23], a[192:195], 0
  v_cvt_pk_bf16_f32 v112, v76, v77
  v_cvt_pk_bf16_f32 v113, v78, v79
  v_mfma_f32_16x16x32_bf16 v[76:79], v[20:23], a[204:207], 0
  v_mul_f32 v152, v152, v201
  v_mul_f32 v153, v153, v201
  v_mfma_f32_16x16x32_bf16 v[68:71], v[28:31], a[188:191], v[68:71]
  v_mul_f32 v154, v154, v201
  v_mul_f32 v155, v155, v201
  v_mfma_f32_16x16x32_bf16 v[72:75], v[24:27], a[196:199], v[72:75]
  v_cvt_pk_bf16_f32 v152, v152, v153
  v_cvt_pk_bf16_f32 v154, v154, v155
  v_mfma_f32_16x16x32_bf16 v[76:79], v[24:27], a[208:211], v[76:79]
  v_cndmask_b32_e64 v176, 0, v152, s[36:37]
  v_cndmask_b32_e64 v177, 0, v154, s[36:37]
  v_mfma_f32_16x16x32_bf16 v[72:75], v[28:31], a[200:203], v[72:75]
  v_cndmask_b32_e64 v217, v212, v213, s[30:31]
  v_cndmask_b32_e64 v217, v217, v214, s[32:33]
  s_waitcnt lgkmcnt(0)
  v_mfma_f32_16x16x32_bf16 v[80:83], v[104:107], v[176:179], 0
  ds_write_b128 v4, v[184:187] offset:33792
  v_cndmask_b32_e64 v217, v217, v215, s[34:35]
  v_mfma_f32_16x16x32_bf16 v[76:79], v[28:31], a[212:215], v[76:79]
  v_mul_f32 v218, s58, v216
  v_cvt_pk_bf16_f32 v116, v68, v69
  v_mfma_f32_16x16x32_bf16 v[84:87], v[108:111], v[176:179], 0
  v_cvt_pk_bf16_f32 v117, v70, v71
  v_fma_f32 v217, -v218, v216, v217
  v_mfma_f32_16x16x32_bf16 v[88:91], v[112:115], v[176:179], 0
  v_cvt_pk_bf16_f32 v184, v80, v81
  v_cvt_pk_bf16_f32 v185, v82, v83
  v_mfma_f32_16x16x32_bf16 v[80:83], v[116:119], v[176:179], 0
  ds_write_b128 v4, v[188:191] offset:33856
  v_fma_f32 v217, v217, s58, v13
  v_cvt_pk_bf16_f32 v120, v72, v73
  v_cvt_pk_bf16_f32 v121, v74, v75
  v_cvt_pk_bf16_f32 v124, v76, v77
  v_cvt_pk_bf16_f32 v125, v78, v79
  v_rsq_f32 v217, v217
  v_cvt_pk_bf16_f32 v186, v84, v85
  v_cvt_pk_bf16_f32 v187, v86, v87
  v_mfma_f32_16x16x32_bf16 v[84:87], v[120:123], v[176:179], 0
  v_cvt_pk_bf16_f32 v188, v88, v89
  v_cvt_pk_bf16_f32 v189, v90, v91
  v_mfma_f32_16x16x32_bf16 v[88:91], v[124:127], v[176:179], 0
  ds_write_b32 v6, v217 offset:160
  v_cvt_pk_bf16_f32 v190, v80, v81
  v_mfma_f32_16x16x32_bf16 v[212:215], v[184:187], v[184:187], 0
  v_cvt_pk_bf16_f32 v191, v82, v83
  ds_write_b128 v4, v[192:195] offset:33920
  v_mfma_f32_16x16x32_bf16 v[216:219], v[16:19], v[184:187], 0
  v_cvt_pk_bf16_f32 v192, v84, v85
  v_cvt_pk_bf16_f32 v193, v86, v87
  v_mfma_f32_16x16x32_bf16 v[212:215], v[188:191], v[188:191], v[212:215]
  v_cvt_pk_bf16_f32 v194, v88, v89
  v_cvt_pk_bf16_f32 v195, v90, v91
  v_mfma_f32_16x16x32_bf16 v[216:219], v[16:19], v[188:191], v[216:219]
  ds_write_b128 v4, v[184:187] offset:36864
  ds_write_b128 v4, v[188:191] offset:36928
  v_mfma_f32_16x16x32_bf16 v[212:215], v[192:195], v[192:195], v[212:215]
  ds_write_b128 v4, v[192:195] offset:36992
  v_lshrrev_b32 v4, 2, v2
  v_mfma_f32_16x16x32_bf16 v[216:219], v[16:19], v[192:195], v[216:219]
  s_nop 7
  v_cndmask_b32_e64 v217, v212, v213, s[30:31]
  v_cndmask_b32_e64 v217, v217, v214, s[32:33]
  v_cndmask_b32_e64 v217, v217, v215, s[34:35]
  v_mul_f32 v218, s58, v216
  v_fma_f32 v217, -v218, v216, v217
  v_fma_f32 v217, v217, s58, v13
  v_rsq_f32 v217, v217
  ds_write_b32 v6, v217 offset:176
  v_mul_u32_u24 v6, 0xc00, v4
  v_add3_u32 v6, v6, v7, v241
  v_add_u32 v228, 0xc00, v6
  v_add_u32 v6, 0x6c00, v228
  v_cndmask_b32_e64 v229, v6, v241, s[82:83]
  v_lshl_add_u32 v6, v3, 2, v4
  v_add_u32 v7, -1, v6
  v_ashrrev_i32 v8, 2, v7
  v_and_b32 v7, 3, v7
  v_mul_i32_i24 v8, 0xc00, v8
  v_mul_u32_u24 v7, 0xc0, v7
  v_add3_u32 v7, v7, v8, v5
  v_add_u32 v7, 0xc00, v7
  v_add_u32 v8, 0xc0, v5
  v_cmp_eq_u32_e64 s[40:41], 0, v6
  v_cmp_le_u32_e64 s[42:43], 13, v6
  ds_read_b128 a[144:147], v228
  v_cndmask_b32_e64 v230, v7, v8, s[40:41]
  v_add_u32 v7, 0x2400, v7
  v_cndmask_b32_e64 v231, v7, v8, s[40:41]
  v_add_u32 v7, 0x2400, v7
  v_cndmask_b32_e64 v232, v7, v8, s[40:41]
  v_add_u32 v7, 0x2400, v7
  v_cndmask_b32_e64 v233, v7, v5, s[42:43]
  v_xor_b32 v7, v3, v252
  v_lshlrev_b32 v7, 4, v7
  v_mul_u32_u24 v252, 0x300, v252
  v_add3_u32 v252, v252, v7, v240
  ds_read_b128 a[180:183], v252
  ds_read_b128 a[184:187], v252 offset:64
  ds_read_b128 a[188:191], v252 offset:128
  ds_read_b128 a[148:151], v228 offset:64
  ds_read_b128 a[152:155], v228 offset:128
  ds_read_b128 a[156:159], v228 offset:12288
  ds_read_b128 a[160:163], v228 offset:12352
  ds_read_b128 a[164:167], v228 offset:12416
  v_add_u32 v4, 0, v2
  v_mul_u32_u24 v6, 37, v4
  v_lshrrev_b32 v6, 8, v6
  v_mul_u32_u24 v6, s60, v6
  v_mul_u32_u24 v4, 0xc0, v4
  ds_read_b128 a[168:171], v228 offset:24576
  v_add3_u32 v4, v4, v6, v14
  v_cmp_gt_u32_e64 s[82:83], 12, v2
  v_mov_b32 v6, 0x7f000000
  ds_read_b128 a[172:175], v228 offset:24640
  v_cndmask_b32_e64 v234, v6, v4, s[82:83]
  v_add_u32 v4, 12, v2
  ds_read_b128 a[176:179], v228 offset:24704
  v_mul_u32_u24 v6, 37, v4
  v_lshrrev_b32 v6, 8, v6
  v_mul_u32_u24 v6, s60, v6
  v_mul_u32_u24 v4, 0xc0, v4
  v_add3_u32 v4, v4, v6, v14
  v_cmp_gt_u32_e64 s[82:83], 12, v2
  v_mov_b32 v6, 0x7f000000
  v_and_b32 v7, 3, v2
  v_cndmask_b32_e64 v235, v6, v4, s[82:83]
  v_add_u32 v4, 24, v2
  v_mul_u32_u24 v7, 0xc0, v7
  s_waitcnt lgkmcnt(3)
  v_mfma_f32_16x16x32_bf16 v[68:71], a[0:3], a[180:183], 0
  v_mul_u32_u24 v6, 37, v4
  v_add_u32 v7, v7, v250
  v_mfma_f32_16x16x32_bf16 v[72:75], a[12:15], a[180:183], 0
  v_lshrrev_b32 v6, 8, v6
  v_mul_u32_u24 v6, s60, v6
  v_mfma_f32_16x16x32_bf16 v[68:71], a[4:7], a[184:187], v[68:71]
  v_mul_u32_u24 v4, 0xc0, v4
  v_add3_u32 v4, v4, v6, v14
  v_mfma_f32_16x16x32_bf16 v[72:75], a[16:19], a[184:187], v[72:75]
  v_cmp_gt_u32_e64 s[82:83], 12, v2
  v_mov_b32 v6, 0x7f000000
  v_mfma_f32_16x16x32_bf16 v[76:79], a[24:27], a[180:183], 0
  ds_read_b128 a[228:231], v228
  v_cndmask_b32_e64 v236, v6, v4, s[82:83]
  v_mfma_f32_16x16x32_bf16 v[80:83], a[36:39], a[180:183], 0
  v_add_u32 v4, 36, v2
  ds_read_b128 a[232:235], v228 offset:64
  v_mfma_f32_16x16x32_bf16 v[68:71], a[8:11], a[188:191], v[68:71]
  v_mul_u32_u24 v6, 37, v4
  v_lshrrev_b32 v6, 8, v6
  v_mfma_f32_16x16x32_bf16 v[72:75], a[20:23], a[188:191], v[72:75]
  ds_read_b128 a[236:239], v228 offset:128
  v_mul_u32_u24 v6, s60, v6
  v_mfma_f32_16x16x32_bf16 v[76:79], a[28:31], a[184:187], v[76:79]
  v_mul_u32_u24 v4, 0xc0, v4
  v_add3_u32 v4, v4, v6, v14
  v_mfma_f32_16x16x32_bf16 v[80:83], a[40:43], a[184:187], v[80:83]
  v_cvt_pk_bf16_f32 v216, v68, v69
  v_cvt_pk_bf16_f32 v217, v70, v71
  v_mfma_f32_16x16x32_bf16 v[76:79], a[32:35], a[188:191], v[76:79]
  v_cvt_pk_bf16_f32 v218, v72, v73
  v_cvt_pk_bf16_f32 v219, v74, v75
  v_mfma_f32_16x16x32_bf16 v[80:83], a[44:47], a[188:191], v[80:83]
  ds_write_b128 v7, v[216:219]
  v_cmp_gt_u32_e64 s[82:83], 13, v2
  v_mfma_f32_16x16x32_bf16 v[84:87], a[48:51], a[180:183], 0
  v_mov_b32 v6, 0x7f000000
  v_cndmask_b32_e64 v237, v6, v4, s[82:83]
  v_mfma_f32_16x16x32_bf16 v[84:87], a[52:55], a[184:187], v[84:87]
  v_cvt_pk_bf16_f32 v220, v76, v77
  v_cvt_pk_bf16_f32 v221, v78, v79
  v_mfma_f32_16x16x32_bf16 v[68:71], a[60:63], a[180:183], 0
  v_cvt_pk_bf16_f32 v222, v80, v81
  v_cvt_pk_bf16_f32 v223, v82, v83
  v_mfma_f32_16x16x32_bf16 v[72:75], a[0:3], a[144:147], 0
  ds_write_b128 v7, v[220:223] offset:64
  v_lshl_add_u32 v4, v2, 2, v240
  v_mfma_f32_16x16x32_bf16 v[84:87], a[56:59], a[188:191], v[84:87]
  v_add_u32 v239, 0x180, v4
  v_min_u32 v4, 12, v2
  v_mfma_f32_16x16x32_bf16 v[68:71], a[64:67], a[184:187], v[68:71]
  v_lshl_add_u32 v4, v4, 2, v240
  v_add_u32 v13, 0x210, v4
  v_mfma_f32_16x16x32_bf16 v[72:75], a[4:7], a[148:151], v[72:75]
  v_mov_b32 v4, 0xff800000
  v_cndmask_b32_e64 v244, v4, 0, s[38:39]
  v_mfma_f32_16x16x32_bf16 v[76:79], a[12:15], a[144:147], 0
  v_cvt_pk_bf16_f32 v224, v84, v85
  v_cvt_pk_bf16_f32 v225, v86, v87
  v_mfma_f32_16x16x32_bf16 v[80:83], a[24:27], a[144:147], 0
  ds_read_b128 v[184:187], v238
  ds_read_b128 v[188:191], v238 offset:64
  v_mfma_f32_16x16x32_bf16 v[68:71], a[68:71], a[188:191], v[68:71]
  ds_read_b32 v200, v239
  ds_read_b128 v[192:195], v238 offset:128
  v_mfma_f32_16x16x32_bf16 v[72:75], a[8:11], a[152:155], v[72:75]
  ds_read_b32 v196, v240 offset:576
  v_lshlrev_b32 v4, 2, v3
  v_mfma_f32_16x16x32_bf16 v[76:79], a[16:19], a[148:151], v[76:79]
  v_sub_u32 v4, v2, v4
  v_add_u32 v4, 1, v4
  v_mfma_f32_16x16x32_bf16 v[80:83], a[28:31], a[148:151], v[80:83]
  v_cvt_pk_bf16_f32 v226, v68, v69
  v_cvt_pk_bf16_f32 v227, v70, v71
  v_mfma_f32_16x16x32_bf16 v[76:79], a[20:23], a[152:155], v[76:79]
  v_cvt_pk_bf16_f32 v100, v72, v73
  v_cvt_pk_bf16_f32 v101, v74, v75
  v_mfma_f32_16x16x32_bf16 v[80:83], a[32:35], a[152:155], v[80:83]
  ds_write_b128 v7, v[224:227] offset:128
  ds_read_b128 a[216:219], v250
  v_mfma_f32_16x16x32_bf16 v[84:87], a[36:39], a[144:147], 0
  ds_read_b128 a[220:223], v250 offset:64
  ds_read_b128 a[224:227], v250 offset:128
  v_mfma_f32_16x16x32_bf16 v[84:87], a[40:43], a[148:151], v[84:87]
  v_cvt_pk_bf16_f32 v102, v76, v77
  v_cvt_pk_bf16_f32 v103, v78, v79
  v_mfma_f32_16x16x32_bf16 v[68:71], a[48:51], a[144:147], 0
  v_cvt_pk_bf16_f32 v104, v80, v81
  v_cvt_pk_bf16_f32 v105, v82, v83
  v_mfma_f32_16x16x32_bf16 v[72:75], a[60:63], a[144:147], 0
  v_cmp_eq_u32_e64 s[82:83], 0, v4
  v_cndmask_b32_e64 v233, v233, v8, s[40:41]
  v_mfma_f32_16x16x32_bf16 v[84:87], a[44:47], a[152:155], v[84:87]
  v_cndmask_b32_e64 v5, 0, 1.0, s[82:83]
  v_cndmask_b32_e64 v242, v5, 0, s[38:39]
  v_mfma_f32_16x16x32_bf16 v[68:71], a[52:55], a[148:151], v[68:71]
  v_cmp_eq_u32_e64 s[82:83], 1, v4
  v_and_b32 v5, 1, v4
  v_mfma_f32_16x16x32_bf16 v[72:75], a[64:67], a[148:151], v[72:75]
  v_cndmask_b32_e64 v243, 0, 1.0, s[82:83]
  v_mov_b32 v8, 0x3f80
  v_mfma_f32_16x16x32_bf16 v[76:79], a[0:3], a[156:159], 0
  v_cvt_pk_bf16_f32 v106, v84, v85
  v_cvt_pk_bf16_f32 v107, v86, v87
  v_mfma_f32_16x16x32_bf16 v[80:83], a[12:15], a[156:159], 0
  v_lshlrev_b32 v5, 4, v5
  v_ashrrev_i32 v6, 1, v4
  v_mfma_f32_16x16x32_bf16 v[68:71], a[56:59], a[152:155], v[68:71]
  v_lshlrev_b32 v5, v5, v8
  v_cmp_eq_i32_e64 s[82:83], 1, v6
  v_mfma_f32_16x16x32_bf16 v[72:75], a[68:71], a[152:155], v[72:75]
  s_waitcnt lgkmcnt(0)
  v_mul_f32 v200, s59, v200
  v_cndmask_b32_e64 v175, 0, v5, s[82:83]
  v_mfma_f32_16x16x32_bf16 v[76:79], a[4:7], a[160:163], v[76:79]
  v_and_b32 v5, 1, v4
  v_lshlrev_b32 v5, 4, v5
  v_mfma_f32_16x16x32_bf16 v[80:83], a[16:19], a[160:163], v[80:83]
  v_cvt_pk_bf16_f32 v108, v68, v69
  v_cvt_pk_bf16_f32 v109, v70, v71
  v_mfma_f32_16x16x32_bf16 v[76:79], a[8:11], a[164:167], v[76:79]
  v_cvt_pk_bf16_f32 v110, v72, v73
  v_cvt_pk_bf16_f32 v111, v74, v75
  v_mfma_f32_16x16x32_bf16 v[80:83], a[20:23], a[164:167], v[80:83]
  v_ashrrev_i32 v6, 1, v4
  ds_read_b128 a[240:243], v228 offset:9216
  v_mfma_f32_16x16x32_bf16 v[84:87], a[24:27], a[156:159], 0
  v_lshlrev_b32 v5, v5, v8
  v_cmp_eq_i32_e64 s[82:83], 1, v6
  v_mfma_f32_16x16x32_bf16 v[84:87], a[28:31], a[160:163], v[84:87]
  v_cvt_pk_bf16_f32 v112, v76, v77
  v_cvt_pk_bf16_f32 v113, v78, v79
  v_mfma_f32_16x16x32_bf16 v[68:71], a[36:39], a[156:159], 0
  v_cvt_pk_bf16_f32 v114, v80, v81
  v_cvt_pk_bf16_f32 v115, v82, v83
  v_mfma_f32_16x16x32_bf16 v[72:75], a[48:51], a[156:159], 0
  v_cndmask_b32_e64 v183, 0, v5, s[82:83]
  ds_read_b128 a[244:247], v228 offset:9280
  v_mfma_f32_16x16x32_bf16 v[84:87], a[32:35], a[164:167], v[84:87]
  ds_read_b128 a[248:251], v228 offset:9344
  ds_read_b32 v208, v239 offset:48
  v_mfma_f32_16x16x32_bf16 v[68:71], a[40:43], a[160:163], v[68:71]
  v_mfma_f32_16x16x32_bf16 v[72:75], a[52:55], a[160:163], v[72:75]
  v_mfma_f32_16x16x32_bf16 v[76:79], a[60:63], a[156:159], 0
  v_mfma_f32_16x16x32_bf16 v[80:83], a[0:3], a[168:171], 0
  v_mfma_f32_16x16x32_bf16 v[68:71], a[44:47], a[164:167], v[68:71]
  s_nop 0
  v_cvt_pk_bf16_f32 v116, v84, v85
  v_mfma_f32_16x16x32_bf16 v[72:75], a[56:59], a[164:167], v[72:75]
  v_cvt_pk_bf16_f32 v117, v86, v87
  v_mfma_f32_16x16x32_bf16 v[76:79], a[64:67], a[160:163], v[76:79]
  v_mfma_f32_16x16x32_bf16 v[80:83], a[4:7], a[172:175], v[80:83]
  s_waitcnt lgkmcnt(0)
  v_mul_f32 v208, s59, v208
  v_mfma_f32_16x16x32_bf16 v[76:79], a[68:71], a[164:167], v[76:79]
  v_cvt_pk_bf16_f32 v118, v68, v69
  v_cvt_pk_bf16_f32 v119, v70, v71
  v_mfma_f32_16x16x32_bf16 v[80:83], a[8:11], a[176:179], v[80:83]
  v_cvt_pk_bf16_f32 v120, v72, v73
  v_cvt_pk_bf16_f32 v121, v74, v75
  v_mfma_f32_16x16x32_bf16 v[84:87], a[12:15], a[168:171], 0
  s_lshl_b32 s27, s20, 12
  v_lshlrev_b32 v253, 6, v1
  v_mfma_f32_16x16x32_bf16 v[84:87], a[16:19], a[172:175], v[84:87]
  v_cvt_pk_bf16_f32 v122, v76, v77
  v_cvt_pk_bf16_f32 v123, v78, v79
  v_mfma_f32_16x16x32_bf16 v[68:71], a[24:27], a[168:171], 0
  v_cvt_pk_bf16_f32 v124, v80, v81
  v_cvt_pk_bf16_f32 v125, v82, v83
  v_mfma_f32_16x16x32_bf16 v[72:75], a[36:39], a[168:171], 0
  v_add_u32 v253, s27, v253
  v_mfma_f32_16x16x32_bf16 v[84:87], a[20:23], a[176:179], v[84:87]
  v_xor_b32 v248, 16, v228
  v_mfma_f32_16x16x32_bf16 v[68:71], a[28:31], a[172:175], v[68:71]
  v_mfma_f32_16x16x32_bf16 v[72:75], a[40:43], a[172:175], v[72:75]
  v_mfma_f32_16x16x32_bf16 v[76:79], a[48:51], a[168:171], 0
  v_mfma_f32_16x16x32_bf16 v[80:83], a[60:63], a[168:171], 0
  v_mfma_f32_16x16x32_bf16 v[68:71], a[32:35], a[176:179], v[68:71]
  v_mfma_f32_16x16x32_bf16 v[72:75], a[44:47], a[176:179], v[72:75]
  s_nop 0
  v_cvt_pk_bf16_f32 v126, v84, v85
  v_mfma_f32_16x16x32_bf16 v[76:79], a[52:55], a[172:175], v[76:79]
  v_cvt_pk_bf16_f32 v127, v86, v87
  ds_read_b128 a[192:195], v248 offset:13056
  v_mfma_f32_16x16x32_bf16 v[80:83], a[64:67], a[172:175], v[80:83]
  ds_read_b128 a[196:199], v248 offset:13120
  v_cvt_pk_bf16_f32 v128, v68, v69
  v_mfma_f32_16x16x32_bf16 v[76:79], a[56:59], a[176:179], v[76:79]
  v_cvt_pk_bf16_f32 v129, v70, v71
  v_cvt_pk_bf16_f32 v130, v72, v73
  v_mfma_f32_16x16x32_bf16 v[80:83], a[68:71], a[176:179], v[80:83]
  v_cvt_pk_bf16_f32 v131, v74, v75
  ds_read_b128 a[200:203], v248 offset:13184
  v_mfma_f32_16x16x32_bf16 v[136:139], v[100:103], a[228:231], 0
  ds_read_b128 a[204:207], v248 offset:25344
  ds_read_b128 a[208:211], v248 offset:25408
  v_mfma_f32_16x16x32_bf16 v[140:143], v[112:115], a[228:231], 0
  v_cvt_pk_bf16_f32 v132, v76, v77
  v_cvt_pk_bf16_f32 v133, v78, v79
  v_mfma_f32_16x16x32_bf16 v[144:147], v[124:127], a[228:231], 0
  v_cvt_pk_bf16_f32 v134, v80, v81
  v_cvt_pk_bf16_f32 v135, v82, v83
  v_mfma_f32_16x16x32_bf16 v[148:151], a[216:219], a[228:231], v[244:247]
  ds_read_b128 a[228:231], v228 offset:18432
  ds_read_b128 a[212:215], v248 offset:25472
  v_mfma_f32_16x16x32_bf16 v[136:139], v[104:107], a[232:235], v[136:139]
  v_mfma_f32_16x16x32_bf16 v[140:143], v[116:119], a[232:235], v[140:143]
  v_mfma_f32_16x16x32_bf16 v[144:147], v[128:131], a[232:235], v[144:147]
  v_mfma_f32_16x16x32_bf16 v[148:151], a[220:223], a[232:235], v[148:151]
  ds_read_b128 a[232:235], v228 offset:18496
  v_mfma_f32_16x16x32_bf16 v[136:139], v[108:111], a[236:239], v[136:139]
  v_mfma_f32_16x16x32_bf16 v[140:143], v[120:123], a[236:239], v[140:143]
  v_mfma_f32_16x16x32_bf16 v[144:147], v[132:135], a[236:239], v[144:147]
  v_mfma_f32_16x16x32_bf16 v[148:151], a[224:227], a[236:239], v[148:151]
  ds_read_b128 a[236:239], v228 offset:18560
  v_mfma_f32_16x16x32_bf16 v[88:91], a[72:75], a[180:183], 0
  v_mfma_f32_16x16x32_bf16 v[88:91], a[76:79], a[184:187], v[88:91]
  v_mfma_f32_16x16x32_bf16 v[88:91], a[80:83], a[188:191], v[88:91]
  s_nop 0
  v_mul_f32 v136, v136, v184
  v_mfma_f32_16x16x32_bf16 v[92:95], a[84:87], a[180:183], 0
  v_mul_f32 v137, v137, v185
  v_mul_f32 v138, v138, v186
  v_mfma_f32_16x16x32_bf16 v[92:95], a[88:91], a[184:187], v[92:95]
  v_mul_f32 v139, v139, v187
  v_mul_f32 v140, v140, v188
  v_mfma_f32_16x16x32_bf16 v[92:95], a[92:95], a[188:191], v[92:95]
  v_cvt_pk_bf16_f32 v216, v88, v89
  v_cvt_pk_bf16_f32 v217, v90, v91
  v_mfma_f32_16x16x32_bf16 v[88:91], a[108:111], a[180:183], 0
  v_mul_f32 v141, v141, v189
  v_mul_f32 v142, v142, v190
  v_mfma_f32_16x16x32_bf16 v[88:91], a[112:115], a[184:187], v[88:91]
  v_mul_f32 v143, v143, v191
  v_mul_f32 v136, v136, v200
  v_mfma_f32_16x16x32_bf16 v[88:91], a[116:119], a[188:191], v[88:91]
  v_cvt_pk_bf16_f32 v218, v92, v93
  v_cvt_pk_bf16_f32 v219, v94, v95
  v_mfma_f32_16x16x32_bf16 v[92:95], a[120:123], a[180:183], 0
  ds_write_b128 v252, v[216:219] offset:192
  v_mul_f32 v137, v137, v200
  v_mfma_f32_16x16x32_bf16 v[96:99], a[96:99], a[180:183], 0
  v_mul_f32 v138, v138, v200
  v_mul_f32 v139, v139, v200
  v_mfma_f32_16x16x32_bf16 v[92:95], a[124:127], a[184:187], v[92:95]
  v_cvt_pk_bf16_f32 v222, v88, v89
  v_cvt_pk_bf16_f32 v223, v90, v91
  v_mfma_f32_16x16x32_bf16 v[88:91], a[144:147], a[72:75], 0
  v_mul_f32 v140, v140, v200
  v_mul_f32 v141, v141, v200
  v_mfma_f32_16x16x32_bf16 v[88:91], a[148:151], a[76:79], v[88:91]
  v_mul_f32 v142, v142, v200
  v_mul_f32 v143, v143, v200
  v_mfma_f32_16x16x32_bf16 v[88:91], a[152:155], a[80:83], v[88:91]
  v_mul_f32 v144, v144, v192
  v_mul_f32 v145, v145, v193
  v_mfma_f32_16x16x32_bf16 v[96:99], a[100:103], a[184:187], v[96:99]
  v_mul_f32 v146, v146, v194
  v_mul_f32 v147, v147, v195
  v_mfma_f32_16x16x32_bf16 v[92:95], a[128:131], a[188:191], v[92:95]
  v_mul_f32 v148, v148, v196
  v_exp_f32 v136, v136
  v_mfma_f32_16x16x32_bf16 v[96:99], a[104:107], a[188:191], v[96:99]
  v_cvt_pk_bf16_f32 v20, v88, v89
  v_cvt_pk_bf16_f32 v21, v90, v91
  v_mfma_f32_16x16x32_bf16 v[88:91], a[144:147], a[108:111], 0
  v_exp_f32 v137, v137
  v_mfma_f32_16x16x32_bf16 v[88:91], a[148:151], a[112:115], v[88:91]
  v_cvt_pk_bf16_f32 v224, v92, v93
  v_cvt_pk_bf16_f32 v225, v94, v95
  v_mfma_f32_16x16x32_bf16 v[92:95], a[144:147], a[84:87], 0
  v_cvt_pk_bf16_f32 v220, v96, v97
  v_cvt_pk_bf16_f32 v221, v98, v99
  v_mfma_f32_16x16x32_bf16 v[96:99], a[132:135], a[180:183], 0
  ds_write_b128 v252, v[220:223] offset:256
  v_exp_f32 v138, v138
  v_mfma_f32_16x16x32_bf16 v[92:95], a[148:151], a[88:91], v[92:95]
  v_exp_f32 v139, v139
  v_mfma_f32_16x16x32_bf16 v[88:91], a[152:155], a[116:119], v[88:91]
  v_exp_f32 v140, v140
  v_mfma_f32_16x16x32_bf16 v[96:99], a[136:139], a[184:187], v[96:99]
  v_exp_f32 v141, v141
  v_mfma_f32_16x16x32_bf16 v[92:95], a[152:155], a[92:95], v[92:95]
  v_exp_f32 v142, v142
  v_mfma_f32_16x16x32_bf16 v[96:99], a[140:143], a[188:191], v[96:99]
  v_exp_f32 v143, v143
  v_mfma_f32_16x16x32_bf16 v[152:155], v[100:103], a[240:243], 0
  v_cvt_pk_bf16_f32 v44, v88, v89
  v_cvt_pk_bf16_f32 v45, v90, v91
  v_mfma_f32_16x16x32_bf16 v[88:91], a[156:159], a[72:75], 0
  v_mul_f32 v144, v144, v200
  v_cvt_pk_bf16_f32 v28, v92, v93
  v_mfma_f32_16x16x32_bf16 v[88:91], a[160:163], a[76:79], v[88:91]
  v_cvt_pk_bf16_f32 v29, v94, v95
  v_cvt_pk_bf16_f32 v226, v96, v97
  v_mfma_f32_16x16x32_bf16 v[92:95], a[144:147], a[120:123], 0
  v_cvt_pk_bf16_f32 v227, v98, v99
  ds_write_b128 v252, v[224:227] offset:320
  v_mfma_f32_16x16x32_bf16 v[96:99], a[144:147], a[96:99], 0
  ds_read_b64_tr_b16 v[26:27], v230
  v_mul_f32 v145, v145, v200
  v_mfma_f32_16x16x32_bf16 v[92:95], a[148:151], a[124:127], v[92:95]
  v_mul_f32 v146, v146, v200
  v_mul_f32 v147, v147, v200
  v_mfma_f32_16x16x32_bf16 v[88:91], a[164:167], a[80:83], v[88:91]
  v_mul_f32 v148, v148, v200
  v_exp_f32 v144, v144
  v_mfma_f32_16x16x32_bf16 v[96:99], a[148:151], a[100:103], v[96:99]
  v_exp_f32 v145, v145
  v_mfma_f32_16x16x32_bf16 v[92:95], a[152:155], a[128:131], v[92:95]
  v_exp_f32 v146, v146
  v_mfma_f32_16x16x32_bf16 v[96:99], a[152:155], a[104:107], v[96:99]
  v_exp_f32 v147, v147
  v_mfma_f32_16x16x32_bf16 v[156:159], v[112:115], a[240:243], 0
  v_cvt_pk_bf16_f32 v22, v88, v89
  v_cvt_pk_bf16_f32 v23, v90, v91
  v_mfma_f32_16x16x32_bf16 v[88:91], a[156:159], a[108:111], 0
  v_exp_f32 v148, v148
  v_mfma_f32_16x16x32_bf16 v[88:91], a[160:163], a[112:115], v[88:91]
  v_cvt_pk_bf16_f32 v52, v92, v93
  v_cvt_pk_bf16_f32 v53, v94, v95
  v_mfma_f32_16x16x32_bf16 v[92:95], a[156:159], a[84:87], 0
  v_cvt_pk_bf16_f32 v36, v96, v97
  v_cvt_pk_bf16_f32 v37, v98, v99
  v_mfma_f32_16x16x32_bf16 v[96:99], a[144:147], a[132:135], 0
  v_cvt_pk_bf16_f32 v4, v136, v137
  v_cvt_pk_bf16_f32 v5, v138, v139
  v_mfma_f32_16x16x32_bf16 v[92:95], a[160:163], a[88:91], v[92:95]
  v_cvt_pk_bf16_f32 v6, v140, v141
  v_cvt_pk_bf16_f32 v7, v142, v143
  v_mfma_f32_16x16x32_bf16 v[88:91], a[164:167], a[116:119], v[88:91]
  v_cvt_pk_bf16_f32 v8, v144, v145
  v_cvt_pk_bf16_f32 v9, v146, v147
  v_mfma_f32_16x16x32_bf16 v[96:99], a[148:151], a[136:139], v[96:99]
  v_cvt_pk_bf16_f32 v10, v148, v15
  ds_read_b64_tr_b16 v[50:51], v230 offset:72
  v_mfma_f32_16x16x32_bf16 v[92:95], a[164:167], a[92:95], v[92:95]
  ds_read_b64_tr_b16 v[34:35], v230 offset:8
  v_mul_f32 v136, v136, v184
  v_mfma_f32_16x16x32_bf16 v[96:99], a[152:155], a[140:143], v[96:99]
  v_cvt_pk_bf16_f32 v46, v88, v89
  v_cvt_pk_bf16_f32 v47, v90, v91
  v_mfma_f32_16x16x32_bf16 v[88:91], a[168:171], a[72:75], 0
  v_mul_f32 v137, v137, v185
  v_mul_f32 v138, v138, v186
  v_mfma_f32_16x16x32_bf16 v[88:91], a[172:175], a[76:79], v[88:91]
  v_cvt_pk_bf16_f32 v30, v92, v93
  v_cvt_pk_bf16_f32 v31, v94, v95
  v_mfma_f32_16x16x32_bf16 v[92:95], a[156:159], a[120:123], 0
  v_cvt_pk_bf16_f32 v60, v96, v97
  v_cvt_pk_bf16_f32 v61, v98, v99
  v_mfma_f32_16x16x32_bf16 v[96:99], a[156:159], a[96:99], 0
  v_mul_f32 v139, v139, v187
  v_mul_f32 v140, v140, v188
  v_mfma_f32_16x16x32_bf16 v[92:95], a[160:163], a[124:127], v[92:95]
  v_mul_f32 v141, v141, v189
  v_mul_f32 v142, v142, v190
  v_mfma_f32_16x16x32_bf16 v[88:91], a[176:179], a[80:83], v[88:91]
  v_mul_f32 v143, v143, v191
  v_mul_f32 v144, v144, v192
  v_mfma_f32_16x16x32_bf16 v[96:99], a[160:163], a[100:103], v[96:99]
  v_mul_f32 v145, v145, v193
  v_mul_f32 v146, v146, v194
  v_mfma_f32_16x16x32_bf16 v[92:95], a[164:167], a[128:131], v[92:95]
  v_mul_f32 v147, v147, v195
  v_mul_f32 v148, v148, v196
  v_mfma_f32_16x16x32_bf16 v[96:99], a[164:167], a[104:107], v[96:99]
  v_cvt_pk_bf16_f32 v24, v88, v89
  v_cvt_pk_bf16_f32 v25, v90, v91
  v_mfma_f32_16x16x32_bf16 v[88:91], a[168:171], a[108:111], 0
  ds_read_b64_tr_b16 v[58:59], v230 offset:128
  ds_read_b64_tr_b16 v[42:43], v230 offset:64
  v_mfma_f32_16x16x32_bf16 v[88:91], a[172:175], a[112:115], v[88:91]
  v_cvt_pk_bf16_f32 v54, v92, v93
  v_cvt_pk_bf16_f32 v55, v94, v95
  v_mfma_f32_16x16x32_bf16 v[92:95], a[168:171], a[84:87], 0
  v_cvt_pk_bf16_f32 v38, v96, v97
  v_cvt_pk_bf16_f32 v39, v98, v99
  v_mfma_f32_16x16x32_bf16 v[96:99], a[156:159], a[132:135], 0
  ds_read_b64_tr_b16 v[66:67], v230 offset:136
  ds_read_b32 v200, v239 offset:96
  v_mfma_f32_16x16x32_bf16 v[92:95], a[172:175], a[88:91], v[92:95]
  ds_read_b128 a[180:183], v248 offset:768
  ds_read_b128 a[184:187], v248 offset:832
  v_mfma_f32_16x16x32_bf16 v[88:91], a[176:179], a[116:119], v[88:91]
  ds_read_b128 a[188:191], v248 offset:896
  v_mfma_f32_16x16x32_bf16 v[96:99], a[160:163], a[136:139], v[96:99]
  v_mfma_f32_16x16x32_bf16 v[92:95], a[176:179], a[92:95], v[92:95]
  v_mfma_f32_16x16x32_bf16 v[96:99], a[164:167], a[140:143], v[96:99]
  v_mfma_f32_16x16x32_bf16 v[152:155], v[104:107], a[244:247], v[152:155]
  v_mfma_f32_16x16x32_bf16 v[156:159], v[116:119], a[244:247], v[156:159]
  s_nop 1
  v_cvt_pk_bf16_f32 v48, v88, v89
  v_mfma_f32_16x16x32_bf16 v[160:163], v[124:127], a[240:243], 0
  v_cvt_pk_bf16_f32 v49, v90, v91
  v_cvt_pk_bf16_f32 v32, v92, v93
  v_mfma_f32_16x16x32_bf16 v[88:91], v[16:19], v[4:7], 0
  v_cvt_pk_bf16_f32 v33, v94, v95
  v_cvt_pk_bf16_f32 v62, v96, v97
  v_mfma_f32_16x16x32_bf16 v[92:95], a[168:171], a[120:123], 0
  v_cvt_pk_bf16_f32 v63, v98, v99
  s_waitcnt lgkmcnt(2)
  v_mul_f32 v200, s59, v200
  v_mfma_f32_16x16x32_bf16 v[88:91], v[16:19], v[8:11], v[88:91]
  v_mfma_f32_16x16x32_bf16 v[96:99], a[168:171], a[96:99], 0
  v_mfma_f32_16x16x32_bf16 v[92:95], a[172:175], a[124:127], v[92:95]
  v_mfma_f32_16x16x32_bf16 v[96:99], a[172:175], a[100:103], v[96:99]
  v_mfma_f32_16x16x32_bf16 v[92:95], a[176:179], a[128:131], v[92:95]
  v_mfma_f32_16x16x32_bf16 v[96:99], a[176:179], a[104:107], v[96:99]
  v_mfma_f32_16x16x32_bf16 v[164:167], a[216:219], a[240:243], v[244:247]
  ds_read_b128 a[240:243], v229
  s_nop 0
  v_rcp_f32 v204, v88
  v_mfma_f32_16x16x32_bf16 v[152:155], v[108:111], a[248:251], v[152:155]
  v_mul_f32 v136, v136, v204
  v_mul_f32 v137, v137, v204
  v_mfma_f32_16x16x32_bf16 v[156:159], v[120:123], a[248:251], v[156:159]
  v_mul_f32 v138, v138, v204
  v_mul_f32 v139, v139, v204
  v_mfma_f32_16x16x32_bf16 v[160:163], v[128:131], a[244:247], v[160:163]
  v_mul_f32 v140, v140, v204
  v_mul_f32 v141, v141, v204
  v_mfma_f32_16x16x32_bf16 v[164:167], a[220:223], a[244:247], v[164:167]
  v_mul_f32 v142, v142, v204
  v_mul_f32 v143, v143, v204
  v_mfma_f32_16x16x32_bf16 v[160:163], v[132:135], a[248:251], v[160:163]
  v_cvt_pk_bf16_f32 v168, v136, v137
  v_cvt_pk_bf16_f32 v169, v138, v139
  v_mfma_f32_16x16x32_bf16 v[164:167], a[224:227], a[248:251], v[164:167]
  v_cvt_pk_bf16_f32 v170, v140, v141
  v_cvt_pk_bf16_f32 v171, v142, v143
  v_mfma_f32_16x16x32_bf16 v[136:139], v[100:103], a[228:231], 0
  v_cvt_pk_bf16_f32 v56, v92, v93
  v_cvt_pk_bf16_f32 v57, v94, v95
  v_mfma_f32_16x16x32_bf16 v[92:95], v[20:23], v[168:171], 0
  v_mul_f32 v144, v144, v204
  v_mul_f32 v145, v145, v204
  v_mfma_f32_16x16x32_bf16 v[140:143], v[112:115], a[228:231], 0
  v_mul_f32 v146, v146, v204
  v_mul_f32 v147, v147, v204
  v_mfma_f32_16x16x32_bf16 v[136:139], v[104:107], a[232:235], v[136:139]
  v_fma_f32 v148, v148, v204, v242
  v_cvt_pk_bf16_f32 v40, v96, v97
  v_mfma_f32_16x16x32_bf16 v[140:143], v[116:119], a[232:235], v[140:143]
  v_cvt_pk_bf16_f32 v41, v98, v99
  v_cvt_pk_bf16_f32 v172, v144, v145
  v_mfma_f32_16x16x32_bf16 v[96:99], a[168:171], a[132:135], 0
  v_cvt_pk_bf16_f32 v173, v146, v147
  v_cvt_pk_bf16_f32 v174, v148, v243
  v_mfma_f32_16x16x32_bf16 v[96:99], a[172:175], a[136:139], v[96:99]
  v_mul_f32 v152, v152, v184
  v_mul_f32 v153, v153, v185
  v_mfma_f32_16x16x32_bf16 v[92:95], v[24:27], v[172:175], v[92:95]
  v_mul_f32 v154, v154, v186
  v_mul_f32 v155, v155, v187
  v_mfma_f32_16x16x32_bf16 v[96:99], a[176:179], a[140:143], v[96:99]
  v_mul_f32 v156, v156, v188
  v_mul_f32 v157, v157, v189
  v_mfma_f32_16x16x32_bf16 v[144:147], v[124:127], a[228:231], 0
  v_mul_f32 v158, v158, v190
  v_mul_f32 v159, v159, v191
  v_mfma_f32_16x16x32_bf16 v[148:151], a[216:219], a[228:231], v[244:247]
  v_cvt_pk_bf16_f32 v216, v92, v93
  v_cvt_pk_bf16_f32 v217, v94, v95
  v_mfma_f32_16x16x32_bf16 v[92:95], v[44:47], v[168:171], 0
  v_cvt_pk_bf16_f32 v64, v96, v97
  v_cvt_pk_bf16_f32 v65, v98, v99
  v_mfma_f32_16x16x32_bf16 v[92:95], v[48:51], v[172:175], v[92:95]
  v_mul_f32 v152, v152, v208
  v_mul_f32 v153, v153, v208
  v_mfma_f32_16x16x32_bf16 v[96:99], v[28:31], v[168:171], 0
  v_mul_f32 v154, v154, v208
  v_mul_f32 v155, v155, v208
  v_mfma_f32_16x16x32_bf16 v[96:99], v[32:35], v[172:175], v[96:99]
  v_mul_f32 v156, v156, v208
  v_mul_f32 v157, v157, v208
  v_mfma_f32_16x16x32_bf16 v[136:139], v[108:111], a[236:239], v[136:139]
  v_mul_f32 v158, v158, v208
  v_mul_f32 v159, v159, v208
  v_mfma_f32_16x16x32_bf16 v[140:143], v[120:123], a[236:239], v[140:143]
  ds_read_b64_tr_b16 v[26:27], v231
  v_mul_f32 v160, v160, v192
  v_mfma_f32_16x16x32_bf16 v[144:147], v[128:131], a[232:235], v[144:147]
  v_mul_f32 v161, v161, v193
  v_mul_f32 v162, v162, v194
  v_mfma_f32_16x16x32_bf16 v[148:151], a[220:223], a[232:235], v[148:151]
  v_mul_f32 v163, v163, v195
  v_mul_f32 v164, v164, v196
  v_mfma_f32_16x16x32_bf16 v[144:147], v[132:135], a[236:239], v[144:147]
  v_exp_f32 v152, v152
  v_mfma_f32_16x16x32_bf16 v[148:151], a[224:227], a[236:239], v[148:151]
  v_exp_f32 v153, v153
  v_mfma_f32_16x16x32_bf16 v[84:87], a[0:3], a[180:183], 0
  v_exp_f32 v154, v154
  s_waitcnt lgkmcnt(1)
  v_mfma_f32_16x16x32_bf16 v[84:87], a[4:7], a[184:187], v[84:87]
  v_exp_f32 v155, v155
  v_mfma_f32_16x16x32_bf16 v[68:71], a[12:15], a[180:183], 0
  v_exp_f32 v156, v156
  v_mfma_f32_16x16x32_bf16 v[72:75], a[24:27], a[180:183], 0
  v_exp_f32 v157, v157
  v_mfma_f32_16x16x32_bf16 v[84:87], a[8:11], a[188:191], v[84:87]
  v_exp_f32 v158, v158
  v_mfma_f32_16x16x32_bf16 v[68:71], a[16:19], a[184:187], v[68:71]
  v_exp_f32 v159, v159
  v_mfma_f32_16x16x32_bf16 v[72:75], a[28:31], a[184:187], v[72:75]
  v_mul_f32 v160, v160, v208
  v_mul_f32 v161, v161, v208
  v_mfma_f32_16x16x32_bf16 v[68:71], a[20:23], a[188:191], v[68:71]
  v_mul_f32 v162, v162, v208
  v_mul_f32 v163, v163, v208
  v_mfma_f32_16x16x32_bf16 v[72:75], a[32:35], a[188:191], v[72:75]
  v_mul_f32 v164, v164, v208
  v_exp_f32 v160, v160
  v_mfma_f32_16x16x32_bf16 v[76:79], a[36:39], a[180:183], 0
  v_exp_f32 v161, v161
  v_mfma_f32_16x16x32_bf16 v[76:79], a[40:43], a[184:187], v[76:79]
  v_exp_f32 v162, v162
  v_mfma_f32_16x16x32_bf16 v[80:83], a[48:51], a[180:183], 0
  v_exp_f32 v163, v163
  v_mfma_f32_16x16x32_bf16 v[76:79], a[44:47], a[188:191], v[76:79]
  v_exp_f32 v164, v164
  v_mfma_f32_16x16x32_bf16 v[80:83], a[52:55], a[184:187], v[80:83]
  v_cvt_pk_bf16_f32 v4, v152, v153
  v_cvt_pk_bf16_f32 v5, v154, v155
  v_mfma_f32_16x16x32_bf16 v[80:83], a[56:59], a[188:191], v[80:83]
  v_cvt_pk_bf16_f32 v6, v156, v157
  v_cvt_pk_bf16_f32 v7, v158, v159
  v_cvt_pk_bf16_f32 v222, v92, v93
  v_cvt_pk_bf16_f32 v223, v94, v95
  v_mfma_f32_16x16x32_bf16 v[92:95], v[16:19], v[4:7], 0
  v_cvt_pk_bf16_f32 v8, v160, v161
  v_cvt_pk_bf16_f32 v9, v162, v163
  v_cvt_pk_bf16_f32 v10, v164, v15
  v_cvt_pk_bf16_f32 v218, v96, v97
  v_cvt_pk_bf16_f32 v219, v98, v99
  v_mfma_f32_16x16x32_bf16 v[92:95], v[16:19], v[8:11], v[92:95]
  ds_read_b64_tr_b16 v[50:51], v231 offset:72
  v_max3_f32 v12, v12, v88, v204
  v_mfma_f32_16x16x32_bf16 v[96:99], v[52:55], v[168:171], 0
  ds_read_b64_tr_b16 v[34:35], v231 offset:8
  v_mul_f32 v152, v152, v184
  v_mfma_f32_16x16x32_bf16 v[96:99], v[56:59], v[172:175], v[96:99]
  v_mul_f32 v153, v153, v185
  v_mul_f32 v154, v154, v186
  v_mfma_f32_16x16x32_bf16 v[88:91], v[36:39], v[168:171], 0
  v_rcp_f32 v212, v92
  v_mfma_f32_16x16x32_bf16 v[88:91], v[40:43], v[172:175], v[88:91]
  v_mul_f32 v155, v155, v187
  v_mul_f32 v156, v156, v188
  v_mul_f32 v157, v157, v189
  v_mul_f32 v158, v158, v190
  v_mul_f32 v159, v159, v191
  v_mul_f32 v152, v152, v212
  v_mul_f32 v153, v153, v212
  v_mul_f32 v154, v154, v212
  v_mul_f32 v155, v155, v212
  v_mul_f32 v156, v156, v212
  v_mul_f32 v157, v157, v212
  v_mul_f32 v158, v158, v212
  v_mul_f32 v159, v159, v212
  v_mul_f32 v160, v160, v192
  v_mul_f32 v161, v161, v193
  v_mul_f32 v162, v162, v194
  v_mul_f32 v163, v163, v195
  v_mul_f32 v164, v164, v196
  v_cvt_pk_bf16_f32 v176, v152, v153
  v_cvt_pk_bf16_f32 v177, v154, v155
  v_mfma_f32_16x16x32_bf16 v[152:155], v[100:103], a[240:243], 0
  v_cvt_pk_bf16_f32 v178, v156, v157
  v_cvt_pk_bf16_f32 v179, v158, v159
  v_mfma_f32_16x16x32_bf16 v[156:159], v[112:115], a[240:243], 0
  v_cvt_pk_bf16_f32 v224, v96, v97
  v_cvt_pk_bf16_f32 v225, v98, v99
  v_mfma_f32_16x16x32_bf16 v[96:99], v[20:23], v[176:179], 0
  v_mul_f32 v160, v160, v212
  v_mul_f32 v161, v161, v212
  v_mul_f32 v162, v162, v212
  v_mul_f32 v163, v163, v212
  v_fma_f32 v164, v164, v212, v242
  v_cvt_pk_bf16_f32 v180, v160, v161
  v_cvt_pk_bf16_f32 v181, v162, v163
  v_mfma_f32_16x16x32_bf16 v[160:163], v[124:127], a[240:243], 0
  v_cvt_pk_bf16_f32 v182, v164, v243
  v_cvt_pk_bf16_f32 v220, v88, v89
  v_mfma_f32_16x16x32_bf16 v[164:167], a[216:219], a[240:243], v[244:247]
  v_cvt_pk_bf16_f32 v221, v90, v91
  ds_read_b64_tr_b16 v[58:59], v231 offset:128
  s_waitcnt lgkmcnt(1)
  v_mfma_f32_16x16x32_bf16 v[96:99], v[24:27], v[180:183], v[96:99]
  buffer_store_dwordx4 v[216:219], v234, s[8:11], s61 offen sc1
  ds_read_b64_tr_b16 v[42:43], v231 offset:64
  v_mfma_f32_16x16x32_bf16 v[88:91], v[60:63], v[168:171], 0
  v_mul_f32 v136, v136, v184
  v_mul_f32 v137, v137, v185
  v_mfma_f32_16x16x32_bf16 v[88:91], v[64:67], v[172:175], v[88:91]
  v_mul_f32 v138, v138, v186
  v_mul_f32 v139, v139, v187
  v_cvt_pk_bf16_f32 v216, v96, v97
  v_cvt_pk_bf16_f32 v217, v98, v99
  v_mfma_f32_16x16x32_bf16 v[96:99], v[44:47], v[176:179], 0
  v_mul_f32 v140, v140, v188
  v_mul_f32 v141, v141, v189
  v_mfma_f32_16x16x32_bf16 v[96:99], v[48:51], v[180:183], v[96:99]
  v_mul_f32 v142, v142, v190
  v_mul_f32 v143, v143, v191
  v_cvt_pk_bf16_f32 v226, v88, v89
  v_cvt_pk_bf16_f32 v227, v90, v91
  v_mfma_f32_16x16x32_bf16 v[88:91], v[28:31], v[176:179], 0
  v_mul_f32 v136, v136, v200
  v_mul_f32 v137, v137, v200
  v_mfma_f32_16x16x32_bf16 v[88:91], v[32:35], v[180:183], v[88:91]
  v_mul_f32 v138, v138, v200
  v_mul_f32 v139, v139, v200
  v_mul_f32 v140, v140, v200
  v_mul_f32 v141, v141, v200
  v_mul_f32 v142, v142, v200
  v_mul_f32 v143, v143, v200
  ds_read_b64_tr_b16 v[26:27], v232
  v_mul_f32 v144, v144, v192
  v_mul_f32 v145, v145, v193
  v_mul_f32 v146, v146, v194
  v_mul_f32 v147, v147, v195
  v_mul_f32 v148, v148, v196
  v_exp_f32 v136, v136
  v_exp_f32 v137, v137
  v_exp_f32 v138, v138
  v_exp_f32 v139, v139
  v_exp_f32 v140, v140
  v_exp_f32 v141, v141
  v_exp_f32 v142, v142
  v_exp_f32 v143, v143
  v_mul_f32 v144, v144, v200
  v_mul_f32 v145, v145, v200
  v_mul_f32 v146, v146, v200
  v_mul_f32 v147, v147, v200
  v_mul_f32 v148, v148, v200
  ds_read_b128 a[244:247], v229 offset:64
  buffer_store_dwordx4 v[220:223], v234, s[8:11], s61 offen offset:64 sc1
  v_exp_f32 v144, v144
  v_exp_f32 v145, v145
  v_exp_f32 v146, v146
  v_exp_f32 v147, v147
  v_exp_f32 v148, v148
  v_cvt_pk_bf16_f32 v4, v136, v137
  v_cvt_pk_bf16_f32 v5, v138, v139
  v_cvt_pk_bf16_f32 v6, v140, v141
  v_cvt_pk_bf16_f32 v7, v142, v143
  v_cvt_pk_bf16_f32 v222, v96, v97
  v_cvt_pk_bf16_f32 v223, v98, v99
  v_mfma_f32_16x16x32_bf16 v[96:99], v[16:19], v[4:7], 0
  ds_read_b128 a[248:251], v229 offset:128
  ds_read_b64_tr_b16 v[66:67], v231 offset:136
  v_cvt_pk_bf16_f32 v8, v144, v145
  v_cvt_pk_bf16_f32 v9, v146, v147
  v_cvt_pk_bf16_f32 v10, v148, v15
  v_cvt_pk_bf16_f32 v218, v88, v89
  v_cvt_pk_bf16_f32 v219, v90, v91
  v_mfma_f32_16x16x32_bf16 v[96:99], v[16:19], v[8:11], v[96:99]
  ds_read_b64_tr_b16 v[50:51], v232 offset:72
  ds_read_b32 v208, v13
  v_mfma_f32_16x16x32_bf16 v[88:91], v[52:55], v[176:179], 0
  v_max3_f32 v12, v12, v92, v212
  ds_read_b64_tr_b16 v[34:35], v232 offset:8
  s_waitcnt lgkmcnt(5)
  v_mfma_f32_16x16x32_bf16 v[88:91], v[56:59], v[180:183], v[88:91]
  v_mul_f32 v136, v136, v184
  v_mul_f32 v137, v137, v185
  v_mfma_f32_16x16x32_bf16 v[92:95], v[36:39], v[176:179], 0
  v_rcp_f32 v204, v96
  v_mfma_f32_16x16x32_bf16 v[92:95], v[40:43], v[180:183], v[92:95]
  v_mul_f32 v138, v138, v186
  v_mul_f32 v139, v139, v187
  v_mfma_f32_16x16x32_bf16 v[152:155], v[104:107], a[244:247], v[152:155]
  v_mul_f32 v140, v140, v188
  v_mul_f32 v141, v141, v189
  v_mfma_f32_16x16x32_bf16 v[156:159], v[116:119], a[244:247], v[156:159]
  v_mul_f32 v142, v142, v190
  v_mul_f32 v143, v143, v191
  s_waitcnt lgkmcnt(1)
  v_mfma_f32_16x16x32_bf16 v[152:155], v[108:111], a[248:251], v[152:155]
  v_mul_f32 v136, v136, v204
  v_mul_f32 v137, v137, v204
  v_mfma_f32_16x16x32_bf16 v[156:159], v[120:123], a[248:251], v[156:159]
  v_mul_f32 v138, v138, v204
  v_mul_f32 v139, v139, v204
  v_mfma_f32_16x16x32_bf16 v[160:163], v[128:131], a[244:247], v[160:163]
  v_mul_f32 v140, v140, v204
  v_mul_f32 v141, v141, v204
  v_mfma_f32_16x16x32_bf16 v[164:167], a[220:223], a[244:247], v[164:167]
  v_mul_f32 v142, v142, v204
  v_mul_f32 v143, v143, v204
  v_mfma_f32_16x16x32_bf16 v[160:163], v[132:135], a[248:251], v[160:163]
  buffer_store_dwordx4 v[224:227], v234, s[8:11], s61 offen offset:128 sc1
  v_mul_f32 v144, v144, v192
  v_mfma_f32_16x16x32_bf16 v[164:167], a[224:227], a[248:251], v[164:167]
  v_mul_f32 v145, v145, v193
  v_mul_f32 v146, v146, v194
  v_mul_f32 v147, v147, v195
  v_mul_f32 v148, v148, v196
  v_cvt_pk_bf16_f32 v168, v136, v137
  v_cvt_pk_bf16_f32 v169, v138, v139
  v_cvt_pk_bf16_f32 v170, v140, v141
  v_cvt_pk_bf16_f32 v171, v142, v143
  v_cvt_pk_bf16_f32 v224, v88, v89
  v_cvt_pk_bf16_f32 v225, v90, v91
  v_mfma_f32_16x16x32_bf16 v[88:91], v[20:23], v[168:171], 0
  v_mul_f32 v144, v144, v204
  v_mul_f32 v145, v145, v204
  v_mul_f32 v146, v146, v204
  v_mul_f32 v147, v147, v204
  v_fma_f32 v148, v148, v204, v242
  v_cvt_pk_bf16_f32 v172, v144, v145
  v_cvt_pk_bf16_f32 v173, v146, v147
  v_cvt_pk_bf16_f32 v174, v148, v243
  v_cvt_pk_bf16_f32 v220, v92, v93
  v_cvt_pk_bf16_f32 v221, v94, v95
  v_mfma_f32_16x16x32_bf16 v[88:91], v[24:27], v[172:175], v[88:91]
  ds_read_b64_tr_b16 v[58:59], v232 offset:128
  buffer_store_dwordx4 v[216:219], v235, s[8:11], s61 offen sc1
  v_mfma_f32_16x16x32_bf16 v[92:95], v[60:63], v[176:179], 0
  ds_read_b64_tr_b16 v[42:43], v232 offset:64
  v_cvt_pk_bf16_f32 v100, v84, v85
  v_mfma_f32_16x16x32_bf16 v[92:95], v[64:67], v[180:183], v[92:95]
  v_cvt_pk_bf16_f32 v101, v86, v87
  v_mul_f32 v208, s59, v208
  v_mfma_f32_16x16x32_bf16 v[84:87], a[60:63], a[180:183], 0
  v_cvt_pk_bf16_f32 v216, v88, v89
  v_cvt_pk_bf16_f32 v217, v90, v91
  v_mfma_f32_16x16x32_bf16 v[88:91], v[44:47], v[168:171], 0
  v_mul_f32 v152, v152, v184
  v_mul_f32 v153, v153, v185
  v_mfma_f32_16x16x32_bf16 v[88:91], v[48:51], v[172:175], v[88:91]
  v_mul_f32 v154, v154, v186
  v_mul_f32 v155, v155, v187
  v_mfma_f32_16x16x32_bf16 v[84:87], a[64:67], a[184:187], v[84:87]
  v_mul_f32 v156, v156, v188
  v_mul_f32 v157, v157, v189
  v_mfma_f32_16x16x32_bf16 v[84:87], a[68:71], a[188:191], v[84:87]
  v_mul_f32 v158, v158, v190
  v_mul_f32 v159, v159, v191
  v_cvt_pk_bf16_f32 v102, v68, v69
  v_cvt_pk_bf16_f32 v103, v70, v71
  v_mfma_f32_16x16x32_bf16 v[68:71], a[0:3], a[192:195], 0
  v_cvt_pk_bf16_f32 v104, v72, v73
  v_cvt_pk_bf16_f32 v105, v74, v75
  v_mfma_f32_16x16x32_bf16 v[72:75], a[12:15], a[192:195], 0
  v_cvt_pk_bf16_f32 v226, v92, v93
  v_cvt_pk_bf16_f32 v227, v94, v95
  v_mfma_f32_16x16x32_bf16 v[92:95], v[28:31], v[168:171], 0
  v_mul_f32 v152, v152, v208
  v_mul_f32 v153, v153, v208
  v_mfma_f32_16x16x32_bf16 v[68:71], a[4:7], a[196:199], v[68:71]
  v_mul_f32 v154, v154, v208
  v_mul_f32 v155, v155, v208
  v_mfma_f32_16x16x32_bf16 v[72:75], a[16:19], a[196:199], v[72:75]
  v_mul_f32 v156, v156, v208
  v_mul_f32 v157, v157, v208
  s_waitcnt lgkmcnt(0)
  v_mfma_f32_16x16x32_bf16 v[92:95], v[32:35], v[172:175], v[92:95]
  v_mul_f32 v158, v158, v208
  v_mul_f32 v159, v159, v208
  v_mfma_f32_16x16x32_bf16 v[68:71], a[8:11], a[200:203], v[68:71]
  ds_read_b64_tr_b16 v[26:27], v233
  v_mul_f32 v160, v160, v192
  v_mfma_f32_16x16x32_bf16 v[72:75], a[20:23], a[200:203], v[72:75]
  v_mul_f32 v161, v161, v193
  v_mul_f32 v162, v162, v194
  v_mul_f32 v163, v163, v195
  v_mul_f32 v164, v164, v196
  v_exp_f32 v152, v152
  v_exp_f32 v153, v153
  v_exp_f32 v154, v154
  v_exp_f32 v155, v155
  v_exp_f32 v156, v156
  v_exp_f32 v157, v157
  v_exp_f32 v158, v158
  v_exp_f32 v159, v159
  v_mul_f32 v160, v160, v208
  v_mul_f32 v161, v161, v208
  v_mul_f32 v162, v162, v208
  v_mul_f32 v163, v163, v208
  v_mul_f32 v164, v164, v208
  buffer_store_dwordx4 v[220:223], v235, s[8:11], s61 offen offset:64 sc1
  v_exp_f32 v160, v160
  v_exp_f32 v161, v161
  v_exp_f32 v162, v162
  v_exp_f32 v163, v163
  v_exp_f32 v164, v164
  v_cvt_pk_bf16_f32 v4, v152, v153
  v_cvt_pk_bf16_f32 v5, v154, v155
  v_cvt_pk_bf16_f32 v6, v156, v157
  v_cvt_pk_bf16_f32 v7, v158, v159
  v_cvt_pk_bf16_f32 v222, v88, v89
  v_cvt_pk_bf16_f32 v223, v90, v91
  v_mfma_f32_16x16x32_bf16 v[88:91], v[16:19], v[4:7], 0
  ds_read_b64_tr_b16 v[66:67], v232 offset:136
  v_cvt_pk_bf16_f32 v106, v76, v77
  v_cvt_pk_bf16_f32 v107, v78, v79
  v_mfma_f32_16x16x32_bf16 v[76:79], a[24:27], a[192:195], 0
  v_cvt_pk_bf16_f32 v8, v160, v161
  v_cvt_pk_bf16_f32 v9, v162, v163
  v_mfma_f32_16x16x32_bf16 v[76:79], a[28:31], a[196:199], v[76:79]
  v_cvt_pk_bf16_f32 v10, v164, v15
  v_cvt_pk_bf16_f32 v108, v80, v81
  v_mfma_f32_16x16x32_bf16 v[76:79], a[32:35], a[200:203], v[76:79]
  v_cvt_pk_bf16_f32 v109, v82, v83
  v_cvt_pk_bf16_f32 v110, v84, v85
  v_mfma_f32_16x16x32_bf16 v[88:91], v[16:19], v[8:11], v[88:91]
  v_cvt_pk_bf16_f32 v111, v86, v87
  v_cvt_pk_bf16_f32 v218, v92, v93
  v_mfma_f32_16x16x32_bf16 v[80:83], a[36:39], a[192:195], 0
  v_cvt_pk_bf16_f32 v219, v94, v95
  ds_read_b64_tr_b16 v[50:51], v233 offset:72
  v_mfma_f32_16x16x32_bf16 v[84:87], a[48:51], a[192:195], 0
  ds_read_b128 a[216:219], v250 offset:192
  v_cvt_pk_bf16_f32 v112, v68, v69
  v_mfma_f32_16x16x32_bf16 v[92:95], v[52:55], v[168:171], 0
  v_cvt_pk_bf16_f32 v113, v70, v71
  v_cvt_pk_bf16_f32 v114, v72, v73
  v_mfma_f32_16x16x32_bf16 v[80:83], a[40:43], a[196:199], v[80:83]
  v_cvt_pk_bf16_f32 v115, v74, v75
  ds_read_b128 a[228:231], v248 offset:768
  v_mfma_f32_16x16x32_bf16 v[84:87], a[52:55], a[196:199], v[84:87]
  v_max3_f32 v12, v12, v96, v204
  ds_read_b128 a[220:223], v250 offset:256
  v_mfma_f32_16x16x32_bf16 v[68:71], a[60:63], a[192:195], 0
  ds_read_b128 a[232:235], v248 offset:832
  v_rcp_f32 v212, v88
  v_mfma_f32_16x16x32_bf16 v[72:75], a[0:3], a[204:207], 0
  ds_read_b64_tr_b16 v[34:35], v233 offset:8
  v_mul_f32 v152, v152, v184
  v_mfma_f32_16x16x32_bf16 v[92:95], v[56:59], v[172:175], v[92:95]
  v_mul_f32 v153, v153, v185
  v_mul_f32 v154, v154, v186
  v_mfma_f32_16x16x32_bf16 v[96:99], v[36:39], v[168:171], 0
  v_mul_f32 v155, v155, v187
  v_mul_f32 v156, v156, v188
  v_mfma_f32_16x16x32_bf16 v[80:83], a[44:47], a[200:203], v[80:83]
  v_mul_f32 v157, v157, v189
  v_mul_f32 v158, v158, v190
  v_mfma_f32_16x16x32_bf16 v[84:87], a[56:59], a[200:203], v[84:87]
  v_mul_f32 v159, v159, v191
  ds_read_b128 a[224:227], v250 offset:320
  v_mfma_f32_16x16x32_bf16 v[68:71], a[64:67], a[196:199], v[68:71]
  ds_read_b128 a[236:239], v248 offset:896
  v_mul_f32 v152, v152, v212
  v_mfma_f32_16x16x32_bf16 v[72:75], a[4:7], a[208:211], v[72:75]
  v_mul_f32 v153, v153, v212
  v_mul_f32 v154, v154, v212
  v_mfma_f32_16x16x32_bf16 v[96:99], v[40:43], v[172:175], v[96:99]
  v_mul_f32 v155, v155, v212
  v_mul_f32 v156, v156, v212
  v_mfma_f32_16x16x32_bf16 v[68:71], a[68:71], a[200:203], v[68:71]
  v_mul_f32 v157, v157, v212
  v_mul_f32 v158, v158, v212
  v_mfma_f32_16x16x32_bf16 v[72:75], a[8:11], a[212:215], v[72:75]
  v_mul_f32 v159, v159, v212
  buffer_store_dwordx4 v[224:227], v235, s[8:11], s61 offen offset:128 sc1
  s_waitcnt lgkmcnt(2)
  v_mfma_f32_16x16x32_bf16 v[136:139], v[100:103], a[228:231], 0
  v_mul_f32 v160, v160, v192
  v_mul_f32 v161, v161, v193
  v_mfma_f32_16x16x32_bf16 v[140:143], v[112:115], a[228:231], 0
  v_mul_f32 v162, v162, v194
  v_mul_f32 v163, v163, v195
  v_mfma_f32_16x16x32_bf16 v[148:151], a[216:219], a[228:231], v[244:247]
  v_mul_f32 v164, v164, v196
  v_cvt_pk_bf16_f32 v176, v152, v153
  v_mfma_f32_16x16x32_bf16 v[136:139], v[104:107], a[232:235], v[136:139]
  v_cvt_pk_bf16_f32 v177, v154, v155
  v_cvt_pk_bf16_f32 v178, v156, v157
  v_mfma_f32_16x16x32_bf16 v[148:151], a[220:223], a[232:235], v[148:151]
  v_cvt_pk_bf16_f32 v179, v158, v159
  v_cvt_pk_bf16_f32 v116, v76, v77
  s_waitcnt lgkmcnt(0)
  v_mfma_f32_16x16x32_bf16 v[136:139], v[108:111], a[236:239], v[136:139]
  v_cvt_pk_bf16_f32 v117, v78, v79
  v_cvt_pk_bf16_f32 v224, v92, v93
  v_mfma_f32_16x16x32_bf16 v[76:79], a[12:15], a[204:207], 0
  v_cvt_pk_bf16_f32 v225, v94, v95
  v_mul_f32 v160, v160, v212
  v_mfma_f32_16x16x32_bf16 v[92:95], v[20:23], v[176:179], 0
  v_mul_f32 v161, v161, v212
  v_mul_f32 v162, v162, v212
  v_mfma_f32_16x16x32_bf16 v[76:79], a[16:19], a[208:211], v[76:79]
  v_mul_f32 v163, v163, v212
  v_fma_f32 v164, v164, v212, v242
  v_mfma_f32_16x16x32_bf16 v[76:79], a[20:23], a[212:215], v[76:79]
  v_cvt_pk_bf16_f32 v180, v160, v161
  v_cvt_pk_bf16_f32 v181, v162, v163
  v_mfma_f32_16x16x32_bf16 v[148:151], a[224:227], a[236:239], v[148:151]
  v_cvt_pk_bf16_f32 v182, v164, v243
  v_cvt_pk_bf16_f32 v118, v80, v81
  v_cvt_pk_bf16_f32 v119, v82, v83
  v_mfma_f32_16x16x32_bf16 v[80:83], a[24:27], a[204:207], 0
  v_cvt_pk_bf16_f32 v120, v84, v85
  v_cvt_pk_bf16_f32 v121, v86, v87
  v_mfma_f32_16x16x32_bf16 v[84:87], a[36:39], a[204:207], 0
  v_cvt_pk_bf16_f32 v220, v96, v97
  v_cvt_pk_bf16_f32 v221, v98, v99
  v_mfma_f32_16x16x32_bf16 v[92:95], v[24:27], v[180:183], v[92:95]
  v_cvt_pk_bf16_f32 v122, v68, v69
  v_cvt_pk_bf16_f32 v123, v70, v71
  v_mfma_f32_16x16x32_bf16 v[96:99], v[60:63], v[168:171], 0
  v_cvt_pk_bf16_f32 v124, v72, v73
  v_cvt_pk_bf16_f32 v125, v74, v75
  v_mfma_f32_16x16x32_bf16 v[80:83], a[28:31], a[208:211], v[80:83]
  ds_read_b64_tr_b16 v[58:59], v233 offset:128
  buffer_store_dwordx4 v[216:219], v236, s[8:11], s61 offen sc1
  v_mfma_f32_16x16x32_bf16 v[84:87], a[40:43], a[208:211], v[84:87]
  ds_read_b64_tr_b16 v[42:43], v233 offset:64
  v_cvt_pk_bf16_f32 v216, v92, v93
  v_mfma_f32_16x16x32_bf16 v[68:71], a[48:51], a[204:207], 0
  v_cvt_pk_bf16_f32 v217, v94, v95
  v_cvt_pk_bf16_f32 v126, v76, v77
  v_mfma_f32_16x16x32_bf16 v[72:75], a[60:63], a[204:207], 0
  v_cvt_pk_bf16_f32 v127, v78, v79
  buffer_store_dwordx4 v[220:223], v236, s[8:11], s61 offen offset:64 sc1
  v_mfma_f32_16x16x32_bf16 v[96:99], v[64:67], v[172:175], v[96:99]
  ds_read_b64_tr_b16 v[66:67], v233 offset:136
  v_max3_f32 v12, v12, v88, v212
  v_mfma_f32_16x16x32_bf16 v[80:83], a[32:35], a[212:215], v[80:83]
  ds_read_b128 v[184:187], v238 offset:768
  ds_read_b128 v[188:191], v238 offset:832
  v_mfma_f32_16x16x32_bf16 v[84:87], a[44:47], a[212:215], v[84:87]
  ds_read_b32 v200, v239 offset:768
  ds_read_b128 v[192:195], v238 offset:896
  v_mfma_f32_16x16x32_bf16 v[68:71], a[52:55], a[208:211], v[68:71]
  v_cvt_pk_bf16_f32 v226, v96, v97
  v_cvt_pk_bf16_f32 v227, v98, v99
  v_mfma_f32_16x16x32_bf16 v[72:75], a[64:67], a[208:211], v[72:75]
  v_cvt_pk_bf16_f32 v128, v80, v81
  v_cvt_pk_bf16_f32 v129, v82, v83
  v_mfma_f32_16x16x32_bf16 v[92:95], v[44:47], v[176:179], 0
  v_cvt_pk_bf16_f32 v130, v84, v85
  v_cvt_pk_bf16_f32 v131, v86, v87
  v_mfma_f32_16x16x32_bf16 v[68:71], a[56:59], a[212:215], v[68:71]
  buffer_store_dwordx4 v[224:227], v236, s[8:11], s61 offen offset:128 sc1
  ds_read_b32 v196, v240 offset:1344
  v_mfma_f32_16x16x32_bf16 v[72:75], a[68:71], a[212:215], v[72:75]
  ds_read_b128 a[240:243], v248 offset:9984
  ds_read_b128 a[244:247], v248 offset:10048
  v_mfma_f32_16x16x32_bf16 v[92:95], v[48:51], v[180:183], v[92:95]
  ds_read_b128 a[248:251], v248 offset:10112
  ds_read_b32 v208, v239 offset:816
  v_mfma_f32_16x16x32_bf16 v[144:147], v[124:127], a[228:231], 0
  v_cvt_pk_bf16_f32 v132, v68, v69
  v_cvt_pk_bf16_f32 v133, v70, v71
  v_mfma_f32_16x16x32_bf16 v[96:99], v[28:31], v[176:179], 0
  v_cvt_pk_bf16_f32 v134, v72, v73
  v_cvt_pk_bf16_f32 v135, v74, v75
  v_mfma_f32_16x16x32_bf16 v[140:143], v[116:119], a[232:235], v[140:143]
  v_cvt_pk_bf16_f32 v222, v92, v93
  v_cvt_pk_bf16_f32 v223, v94, v95
  v_mfma_f32_16x16x32_bf16 v[144:147], v[128:131], a[232:235], v[144:147]
  s_waitcnt lgkmcnt(5)
  v_mul_f32 v200, s59, v200
  v_mul_f32 v136, v136, v184
  v_mfma_f32_16x16x32_bf16 v[96:99], v[32:35], v[180:183], v[96:99]
  v_mul_f32 v137, v137, v185
  v_mul_f32 v138, v138, v186
  v_mfma_f32_16x16x32_bf16 v[140:143], v[120:123], a[236:239], v[140:143]
  v_mul_f32 v139, v139, v187
  v_mul_f32 v136, v136, v200
  v_mfma_f32_16x16x32_bf16 v[144:147], v[132:135], a[236:239], v[144:147]
  v_mul_f32 v137, v137, v200
  v_mul_f32 v138, v138, v200
  v_mfma_f32_16x16x32_bf16 v[92:95], a[180:183], a[72:75], 0
  v_cvt_pk_bf16_f32 v218, v96, v97
  v_cvt_pk_bf16_f32 v219, v98, v99
  v_mfma_f32_16x16x32_bf16 v[92:95], a[184:187], a[76:79], v[92:95]
  buffer_store_dwordx4 v[216:219], v237, s[8:11], s61 offen sc1
  v_mul_f32 v140, v140, v188
  v_mfma_f32_16x16x32_bf16 v[96:99], v[52:55], v[176:179], 0
  v_mul_f32 v141, v141, v189
  v_mul_f32 v142, v142, v190
  v_mfma_f32_16x16x32_bf16 v[92:95], a[188:191], a[80:83], v[92:95]
  v_mul_f32 v143, v143, v191
  v_mul_f32 v139, v139, v200
  v_mfma_f32_16x16x32_bf16 v[96:99], v[56:59], v[180:183], v[96:99]
  v_mul_f32 v140, v140, v200
  v_mul_f32 v141, v141, v200
  v_mfma_f32_16x16x32_bf16 v[88:91], v[36:39], v[176:179], 0
  v_mul_f32 v142, v142, v200
  v_mul_f32 v143, v143, v200
  v_mfma_f32_16x16x32_bf16 v[88:91], v[40:43], v[180:183], v[88:91]
  v_cvt_pk_bf16_f32 v20, v92, v93
  v_cvt_pk_bf16_f32 v21, v94, v95
  v_mfma_f32_16x16x32_bf16 v[92:95], a[180:183], a[108:111], 0
  v_cvt_pk_bf16_f32 v224, v96, v97
  v_cvt_pk_bf16_f32 v225, v98, v99
  v_mfma_f32_16x16x32_bf16 v[96:99], a[180:183], a[84:87], 0
  v_mul_f32 v144, v144, v192
  v_mul_f32 v145, v145, v193
  v_mfma_f32_16x16x32_bf16 v[92:95], a[184:187], a[112:115], v[92:95]
  v_cvt_pk_bf16_f32 v220, v88, v89
  v_cvt_pk_bf16_f32 v221, v90, v91
  v_mfma_f32_16x16x32_bf16 v[96:99], a[184:187], a[88:91], v[96:99]
  buffer_store_dwordx4 v[220:223], v237, s[8:11], s61 offen offset:64 sc1
  v_mul_f32 v146, v146, v194
  v_mfma_f32_16x16x32_bf16 v[92:95], a[188:191], a[116:119], v[92:95]
  v_mul_f32 v147, v147, v195
  s_waitcnt lgkmcnt(0)
  v_mul_f32 v148, v148, v196
  v_mfma_f32_16x16x32_bf16 v[88:91], v[60:63], v[176:179], 0
  v_exp_f32 v136, v136
  v_mfma_f32_16x16x32_bf16 v[96:99], a[188:191], a[92:95], v[96:99]
  v_exp_f32 v137, v137
  v_mfma_f32_16x16x32_bf16 v[88:91], v[64:67], v[180:183], v[88:91]
  v_exp_f32 v138, v138
  v_mfma_f32_16x16x32_bf16 v[152:155], v[100:103], a[240:243], 0
  v_cvt_pk_bf16_f32 v44, v92, v93
  v_cvt_pk_bf16_f32 v45, v94, v95
  v_mfma_f32_16x16x32_bf16 v[92:95], a[192:195], a[72:75], 0
  v_exp_f32 v139, v139
  v_mfma_f32_16x16x32_bf16 v[92:95], a[196:199], a[76:79], v[92:95]
  v_cvt_pk_bf16_f32 v28, v96, v97
  v_cvt_pk_bf16_f32 v29, v98, v99
  v_mfma_f32_16x16x32_bf16 v[96:99], a[180:183], a[120:123], 0
  v_cvt_pk_bf16_f32 v226, v88, v89
  v_cvt_pk_bf16_f32 v227, v90, v91
  v_mfma_f32_16x16x32_bf16 v[88:91], a[180:183], a[96:99], 0
  buffer_store_dwordx4 v[224:227], v237, s[8:11], s61 offen offset:128 sc1
  s_mov_b32 s26, L_END-L_PCX0-4
  v_mfma_f32_16x16x32_bf16 v[96:99], a[184:187], a[124:127], v[96:99]
  s_getpc_b64 s[24:25]
L_PCX0:
  v_min_u32 v253, s26, v253
  v_mfma_f32_16x16x32_bf16 v[92:95], a[200:203], a[80:83], v[92:95]
  v_add_co_u32 v254, vcc, s24, v253
  v_mov_b32 v255, s25
  v_mfma_f32_16x16x32_bf16 v[88:91], a[184:187], a[100:103], v[88:91]
  s_mov_b32 m0, 0x27100
  v_addc_co_u32 v255, vcc, 0, v255, vcc
  v_mfma_f32_16x16x32_bf16 v[96:99], a[188:191], a[128:131], v[96:99]
  global_load_lds_dword v[254:255], off
  v_mfma_f32_16x16x32_bf16 v[88:91], a[188:191], a[104:107], v[88:91]
  v_cvt_pk_bf16_f32 v22, v92, v93
  v_cvt_pk_bf16_f32 v23, v94, v95
  v_mfma_f32_16x16x32_bf16 v[92:95], a[192:195], a[108:111], 0
  v_lshlrev_b32 v253, 6, v1
  v_add_u32 v253, s27, v253
  v_mfma_f32_16x16x32_bf16 v[92:95], a[196:199], a[112:115], v[92:95]
  v_cvt_pk_bf16_f32 v52, v96, v97
  v_cvt_pk_bf16_f32 v53, v98, v99
  v_mfma_f32_16x16x32_bf16 v[96:99], a[192:195], a[84:87], 0
  v_cvt_pk_bf16_f32 v36, v88, v89
  v_cvt_pk_bf16_f32 v37, v90, v91
  v_mfma_f32_16x16x32_bf16 v[88:91], a[180:183], a[132:135], 0
  v_add_u32 v253, 0x4000, v253
  v_min_u32 v253, s26, v253
  v_mfma_f32_16x16x32_bf16 v[96:99], a[196:199], a[88:91], v[96:99]
  v_add_co_u32 v254, vcc, s24, v253
  v_xor_b32 v253, 16, v230
  v_mfma_f32_16x16x32_bf16 v[92:95], a[200:203], a[116:119], v[92:95]
  ds_read_b64_tr_b16 v[26:27], v253 offset:768
  v_exp_f32 v140, v140
  v_mfma_f32_16x16x32_bf16 v[88:91], a[184:187], a[136:139], v[88:91]
  v_exp_f32 v141, v141
  v_mfma_f32_16x16x32_bf16 v[96:99], a[200:203], a[92:95], v[96:99]
  v_exp_f32 v142, v142
  v_mfma_f32_16x16x32_bf16 v[88:91], a[188:191], a[140:143], v[88:91]
  v_exp_f32 v143, v143
  v_mfma_f32_16x16x32_bf16 v[156:159], v[112:115], a[240:243], 0
  v_cvt_pk_bf16_f32 v46, v92, v93
  v_cvt_pk_bf16_f32 v47, v94, v95
  v_mfma_f32_16x16x32_bf16 v[92:95], a[204:207], a[72:75], 0
  v_mul_f32 v144, v144, v200
  v_cvt_pk_bf16_f32 v30, v96, v97
  v_mfma_f32_16x16x32_bf16 v[92:95], a[208:211], a[76:79], v[92:95]
  v_cvt_pk_bf16_f32 v31, v98, v99
  v_cvt_pk_bf16_f32 v60, v88, v89
  v_mfma_f32_16x16x32_bf16 v[96:99], a[192:195], a[120:123], 0
  v_cvt_pk_bf16_f32 v61, v90, v91
  v_mul_f32 v145, v145, v200
  v_mfma_f32_16x16x32_bf16 v[88:91], a[192:195], a[96:99], 0
  v_mul_f32 v146, v146, v200
  v_mul_f32 v147, v147, v200
  v_mfma_f32_16x16x32_bf16 v[96:99], a[196:199], a[124:127], v[96:99]
  v_mul_f32 v148, v148, v200
  v_exp_f32 v144, v144
  v_mfma_f32_16x16x32_bf16 v[92:95], a[212:215], a[80:83], v[92:95]
  v_exp_f32 v145, v145
  v_mfma_f32_16x16x32_bf16 v[88:91], a[196:199], a[100:103], v[88:91]
  v_exp_f32 v146, v146
  v_mfma_f32_16x16x32_bf16 v[96:99], a[200:203], a[128:131], v[96:99]
  v_exp_f32 v147, v147
  v_mfma_f32_16x16x32_bf16 v[88:91], a[200:203], a[104:107], v[88:91]
  v_exp_f32 v148, v148
  v_mfma_f32_16x16x32_bf16 v[152:155], v[104:107], a[244:247], v[152:155]
  v_cvt_pk_bf16_f32 v24, v92, v93
  v_cvt_pk_bf16_f32 v25, v94, v95
  v_mfma_f32_16x16x32_bf16 v[92:95], a[204:207], a[108:111], 0
  v_cvt_pk_bf16_f32 v4, v136, v137
  v_cvt_pk_bf16_f32 v54, v96, v97
  v_mfma_f32_16x16x32_bf16 v[92:95], a[208:211], a[112:115], v[92:95]
  v_cvt_pk_bf16_f32 v55, v98, v99
  v_cvt_pk_bf16_f32 v38, v88, v89
  v_mfma_f32_16x16x32_bf16 v[96:99], a[204:207], a[84:87], 0
  v_cvt_pk_bf16_f32 v39, v90, v91
  v_cvt_pk_bf16_f32 v5, v138, v139
  v_mfma_f32_16x16x32_bf16 v[88:91], a[192:195], a[132:135], 0
  v_cvt_pk_bf16_f32 v6, v140, v141
  v_cvt_pk_bf16_f32 v7, v142, v143
  v_mfma_f32_16x16x32_bf16 v[96:99], a[208:211], a[88:91], v[96:99]
  v_cvt_pk_bf16_f32 v8, v144, v145
  v_cvt_pk_bf16_f32 v9, v146, v147
  v_mfma_f32_16x16x32_bf16 v[92:95], a[212:215], a[116:119], v[92:95]
  v_cvt_pk_bf16_f32 v10, v148, v15
  ds_read_b64_tr_b16 v[50:51], v253 offset:840
  v_mfma_f32_16x16x32_bf16 v[88:91], a[196:199], a[136:139], v[88:91]
  ds_read_b64_tr_b16 v[34:35], v253 offset:776
  v_mul_f32 v136, v136, v184
  v_mfma_f32_16x16x32_bf16 v[96:99], a[212:215], a[92:95], v[96:99]
  v_mul_f32 v137, v137, v185
  v_mul_f32 v138, v138, v186
  v_mfma_f32_16x16x32_bf16 v[88:91], a[200:203], a[140:143], v[88:91]
  v_cvt_pk_bf16_f32 v48, v92, v93
  v_cvt_pk_bf16_f32 v49, v94, v95
  v_mfma_f32_16x16x32_bf16 v[92:95], v[16:19], v[4:7], 0
  v_mul_f32 v139, v139, v187
  v_mul_f32 v140, v140, v188
  v_mfma_f32_16x16x32_bf16 v[92:95], v[16:19], v[8:11], v[92:95]
  v_cvt_pk_bf16_f32 v32, v96, v97
  v_cvt_pk_bf16_f32 v33, v98, v99
  v_mfma_f32_16x16x32_bf16 v[96:99], a[204:207], a[120:123], 0
  v_cvt_pk_bf16_f32 v62, v88, v89
  v_cvt_pk_bf16_f32 v63, v90, v91
  v_mfma_f32_16x16x32_bf16 v[88:91], a[204:207], a[96:99], 0
  v_mul_f32 v141, v141, v189
  v_mul_f32 v142, v142, v190
  v_mfma_f32_16x16x32_bf16 v[96:99], a[208:211], a[124:127], v[96:99]
  v_rcp_f32 v204, v92
  v_mfma_f32_16x16x32_bf16 v[88:91], a[208:211], a[100:103], v[88:91]
  v_mul_f32 v143, v143, v191
  v_mul_f32 v136, v136, v204
  v_mfma_f32_16x16x32_bf16 v[96:99], a[212:215], a[128:131], v[96:99]
  v_mul_f32 v137, v137, v204
  v_mul_f32 v138, v138, v204
  v_mfma_f32_16x16x32_bf16 v[88:91], a[212:215], a[104:107], v[88:91]
  v_mul_f32 v139, v139, v204
  v_mul_f32 v140, v140, v204
  v_mfma_f32_16x16x32_bf16 v[156:159], v[116:119], a[244:247], v[156:159]
  v_mul_f32 v141, v141, v204
  v_mul_f32 v142, v142, v204
  v_mfma_f32_16x16x32_bf16 v[160:163], v[124:127], a[240:243], 0
  v_mul_f32 v143, v143, v204
  v_mul_f32 v144, v144, v192
  v_mfma_f32_16x16x32_bf16 v[164:167], a[216:219], a[240:243], v[244:247]
  v_mul_f32 v145, v145, v193
  v_mul_f32 v146, v146, v194
  v_mfma_f32_16x16x32_bf16 v[152:155], v[108:111], a[248:251], v[152:155]
  v_mul_f32 v147, v147, v195
  v_mul_f32 v148, v148, v196
  v_mfma_f32_16x16x32_bf16 v[156:159], v[120:123], a[248:251], v[156:159]
  v_cvt_pk_bf16_f32 v168, v136, v137
  v_cvt_pk_bf16_f32 v169, v138, v139
  v_mfma_f32_16x16x32_bf16 v[160:163], v[128:131], a[244:247], v[160:163]
  v_cvt_pk_bf16_f32 v170, v140, v141
  v_cvt_pk_bf16_f32 v171, v142, v143
  v_mfma_f32_16x16x32_bf16 v[164:167], a[220:223], a[244:247], v[164:167]
  v_cvt_pk_bf16_f32 v56, v96, v97
  v_cvt_pk_bf16_f32 v57, v98, v99
  v_mfma_f32_16x16x32_bf16 v[96:99], v[20:23], v[168:171], 0
  v_mul_f32 v144, v144, v204
  v_mul_f32 v145, v145, v204
  v_mfma_f32_16x16x32_bf16 v[160:163], v[132:135], a[248:251], v[160:163]
  v_mul_f32 v146, v146, v204
  v_mul_f32 v147, v147, v204
  v_mfma_f32_16x16x32_bf16 v[164:167], a[224:227], a[248:251], v[164:167]
  v_fma_f32 v148, v148, v204, v242
  v_mov_b32 v255, s25
  v_cvt_pk_bf16_f32 v40, v88, v89
  v_cvt_pk_bf16_f32 v41, v90, v91
  v_mfma_f32_16x16x32_bf16 v[88:91], a[204:207], a[132:135], 0
  v_cvt_pk_bf16_f32 v172, v144, v145
  v_cvt_pk_bf16_f32 v173, v146, v147
  v_mfma_f32_16x16x32_bf16 v[88:91], a[208:211], a[136:139], v[88:91]
  v_cvt_pk_bf16_f32 v174, v148, v243
  v_addc_co_u32 v255, vcc, 0, v255, vcc
  v_mfma_f32_16x16x32_bf16 v[88:91], a[212:215], a[140:143], v[88:91]
  global_load_lds_dword v[254:255], off
  s_waitcnt lgkmcnt(0)
  v_mfma_f32_16x16x32_bf16 v[96:99], v[24:27], v[172:175], v[96:99]
  ds_read_b64_tr_b16 v[58:59], v253 offset:896
  ds_read_b64_tr_b16 v[42:43], v253 offset:832
  v_mul_f32 v208, s59, v208
  v_mul_f32 v152, v152, v184
  v_mul_f32 v153, v153, v185
  v_mul_f32 v154, v154, v186
  v_mul_f32 v155, v155, v187
  v_mul_f32 v156, v156, v188
  v_cvt_pk_bf16_f32 v216, v96, v97
  v_cvt_pk_bf16_f32 v217, v98, v99
  v_mfma_f32_16x16x32_bf16 v[96:99], v[44:47], v[168:171], 0
  v_mul_f32 v157, v157, v189
  v_mul_f32 v158, v158, v190
  v_mfma_f32_16x16x32_bf16 v[96:99], v[48:51], v[172:175], v[96:99]
  v_mul_f32 v159, v159, v191
  v_cvt_pk_bf16_f32 v64, v88, v89
  v_cvt_pk_bf16_f32 v65, v90, v91
  v_mfma_f32_16x16x32_bf16 v[88:91], v[28:31], v[168:171], 0
  v_xor_b32 v254, 16, v231
  v_mul_f32 v152, v152, v208
  v_mfma_f32_16x16x32_bf16 v[88:91], v[32:35], v[172:175], v[88:91]
  v_mul_f32 v153, v153, v208
  v_mul_f32 v154, v154, v208
  v_mul_f32 v155, v155, v208
  v_mul_f32 v156, v156, v208
  v_mul_f32 v157, v157, v208
  v_mul_f32 v158, v158, v208
  v_mul_f32 v159, v159, v208
  ds_read_b128 a[228:231], v248 offset:19200
  ds_read_b64_tr_b16 v[26:27], v254 offset:768
  v_mul_f32 v160, v160, v192
  v_mul_f32 v161, v161, v193
  v_mul_f32 v162, v162, v194
  v_mul_f32 v163, v163, v195
  v_mul_f32 v164, v164, v196
  v_exp_f32 v152, v152
  v_exp_f32 v153, v153
  v_exp_f32 v154, v154
  v_exp_f32 v155, v155
  v_exp_f32 v156, v156
  v_exp_f32 v157, v157
  v_exp_f32 v158, v158
  v_exp_f32 v159, v159
  v_mul_f32 v160, v160, v208
  v_mul_f32 v161, v161, v208
  v_mul_f32 v162, v162, v208
  v_mul_f32 v163, v163, v208
  v_mul_f32 v164, v164, v208
  ds_read_b128 a[232:235], v248 offset:19264
  v_exp_f32 v160, v160
  v_exp_f32 v161, v161
  s_waitcnt lgkmcnt(1)
  v_mfma_f32_16x16x32_bf16 v[136:139], v[100:103], a[228:231], 0
  v_exp_f32 v162, v162
  v_mfma_f32_16x16x32_bf16 v[140:143], v[112:115], a[228:231], 0
  v_exp_f32 v163, v163
  v_mfma_f32_16x16x32_bf16 v[144:147], v[124:127], a[228:231], 0
  v_exp_f32 v164, v164
  v_mfma_f32_16x16x32_bf16 v[148:151], a[216:219], a[228:231], v[244:247]
  v_cvt_pk_bf16_f32 v4, v152, v153
  v_cvt_pk_bf16_f32 v5, v154, v155
  v_cvt_pk_bf16_f32 v6, v156, v157
  v_cvt_pk_bf16_f32 v7, v158, v159
  v_cvt_pk_bf16_f32 v222, v96, v97
  v_cvt_pk_bf16_f32 v223, v98, v99
  v_mfma_f32_16x16x32_bf16 v[96:99], v[16:19], v[4:7], 0
  ds_read_b128 a[236:239], v248 offset:19328
  ds_read_b64_tr_b16 v[66:67], v253 offset:904
  v_cvt_pk_bf16_f32 v8, v160, v161
  v_cvt_pk_bf16_f32 v9, v162, v163
  v_cvt_pk_bf16_f32 v10, v164, v15
  s_waitcnt lgkmcnt(2)
  v_mfma_f32_16x16x32_bf16 v[136:139], v[104:107], a[232:235], v[136:139]
  v_cvt_pk_bf16_f32 v218, v88, v89
  v_cvt_pk_bf16_f32 v219, v90, v91
  v_mfma_f32_16x16x32_bf16 v[96:99], v[16:19], v[8:11], v[96:99]
  ds_read_b64_tr_b16 v[50:51], v254 offset:840
  ds_read_b32 v200, v239 offset:864
  v_mfma_f32_16x16x32_bf16 v[88:91], v[52:55], v[168:171], 0
  v_max3_f32 v12, v12, v92, v204
  ds_read_b64_tr_b16 v[34:35], v254 offset:776
  v_mfma_f32_16x16x32_bf16 v[88:91], v[56:59], v[172:175], v[88:91]
  v_mul_f32 v152, v152, v184
  v_mul_f32 v153, v153, v185
  v_mfma_f32_16x16x32_bf16 v[92:95], v[36:39], v[168:171], 0
  v_rcp_f32 v212, v96
  v_mfma_f32_16x16x32_bf16 v[92:95], v[40:43], v[172:175], v[92:95]
  v_mul_f32 v154, v154, v186
  v_mul_f32 v155, v155, v187
  v_mfma_f32_16x16x32_bf16 v[140:143], v[116:119], a[232:235], v[140:143]
  v_mul_f32 v156, v156, v188
  v_mul_f32 v157, v157, v189
  s_waitcnt lgkmcnt(3)
  v_mfma_f32_16x16x32_bf16 v[136:139], v[108:111], a[236:239], v[136:139]
  v_mul_f32 v158, v158, v190
  v_mul_f32 v159, v159, v191
  v_mfma_f32_16x16x32_bf16 v[140:143], v[120:123], a[236:239], v[140:143]
  v_mul_f32 v152, v152, v212
  v_mul_f32 v153, v153, v212
  v_mfma_f32_16x16x32_bf16 v[144:147], v[128:131], a[232:235], v[144:147]
  v_mul_f32 v154, v154, v212
  v_mul_f32 v155, v155, v212
  v_mfma_f32_16x16x32_bf16 v[148:151], a[220:223], a[232:235], v[148:151]
  v_mul_f32 v156, v156, v212
  v_mul_f32 v157, v157, v212
  v_mfma_f32_16x16x32_bf16 v[144:147], v[132:135], a[236:239], v[144:147]
  v_mul_f32 v158, v158, v212
  v_mul_f32 v159, v159, v212
  v_mfma_f32_16x16x32_bf16 v[148:151], a[224:227], a[236:239], v[148:151]
  v_mul_f32 v160, v160, v192
  v_mul_f32 v161, v161, v193
  v_mul_f32 v162, v162, v194
  v_mul_f32 v163, v163, v195
  v_mul_f32 v164, v164, v196
  v_cvt_pk_bf16_f32 v176, v152, v153
  v_cvt_pk_bf16_f32 v177, v154, v155
  v_cvt_pk_bf16_f32 v178, v156, v157
  v_cvt_pk_bf16_f32 v179, v158, v159
  v_cvt_pk_bf16_f32 v224, v88, v89
  v_cvt_pk_bf16_f32 v225, v90, v91
  v_mfma_f32_16x16x32_bf16 v[88:91], v[20:23], v[176:179], 0
  v_mul_f32 v160, v160, v212
  v_mul_f32 v161, v161, v212
  v_mul_f32 v162, v162, v212
  v_mul_f32 v163, v163, v212
  v_fma_f32 v164, v164, v212, v242
  v_cvt_pk_bf16_f32 v180, v160, v161
  v_cvt_pk_bf16_f32 v181, v162, v163
  v_cvt_pk_bf16_f32 v182, v164, v243
  v_cvt_pk_bf16_f32 v220, v92, v93
  v_cvt_pk_bf16_f32 v221, v94, v95
  v_mfma_f32_16x16x32_bf16 v[88:91], v[24:27], v[180:183], v[88:91]
  ds_read_b64_tr_b16 v[58:59], v254 offset:896
  buffer_store_dwordx4 v[216:219], v234, s[8:11], s62 offen sc1
  v_mfma_f32_16x16x32_bf16 v[92:95], v[60:63], v[168:171], 0
  ds_read_b64_tr_b16 v[42:43], v254 offset:832
  v_xor_b32 v249, 32, v228
  v_mfma_f32_16x16x32_bf16 v[92:95], v[64:67], v[172:175], v[92:95]
  ds_read_b128 a[144:147], v249 offset:1536
  s_waitcnt lgkmcnt(3)
  v_mul_f32 v200, s59, v200
  v_cvt_pk_bf16_f32 v216, v88, v89
  v_cvt_pk_bf16_f32 v217, v90, v91
  v_mfma_f32_16x16x32_bf16 v[88:91], v[44:47], v[176:179], 0
  v_mul_f32 v136, v136, v184
  v_mul_f32 v137, v137, v185
  v_mfma_f32_16x16x32_bf16 v[88:91], v[48:51], v[180:183], v[88:91]
  v_mul_f32 v138, v138, v186
  v_mul_f32 v139, v139, v187
  v_mul_f32 v140, v140, v188
  v_mul_f32 v141, v141, v189
  v_mul_f32 v142, v142, v190
  v_mul_f32 v143, v143, v191
  v_xor_b32 v251, 16, v229
  v_cvt_pk_bf16_f32 v226, v92, v93
  v_cvt_pk_bf16_f32 v227, v94, v95
  v_mfma_f32_16x16x32_bf16 v[92:95], v[28:31], v[176:179], 0
  v_xor_b32 v253, 16, v232
  v_mul_f32 v136, v136, v200
  v_mfma_f32_16x16x32_bf16 v[92:95], v[32:35], v[180:183], v[92:95]
  v_mul_f32 v137, v137, v200
  v_mul_f32 v138, v138, v200
  v_mul_f32 v139, v139, v200
  v_mul_f32 v140, v140, v200
  v_mul_f32 v141, v141, v200
  v_mul_f32 v142, v142, v200
  v_mul_f32 v143, v143, v200
  s_waitcnt lgkmcnt(0)
  v_mfma_f32_16x16x32_bf16 v[76:79], a[0:3], a[144:147], 0
  ds_read_b128 a[240:243], v251 offset:768
  ds_read_b128 a[148:151], v249 offset:1600
  v_mfma_f32_16x16x32_bf16 v[80:83], a[12:15], a[144:147], 0
  ds_read_b64_tr_b16 v[26:27], v253 offset:768
  v_mul_f32 v144, v144, v192
  v_mfma_f32_16x16x32_bf16 v[84:87], a[24:27], a[144:147], 0
  v_mul_f32 v145, v145, v193
  v_mul_f32 v146, v146, v194
  v_mfma_f32_16x16x32_bf16 v[68:71], a[36:39], a[144:147], 0
  v_mul_f32 v147, v147, v195
  v_mul_f32 v148, v148, v196
  v_mfma_f32_16x16x32_bf16 v[72:75], a[48:51], a[144:147], 0
  v_exp_f32 v136, v136
  v_exp_f32 v137, v137
  v_exp_f32 v138, v138
  v_exp_f32 v139, v139
  v_exp_f32 v140, v140
  v_exp_f32 v141, v141
  v_exp_f32 v142, v142
  v_exp_f32 v143, v143
  s_waitcnt lgkmcnt(0)
  v_mfma_f32_16x16x32_bf16 v[152:155], v[100:103], a[240:243], 0
  v_mul_f32 v144, v144, v200
  v_mul_f32 v145, v145, v200
  v_mfma_f32_16x16x32_bf16 v[156:159], v[112:115], a[240:243], 0
  v_mul_f32 v146, v146, v200
  v_mul_f32 v147, v147, v200
  v_mfma_f32_16x16x32_bf16 v[76:79], a[4:7], a[148:151], v[76:79]
  v_mul_f32 v148, v148, v200
  ds_read_b128 a[244:247], v251 offset:832
  v_mfma_f32_16x16x32_bf16 v[160:163], v[124:127], a[240:243], 0
  ds_read_b128 a[152:155], v249 offset:1664
  buffer_store_dwordx4 v[220:223], v234, s[8:11], s62 offen offset:64 sc1
  v_mfma_f32_16x16x32_bf16 v[164:167], a[216:219], a[240:243], v[244:247]
  v_exp_f32 v144, v144
  v_mfma_f32_16x16x32_bf16 v[80:83], a[16:19], a[148:151], v[80:83]
  v_exp_f32 v145, v145
  v_mfma_f32_16x16x32_bf16 v[84:87], a[28:31], a[148:151], v[84:87]
  v_exp_f32 v146, v146
  v_mfma_f32_16x16x32_bf16 v[68:71], a[40:43], a[148:151], v[68:71]
  v_exp_f32 v147, v147
  v_mfma_f32_16x16x32_bf16 v[72:75], a[52:55], a[148:151], v[72:75]
  v_exp_f32 v148, v148
  v_cvt_pk_bf16_f32 v4, v136, v137
  v_cvt_pk_bf16_f32 v5, v138, v139
  v_cvt_pk_bf16_f32 v6, v140, v141
  v_cvt_pk_bf16_f32 v7, v142, v143
  v_cvt_pk_bf16_f32 v222, v88, v89
  v_cvt_pk_bf16_f32 v223, v90, v91
  v_mfma_f32_16x16x32_bf16 v[88:91], v[16:19], v[4:7], 0
  ds_read_b128 a[248:251], v251 offset:896
  ds_read_b64_tr_b16 v[66:67], v254 offset:904
  s_waitcnt lgkmcnt(2)
  v_mfma_f32_16x16x32_bf16 v[152:155], v[104:107], a[244:247], v[152:155]
  v_cvt_pk_bf16_f32 v8, v144, v145
  v_cvt_pk_bf16_f32 v9, v146, v147
  v_mfma_f32_16x16x32_bf16 v[156:159], v[116:119], a[244:247], v[156:159]
  v_cvt_pk_bf16_f32 v10, v148, v15
  v_cvt_pk_bf16_f32 v218, v92, v93
  v_mfma_f32_16x16x32_bf16 v[76:79], a[8:11], a[152:155], v[76:79]
  v_cvt_pk_bf16_f32 v219, v94, v95
  ds_read_b64_tr_b16 v[50:51], v253 offset:840
  v_mfma_f32_16x16x32_bf16 v[88:91], v[16:19], v[8:11], v[88:91]
  ds_read_b32 v208, v13 offset:768
  ds_read_b128 a[156:159], v249 offset:13824
  v_mfma_f32_16x16x32_bf16 v[92:95], v[52:55], v[176:179], 0
  v_max3_f32 v12, v12, v96, v212
  ds_read_b128 a[160:163], v249 offset:13888
  v_mfma_f32_16x16x32_bf16 v[92:95], v[56:59], v[180:183], v[92:95]
  ds_read_b64_tr_b16 v[34:35], v253 offset:776
  v_mul_f32 v136, v136, v184
  v_mfma_f32_16x16x32_bf16 v[96:99], v[36:39], v[176:179], 0
  v_rcp_f32 v204, v88
  v_mfma_f32_16x16x32_bf16 v[96:99], v[40:43], v[180:183], v[96:99]
  v_mul_f32 v137, v137, v185
  v_mul_f32 v138, v138, v186
  s_waitcnt lgkmcnt(5)
  v_mfma_f32_16x16x32_bf16 v[152:155], v[108:111], a[248:251], v[152:155]
  v_mul_f32 v139, v139, v187
  v_mul_f32 v140, v140, v188
  v_mfma_f32_16x16x32_bf16 v[156:159], v[120:123], a[248:251], v[156:159]
  v_mul_f32 v141, v141, v189
  v_mul_f32 v142, v142, v190
  v_mfma_f32_16x16x32_bf16 v[160:163], v[128:131], a[244:247], v[160:163]
  v_mul_f32 v143, v143, v191
  v_mul_f32 v136, v136, v204
  v_mfma_f32_16x16x32_bf16 v[164:167], a[220:223], a[244:247], v[164:167]
  v_mul_f32 v137, v137, v204
  v_mul_f32 v138, v138, v204
  v_mfma_f32_16x16x32_bf16 v[80:83], a[20:23], a[152:155], v[80:83]
  v_mul_f32 v139, v139, v204
  v_mul_f32 v140, v140, v204
  v_mfma_f32_16x16x32_bf16 v[84:87], a[32:35], a[152:155], v[84:87]
  v_mul_f32 v141, v141, v204
  v_mul_f32 v142, v142, v204
  v_mfma_f32_16x16x32_bf16 v[160:163], v[132:135], a[248:251], v[160:163]
  v_mul_f32 v143, v143, v204
  buffer_store_dwordx4 v[224:227], v234, s[8:11], s62 offen offset:128 sc1
  v_mfma_f32_16x16x32_bf16 v[164:167], a[224:227], a[248:251], v[164:167]
  ds_read_b128 a[164:167], v249 offset:13952
  v_mul_f32 v144, v144, v192
  v_mfma_f32_16x16x32_bf16 v[68:71], a[44:47], a[152:155], v[68:71]
  v_mul_f32 v145, v145, v193
  v_mul_f32 v146, v146, v194
  v_mfma_f32_16x16x32_bf16 v[72:75], a[56:59], a[152:155], v[72:75]
  v_mul_f32 v147, v147, v195
  v_mul_f32 v148, v148, v196
  v_cvt_pk_bf16_f32 v168, v136, v137
  v_cvt_pk_bf16_f32 v169, v138, v139
  v_cvt_pk_bf16_f32 v170, v140, v141
  v_cvt_pk_bf16_f32 v171, v142, v143
  v_cvt_pk_bf16_f32 v224, v92, v93
  v_cvt_pk_bf16_f32 v225, v94, v95
  v_mfma_f32_16x16x32_bf16 v[92:95], v[20:23], v[168:171], 0
  v_mul_f32 v144, v144, v204
  v_mul_f32 v145, v145, v204
  v_mul_f32 v146, v146, v204
  v_mul_f32 v147, v147, v204
  v_fma_f32 v148, v148, v204, v242
  v_cvt_pk_bf16_f32 v172, v144, v145
  v_cvt_pk_bf16_f32 v173, v146, v147
  v_cvt_pk_bf16_f32 v174, v148, v243
  v_cvt_pk_bf16_f32 v220, v96, v97
  v_cvt_pk_bf16_f32 v221, v98, v99
  v_mfma_f32_16x16x32_bf16 v[92:95], v[24:27], v[172:175], v[92:95]
  ds_read_b128 a[168:171], v249 offset:26112
  ds_read_b64_tr_b16 v[58:59], v253 offset:896
  v_mfma_f32_16x16x32_bf16 v[96:99], v[60:63], v[176:179], 0
  buffer_store_dwordx4 v[216:219], v235, s[8:11], s62 offen sc1
  ds_read_b128 a[172:175], v249 offset:26176
  v_mfma_f32_16x16x32_bf16 v[96:99], v[64:67], v[180:183], v[96:99]
  ds_read_b64_tr_b16 v[42:43], v253 offset:832
  ds_read_b128 a[176:179], v249 offset:26240
  v_cvt_pk_bf16_f32 v216, v92, v93
  v_cvt_pk_bf16_f32 v217, v94, v95
  v_mfma_f32_16x16x32_bf16 v[92:95], v[44:47], v[168:171], 0
  v_cvt_pk_bf16_f32 v100, v76, v77
  v_cvt_pk_bf16_f32 v101, v78, v79
  v_mfma_f32_16x16x32_bf16 v[76:79], a[60:63], a[144:147], 0
  s_waitcnt lgkmcnt(5)
  v_mul_f32 v208, s59, v208
  v_mul_f32 v152, v152, v184
  v_mfma_f32_16x16x32_bf16 v[92:95], v[48:51], v[172:175], v[92:95]
  v_mul_f32 v153, v153, v185
  v_mul_f32 v154, v154, v186
  v_mfma_f32_16x16x32_bf16 v[76:79], a[64:67], a[148:151], v[76:79]
  v_mul_f32 v155, v155, v187
  v_mul_f32 v156, v156, v188
  v_mfma_f32_16x16x32_bf16 v[76:79], a[68:71], a[152:155], v[76:79]
  v_mul_f32 v157, v157, v189
  v_mul_f32 v158, v158, v190
  v_mul_f32 v159, v159, v191
  v_cvt_pk_bf16_f32 v102, v80, v81
  v_cvt_pk_bf16_f32 v103, v82, v83
  v_mfma_f32_16x16x32_bf16 v[80:83], a[0:3], a[156:159], 0
  v_cvt_pk_bf16_f32 v104, v84, v85
  v_cvt_pk_bf16_f32 v105, v86, v87
  v_mfma_f32_16x16x32_bf16 v[84:87], a[12:15], a[156:159], 0
  v_cvt_pk_bf16_f32 v226, v96, v97
  v_cvt_pk_bf16_f32 v227, v98, v99
  v_mfma_f32_16x16x32_bf16 v[96:99], v[28:31], v[168:171], 0
  v_xor_b32 v254, 16, v233
  v_mul_f32 v152, v152, v208
  v_mfma_f32_16x16x32_bf16 v[80:83], a[4:7], a[160:163], v[80:83]
  v_mul_f32 v153, v153, v208
  v_mul_f32 v154, v154, v208
  v_mfma_f32_16x16x32_bf16 v[84:87], a[16:19], a[160:163], v[84:87]
  v_mul_f32 v155, v155, v208
  v_mul_f32 v156, v156, v208
  v_mfma_f32_16x16x32_bf16 v[96:99], v[32:35], v[172:175], v[96:99]
  v_mul_f32 v157, v157, v208
  v_mul_f32 v158, v158, v208
  v_mfma_f32_16x16x32_bf16 v[80:83], a[8:11], a[164:167], v[80:83]
  v_mul_f32 v159, v159, v208
  ds_read_b64_tr_b16 v[26:27], v254 offset:768
  v_mfma_f32_16x16x32_bf16 v[84:87], a[20:23], a[164:167], v[84:87]
  v_mul_f32 v160, v160, v192
  v_mul_f32 v161, v161, v193
  v_mul_f32 v162, v162, v194
  v_mul_f32 v163, v163, v195
  v_mul_f32 v164, v164, v196
  v_exp_f32 v152, v152
  v_exp_f32 v153, v153
  v_exp_f32 v154, v154
  v_exp_f32 v155, v155
  v_exp_f32 v156, v156
  v_exp_f32 v157, v157
  v_exp_f32 v158, v158
  v_exp_f32 v159, v159
  v_mul_f32 v160, v160, v208
  v_mul_f32 v161, v161, v208
  v_mul_f32 v162, v162, v208
  v_mul_f32 v163, v163, v208
  v_mul_f32 v164, v164, v208
  buffer_store_dwordx4 v[220:223], v235, s[8:11], s62 offen offset:64 sc1
  v_exp_f32 v160, v160
  v_exp_f32 v161, v161
  v_exp_f32 v162, v162
  v_exp_f32 v163, v163
  v_exp_f32 v164, v164
  v_cvt_pk_bf16_f32 v4, v152, v153
  v_cvt_pk_bf16_f32 v5, v154, v155
  v_cvt_pk_bf16_f32 v6, v156, v157
  v_cvt_pk_bf16_f32 v7, v158, v159
  v_cvt_pk_bf16_f32 v222, v92, v93
  v_cvt_pk_bf16_f32 v223, v94, v95
  v_mfma_f32_16x16x32_bf16 v[92:95], v[16:19], v[4:7], 0
  ds_read_b64_tr_b16 v[66:67], v253 offset:904
  v_cvt_pk_bf16_f32 v106, v68, v69
  v_cvt_pk_bf16_f32 v107, v70, v71
  v_mfma_f32_16x16x32_bf16 v[68:71], a[24:27], a[156:159], 0
  v_cvt_pk_bf16_f32 v8, v160, v161
  v_cvt_pk_bf16_f32 v9, v162, v163
  v_mfma_f32_16x16x32_bf16 v[68:71], a[28:31], a[160:163], v[68:71]
  v_cvt_pk_bf16_f32 v10, v164, v15
  v_cvt_pk_bf16_f32 v108, v72, v73
  v_mfma_f32_16x16x32_bf16 v[68:71], a[32:35], a[164:167], v[68:71]
  v_cvt_pk_bf16_f32 v109, v74, v75
  v_cvt_pk_bf16_f32 v110, v76, v77
  v_mfma_f32_16x16x32_bf16 v[92:95], v[16:19], v[8:11], v[92:95]
  v_cvt_pk_bf16_f32 v111, v78, v79
  v_cvt_pk_bf16_f32 v218, v96, v97
  v_mfma_f32_16x16x32_bf16 v[72:75], a[36:39], a[156:159], 0
  v_cvt_pk_bf16_f32 v219, v98, v99
  ds_read_b64_tr_b16 v[50:51], v254 offset:840
  v_mfma_f32_16x16x32_bf16 v[76:79], a[48:51], a[156:159], 0
  ds_read_b128 a[216:219], v250 offset:384
  v_cvt_pk_bf16_f32 v112, v80, v81
  v_mfma_f32_16x16x32_bf16 v[96:99], v[52:55], v[168:171], 0
  v_cvt_pk_bf16_f32 v113, v82, v83
  v_cvt_pk_bf16_f32 v114, v84, v85
  v_mfma_f32_16x16x32_bf16 v[72:75], a[40:43], a[160:163], v[72:75]
  v_cvt_pk_bf16_f32 v115, v86, v87
  ds_read_b128 a[228:231], v249 offset:1536
  v_mfma_f32_16x16x32_bf16 v[76:79], a[52:55], a[160:163], v[76:79]
  v_max3_f32 v12, v12, v88, v204
  ds_read_b128 a[220:223], v250 offset:448
  v_mfma_f32_16x16x32_bf16 v[80:83], a[60:63], a[156:159], 0
  ds_read_b128 a[232:235], v249 offset:1600
  v_rcp_f32 v212, v92
  s_waitcnt lgkmcnt(5)
  v_mfma_f32_16x16x32_bf16 v[84:87], a[0:3], a[168:171], 0
  ds_read_b64_tr_b16 v[34:35], v254 offset:776
  v_mul_f32 v152, v152, v184
  v_mfma_f32_16x16x32_bf16 v[96:99], v[56:59], v[172:175], v[96:99]
  v_mul_f32 v153, v153, v185
  v_mul_f32 v154, v154, v186
  v_mfma_f32_16x16x32_bf16 v[88:91], v[36:39], v[168:171], 0
  v_mul_f32 v155, v155, v187
  v_mul_f32 v156, v156, v188
  v_mfma_f32_16x16x32_bf16 v[72:75], a[44:47], a[164:167], v[72:75]
  v_mul_f32 v157, v157, v189
  v_mul_f32 v158, v158, v190
  v_mfma_f32_16x16x32_bf16 v[76:79], a[56:59], a[164:167], v[76:79]
  v_mul_f32 v159, v159, v191
  ds_read_b128 a[224:227], v250 offset:512
  v_mfma_f32_16x16x32_bf16 v[80:83], a[64:67], a[160:163], v[80:83]
  ds_read_b128 a[236:239], v249 offset:1664
  v_mul_f32 v152, v152, v212
  v_mfma_f32_16x16x32_bf16 v[84:87], a[4:7], a[172:175], v[84:87]
  v_mul_f32 v153, v153, v212
  v_mul_f32 v154, v154, v212
  v_mfma_f32_16x16x32_bf16 v[88:91], v[40:43], v[172:175], v[88:91]
  v_mul_f32 v155, v155, v212
  v_mul_f32 v156, v156, v212
  v_mfma_f32_16x16x32_bf16 v[80:83], a[68:71], a[164:167], v[80:83]
  v_mul_f32 v157, v157, v212
  v_mul_f32 v158, v158, v212
  v_mfma_f32_16x16x32_bf16 v[84:87], a[8:11], a[176:179], v[84:87]
  v_mul_f32 v159, v159, v212
  buffer_store_dwordx4 v[224:227], v235, s[8:11], s62 offen offset:128 sc1
  s_waitcnt lgkmcnt(2)
  v_mfma_f32_16x16x32_bf16 v[136:139], v[100:103], a[228:231], 0
  v_mul_f32 v160, v160, v192
  v_mul_f32 v161, v161, v193
  v_mfma_f32_16x16x32_bf16 v[140:143], v[112:115], a[228:231], 0
  v_mul_f32 v162, v162, v194
  v_mul_f32 v163, v163, v195
  v_mfma_f32_16x16x32_bf16 v[148:151], a[216:219], a[228:231], v[244:247]
  v_mul_f32 v164, v164, v196
  v_cvt_pk_bf16_f32 v176, v152, v153
  v_mfma_f32_16x16x32_bf16 v[136:139], v[104:107], a[232:235], v[136:139]
  v_cvt_pk_bf16_f32 v177, v154, v155
  v_cvt_pk_bf16_f32 v178, v156, v157
  v_mfma_f32_16x16x32_bf16 v[148:151], a[220:223], a[232:235], v[148:151]
  v_cvt_pk_bf16_f32 v179, v158, v159
  v_cvt_pk_bf16_f32 v116, v68, v69
  s_waitcnt lgkmcnt(0)
  v_mfma_f32_16x16x32_bf16 v[136:139], v[108:111], a[236:239], v[136:139]
  v_cvt_pk_bf16_f32 v117, v70, v71
  v_cvt_pk_bf16_f32 v224, v96, v97
  v_mfma_f32_16x16x32_bf16 v[68:71], a[12:15], a[168:171], 0
  v_cvt_pk_bf16_f32 v225, v98, v99
  v_mul_f32 v160, v160, v212
  v_mfma_f32_16x16x32_bf16 v[96:99], v[20:23], v[176:179], 0
  v_mul_f32 v161, v161, v212
  v_mul_f32 v162, v162, v212
  v_mfma_f32_16x16x32_bf16 v[68:71], a[16:19], a[172:175], v[68:71]
  v_mul_f32 v163, v163, v212
  v_fma_f32 v164, v164, v212, v242
  v_mfma_f32_16x16x32_bf16 v[68:71], a[20:23], a[176:179], v[68:71]
  v_cvt_pk_bf16_f32 v180, v160, v161
  v_cvt_pk_bf16_f32 v181, v162, v163
  v_mfma_f32_16x16x32_bf16 v[148:151], a[224:227], a[236:239], v[148:151]
  v_cvt_pk_bf16_f32 v182, v164, v243
  v_cvt_pk_bf16_f32 v118, v72, v73
  v_cvt_pk_bf16_f32 v119, v74, v75
  v_mfma_f32_16x16x32_bf16 v[72:75], a[24:27], a[168:171], 0
  v_cvt_pk_bf16_f32 v120, v76, v77
  v_cvt_pk_bf16_f32 v121, v78, v79
  v_mfma_f32_16x16x32_bf16 v[76:79], a[36:39], a[168:171], 0
  v_cvt_pk_bf16_f32 v220, v88, v89
  v_cvt_pk_bf16_f32 v221, v90, v91
  v_mfma_f32_16x16x32_bf16 v[96:99], v[24:27], v[180:183], v[96:99]
  v_cvt_pk_bf16_f32 v122, v80, v81
  v_cvt_pk_bf16_f32 v123, v82, v83
  v_mfma_f32_16x16x32_bf16 v[88:91], v[60:63], v[168:171], 0
  v_cvt_pk_bf16_f32 v124, v84, v85
  v_cvt_pk_bf16_f32 v125, v86, v87
  v_mfma_f32_16x16x32_bf16 v[72:75], a[28:31], a[172:175], v[72:75]
  ds_read_b64_tr_b16 v[58:59], v254 offset:896
  buffer_store_dwordx4 v[216:219], v236, s[8:11], s62 offen sc1
  v_mfma_f32_16x16x32_bf16 v[76:79], a[40:43], a[172:175], v[76:79]
  ds_read_b64_tr_b16 v[42:43], v254 offset:832
  v_cvt_pk_bf16_f32 v216, v96, v97
  v_mfma_f32_16x16x32_bf16 v[80:83], a[48:51], a[168:171], 0
  v_cvt_pk_bf16_f32 v217, v98, v99
  v_cvt_pk_bf16_f32 v126, v68, v69
  v_mfma_f32_16x16x32_bf16 v[84:87], a[60:63], a[168:171], 0
  v_cvt_pk_bf16_f32 v127, v70, v71
  buffer_store_dwordx4 v[220:223], v236, s[8:11], s62 offen offset:64 sc1
  v_mfma_f32_16x16x32_bf16 v[88:91], v[64:67], v[172:175], v[88:91]
  ds_read_b64_tr_b16 v[66:67], v254 offset:904
  v_max3_f32 v12, v12, v92, v212
  v_mfma_f32_16x16x32_bf16 v[72:75], a[32:35], a[176:179], v[72:75]
  ds_read_b128 v[184:187], v238 offset:1536
  ds_read_b128 v[188:191], v238 offset:1600
  v_mfma_f32_16x16x32_bf16 v[76:79], a[44:47], a[176:179], v[76:79]
  ds_read_b32 v200, v239 offset:1536
  ds_read_b128 v[192:195], v238 offset:1664
  v_mfma_f32_16x16x32_bf16 v[80:83], a[52:55], a[172:175], v[80:83]
  v_cvt_pk_bf16_f32 v226, v88, v89
  v_cvt_pk_bf16_f32 v227, v90, v91
  v_mfma_f32_16x16x32_bf16 v[84:87], a[64:67], a[172:175], v[84:87]
  v_cvt_pk_bf16_f32 v128, v72, v73
  v_cvt_pk_bf16_f32 v129, v74, v75
  v_mfma_f32_16x16x32_bf16 v[96:99], v[44:47], v[176:179], 0
  v_cvt_pk_bf16_f32 v130, v76, v77
  v_cvt_pk_bf16_f32 v131, v78, v79
  v_mfma_f32_16x16x32_bf16 v[80:83], a[56:59], a[176:179], v[80:83]
  buffer_store_dwordx4 v[224:227], v236, s[8:11], s62 offen offset:128 sc1
  ds_read_b32 v196, v240 offset:2112
  v_mfma_f32_16x16x32_bf16 v[84:87], a[68:71], a[176:179], v[84:87]
  s_lshl_b32 s27, s20, 12
  v_lshlrev_b32 v253, 6, v1
  v_mfma_f32_16x16x32_bf16 v[96:99], v[48:51], v[180:183], v[96:99]
  v_add_u32 v253, s27, v253
  ds_read_b128 a[240:243], v249 offset:10752
  v_mfma_f32_16x16x32_bf16 v[144:147], v[124:127], a[228:231], 0
  v_cvt_pk_bf16_f32 v132, v80, v81
  v_cvt_pk_bf16_f32 v133, v82, v83
  v_mfma_f32_16x16x32_bf16 v[88:91], v[28:31], v[176:179], 0
  v_cvt_pk_bf16_f32 v134, v84, v85
  v_cvt_pk_bf16_f32 v135, v86, v87
  v_mfma_f32_16x16x32_bf16 v[140:143], v[116:119], a[232:235], v[140:143]
  v_cvt_pk_bf16_f32 v222, v96, v97
  v_cvt_pk_bf16_f32 v223, v98, v99
  v_mfma_f32_16x16x32_bf16 v[144:147], v[128:131], a[232:235], v[144:147]
  s_waitcnt lgkmcnt(2)
  v_mul_f32 v200, s59, v200
  v_mul_f32 v136, v136, v184
  v_mfma_f32_16x16x32_bf16 v[88:91], v[32:35], v[180:183], v[88:91]
  v_mul_f32 v137, v137, v185
  v_mul_f32 v138, v138, v186
  v_mfma_f32_16x16x32_bf16 v[140:143], v[120:123], a[236:239], v[140:143]
  v_mul_f32 v139, v139, v187
  v_mul_f32 v136, v136, v200
  v_mfma_f32_16x16x32_bf16 v[144:147], v[132:135], a[236:239], v[144:147]
  v_mul_f32 v137, v137, v200
  v_mul_f32 v138, v138, v200
  v_mfma_f32_16x16x32_bf16 v[96:99], a[144:147], a[72:75], 0
  v_cvt_pk_bf16_f32 v218, v88, v89
  v_cvt_pk_bf16_f32 v219, v90, v91
  v_mfma_f32_16x16x32_bf16 v[96:99], a[148:151], a[76:79], v[96:99]
  buffer_store_dwordx4 v[216:219], v237, s[8:11], s62 offen sc1
  v_mul_f32 v140, v140, v188
  v_mfma_f32_16x16x32_bf16 v[88:91], v[52:55], v[176:179], 0
  v_mul_f32 v141, v141, v189
  v_mul_f32 v142, v142, v190
  v_mfma_f32_16x16x32_bf16 v[96:99], a[152:155], a[80:83], v[96:99]
  v_mul_f32 v143, v143, v191
  v_mul_f32 v139, v139, v200
  v_mfma_f32_16x16x32_bf16 v[88:91], v[56:59], v[180:183], v[88:91]
  v_mul_f32 v140, v140, v200
  v_mul_f32 v141, v141, v200
  v_mfma_f32_16x16x32_bf16 v[92:95], v[36:39], v[176:179], 0
  v_mul_f32 v142, v142, v200
  v_mul_f32 v143, v143, v200
  v_mfma_f32_16x16x32_bf16 v[92:95], v[40:43], v[180:183], v[92:95]
  v_cvt_pk_bf16_f32 v20, v96, v97
  v_cvt_pk_bf16_f32 v21, v98, v99
  v_mfma_f32_16x16x32_bf16 v[96:99], a[144:147], a[108:111], 0
  v_cvt_pk_bf16_f32 v224, v88, v89
  v_cvt_pk_bf16_f32 v225, v90, v91
  v_mfma_f32_16x16x32_bf16 v[88:91], a[144:147], a[84:87], 0
  v_mul_f32 v144, v144, v192
  v_mul_f32 v145, v145, v193
  v_mfma_f32_16x16x32_bf16 v[96:99], a[148:151], a[112:115], v[96:99]
  v_cvt_pk_bf16_f32 v220, v92, v93
  v_cvt_pk_bf16_f32 v221, v94, v95
  v_mfma_f32_16x16x32_bf16 v[88:91], a[148:151], a[88:91], v[88:91]
  buffer_store_dwordx4 v[220:223], v237, s[8:11], s62 offen offset:64 sc1
  v_mul_f32 v146, v146, v194
  v_mfma_f32_16x16x32_bf16 v[96:99], a[152:155], a[116:119], v[96:99]
  v_mul_f32 v147, v147, v195
  s_waitcnt lgkmcnt(0)
  v_mul_f32 v148, v148, v196
  v_mfma_f32_16x16x32_bf16 v[92:95], v[60:63], v[176:179], 0
  v_exp_f32 v136, v136
  v_mfma_f32_16x16x32_bf16 v[88:91], a[152:155], a[92:95], v[88:91]
  v_exp_f32 v137, v137
  v_mfma_f32_16x16x32_bf16 v[92:95], v[64:67], v[180:183], v[92:95]
  v_exp_f32 v138, v138
  v_mfma_f32_16x16x32_bf16 v[152:155], v[100:103], a[240:243], 0
  v_cvt_pk_bf16_f32 v44, v96, v97
  v_cvt_pk_bf16_f32 v45, v98, v99
  v_mfma_f32_16x16x32_bf16 v[96:99], a[156:159], a[72:75], 0
  v_exp_f32 v139, v139
  v_mfma_f32_16x16x32_bf16 v[96:99], a[160:163], a[76:79], v[96:99]
  v_cvt_pk_bf16_f32 v28, v88, v89
  v_cvt_pk_bf16_f32 v29, v90, v91
  v_mfma_f32_16x16x32_bf16 v[88:91], a[144:147], a[120:123], 0
  v_cvt_pk_bf16_f32 v226, v92, v93
  v_cvt_pk_bf16_f32 v227, v94, v95
  v_mfma_f32_16x16x32_bf16 v[92:95], a[144:147], a[96:99], 0
  buffer_store_dwordx4 v[224:227], v237, s[8:11], s62 offen offset:128 sc1
  s_mov_b32 s26, L_END-L_PCX1-4
  v_mfma_f32_16x16x32_bf16 v[88:91], a[148:151], a[124:127], v[88:91]
  s_getpc_b64 s[24:25]
L_PCX1:
  v_min_u32 v253, s26, v253
  v_mfma_f32_16x16x32_bf16 v[96:99], a[164:167], a[80:83], v[96:99]
  v_add_co_u32 v254, vcc, s24, v253
  v_mov_b32 v255, s25
  v_mfma_f32_16x16x32_bf16 v[92:95], a[148:151], a[100:103], v[92:95]
  s_mov_b32 m0, 0x27100
  v_addc_co_u32 v255, vcc, 0, v255, vcc
  v_mfma_f32_16x16x32_bf16 v[88:91], a[152:155], a[128:131], v[88:91]
  global_load_lds_dword v[254:255], off
  v_mfma_f32_16x16x32_bf16 v[92:95], a[152:155], a[104:107], v[92:95]
  v_cvt_pk_bf16_f32 v22, v96, v97
  v_cvt_pk_bf16_f32 v23, v98, v99
  v_mfma_f32_16x16x32_bf16 v[96:99], a[156:159], a[108:111], 0
  v_lshlrev_b32 v253, 6, v1
  v_add_u32 v253, s27, v253
  v_mfma_f32_16x16x32_bf16 v[96:99], a[160:163], a[112:115], v[96:99]
  v_cvt_pk_bf16_f32 v52, v88, v89
  v_cvt_pk_bf16_f32 v53, v90, v91
  v_mfma_f32_16x16x32_bf16 v[88:91], a[156:159], a[84:87], 0
  v_cvt_pk_bf16_f32 v36, v92, v93
  v_cvt_pk_bf16_f32 v37, v94, v95
  v_mfma_f32_16x16x32_bf16 v[92:95], a[144:147], a[132:135], 0
  v_add_u32 v253, 0x4000, v253
  v_min_u32 v253, s26, v253
  v_mfma_f32_16x16x32_bf16 v[88:91], a[160:163], a[88:91], v[88:91]
  v_add_co_u32 v254, vcc, s24, v253
  v_xor_b32 v253, 32, v230
  v_mfma_f32_16x16x32_bf16 v[96:99], a[164:167], a[116:119], v[96:99]
  ds_read_b64_tr_b16 v[26:27], v253 offset:1536
  v_exp_f32 v140, v140
  v_mfma_f32_16x16x32_bf16 v[92:95], a[148:151], a[136:139], v[92:95]
  v_exp_f32 v141, v141
  v_mfma_f32_16x16x32_bf16 v[88:91], a[164:167], a[92:95], v[88:91]
  v_exp_f32 v142, v142
  v_mfma_f32_16x16x32_bf16 v[92:95], a[152:155], a[140:143], v[92:95]
  v_exp_f32 v143, v143
  v_mfma_f32_16x16x32_bf16 v[156:159], v[112:115], a[240:243], 0
  v_cvt_pk_bf16_f32 v46, v96, v97
  v_cvt_pk_bf16_f32 v47, v98, v99
  v_mfma_f32_16x16x32_bf16 v[96:99], a[168:171], a[72:75], 0
  v_mul_f32 v144, v144, v200
  v_cvt_pk_bf16_f32 v30, v88, v89
  v_mfma_f32_16x16x32_bf16 v[96:99], a[172:175], a[76:79], v[96:99]
  v_cvt_pk_bf16_f32 v31, v90, v91
  v_cvt_pk_bf16_f32 v60, v92, v93
  v_mfma_f32_16x16x32_bf16 v[88:91], a[156:159], a[120:123], 0
  v_cvt_pk_bf16_f32 v61, v94, v95
  v_mul_f32 v145, v145, v200
  v_mfma_f32_16x16x32_bf16 v[92:95], a[156:159], a[96:99], 0
  v_mul_f32 v146, v146, v200
  v_mul_f32 v147, v147, v200
  v_mfma_f32_16x16x32_bf16 v[88:91], a[160:163], a[124:127], v[88:91]
  v_mul_f32 v148, v148, v200
  ds_read_b128 a[244:247], v249 offset:10816
  v_mfma_f32_16x16x32_bf16 v[96:99], a[176:179], a[80:83], v[96:99]
  v_exp_f32 v144, v144
  v_mfma_f32_16x16x32_bf16 v[92:95], a[160:163], a[100:103], v[92:95]
  v_exp_f32 v145, v145
  v_mfma_f32_16x16x32_bf16 v[88:91], a[164:167], a[128:131], v[88:91]
  v_exp_f32 v146, v146
  v_mfma_f32_16x16x32_bf16 v[92:95], a[164:167], a[104:107], v[92:95]
  v_exp_f32 v147, v147
  v_mfma_f32_16x16x32_bf16 v[160:163], v[124:127], a[240:243], 0
  v_cvt_pk_bf16_f32 v24, v96, v97
  v_cvt_pk_bf16_f32 v25, v98, v99
  v_mfma_f32_16x16x32_bf16 v[96:99], a[168:171], a[108:111], 0
  v_exp_f32 v148, v148
  v_mfma_f32_16x16x32_bf16 v[96:99], a[172:175], a[112:115], v[96:99]
  v_cvt_pk_bf16_f32 v54, v88, v89
  v_cvt_pk_bf16_f32 v55, v90, v91
  v_mfma_f32_16x16x32_bf16 v[88:91], a[168:171], a[84:87], 0
  v_cvt_pk_bf16_f32 v38, v92, v93
  v_cvt_pk_bf16_f32 v39, v94, v95
  v_mfma_f32_16x16x32_bf16 v[92:95], a[156:159], a[132:135], 0
  v_cvt_pk_bf16_f32 v4, v136, v137
  v_cvt_pk_bf16_f32 v5, v138, v139
  v_mfma_f32_16x16x32_bf16 v[88:91], a[172:175], a[88:91], v[88:91]
  v_cvt_pk_bf16_f32 v6, v140, v141
  v_cvt_pk_bf16_f32 v7, v142, v143
  v_mfma_f32_16x16x32_bf16 v[96:99], a[176:179], a[116:119], v[96:99]
  ds_read_b128 a[248:251], v249 offset:10880
  v_cvt_pk_bf16_f32 v8, v144, v145
  v_mfma_f32_16x16x32_bf16 v[92:95], a[160:163], a[136:139], v[92:95]
  v_cvt_pk_bf16_f32 v9, v146, v147
  v_cvt_pk_bf16_f32 v10, v148, v15
  v_mfma_f32_16x16x32_bf16 v[88:91], a[176:179], a[92:95], v[88:91]
  ds_read_b64_tr_b16 v[50:51], v253 offset:1608
  ds_read_b32 v208, v239 offset:1584
  v_mfma_f32_16x16x32_bf16 v[92:95], a[164:167], a[140:143], v[92:95]
  v_cvt_pk_bf16_f32 v48, v96, v97
  v_cvt_pk_bf16_f32 v49, v98, v99
  v_mfma_f32_16x16x32_bf16 v[96:99], v[16:19], v[4:7], 0
  ds_read_b64_tr_b16 v[34:35], v253 offset:1544
  v_mul_f32 v136, v136, v184
  v_mfma_f32_16x16x32_bf16 v[96:99], v[16:19], v[8:11], v[96:99]
  v_cvt_pk_bf16_f32 v32, v88, v89
  v_cvt_pk_bf16_f32 v33, v90, v91
  v_mfma_f32_16x16x32_bf16 v[88:91], a[168:171], a[120:123], 0
  v_cvt_pk_bf16_f32 v62, v92, v93
  v_cvt_pk_bf16_f32 v63, v94, v95
  v_mfma_f32_16x16x32_bf16 v[92:95], a[168:171], a[96:99], 0
  v_mul_f32 v137, v137, v185
  v_mul_f32 v138, v138, v186
  v_mfma_f32_16x16x32_bf16 v[88:91], a[172:175], a[124:127], v[88:91]
  v_rcp_f32 v204, v96
  v_mfma_f32_16x16x32_bf16 v[92:95], a[172:175], a[100:103], v[92:95]
  v_mul_f32 v139, v139, v187
  v_mul_f32 v140, v140, v188
  v_mfma_f32_16x16x32_bf16 v[88:91], a[176:179], a[128:131], v[88:91]
  v_mul_f32 v141, v141, v189
  v_mul_f32 v142, v142, v190
  v_mfma_f32_16x16x32_bf16 v[92:95], a[176:179], a[104:107], v[92:95]
  v_mul_f32 v143, v143, v191
  v_mul_f32 v136, v136, v204
  s_waitcnt lgkmcnt(0)
  v_mfma_f32_16x16x32_bf16 v[152:155], v[104:107], a[244:247], v[152:155]
  v_mul_f32 v137, v137, v204
  v_mul_f32 v138, v138, v204
  v_mfma_f32_16x16x32_bf16 v[156:159], v[116:119], a[244:247], v[156:159]
  v_mul_f32 v139, v139, v204
  v_mul_f32 v140, v140, v204
  v_mfma_f32_16x16x32_bf16 v[164:167], a[216:219], a[240:243], v[244:247]
  v_mul_f32 v141, v141, v204
  v_mul_f32 v142, v142, v204
  v_mfma_f32_16x16x32_bf16 v[152:155], v[108:111], a[248:251], v[152:155]
  v_mul_f32 v143, v143, v204
  v_mul_f32 v144, v144, v192
  v_mfma_f32_16x16x32_bf16 v[156:159], v[120:123], a[248:251], v[156:159]
  v_mul_f32 v145, v145, v193
  v_mul_f32 v146, v146, v194
  v_mfma_f32_16x16x32_bf16 v[160:163], v[128:131], a[244:247], v[160:163]
  v_mul_f32 v147, v147, v195
  v_mul_f32 v148, v148, v196
  v_mfma_f32_16x16x32_bf16 v[164:167], a[220:223], a[244:247], v[164:167]
  v_cvt_pk_bf16_f32 v168, v136, v137
  v_cvt_pk_bf16_f32 v169, v138, v139
  v_mfma_f32_16x16x32_bf16 v[160:163], v[132:135], a[248:251], v[160:163]
  v_cvt_pk_bf16_f32 v170, v140, v141
  v_cvt_pk_bf16_f32 v171, v142, v143
  v_mfma_f32_16x16x32_bf16 v[164:167], a[224:227], a[248:251], v[164:167]
  v_cvt_pk_bf16_f32 v56, v88, v89
  v_cvt_pk_bf16_f32 v57, v90, v91
  v_mfma_f32_16x16x32_bf16 v[88:91], v[20:23], v[168:171], 0
  v_mul_f32 v144, v144, v204
  v_mul_f32 v145, v145, v204
  v_mul_f32 v146, v146, v204
  v_mul_f32 v147, v147, v204
  v_fma_f32 v148, v148, v204, v242
  v_mov_b32 v255, s25
  v_cvt_pk_bf16_f32 v40, v92, v93
  v_cvt_pk_bf16_f32 v41, v94, v95
  v_mfma_f32_16x16x32_bf16 v[92:95], a[168:171], a[132:135], 0
  v_cvt_pk_bf16_f32 v172, v144, v145
  v_cvt_pk_bf16_f32 v173, v146, v147
  v_mfma_f32_16x16x32_bf16 v[92:95], a[172:175], a[136:139], v[92:95]
  v_cvt_pk_bf16_f32 v174, v148, v243
  v_addc_co_u32 v255, vcc, 0, v255, vcc
  v_mfma_f32_16x16x32_bf16 v[92:95], a[176:179], a[140:143], v[92:95]
  global_load_lds_dword v[254:255], off
  v_mfma_f32_16x16x32_bf16 v[88:91], v[24:27], v[172:175], v[88:91]
  ds_read_b64_tr_b16 v[58:59], v253 offset:1664
  ds_read_b64_tr_b16 v[42:43], v253 offset:1600
  v_mul_f32 v208, s59, v208
  v_mul_f32 v152, v152, v184
  v_mul_f32 v153, v153, v185
  v_mul_f32 v154, v154, v186
  v_mul_f32 v155, v155, v187
  v_mul_f32 v156, v156, v188
  v_cvt_pk_bf16_f32 v216, v88, v89
  v_cvt_pk_bf16_f32 v217, v90, v91
  v_mfma_f32_16x16x32_bf16 v[88:91], v[44:47], v[168:171], 0
  v_mul_f32 v157, v157, v189
  v_mul_f32 v158, v158, v190
  v_mfma_f32_16x16x32_bf16 v[88:91], v[48:51], v[172:175], v[88:91]
  v_mul_f32 v159, v159, v191
  v_cvt_pk_bf16_f32 v64, v92, v93
  v_cvt_pk_bf16_f32 v65, v94, v95
  v_mfma_f32_16x16x32_bf16 v[92:95], v[28:31], v[168:171], 0
  v_xor_b32 v254, 32, v231
  v_mul_f32 v152, v152, v208
  v_mfma_f32_16x16x32_bf16 v[92:95], v[32:35], v[172:175], v[92:95]
  v_mul_f32 v153, v153, v208
  v_mul_f32 v154, v154, v208
  v_mul_f32 v155, v155, v208
  v_mul_f32 v156, v156, v208
  v_mul_f32 v157, v157, v208
  v_mul_f32 v158, v158, v208
  v_mul_f32 v159, v159, v208
  ds_read_b128 a[228:231], v249 offset:19968
  ds_read_b64_tr_b16 v[26:27], v254 offset:1536
  v_mul_f32 v160, v160, v192
  v_mul_f32 v161, v161, v193
  v_mul_f32 v162, v162, v194
  v_mul_f32 v163, v163, v195
  v_mul_f32 v164, v164, v196
  v_exp_f32 v152, v152
  v_exp_f32 v153, v153
  v_exp_f32 v154, v154
  v_exp_f32 v155, v155
  v_exp_f32 v156, v156
  v_exp_f32 v157, v157
  v_exp_f32 v158, v158
  v_exp_f32 v159, v159
  v_mul_f32 v160, v160, v208
  v_mul_f32 v161, v161, v208
  v_mul_f32 v162, v162, v208
  v_mul_f32 v163, v163, v208
  v_mul_f32 v164, v164, v208
  ds_read_b128 a[232:235], v249 offset:20032
  v_exp_f32 v160, v160
  v_exp_f32 v161, v161
  s_waitcnt lgkmcnt(1)
  v_mfma_f32_16x16x32_bf16 v[136:139], v[100:103], a[228:231], 0
  v_exp_f32 v162, v162
  v_mfma_f32_16x16x32_bf16 v[140:143], v[112:115], a[228:231], 0
  v_exp_f32 v163, v163
  v_mfma_f32_16x16x32_bf16 v[144:147], v[124:127], a[228:231], 0
  v_exp_f32 v164, v164
  v_mfma_f32_16x16x32_bf16 v[148:151], a[216:219], a[228:231], v[244:247]
  v_cvt_pk_bf16_f32 v4, v152, v153
  v_cvt_pk_bf16_f32 v5, v154, v155
  v_cvt_pk_bf16_f32 v6, v156, v157
  v_cvt_pk_bf16_f32 v7, v158, v159
  v_cvt_pk_bf16_f32 v222, v88, v89
  v_cvt_pk_bf16_f32 v223, v90, v91
  v_mfma_f32_16x16x32_bf16 v[88:91], v[16:19], v[4:7], 0
  ds_read_b128 a[236:239], v249 offset:20096
  ds_read_b64_tr_b16 v[66:67], v253 offset:1672
  v_cvt_pk_bf16_f32 v8, v160, v161
  v_cvt_pk_bf16_f32 v9, v162, v163
  v_cvt_pk_bf16_f32 v10, v164, v15
  s_waitcnt lgkmcnt(2)
  v_mfma_f32_16x16x32_bf16 v[136:139], v[104:107], a[232:235], v[136:139]
  v_cvt_pk_bf16_f32 v218, v92, v93
  v_cvt_pk_bf16_f32 v219, v94, v95
  v_mfma_f32_16x16x32_bf16 v[88:91], v[16:19], v[8:11], v[88:91]
  ds_read_b64_tr_b16 v[50:51], v254 offset:1608
  ds_read_b32 v200, v239 offset:1632
  v_mfma_f32_16x16x32_bf16 v[92:95], v[52:55], v[168:171], 0
  v_max3_f32 v12, v12, v96, v204
  ds_read_b64_tr_b16 v[34:35], v254 offset:1544
  v_mfma_f32_16x16x32_bf16 v[92:95], v[56:59], v[172:175], v[92:95]
  v_mul_f32 v152, v152, v184
  v_mul_f32 v153, v153, v185
  v_mfma_f32_16x16x32_bf16 v[96:99], v[36:39], v[168:171], 0
  v_rcp_f32 v212, v88
  v_mfma_f32_16x16x32_bf16 v[96:99], v[40:43], v[172:175], v[96:99]
  v_mul_f32 v154, v154, v186
  v_mul_f32 v155, v155, v187
  v_mfma_f32_16x16x32_bf16 v[140:143], v[116:119], a[232:235], v[140:143]
  v_mul_f32 v156, v156, v188
  v_mul_f32 v157, v157, v189
  s_waitcnt lgkmcnt(3)
  v_mfma_f32_16x16x32_bf16 v[136:139], v[108:111], a[236:239], v[136:139]
  v_mul_f32 v158, v158, v190
  v_mul_f32 v159, v159, v191
  v_mfma_f32_16x16x32_bf16 v[140:143], v[120:123], a[236:239], v[140:143]
  v_mul_f32 v152, v152, v212
  v_mul_f32 v153, v153, v212
  v_mfma_f32_16x16x32_bf16 v[144:147], v[128:131], a[232:235], v[144:147]
  v_mul_f32 v154, v154, v212
  v_mul_f32 v155, v155, v212
  v_mfma_f32_16x16x32_bf16 v[148:151], a[220:223], a[232:235], v[148:151]
  v_mul_f32 v156, v156, v212
  v_mul_f32 v157, v157, v212
  v_mfma_f32_16x16x32_bf16 v[144:147], v[132:135], a[236:239], v[144:147]
  v_mul_f32 v158, v158, v212
  v_mul_f32 v159, v159, v212
  v_mfma_f32_16x16x32_bf16 v[148:151], a[224:227], a[236:239], v[148:151]
  v_mul_f32 v160, v160, v192
  v_mul_f32 v161, v161, v193
  v_mul_f32 v162, v162, v194
  v_mul_f32 v163, v163, v195
  v_mul_f32 v164, v164, v196
  v_cvt_pk_bf16_f32 v176, v152, v153
  v_cvt_pk_bf16_f32 v177, v154, v155
  v_cvt_pk_bf16_f32 v178, v156, v157
  v_cvt_pk_bf16_f32 v179, v158, v159
  v_cvt_pk_bf16_f32 v224, v92, v93
  v_cvt_pk_bf16_f32 v225, v94, v95
  v_mfma_f32_16x16x32_bf16 v[92:95], v[20:23], v[176:179], 0
  v_mul_f32 v160, v160, v212
  v_mul_f32 v161, v161, v212
  v_mul_f32 v162, v162, v212
  v_mul_f32 v163, v163, v212
  v_fma_f32 v164, v164, v212, v242
  v_cvt_pk_bf16_f32 v180, v160, v161
  v_cvt_pk_bf16_f32 v181, v162, v163
  v_cvt_pk_bf16_f32 v182, v164, v243
  v_cvt_pk_bf16_f32 v220, v96, v97
  v_cvt_pk_bf16_f32 v221, v98, v99
  v_mfma_f32_16x16x32_bf16 v[92:95], v[24:27], v[180:183], v[92:95]
  ds_read_b64_tr_b16 v[58:59], v254 offset:1664
  buffer_store_dwordx4 v[216:219], v234, s[8:11], s63 offen sc1
  v_mfma_f32_16x16x32_bf16 v[96:99], v[60:63], v[168:171], 0
  ds_read_b64_tr_b16 v[42:43], v254 offset:1600
  v_xor_b32 v248, 48, v228
  v_mfma_f32_16x16x32_bf16 v[96:99], v[64:67], v[172:175], v[96:99]
  ds_read_b128 a[180:183], v248 offset:2304
  s_waitcnt lgkmcnt(3)
  v_mul_f32 v200, s59, v200
  v_cvt_pk_bf16_f32 v216, v92, v93
  v_cvt_pk_bf16_f32 v217, v94, v95
  v_mfma_f32_16x16x32_bf16 v[92:95], v[44:47], v[176:179], 0
  v_mul_f32 v136, v136, v184
  v_mul_f32 v137, v137, v185
  v_mfma_f32_16x16x32_bf16 v[92:95], v[48:51], v[180:183], v[92:95]
  v_mul_f32 v138, v138, v186
  v_mul_f32 v139, v139, v187
  v_mul_f32 v140, v140, v188
  v_mul_f32 v141, v141, v189
  v_mul_f32 v142, v142, v190
  v_mul_f32 v143, v143, v191
  v_xor_b32 v252, 32, v229
  v_cvt_pk_bf16_f32 v226, v96, v97
  v_cvt_pk_bf16_f32 v227, v98, v99
  v_mfma_f32_16x16x32_bf16 v[96:99], v[28:31], v[176:179], 0
  v_xor_b32 v253, 32, v232
  v_mul_f32 v136, v136, v200
  v_mfma_f32_16x16x32_bf16 v[96:99], v[32:35], v[180:183], v[96:99]
  v_mul_f32 v137, v137, v200
  v_mul_f32 v138, v138, v200
  v_mul_f32 v139, v139, v200
  v_mul_f32 v140, v140, v200
  v_mul_f32 v141, v141, v200
  v_mul_f32 v142, v142, v200
  v_mul_f32 v143, v143, v200
  s_waitcnt lgkmcnt(0)
  v_mfma_f32_16x16x32_bf16 v[68:71], a[0:3], a[180:183], 0
  ds_read_b128 a[240:243], v252 offset:1536
  ds_read_b128 a[184:187], v248 offset:2368
  v_mfma_f32_16x16x32_bf16 v[72:75], a[12:15], a[180:183], 0
  ds_read_b64_tr_b16 v[26:27], v253 offset:1536
  v_mul_f32 v144, v144, v192
  v_mfma_f32_16x16x32_bf16 v[76:79], a[24:27], a[180:183], 0
  v_mul_f32 v145, v145, v193
  v_mul_f32 v146, v146, v194
  v_mfma_f32_16x16x32_bf16 v[80:83], a[36:39], a[180:183], 0
  v_mul_f32 v147, v147, v195
  v_mul_f32 v148, v148, v196
  v_mfma_f32_16x16x32_bf16 v[84:87], a[48:51], a[180:183], 0
  v_exp_f32 v136, v136
  v_exp_f32 v137, v137
  v_exp_f32 v138, v138
  v_exp_f32 v139, v139
  v_exp_f32 v140, v140
  v_exp_f32 v141, v141
  v_exp_f32 v142, v142
  v_exp_f32 v143, v143
  s_waitcnt lgkmcnt(0)
  v_mfma_f32_16x16x32_bf16 v[152:155], v[100:103], a[240:243], 0
  v_mul_f32 v144, v144, v200
  v_mul_f32 v145, v145, v200
  v_mfma_f32_16x16x32_bf16 v[156:159], v[112:115], a[240:243], 0
  v_mul_f32 v146, v146, v200
  v_mul_f32 v147, v147, v200
  v_mfma_f32_16x16x32_bf16 v[68:71], a[4:7], a[184:187], v[68:71]
  v_mul_f32 v148, v148, v200
  ds_read_b128 a[244:247], v252 offset:1600
  v_mfma_f32_16x16x32_bf16 v[160:163], v[124:127], a[240:243], 0
  ds_read_b128 a[188:191], v248 offset:2432
  buffer_store_dwordx4 v[220:223], v234, s[8:11], s63 offen offset:64 sc1
  v_mfma_f32_16x16x32_bf16 v[164:167], a[216:219], a[240:243], v[244:247]
  v_exp_f32 v144, v144
  v_mfma_f32_16x16x32_bf16 v[72:75], a[16:19], a[184:187], v[72:75]
  v_exp_f32 v145, v145
  v_mfma_f32_16x16x32_bf16 v[76:79], a[28:31], a[184:187], v[76:79]
  v_exp_f32 v146, v146
  v_mfma_f32_16x16x32_bf16 v[80:83], a[40:43], a[184:187], v[80:83]
  v_exp_f32 v147, v147
  v_mfma_f32_16x16x32_bf16 v[84:87], a[52:55], a[184:187], v[84:87]
  v_exp_f32 v148, v148
  v_cvt_pk_bf16_f32 v4, v136, v137
  v_cvt_pk_bf16_f32 v5, v138, v139
  v_cvt_pk_bf16_f32 v6, v140, v141
  v_cvt_pk_bf16_f32 v7, v142, v143
  v_cvt_pk_bf16_f32 v222, v92, v93
  v_cvt_pk_bf16_f32 v223, v94, v95
  v_mfma_f32_16x16x32_bf16 v[92:95], v[16:19], v[4:7], 0
  ds_read_b128 a[248:251], v252 offset:1664
  ds_read_b64_tr_b16 v[66:67], v254 offset:1672
  s_waitcnt lgkmcnt(2)
  v_mfma_f32_16x16x32_bf16 v[152:155], v[104:107], a[244:247], v[152:155]
  v_cvt_pk_bf16_f32 v8, v144, v145
  v_cvt_pk_bf16_f32 v9, v146, v147
  v_mfma_f32_16x16x32_bf16 v[156:159], v[116:119], a[244:247], v[156:159]
  v_cvt_pk_bf16_f32 v10, v148, v15
  v_cvt_pk_bf16_f32 v218, v96, v97
  v_mfma_f32_16x16x32_bf16 v[68:71], a[8:11], a[188:191], v[68:71]
  v_cvt_pk_bf16_f32 v219, v98, v99
  ds_read_b64_tr_b16 v[50:51], v253 offset:1608
  v_mfma_f32_16x16x32_bf16 v[92:95], v[16:19], v[8:11], v[92:95]
  ds_read_b32 v208, v13 offset:1536
  ds_read_b128 a[192:195], v248 offset:14592
  v_mfma_f32_16x16x32_bf16 v[96:99], v[52:55], v[176:179], 0
  v_max3_f32 v12, v12, v88, v212
  ds_read_b128 a[196:199], v248 offset:14656
  v_mfma_f32_16x16x32_bf16 v[96:99], v[56:59], v[180:183], v[96:99]
  ds_read_b64_tr_b16 v[34:35], v253 offset:1544
  v_mul_f32 v136, v136, v184
  v_mfma_f32_16x16x32_bf16 v[88:91], v[36:39], v[176:179], 0
  v_rcp_f32 v204, v92
  v_mfma_f32_16x16x32_bf16 v[88:91], v[40:43], v[180:183], v[88:91]
  v_mul_f32 v137, v137, v185
  v_mul_f32 v138, v138, v186
  s_waitcnt lgkmcnt(5)
  v_mfma_f32_16x16x32_bf16 v[152:155], v[108:111], a[248:251], v[152:155]
  v_mul_f32 v139, v139, v187
  v_mul_f32 v140, v140, v188
  v_mfma_f32_16x16x32_bf16 v[156:159], v[120:123], a[248:251], v[156:159]
  v_mul_f32 v141, v141, v189
  v_mul_f32 v142, v142, v190
  v_mfma_f32_16x16x32_bf16 v[160:163], v[128:131], a[244:247], v[160:163]
  v_mul_f32 v143, v143, v191
  v_mul_f32 v136, v136, v204
  v_mfma_f32_16x16x32_bf16 v[164:167], a[220:223], a[244:247], v[164:167]
  v_mul_f32 v137, v137, v204
  v_mul_f32 v138, v138, v204
  v_mfma_f32_16x16x32_bf16 v[72:75], a[20:23], a[188:191], v[72:75]
  v_mul_f32 v139, v139, v204
  v_mul_f32 v140, v140, v204
  v_mfma_f32_16x16x32_bf16 v[76:79], a[32:35], a[188:191], v[76:79]
  v_mul_f32 v141, v141, v204
  v_mul_f32 v142, v142, v204
  v_mfma_f32_16x16x32_bf16 v[160:163], v[132:135], a[248:251], v[160:163]
  v_mul_f32 v143, v143, v204
  buffer_store_dwordx4 v[224:227], v234, s[8:11], s63 offen offset:128 sc1
  v_mfma_f32_16x16x32_bf16 v[164:167], a[224:227], a[248:251], v[164:167]
  ds_read_b128 a[200:203], v248 offset:14720
  v_mul_f32 v144, v144, v192
  v_mfma_f32_16x16x32_bf16 v[80:83], a[44:47], a[188:191], v[80:83]
  v_mul_f32 v145, v145, v193
  v_mul_f32 v146, v146, v194
  v_mfma_f32_16x16x32_bf16 v[84:87], a[56:59], a[188:191], v[84:87]
  v_mul_f32 v147, v147, v195
  v_mul_f32 v148, v148, v196
  v_cvt_pk_bf16_f32 v168, v136, v137
  v_cvt_pk_bf16_f32 v169, v138, v139
  v_cvt_pk_bf16_f32 v170, v140, v141
  v_cvt_pk_bf16_f32 v171, v142, v143
  v_cvt_pk_bf16_f32 v224, v96, v97
  v_cvt_pk_bf16_f32 v225, v98, v99
  v_mfma_f32_16x16x32_bf16 v[96:99], v[20:23], v[168:171], 0
  v_mul_f32 v144, v144, v204
  v_mul_f32 v145, v145, v204
  v_mul_f32 v146, v146, v204
  v_mul_f32 v147, v147, v204
  v_fma_f32 v148, v148, v204, v242
  v_cvt_pk_bf16_f32 v172, v144, v145
  v_cvt_pk_bf16_f32 v173, v146, v147
  v_cvt_pk_bf16_f32 v174, v148, v243
  v_cvt_pk_bf16_f32 v220, v88, v89
  v_cvt_pk_bf16_f32 v221, v90, v91
  v_mfma_f32_16x16x32_bf16 v[96:99], v[24:27], v[172:175], v[96:99]
  ds_read_b128 a[204:207], v248 offset:26880
  ds_read_b64_tr_b16 v[58:59], v253 offset:1664
  v_mfma_f32_16x16x32_bf16 v[88:91], v[60:63], v[176:179], 0
  buffer_store_dwordx4 v[216:219], v235, s[8:11], s63 offen sc1
  ds_read_b128 a[208:211], v248 offset:26944
  v_mfma_f32_16x16x32_bf16 v[88:91], v[64:67], v[180:183], v[88:91]
  ds_read_b64_tr_b16 v[42:43], v253 offset:1600
  ds_read_b128 a[212:215], v248 offset:27008
  v_cvt_pk_bf16_f32 v216, v96, v97
  v_cvt_pk_bf16_f32 v217, v98, v99
  v_mfma_f32_16x16x32_bf16 v[96:99], v[44:47], v[168:171], 0
  v_cvt_pk_bf16_f32 v100, v68, v69
  v_cvt_pk_bf16_f32 v101, v70, v71
  v_mfma_f32_16x16x32_bf16 v[68:71], a[60:63], a[180:183], 0
  s_waitcnt lgkmcnt(5)
  v_mul_f32 v208, s59, v208
  v_mul_f32 v152, v152, v184
  v_mfma_f32_16x16x32_bf16 v[96:99], v[48:51], v[172:175], v[96:99]
  v_mul_f32 v153, v153, v185
  v_mul_f32 v154, v154, v186
  v_mfma_f32_16x16x32_bf16 v[68:71], a[64:67], a[184:187], v[68:71]
  v_mul_f32 v155, v155, v187
  v_mul_f32 v156, v156, v188
  v_mfma_f32_16x16x32_bf16 v[68:71], a[68:71], a[188:191], v[68:71]
  v_mul_f32 v157, v157, v189
  v_mul_f32 v158, v158, v190
  v_mul_f32 v159, v159, v191
  v_cvt_pk_bf16_f32 v102, v72, v73
  v_cvt_pk_bf16_f32 v103, v74, v75
  v_mfma_f32_16x16x32_bf16 v[72:75], a[0:3], a[192:195], 0
  v_cvt_pk_bf16_f32 v104, v76, v77
  v_cvt_pk_bf16_f32 v105, v78, v79
  v_mfma_f32_16x16x32_bf16 v[76:79], a[12:15], a[192:195], 0
  v_cvt_pk_bf16_f32 v226, v88, v89
  v_cvt_pk_bf16_f32 v227, v90, v91
  v_mfma_f32_16x16x32_bf16 v[88:91], v[28:31], v[168:171], 0
  v_xor_b32 v254, 32, v233
  v_mul_f32 v152, v152, v208
  v_mfma_f32_16x16x32_bf16 v[72:75], a[4:7], a[196:199], v[72:75]
  v_mul_f32 v153, v153, v208
  v_mul_f32 v154, v154, v208
  v_mfma_f32_16x16x32_bf16 v[76:79], a[16:19], a[196:199], v[76:79]
  v_mul_f32 v155, v155, v208
  v_mul_f32 v156, v156, v208
  v_mfma_f32_16x16x32_bf16 v[88:91], v[32:35], v[172:175], v[88:91]
  v_mul_f32 v157, v157, v208
  v_mul_f32 v158, v158, v208
  v_mfma_f32_16x16x32_bf16 v[72:75], a[8:11], a[200:203], v[72:75]
  v_mul_f32 v159, v159, v208
  ds_read_b64_tr_b16 v[26:27], v254 offset:1536
  v_mfma_f32_16x16x32_bf16 v[76:79], a[20:23], a[200:203], v[76:79]
  v_mul_f32 v160, v160, v192
  v_mul_f32 v161, v161, v193
  v_mul_f32 v162, v162, v194
  v_mul_f32 v163, v163, v195
  v_mul_f32 v164, v164, v196
  v_exp_f32 v152, v152
  v_exp_f32 v153, v153
  v_exp_f32 v154, v154
  v_exp_f32 v155, v155
  v_exp_f32 v156, v156
  v_exp_f32 v157, v157
  v_exp_f32 v158, v158
  v_exp_f32 v159, v159
  v_mul_f32 v160, v160, v208
  v_mul_f32 v161, v161, v208
  v_mul_f32 v162, v162, v208
  v_mul_f32 v163, v163, v208
  v_mul_f32 v164, v164, v208
  buffer_store_dwordx4 v[220:223], v235, s[8:11], s63 offen offset:64 sc1
  v_exp_f32 v160, v160
  v_exp_f32 v161, v161
  v_exp_f32 v162, v162
  v_exp_f32 v163, v163
  v_exp_f32 v164, v164
  v_cvt_pk_bf16_f32 v4, v152, v153
  v_cvt_pk_bf16_f32 v5, v154, v155
  v_cvt_pk_bf16_f32 v6, v156, v157
  v_cvt_pk_bf16_f32 v7, v158, v159
  v_cvt_pk_bf16_f32 v222, v96, v97
  v_cvt_pk_bf16_f32 v223, v98, v99
  v_mfma_f32_16x16x32_bf16 v[96:99], v[16:19], v[4:7], 0
  ds_read_b64_tr_b16 v[66:67], v253 offset:1672
  v_cvt_pk_bf16_f32 v106, v80, v81
  v_cvt_pk_bf16_f32 v107, v82, v83
  v_mfma_f32_16x16x32_bf16 v[80:83], a[24:27], a[192:195], 0
  v_cvt_pk_bf16_f32 v8, v160, v161
  v_cvt_pk_bf16_f32 v9, v162, v163
  v_mfma_f32_16x16x32_bf16 v[80:83], a[28:31], a[196:199], v[80:83]
  v_cvt_pk_bf16_f32 v10, v164, v15
  v_cvt_pk_bf16_f32 v108, v84, v85
  v_mfma_f32_16x16x32_bf16 v[80:83], a[32:35], a[200:203], v[80:83]
  v_cvt_pk_bf16_f32 v109, v86, v87
  v_cvt_pk_bf16_f32 v110, v68, v69
  v_mfma_f32_16x16x32_bf16 v[96:99], v[16:19], v[8:11], v[96:99]
  v_cvt_pk_bf16_f32 v111, v70, v71
  v_cvt_pk_bf16_f32 v218, v88, v89
  v_mfma_f32_16x16x32_bf16 v[84:87], a[36:39], a[192:195], 0
  v_cvt_pk_bf16_f32 v219, v90, v91
  ds_read_b64_tr_b16 v[50:51], v254 offset:1608
  v_mfma_f32_16x16x32_bf16 v[68:71], a[48:51], a[192:195], 0
  ds_read_b128 a[216:219], v250 offset:576
  v_cvt_pk_bf16_f32 v112, v72, v73
  v_mfma_f32_16x16x32_bf16 v[88:91], v[52:55], v[168:171], 0
  v_cvt_pk_bf16_f32 v113, v74, v75
  v_cvt_pk_bf16_f32 v114, v76, v77
  v_mfma_f32_16x16x32_bf16 v[84:87], a[40:43], a[196:199], v[84:87]
  v_cvt_pk_bf16_f32 v115, v78, v79
  ds_read_b128 a[228:231], v248 offset:2304
  v_mfma_f32_16x16x32_bf16 v[68:71], a[52:55], a[196:199], v[68:71]
  v_max3_f32 v12, v12, v92, v204
  ds_read_b128 a[220:223], v250 offset:640
  v_mfma_f32_16x16x32_bf16 v[72:75], a[60:63], a[192:195], 0
  ds_read_b128 a[232:235], v248 offset:2368
  v_rcp_f32 v212, v96
  s_waitcnt lgkmcnt(5)
  v_mfma_f32_16x16x32_bf16 v[76:79], a[0:3], a[204:207], 0
  ds_read_b64_tr_b16 v[34:35], v254 offset:1544
  v_mul_f32 v152, v152, v184
  v_mfma_f32_16x16x32_bf16 v[88:91], v[56:59], v[172:175], v[88:91]
  v_mul_f32 v153, v153, v185
  v_mul_f32 v154, v154, v186
  v_mfma_f32_16x16x32_bf16 v[92:95], v[36:39], v[168:171], 0
  v_mul_f32 v155, v155, v187
  v_mul_f32 v156, v156, v188
  v_mfma_f32_16x16x32_bf16 v[84:87], a[44:47], a[200:203], v[84:87]
  v_mul_f32 v157, v157, v189
  v_mul_f32 v158, v158, v190
  v_mfma_f32_16x16x32_bf16 v[68:71], a[56:59], a[200:203], v[68:71]
  v_mul_f32 v159, v159, v191
  ds_read_b128 a[224:227], v250 offset:704
  v_mfma_f32_16x16x32_bf16 v[72:75], a[64:67], a[196:199], v[72:75]
  ds_read_b128 a[236:239], v248 offset:2432
  v_mul_f32 v152, v152, v212
  v_mfma_f32_16x16x32_bf16 v[76:79], a[4:7], a[208:211], v[76:79]
  v_mul_f32 v153, v153, v212
  v_mul_f32 v154, v154, v212
  v_mfma_f32_16x16x32_bf16 v[92:95], v[40:43], v[172:175], v[92:95]
  v_mul_f32 v155, v155, v212
  v_mul_f32 v156, v156, v212
  v_mfma_f32_16x16x32_bf16 v[72:75], a[68:71], a[200:203], v[72:75]
  v_mul_f32 v157, v157, v212
  v_mul_f32 v158, v158, v212
  v_mfma_f32_16x16x32_bf16 v[76:79], a[8:11], a[212:215], v[76:79]
  v_mul_f32 v159, v159, v212
  buffer_store_dwordx4 v[224:227], v235, s[8:11], s63 offen offset:128 sc1
  s_waitcnt lgkmcnt(2)
  v_mfma_f32_16x16x32_bf16 v[136:139], v[100:103], a[228:231], 0
  v_mul_f32 v160, v160, v192
  v_mul_f32 v161, v161, v193
  v_mfma_f32_16x16x32_bf16 v[140:143], v[112:115], a[228:231], 0
  v_mul_f32 v162, v162, v194
  v_mul_f32 v163, v163, v195
  v_mfma_f32_16x16x32_bf16 v[148:151], a[216:219], a[228:231], v[244:247]
  v_mul_f32 v164, v164, v196
  v_cvt_pk_bf16_f32 v176, v152, v153
  v_mfma_f32_16x16x32_bf16 v[136:139], v[104:107], a[232:235], v[136:139]
  v_cvt_pk_bf16_f32 v177, v154, v155
  v_cvt_pk_bf16_f32 v178, v156, v157
  v_mfma_f32_16x16x32_bf16 v[148:151], a[220:223], a[232:235], v[148:151]
  v_cvt_pk_bf16_f32 v179, v158, v159
  v_cvt_pk_bf16_f32 v116, v80, v81
  s_waitcnt lgkmcnt(0)
  v_mfma_f32_16x16x32_bf16 v[136:139], v[108:111], a[236:239], v[136:139]
  v_cvt_pk_bf16_f32 v117, v82, v83
  v_cvt_pk_bf16_f32 v224, v88, v89
  v_mfma_f32_16x16x32_bf16 v[80:83], a[12:15], a[204:207], 0
  v_cvt_pk_bf16_f32 v225, v90, v91
  v_mul_f32 v160, v160, v212
  v_mfma_f32_16x16x32_bf16 v[88:91], v[20:23], v[176:179], 0
  v_mul_f32 v161, v161, v212
  v_mul_f32 v162, v162, v212
  v_mfma_f32_16x16x32_bf16 v[80:83], a[16:19], a[208:211], v[80:83]
  v_mul_f32 v163, v163, v212
  v_fma_f32 v164, v164, v212, v242
  v_mfma_f32_16x16x32_bf16 v[80:83], a[20:23], a[212:215], v[80:83]
  v_cvt_pk_bf16_f32 v180, v160, v161
  v_cvt_pk_bf16_f32 v181, v162, v163
  v_mfma_f32_16x16x32_bf16 v[148:151], a[224:227], a[236:239], v[148:151]
  v_cvt_pk_bf16_f32 v182, v164, v243
  v_cvt_pk_bf16_f32 v118, v84, v85
  v_cvt_pk_bf16_f32 v119, v86, v87
  v_mfma_f32_16x16x32_bf16 v[84:87], a[24:27], a[204:207], 0
  v_cvt_pk_bf16_f32 v120, v68, v69
  v_cvt_pk_bf16_f32 v121, v70, v71
  v_mfma_f32_16x16x32_bf16 v[68:71], a[36:39], a[204:207], 0
  v_cvt_pk_bf16_f32 v220, v92, v93
  v_cvt_pk_bf16_f32 v221, v94, v95
  v_mfma_f32_16x16x32_bf16 v[88:91], v[24:27], v[180:183], v[88:91]
  v_cvt_pk_bf16_f32 v122, v72, v73
  v_cvt_pk_bf16_f32 v123, v74, v75
  v_mfma_f32_16x16x32_bf16 v[92:95], v[60:63], v[168:171], 0
  v_cvt_pk_bf16_f32 v124, v76, v77
  v_cvt_pk_bf16_f32 v125, v78, v79
  v_mfma_f32_16x16x32_bf16 v[84:87], a[28:31], a[208:211], v[84:87]
  ds_read_b64_tr_b16 v[58:59], v254 offset:1664
  buffer_store_dwordx4 v[216:219], v236, s[8:11], s63 offen sc1
  v_mfma_f32_16x16x32_bf16 v[68:71], a[40:43], a[208:211], v[68:71]
  ds_read_b64_tr_b16 v[42:43], v254 offset:1600
  v_cvt_pk_bf16_f32 v216, v88, v89
  v_mfma_f32_16x16x32_bf16 v[72:75], a[48:51], a[204:207], 0
  v_cvt_pk_bf16_f32 v217, v90, v91
  v_cvt_pk_bf16_f32 v126, v80, v81
  v_mfma_f32_16x16x32_bf16 v[76:79], a[60:63], a[204:207], 0
  v_cvt_pk_bf16_f32 v127, v82, v83
  buffer_store_dwordx4 v[220:223], v236, s[8:11], s63 offen offset:64 sc1
  v_mfma_f32_16x16x32_bf16 v[92:95], v[64:67], v[172:175], v[92:95]
  ds_read_b64_tr_b16 v[66:67], v254 offset:1672
  v_max3_f32 v12, v12, v96, v212
  v_mfma_f32_16x16x32_bf16 v[84:87], a[32:35], a[212:215], v[84:87]
  ds_read_b128 v[184:187], v238 offset:2304
  ds_read_b128 v[188:191], v238 offset:2368
  v_mfma_f32_16x16x32_bf16 v[68:71], a[44:47], a[212:215], v[68:71]
  ds_read_b32 v200, v239 offset:2304
  ds_read_b128 v[192:195], v238 offset:2432
  v_mfma_f32_16x16x32_bf16 v[72:75], a[52:55], a[208:211], v[72:75]
  v_cvt_pk_bf16_f32 v226, v92, v93
  v_cvt_pk_bf16_f32 v227, v94, v95
  v_mfma_f32_16x16x32_bf16 v[76:79], a[64:67], a[208:211], v[76:79]
  v_cvt_pk_bf16_f32 v128, v84, v85
  v_cvt_pk_bf16_f32 v129, v86, v87
  v_mfma_f32_16x16x32_bf16 v[88:91], v[44:47], v[176:179], 0
  v_cvt_pk_bf16_f32 v130, v68, v69
  v_cvt_pk_bf16_f32 v131, v70, v71
  v_mfma_f32_16x16x32_bf16 v[72:75], a[56:59], a[212:215], v[72:75]
  buffer_store_dwordx4 v[224:227], v236, s[8:11], s63 offen offset:128 sc1
  ds_read_b32 v196, v240 offset:2880
  v_mfma_f32_16x16x32_bf16 v[76:79], a[68:71], a[212:215], v[76:79]
  v_xor_b32 v253, 48, v230
  ds_read_b128 a[240:243], v248 offset:11520
  v_mfma_f32_16x16x32_bf16 v[88:91], v[48:51], v[180:183], v[88:91]
  ds_read_b64_tr_b16 v[26:27], v253 offset:2304
  ds_read_b128 a[244:247], v248 offset:11584
  v_mfma_f32_16x16x32_bf16 v[144:147], v[124:127], a[228:231], 0
  v_cvt_pk_bf16_f32 v132, v72, v73
  v_cvt_pk_bf16_f32 v133, v74, v75
  v_mfma_f32_16x16x32_bf16 v[92:95], v[28:31], v[176:179], 0
  v_cvt_pk_bf16_f32 v134, v76, v77
  v_cvt_pk_bf16_f32 v135, v78, v79
  v_mfma_f32_16x16x32_bf16 v[140:143], v[116:119], a[232:235], v[140:143]
  v_cvt_pk_bf16_f32 v222, v88, v89
  v_cvt_pk_bf16_f32 v223, v90, v91
  v_mfma_f32_16x16x32_bf16 v[144:147], v[128:131], a[232:235], v[144:147]
  s_waitcnt lgkmcnt(4)
  v_mul_f32 v200, s59, v200
  v_mul_f32 v136, v136, v184
  v_mfma_f32_16x16x32_bf16 v[92:95], v[32:35], v[180:183], v[92:95]
  v_mul_f32 v137, v137, v185
  v_mul_f32 v138, v138, v186
  v_mfma_f32_16x16x32_bf16 v[140:143], v[120:123], a[236:239], v[140:143]
  v_mul_f32 v139, v139, v187
  v_mul_f32 v136, v136, v200
  v_mfma_f32_16x16x32_bf16 v[144:147], v[132:135], a[236:239], v[144:147]
  v_mul_f32 v137, v137, v200
  v_mul_f32 v138, v138, v200
  v_mfma_f32_16x16x32_bf16 v[88:91], a[180:183], a[72:75], 0
  v_cvt_pk_bf16_f32 v218, v92, v93
  v_cvt_pk_bf16_f32 v219, v94, v95
  v_mfma_f32_16x16x32_bf16 v[88:91], a[184:187], a[76:79], v[88:91]
  v_mul_f32 v140, v140, v188
  v_mul_f32 v141, v141, v189
  v_mfma_f32_16x16x32_bf16 v[92:95], v[52:55], v[176:179], 0
  v_mul_f32 v142, v142, v190
  v_mul_f32 v143, v143, v191
  v_mfma_f32_16x16x32_bf16 v[88:91], a[188:191], a[80:83], v[88:91]
  v_mul_f32 v139, v139, v200
  v_mul_f32 v140, v140, v200
  v_mfma_f32_16x16x32_bf16 v[92:95], v[56:59], v[180:183], v[92:95]
  v_mul_f32 v141, v141, v200
  v_mul_f32 v142, v142, v200
  v_mfma_f32_16x16x32_bf16 v[96:99], v[36:39], v[176:179], 0
  v_mul_f32 v143, v143, v200
  v_mul_f32 v144, v144, v192
  v_mfma_f32_16x16x32_bf16 v[96:99], v[40:43], v[180:183], v[96:99]
  v_cvt_pk_bf16_f32 v20, v88, v89
  v_cvt_pk_bf16_f32 v21, v90, v91
  v_mfma_f32_16x16x32_bf16 v[88:91], a[180:183], a[108:111], 0
  v_cvt_pk_bf16_f32 v224, v92, v93
  v_cvt_pk_bf16_f32 v225, v94, v95
  v_mfma_f32_16x16x32_bf16 v[92:95], a[180:183], a[84:87], 0
  v_mul_f32 v145, v145, v193
  v_mul_f32 v146, v146, v194
  v_mfma_f32_16x16x32_bf16 v[88:91], a[184:187], a[112:115], v[88:91]
  v_cvt_pk_bf16_f32 v220, v96, v97
  v_cvt_pk_bf16_f32 v221, v98, v99
  v_mfma_f32_16x16x32_bf16 v[92:95], a[184:187], a[88:91], v[92:95]
  v_mul_f32 v147, v147, v195
  s_waitcnt lgkmcnt(0)
  v_mul_f32 v148, v148, v196
  v_mfma_f32_16x16x32_bf16 v[88:91], a[188:191], a[116:119], v[88:91]
  v_exp_f32 v136, v136
  v_mfma_f32_16x16x32_bf16 v[96:99], v[60:63], v[176:179], 0
  v_exp_f32 v137, v137
  v_mfma_f32_16x16x32_bf16 v[92:95], a[188:191], a[92:95], v[92:95]
  v_exp_f32 v138, v138
  v_mfma_f32_16x16x32_bf16 v[96:99], v[64:67], v[180:183], v[96:99]
  v_exp_f32 v139, v139
  v_mfma_f32_16x16x32_bf16 v[152:155], v[100:103], a[240:243], 0
  v_cvt_pk_bf16_f32 v44, v88, v89
  v_cvt_pk_bf16_f32 v45, v90, v91
  v_mfma_f32_16x16x32_bf16 v[88:91], a[192:195], a[72:75], 0
  v_exp_f32 v140, v140
  v_mfma_f32_16x16x32_bf16 v[88:91], a[196:199], a[76:79], v[88:91]
  v_cvt_pk_bf16_f32 v28, v92, v93
  v_cvt_pk_bf16_f32 v29, v94, v95
  v_mfma_f32_16x16x32_bf16 v[92:95], a[180:183], a[120:123], 0
  v_cvt_pk_bf16_f32 v226, v96, v97
  v_cvt_pk_bf16_f32 v227, v98, v99
  v_mfma_f32_16x16x32_bf16 v[96:99], a[180:183], a[96:99], 0
  v_exp_f32 v141, v141
  v_mfma_f32_16x16x32_bf16 v[92:95], a[184:187], a[124:127], v[92:95]
  v_exp_f32 v142, v142
  v_mfma_f32_16x16x32_bf16 v[88:91], a[200:203], a[80:83], v[88:91]
  v_exp_f32 v143, v143
  v_mfma_f32_16x16x32_bf16 v[96:99], a[184:187], a[100:103], v[96:99]
  v_mul_f32 v144, v144, v200
  v_mul_f32 v145, v145, v200
  v_mfma_f32_16x16x32_bf16 v[92:95], a[188:191], a[128:131], v[92:95]
  v_mul_f32 v146, v146, v200
  v_mul_f32 v147, v147, v200
  v_mfma_f32_16x16x32_bf16 v[96:99], a[188:191], a[104:107], v[96:99]
  v_cvt_pk_bf16_f32 v22, v88, v89
  v_cvt_pk_bf16_f32 v23, v90, v91
  v_mfma_f32_16x16x32_bf16 v[88:91], a[192:195], a[108:111], 0
  v_mul_f32 v148, v148, v200
  v_exp_f32 v144, v144
  v_mfma_f32_16x16x32_bf16 v[88:91], a[196:199], a[112:115], v[88:91]
  v_cvt_pk_bf16_f32 v52, v92, v93
  v_cvt_pk_bf16_f32 v53, v94, v95
  v_mfma_f32_16x16x32_bf16 v[92:95], a[192:195], a[84:87], 0
  v_cvt_pk_bf16_f32 v36, v96, v97
  v_cvt_pk_bf16_f32 v37, v98, v99
  v_mfma_f32_16x16x32_bf16 v[96:99], a[180:183], a[132:135], 0
  v_exp_f32 v145, v145
  v_mfma_f32_16x16x32_bf16 v[92:95], a[196:199], a[88:91], v[92:95]
  v_exp_f32 v146, v146
  v_mfma_f32_16x16x32_bf16 v[88:91], a[200:203], a[116:119], v[88:91]
  v_exp_f32 v147, v147
  v_mfma_f32_16x16x32_bf16 v[96:99], a[184:187], a[136:139], v[96:99]
  v_exp_f32 v148, v148
  v_mfma_f32_16x16x32_bf16 v[92:95], a[200:203], a[92:95], v[92:95]
  v_cvt_pk_bf16_f32 v4, v136, v137
  v_cvt_pk_bf16_f32 v5, v138, v139
  v_mfma_f32_16x16x32_bf16 v[96:99], a[188:191], a[140:143], v[96:99]
  v_cvt_pk_bf16_f32 v6, v140, v141
  v_cvt_pk_bf16_f32 v46, v88, v89
  v_mfma_f32_16x16x32_bf16 v[156:159], v[112:115], a[240:243], 0
  v_cvt_pk_bf16_f32 v47, v90, v91
  v_cvt_pk_bf16_f32 v7, v142, v143
  v_mfma_f32_16x16x32_bf16 v[88:91], a[204:207], a[72:75], 0
  v_cvt_pk_bf16_f32 v30, v92, v93
  v_cvt_pk_bf16_f32 v31, v94, v95
  v_mfma_f32_16x16x32_bf16 v[92:95], a[192:195], a[120:123], 0
  v_cvt_pk_bf16_f32 v60, v96, v97
  v_cvt_pk_bf16_f32 v61, v98, v99
  v_mfma_f32_16x16x32_bf16 v[88:91], a[208:211], a[76:79], v[88:91]
  ds_read_b128 a[248:251], v248 offset:11648
  v_cvt_pk_bf16_f32 v8, v144, v145
  v_mfma_f32_16x16x32_bf16 v[96:99], a[192:195], a[96:99], 0
  v_cvt_pk_bf16_f32 v9, v146, v147
  v_cvt_pk_bf16_f32 v10, v148, v15
  v_mfma_f32_16x16x32_bf16 v[92:95], a[196:199], a[124:127], v[92:95]
  ds_read_b64_tr_b16 v[50:51], v253 offset:2376
  ds_read_b32 v208, v239 offset:2352
  v_mfma_f32_16x16x32_bf16 v[88:91], a[212:215], a[80:83], v[88:91]
  ds_read_b64_tr_b16 v[34:35], v253 offset:2312
  v_mul_f32 v136, v136, v184
  v_mfma_f32_16x16x32_bf16 v[96:99], a[196:199], a[100:103], v[96:99]
  v_mul_f32 v137, v137, v185
  v_mul_f32 v138, v138, v186
  v_mfma_f32_16x16x32_bf16 v[92:95], a[200:203], a[128:131], v[92:95]
  v_mul_f32 v139, v139, v187
  v_mul_f32 v140, v140, v188
  v_mfma_f32_16x16x32_bf16 v[96:99], a[200:203], a[104:107], v[96:99]
  v_cvt_pk_bf16_f32 v24, v88, v89
  v_cvt_pk_bf16_f32 v25, v90, v91
  v_mfma_f32_16x16x32_bf16 v[88:91], a[204:207], a[108:111], 0
  v_mul_f32 v141, v141, v189
  v_mul_f32 v142, v142, v190
  v_mfma_f32_16x16x32_bf16 v[88:91], a[208:211], a[112:115], v[88:91]
  v_cvt_pk_bf16_f32 v54, v92, v93
  v_cvt_pk_bf16_f32 v55, v94, v95
  v_mfma_f32_16x16x32_bf16 v[92:95], a[204:207], a[84:87], 0
  v_cvt_pk_bf16_f32 v38, v96, v97
  v_cvt_pk_bf16_f32 v39, v98, v99
  v_mfma_f32_16x16x32_bf16 v[96:99], a[192:195], a[132:135], 0
  v_mul_f32 v143, v143, v191
  v_mul_f32 v144, v144, v192
  v_mfma_f32_16x16x32_bf16 v[92:95], a[208:211], a[88:91], v[92:95]
  v_mul_f32 v145, v145, v193
  v_mul_f32 v146, v146, v194
  v_mfma_f32_16x16x32_bf16 v[88:91], a[212:215], a[116:119], v[88:91]
  v_mul_f32 v147, v147, v195
  v_mul_f32 v148, v148, v196
  v_mfma_f32_16x16x32_bf16 v[96:99], a[196:199], a[136:139], v[96:99]
  ds_read_b64_tr_b16 v[58:59], v253 offset:2432
  buffer_store_dwordx4 v[216:219], v237, s[8:11], s63 offen sc1
  v_mfma_f32_16x16x32_bf16 v[92:95], a[212:215], a[92:95], v[92:95]
  ds_read_b64_tr_b16 v[42:43], v253 offset:2368
  s_waitcnt lgkmcnt(2)
  v_mul_f32 v208, s59, v208
  v_mfma_f32_16x16x32_bf16 v[96:99], a[200:203], a[140:143], v[96:99]
  v_cvt_pk_bf16_f32 v48, v88, v89
  v_cvt_pk_bf16_f32 v49, v90, v91
  v_mfma_f32_16x16x32_bf16 v[88:91], v[16:19], v[4:7], 0
  v_xor_b32 v254, 48, v231
  ds_read_b128 a[228:231], v248 offset:20736
  v_mfma_f32_16x16x32_bf16 v[88:91], v[16:19], v[8:11], v[88:91]
  v_cvt_pk_bf16_f32 v32, v92, v93
  v_cvt_pk_bf16_f32 v33, v94, v95
  v_mfma_f32_16x16x32_bf16 v[92:95], a[204:207], a[120:123], 0
  v_cvt_pk_bf16_f32 v62, v96, v97
  v_cvt_pk_bf16_f32 v63, v98, v99
  v_mfma_f32_16x16x32_bf16 v[96:99], a[204:207], a[96:99], 0
  ds_read_b128 a[232:235], v248 offset:20800
  buffer_store_dwordx4 v[220:223], v237, s[8:11], s63 offen offset:64 sc1
  v_mfma_f32_16x16x32_bf16 v[92:95], a[208:211], a[124:127], v[92:95]
  v_rcp_f32 v204, v88
  v_mfma_f32_16x16x32_bf16 v[96:99], a[208:211], a[100:103], v[96:99]
  v_mul_f32 v136, v136, v204
  v_mul_f32 v137, v137, v204
  v_mfma_f32_16x16x32_bf16 v[92:95], a[212:215], a[128:131], v[92:95]
  v_mul_f32 v138, v138, v204
  v_mul_f32 v139, v139, v204
  v_mfma_f32_16x16x32_bf16 v[96:99], a[212:215], a[104:107], v[96:99]
  v_mul_f32 v140, v140, v204
  v_mul_f32 v141, v141, v204
  v_mfma_f32_16x16x32_bf16 v[152:155], v[104:107], a[244:247], v[152:155]
  v_mul_f32 v142, v142, v204
  v_mul_f32 v143, v143, v204
  v_mfma_f32_16x16x32_bf16 v[156:159], v[116:119], a[244:247], v[156:159]
  v_cvt_pk_bf16_f32 v168, v136, v137
  v_cvt_pk_bf16_f32 v169, v138, v139
  v_mfma_f32_16x16x32_bf16 v[160:163], v[124:127], a[240:243], 0
  v_cvt_pk_bf16_f32 v170, v140, v141
  v_cvt_pk_bf16_f32 v171, v142, v143
  v_mfma_f32_16x16x32_bf16 v[164:167], a[216:219], a[240:243], v[244:247]
  v_cvt_pk_bf16_f32 v56, v92, v93
  v_cvt_pk_bf16_f32 v57, v94, v95
  v_mfma_f32_16x16x32_bf16 v[92:95], v[20:23], v[168:171], 0
  v_mul_f32 v144, v144, v204
  v_mul_f32 v145, v145, v204
  v_mfma_f32_16x16x32_bf16 v[152:155], v[108:111], a[248:251], v[152:155]
  v_mul_f32 v146, v146, v204
  v_mul_f32 v147, v147, v204
  v_mfma_f32_16x16x32_bf16 v[156:159], v[120:123], a[248:251], v[156:159]
  v_fma_f32 v148, v148, v204, v242
  v_cvt_pk_bf16_f32 v40, v96, v97
  v_mfma_f32_16x16x32_bf16 v[160:163], v[128:131], a[244:247], v[160:163]
  v_cvt_pk_bf16_f32 v41, v98, v99
  v_cvt_pk_bf16_f32 v172, v144, v145
  v_mfma_f32_16x16x32_bf16 v[96:99], a[204:207], a[132:135], 0
  v_cvt_pk_bf16_f32 v173, v146, v147
  v_cvt_pk_bf16_f32 v174, v148, v243
  v_mfma_f32_16x16x32_bf16 v[96:99], a[208:211], a[136:139], v[96:99]
  v_mul_f32 v152, v152, v184
  v_mul_f32 v153, v153, v185
  v_mfma_f32_16x16x32_bf16 v[92:95], v[24:27], v[172:175], v[92:95]
  v_mul_f32 v154, v154, v186
  v_mul_f32 v155, v155, v187
  v_mfma_f32_16x16x32_bf16 v[164:167], a[220:223], a[244:247], v[164:167]
  v_mul_f32 v156, v156, v188
  v_mul_f32 v157, v157, v189
  v_mfma_f32_16x16x32_bf16 v[96:99], a[212:215], a[140:143], v[96:99]
  v_mul_f32 v158, v158, v190
  v_mul_f32 v159, v159, v191
  v_mfma_f32_16x16x32_bf16 v[160:163], v[132:135], a[248:251], v[160:163]
  v_cvt_pk_bf16_f32 v216, v92, v93
  v_cvt_pk_bf16_f32 v217, v94, v95
  v_mfma_f32_16x16x32_bf16 v[164:167], a[224:227], a[248:251], v[164:167]
  v_mul_f32 v152, v152, v208
  v_mul_f32 v153, v153, v208
  v_mfma_f32_16x16x32_bf16 v[92:95], v[44:47], v[168:171], 0
  v_cvt_pk_bf16_f32 v64, v96, v97
  v_cvt_pk_bf16_f32 v65, v98, v99
  v_mfma_f32_16x16x32_bf16 v[92:95], v[48:51], v[172:175], v[92:95]
  v_mul_f32 v154, v154, v208
  v_mul_f32 v155, v155, v208
  v_mfma_f32_16x16x32_bf16 v[96:99], v[28:31], v[168:171], 0
  v_mul_f32 v156, v156, v208
  v_mul_f32 v157, v157, v208
  v_mfma_f32_16x16x32_bf16 v[96:99], v[32:35], v[172:175], v[96:99]
  v_mul_f32 v158, v158, v208
  v_mul_f32 v159, v159, v208
  s_waitcnt lgkmcnt(0)
  v_mfma_f32_16x16x32_bf16 v[136:139], v[100:103], a[228:231], 0
  ds_read_b64_tr_b16 v[26:27], v254 offset:2304
  v_mul_f32 v160, v160, v192
  v_mfma_f32_16x16x32_bf16 v[140:143], v[112:115], a[228:231], 0
  v_mul_f32 v161, v161, v193
  v_mul_f32 v162, v162, v194
  v_mfma_f32_16x16x32_bf16 v[136:139], v[104:107], a[232:235], v[136:139]
  v_mul_f32 v163, v163, v195
  v_mul_f32 v164, v164, v196
  v_mfma_f32_16x16x32_bf16 v[140:143], v[116:119], a[232:235], v[140:143]
  v_exp_f32 v152, v152
  v_mfma_f32_16x16x32_bf16 v[144:147], v[124:127], a[228:231], 0
  v_exp_f32 v153, v153
  v_mfma_f32_16x16x32_bf16 v[148:151], a[216:219], a[228:231], v[244:247]
  v_exp_f32 v154, v154
  v_mfma_f32_16x16x32_bf16 v[144:147], v[128:131], a[232:235], v[144:147]
  v_exp_f32 v155, v155
  v_mfma_f32_16x16x32_bf16 v[148:151], a[220:223], a[232:235], v[148:151]
  v_exp_f32 v156, v156
  v_exp_f32 v157, v157
  v_exp_f32 v158, v158
  v_exp_f32 v159, v159
  v_mul_f32 v160, v160, v208
  v_mul_f32 v161, v161, v208
  v_mul_f32 v162, v162, v208
  v_mul_f32 v163, v163, v208
  v_mul_f32 v164, v164, v208
  v_exp_f32 v160, v160
  v_exp_f32 v161, v161
  v_exp_f32 v162, v162
  v_exp_f32 v163, v163
  v_exp_f32 v164, v164
  v_cvt_pk_bf16_f32 v4, v152, v153
  v_cvt_pk_bf16_f32 v5, v154, v155
  v_cvt_pk_bf16_f32 v6, v156, v157
  v_cvt_pk_bf16_f32 v7, v158, v159
  v_cvt_pk_bf16_f32 v222, v92, v93
  v_cvt_pk_bf16_f32 v223, v94, v95
  v_mfma_f32_16x16x32_bf16 v[92:95], v[16:19], v[4:7], 0
  ds_read_b128 a[236:239], v248 offset:20864
  ds_read_b64_tr_b16 v[66:67], v253 offset:2440
  v_cvt_pk_bf16_f32 v8, v160, v161
  v_cvt_pk_bf16_f32 v9, v162, v163
  v_cvt_pk_bf16_f32 v10, v164, v15
  v_cvt_pk_bf16_f32 v218, v96, v97
  v_cvt_pk_bf16_f32 v219, v98, v99
  v_mfma_f32_16x16x32_bf16 v[92:95], v[16:19], v[8:11], v[92:95]
  ds_read_b64_tr_b16 v[50:51], v254 offset:2376
  ds_read_b32 v200, v239 offset:2400
  v_mfma_f32_16x16x32_bf16 v[96:99], v[52:55], v[168:171], 0
  v_max3_f32 v12, v12, v88, v204
  ds_read_b64_tr_b16 v[34:35], v254 offset:2312
  v_mfma_f32_16x16x32_bf16 v[96:99], v[56:59], v[172:175], v[96:99]
  v_mul_f32 v152, v152, v184
  v_mul_f32 v153, v153, v185
  v_mfma_f32_16x16x32_bf16 v[88:91], v[36:39], v[168:171], 0
  v_rcp_f32 v212, v92
  v_mfma_f32_16x16x32_bf16 v[88:91], v[40:43], v[172:175], v[88:91]
  v_mul_f32 v154, v154, v186
  v_mul_f32 v155, v155, v187
  v_mul_f32 v156, v156, v188
  v_mul_f32 v157, v157, v189
  v_mul_f32 v158, v158, v190
  v_mul_f32 v159, v159, v191
  v_mul_f32 v152, v152, v212
  s_waitcnt lgkmcnt(3)
  v_mfma_f32_16x16x32_bf16 v[136:139], v[108:111], a[236:239], v[136:139]
  v_mul_f32 v153, v153, v212
  v_mul_f32 v154, v154, v212
  v_mfma_f32_16x16x32_bf16 v[140:143], v[120:123], a[236:239], v[140:143]
  v_mul_f32 v155, v155, v212
  v_mul_f32 v156, v156, v212
  v_mfma_f32_16x16x32_bf16 v[144:147], v[132:135], a[236:239], v[144:147]
  v_mul_f32 v157, v157, v212
  v_mul_f32 v158, v158, v212
  v_mfma_f32_16x16x32_bf16 v[148:151], a[224:227], a[236:239], v[148:151]
  v_mul_f32 v159, v159, v212
  buffer_store_dwordx4 v[224:227], v237, s[8:11], s63 offen offset:128 sc1
  v_mul_f32 v160, v160, v192
  v_mul_f32 v161, v161, v193
  v_mul_f32 v162, v162, v194
  v_mul_f32 v163, v163, v195
  v_mul_f32 v164, v164, v196
  v_cvt_pk_bf16_f32 v176, v152, v153
  v_cvt_pk_bf16_f32 v177, v154, v155
  v_cvt_pk_bf16_f32 v178, v156, v157
  v_cvt_pk_bf16_f32 v179, v158, v159
  v_cvt_pk_bf16_f32 v224, v96, v97
  v_cvt_pk_bf16_f32 v225, v98, v99
  v_mfma_f32_16x16x32_bf16 v[96:99], v[20:23], v[176:179], 0
  v_mul_f32 v160, v160, v212
  v_mul_f32 v161, v161, v212
  v_mul_f32 v162, v162, v212
  v_mul_f32 v163, v163, v212
  v_fma_f32 v164, v164, v212, v242
  v_cvt_pk_bf16_f32 v180, v160, v161
  v_cvt_pk_bf16_f32 v181, v162, v163
  v_cvt_pk_bf16_f32 v182, v164, v243
  ds_read_b64_tr_b16 v[42:43], v254 offset:2368
  v_cvt_pk_bf16_f32 v220, v88, v89
  v_mfma_f32_16x16x32_bf16 v[96:99], v[24:27], v[180:183], v[96:99]
  v_cvt_pk_bf16_f32 v221, v90, v91
  ds_read_b64_tr_b16 v[58:59], v254 offset:2432
  v_mfma_f32_16x16x32_bf16 v[88:91], v[60:63], v[168:171], 0
  buffer_store_dwordx4 v[216:219], v234, s[8:11], s64 offen sc1
  s_waitcnt lgkmcnt(2)
  v_mul_f32 v200, s59, v200
  v_mfma_f32_16x16x32_bf16 v[88:91], v[64:67], v[172:175], v[88:91]
  ds_read_b64_tr_b16 v[66:67], v254 offset:2440
  v_mul_f32 v136, v136, v184
  v_cvt_pk_bf16_f32 v216, v96, v97
  v_cvt_pk_bf16_f32 v217, v98, v99
  v_mfma_f32_16x16x32_bf16 v[96:99], v[44:47], v[176:179], 0
  v_mul_f32 v137, v137, v185
  v_mul_f32 v138, v138, v186
  v_mfma_f32_16x16x32_bf16 v[96:99], v[48:51], v[180:183], v[96:99]
  v_mul_f32 v139, v139, v187
  v_mul_f32 v140, v140, v188
  v_mul_f32 v141, v141, v189
  v_mul_f32 v142, v142, v190
  v_mul_f32 v143, v143, v191
  v_xor_b32 v251, 48, v229
  v_cvt_pk_bf16_f32 v226, v88, v89
  v_cvt_pk_bf16_f32 v227, v90, v91
  v_mfma_f32_16x16x32_bf16 v[88:91], v[28:31], v[176:179], 0
  v_xor_b32 v253, 48, v232
  v_mul_f32 v136, v136, v200
  v_mfma_f32_16x16x32_bf16 v[88:91], v[32:35], v[180:183], v[88:91]
  v_mul_f32 v137, v137, v200
  v_mul_f32 v138, v138, v200
  v_mul_f32 v139, v139, v200
  v_mul_f32 v140, v140, v200
  v_mul_f32 v141, v141, v200
  v_mul_f32 v142, v142, v200
  v_mul_f32 v143, v143, v200
  ds_read_b128 a[240:243], v251 offset:2304
  ds_read_b64_tr_b16 v[26:27], v253 offset:2304
  v_mul_f32 v144, v144, v192
  v_mul_f32 v145, v145, v193
  v_mul_f32 v146, v146, v194
  v_mul_f32 v147, v147, v195
  v_mul_f32 v148, v148, v196
  v_exp_f32 v136, v136
  v_exp_f32 v137, v137
  v_exp_f32 v138, v138
  v_exp_f32 v139, v139
  v_exp_f32 v140, v140
  v_exp_f32 v141, v141
  v_exp_f32 v142, v142
  v_exp_f32 v143, v143
  v_mul_f32 v144, v144, v200
  v_mul_f32 v145, v145, v200
  v_mul_f32 v146, v146, v200
  v_mul_f32 v147, v147, v200
  v_mul_f32 v148, v148, v200
  ds_read_b128 a[244:247], v251 offset:2368
  buffer_store_dwordx4 v[220:223], v234, s[8:11], s64 offen offset:64 sc1
  v_exp_f32 v144, v144
  s_waitcnt lgkmcnt(1)
  v_mfma_f32_16x16x32_bf16 v[152:155], v[100:103], a[240:243], 0
  v_exp_f32 v145, v145
  v_mfma_f32_16x16x32_bf16 v[156:159], v[112:115], a[240:243], 0
  v_exp_f32 v146, v146
  v_mfma_f32_16x16x32_bf16 v[160:163], v[124:127], a[240:243], 0
  v_exp_f32 v147, v147
  v_mfma_f32_16x16x32_bf16 v[164:167], a[216:219], a[240:243], v[244:247]
  v_exp_f32 v148, v148
  v_cvt_pk_bf16_f32 v4, v136, v137
  v_cvt_pk_bf16_f32 v5, v138, v139
  v_cvt_pk_bf16_f32 v6, v140, v141
  v_cvt_pk_bf16_f32 v7, v142, v143
  v_cvt_pk_bf16_f32 v222, v96, v97
  v_cvt_pk_bf16_f32 v223, v98, v99
  v_mfma_f32_16x16x32_bf16 v[96:99], v[16:19], v[4:7], 0
  ds_read_b128 a[248:251], v251 offset:2432
  v_max3_f32 v12, v12, v92, v212
  v_mfma_f32_16x16x32_bf16 v[92:95], v[36:39], v[176:179], 0
  v_cvt_pk_bf16_f32 v8, v144, v145
  v_cvt_pk_bf16_f32 v9, v146, v147
  v_mfma_f32_16x16x32_bf16 v[92:95], v[40:43], v[180:183], v[92:95]
  v_cvt_pk_bf16_f32 v10, v148, v15
  v_cvt_pk_bf16_f32 v218, v88, v89
  s_waitcnt lgkmcnt(1)
  v_mfma_f32_16x16x32_bf16 v[152:155], v[104:107], a[244:247], v[152:155]
  v_cvt_pk_bf16_f32 v219, v90, v91
  ds_read_b64_tr_b16 v[50:51], v253 offset:2376
  v_mfma_f32_16x16x32_bf16 v[96:99], v[16:19], v[8:11], v[96:99]
  ds_read_b32 v208, v13 offset:2304
  ds_read_b64_tr_b16 v[34:35], v253 offset:2312
  v_mfma_f32_16x16x32_bf16 v[88:91], v[52:55], v[176:179], 0
  ds_read_b64_tr_b16 v[42:43], v253 offset:2368
  v_cvt_pk_bf16_f32 v220, v92, v93
  v_mfma_f32_16x16x32_bf16 v[88:91], v[56:59], v[180:183], v[88:91]
  v_cvt_pk_bf16_f32 v221, v94, v95
  v_mul_f32 v136, v136, v184
  v_mfma_f32_16x16x32_bf16 v[92:95], v[60:63], v[176:179], 0
  v_rcp_f32 v204, v96
  v_mfma_f32_16x16x32_bf16 v[92:95], v[64:67], v[180:183], v[92:95]
  v_mul_f32 v137, v137, v185
  v_mul_f32 v138, v138, v186
  v_mfma_f32_16x16x32_bf16 v[156:159], v[116:119], a[244:247], v[156:159]
  v_mul_f32 v139, v139, v187
  v_mul_f32 v140, v140, v188
  s_waitcnt lgkmcnt(3)
  v_mfma_f32_16x16x32_bf16 v[152:155], v[108:111], a[248:251], v[152:155]
  v_mul_f32 v141, v141, v189
  v_mul_f32 v142, v142, v190
  v_mfma_f32_16x16x32_bf16 v[156:159], v[120:123], a[248:251], v[156:159]
  v_mul_f32 v143, v143, v191
  v_mul_f32 v136, v136, v204
  v_mfma_f32_16x16x32_bf16 v[160:163], v[128:131], a[244:247], v[160:163]
  v_mul_f32 v137, v137, v204
  v_mul_f32 v138, v138, v204
  v_mfma_f32_16x16x32_bf16 v[164:167], a[220:223], a[244:247], v[164:167]
  v_mul_f32 v139, v139, v204
  v_mul_f32 v140, v140, v204
  v_mfma_f32_16x16x32_bf16 v[160:163], v[132:135], a[248:251], v[160:163]
  v_mul_f32 v141, v141, v204
  v_mul_f32 v142, v142, v204
  v_mfma_f32_16x16x32_bf16 v[164:167], a[224:227], a[248:251], v[164:167]
  v_mul_f32 v143, v143, v204
  buffer_store_dwordx4 v[224:227], v234, s[8:11], s64 offen offset:128 sc1
  v_mul_f32 v144, v144, v192
  v_mul_f32 v145, v145, v193
  v_mul_f32 v146, v146, v194
  v_mul_f32 v147, v147, v195
  v_mul_f32 v148, v148, v196
  v_cvt_pk_bf16_f32 v168, v136, v137
  v_cvt_pk_bf16_f32 v169, v138, v139
  v_cvt_pk_bf16_f32 v170, v140, v141
  v_cvt_pk_bf16_f32 v171, v142, v143
  v_cvt_pk_bf16_f32 v224, v88, v89
  v_cvt_pk_bf16_f32 v225, v90, v91
  v_mfma_f32_16x16x32_bf16 v[88:91], v[20:23], v[168:171], 0
  v_mul_f32 v144, v144, v204
  v_mul_f32 v145, v145, v204
  v_mul_f32 v146, v146, v204
  v_mul_f32 v147, v147, v204
  v_fma_f32 v148, v148, v204, v242
  v_cvt_pk_bf16_f32 v172, v144, v145
  v_cvt_pk_bf16_f32 v173, v146, v147
  v_cvt_pk_bf16_f32 v174, v148, v243
  ds_read_b64_tr_b16 v[58:59], v253 offset:2432
  ds_read_b64_tr_b16 v[66:67], v253 offset:2440
  v_mfma_f32_16x16x32_bf16 v[88:91], v[24:27], v[172:175], v[88:91]
  buffer_store_dwordx4 v[216:219], v235, s[8:11], s64 offen sc1
  v_cvt_pk_bf16_f32 v226, v92, v93
  v_cvt_pk_bf16_f32 v227, v94, v95
  v_mfma_f32_16x16x32_bf16 v[92:95], v[28:31], v[168:171], 0
  v_max3_f32 v12, v12, v96, v204
  s_waitcnt lgkmcnt(2)
  v_mul_f32 v208, s59, v208
  v_mfma_f32_16x16x32_bf16 v[96:99], v[36:39], v[168:171], 0
  v_mul_f32 v152, v152, v184
  v_cvt_pk_bf16_f32 v216, v88, v89
  v_mfma_f32_16x16x32_bf16 v[92:95], v[32:35], v[172:175], v[92:95]
  v_cvt_pk_bf16_f32 v217, v90, v91
  v_mul_f32 v153, v153, v185
  v_mfma_f32_16x16x32_bf16 v[88:91], v[44:47], v[168:171], 0
  v_mul_f32 v154, v154, v186
  v_mul_f32 v155, v155, v187
  v_mfma_f32_16x16x32_bf16 v[88:91], v[48:51], v[172:175], v[88:91]
  v_mul_f32 v156, v156, v188
  v_mul_f32 v157, v157, v189
  v_mfma_f32_16x16x32_bf16 v[96:99], v[40:43], v[172:175], v[96:99]
  v_mul_f32 v158, v158, v190
  v_mul_f32 v159, v159, v191
  v_xor_b32 v254, 48, v233
  v_mul_f32 v152, v152, v208
  v_mul_f32 v153, v153, v208
  v_mul_f32 v154, v154, v208
  v_mul_f32 v155, v155, v208
  v_mul_f32 v156, v156, v208
  v_mul_f32 v157, v157, v208
  v_mul_f32 v158, v158, v208
  v_mul_f32 v159, v159, v208
  ds_read_b64_tr_b16 v[26:27], v254 offset:2304
  v_mul_f32 v160, v160, v192
  v_mul_f32 v161, v161, v193
  v_mul_f32 v162, v162, v194
  v_mul_f32 v163, v163, v195
  v_mul_f32 v164, v164, v196
  v_exp_f32 v152, v152
  v_exp_f32 v153, v153
  v_exp_f32 v154, v154
  v_exp_f32 v155, v155
  v_exp_f32 v156, v156
  v_exp_f32 v157, v157
  v_exp_f32 v158, v158
  v_exp_f32 v159, v159
  ds_read_b64_tr_b16 v[34:35], v254 offset:2312
  ds_read_b64_tr_b16 v[42:43], v254 offset:2368
  v_mul_f32 v160, v160, v208
  v_mul_f32 v161, v161, v208
  v_mul_f32 v162, v162, v208
  v_mul_f32 v163, v163, v208
  v_mul_f32 v164, v164, v208
  buffer_store_dwordx4 v[220:223], v235, s[8:11], s64 offen offset:64 sc1
  v_exp_f32 v160, v160
  v_exp_f32 v161, v161
  v_exp_f32 v162, v162
  v_exp_f32 v163, v163
  v_exp_f32 v164, v164
  v_cvt_pk_bf16_f32 v4, v152, v153
  v_cvt_pk_bf16_f32 v5, v154, v155
  v_cvt_pk_bf16_f32 v6, v156, v157
  v_cvt_pk_bf16_f32 v7, v158, v159
  v_cvt_pk_bf16_f32 v222, v88, v89
  v_cvt_pk_bf16_f32 v223, v90, v91
  v_mfma_f32_16x16x32_bf16 v[88:91], v[16:19], v[4:7], 0
  v_cvt_pk_bf16_f32 v218, v92, v93
  v_cvt_pk_bf16_f32 v219, v94, v95
  v_mfma_f32_16x16x32_bf16 v[92:95], v[52:55], v[168:171], 0
  v_cvt_pk_bf16_f32 v220, v96, v97
  v_cvt_pk_bf16_f32 v221, v98, v99
  v_mfma_f32_16x16x32_bf16 v[96:99], v[60:63], v[168:171], 0
  v_cvt_pk_bf16_f32 v8, v160, v161
  v_cvt_pk_bf16_f32 v9, v162, v163
  s_waitcnt lgkmcnt(0)
  v_mfma_f32_16x16x32_bf16 v[92:95], v[56:59], v[172:175], v[92:95]
  v_cvt_pk_bf16_f32 v10, v164, v15
  ds_read_b64_tr_b16 v[50:51], v254 offset:2376
  v_mfma_f32_16x16x32_bf16 v[96:99], v[64:67], v[172:175], v[96:99]
  ds_read_b64_tr_b16 v[58:59], v254 offset:2432
  ds_read_b64_tr_b16 v[66:67], v254 offset:2440
  v_mfma_f32_16x16x32_bf16 v[88:91], v[16:19], v[8:11], v[88:91]
  v_mul_f32 v152, v152, v184
  v_mul_f32 v153, v153, v185
  v_mul_f32 v154, v154, v186
  v_mul_f32 v155, v155, v187
  v_mul_f32 v156, v156, v188
  v_mul_f32 v157, v157, v189
  v_mul_f32 v158, v158, v190
  v_mul_f32 v159, v159, v191
  v_rcp_f32 v212, v88
  buffer_store_dwordx4 v[224:227], v235, s[8:11], s64 offen offset:128 sc1
  v_mul_f32 v152, v152, v212
  v_mul_f32 v153, v153, v212
  v_mul_f32 v154, v154, v212
  v_mul_f32 v155, v155, v212
  v_mul_f32 v156, v156, v212
  v_mul_f32 v157, v157, v212
  v_mul_f32 v158, v158, v212
  v_mul_f32 v159, v159, v212
  v_mul_f32 v160, v160, v192
  v_mul_f32 v161, v161, v193
  v_mul_f32 v162, v162, v194
  v_mul_f32 v163, v163, v195
  v_mul_f32 v164, v164, v196
  v_cvt_pk_bf16_f32 v176, v152, v153
  v_cvt_pk_bf16_f32 v177, v154, v155
  v_cvt_pk_bf16_f32 v178, v156, v157
  v_cvt_pk_bf16_f32 v179, v158, v159
  v_cvt_pk_bf16_f32 v224, v92, v93
  v_cvt_pk_bf16_f32 v225, v94, v95
  v_mfma_f32_16x16x32_bf16 v[92:95], v[20:23], v[176:179], 0
  v_mul_f32 v160, v160, v212
  v_mul_f32 v161, v161, v212
  v_mul_f32 v162, v162, v212
  v_mul_f32 v163, v163, v212
  v_fma_f32 v164, v164, v212, v242
  v_cvt_pk_bf16_f32 v226, v96, v97
  v_cvt_pk_bf16_f32 v227, v98, v99
  v_mfma_f32_16x16x32_bf16 v[96:99], v[28:31], v[176:179], 0
  v_max3_f32 v12, v12, v88, v212
  v_cvt_pk_bf16_f32 v180, v160, v161
  v_mfma_f32_16x16x32_bf16 v[88:91], v[36:39], v[176:179], 0
  v_cvt_pk_bf16_f32 v181, v162, v163
  v_cvt_pk_bf16_f32 v182, v164, v243
  buffer_store_dwordx4 v[216:219], v236, s[8:11], s64 offen sc1
  buffer_store_dwordx4 v[220:223], v236, s[8:11], s64 offen offset:64 sc1
  v_mfma_f32_16x16x32_bf16 v[92:95], v[24:27], v[180:183], v[92:95]
  buffer_store_dwordx4 v[224:227], v236, s[8:11], s64 offen offset:128 sc1
  s_mov_b32 s65, 0x5d800000
  v_mfma_f32_16x16x32_bf16 v[96:99], v[32:35], v[180:183], v[96:99]
  v_cmp_lt_f32_e64 s[82:83], s65, v12
  v_mfma_f32_16x16x32_bf16 v[88:91], v[40:43], v[180:183], v[88:91]
  s_nop 2
  v_cvt_pk_bf16_f32 v216, v92, v93
  v_cvt_pk_bf16_f32 v217, v94, v95
  v_mfma_f32_16x16x32_bf16 v[92:95], v[44:47], v[176:179], 0
  v_cvt_pk_bf16_f32 v218, v96, v97
  v_cvt_pk_bf16_f32 v219, v98, v99
  v_mfma_f32_16x16x32_bf16 v[96:99], v[52:55], v[176:179], 0
  v_cvt_pk_bf16_f32 v220, v88, v89
  v_cvt_pk_bf16_f32 v221, v90, v91
  v_mfma_f32_16x16x32_bf16 v[88:91], v[60:63], v[176:179], 0
  buffer_store_dwordx4 v[216:219], v237, s[8:11], s64 offen sc1
  s_waitcnt lgkmcnt(0)
  v_mfma_f32_16x16x32_bf16 v[92:95], v[48:51], v[180:183], v[92:95]
  v_mfma_f32_16x16x32_bf16 v[96:99], v[56:59], v[180:183], v[96:99]
  v_mfma_f32_16x16x32_bf16 v[88:91], v[64:67], v[180:183], v[88:91]
  s_nop 5
  v_cvt_pk_bf16_f32 v222, v92, v93
  v_cvt_pk_bf16_f32 v223, v94, v95
  v_cvt_pk_bf16_f32 v224, v96, v97
  v_cvt_pk_bf16_f32 v225, v98, v99
  v_cvt_pk_bf16_f32 v226, v88, v89
  v_cvt_pk_bf16_f32 v227, v90, v91
  buffer_store_dwordx4 v[220:223], v237, s[8:11], s64 offen offset:64 sc1
  buffer_store_dwordx4 v[224:227], v237, s[8:11], s64 offen offset:128 sc1
  s_nop 4
  s_cmp_lg_u64 s[82:83], 0
  s_cbranch_scc1 L_FB
  s_endpgm
L_END:
  s_endpgm
L_FB:
  s_waitcnt vmcnt(0) lgkmcnt(0)
  ds_read_b128 a[144:147], v228
  ds_read_b128 a[148:151], v228 offset:64
  ds_read_b128 a[152:155], v228 offset:128
  ds_read_b128 a[156:159], v228 offset:12288
  ds_read_b128 a[160:163], v228 offset:12352
  ds_read_b128 a[164:167], v228 offset:12416
  ds_read_b128 a[168:171], v228 offset:24576
  ds_read_b128 a[172:175], v228 offset:24640
  ds_read_b128 a[176:179], v228 offset:24704
  ds_read_b128 a[216:219], v250
  ds_read_b128 a[228:231], v228
  ds_read_b128 a[220:223], v250 offset:64
  ds_read_b128 a[232:235], v228 offset:64
  ds_read_b128 a[224:227], v250 offset:128
  ds_read_b128 a[236:239], v228 offset:128
  ds_read_b128 v[184:187], v238
  ds_read_b128 v[188:191], v238 offset:64
  ds_read_b128 v[192:195], v238 offset:128
  ds_read_b32 v196, v240 offset:576
  ds_read_b32 v200, v239
  ds_read_b128 a[240:243], v228 offset:9216
  ds_read_b128 a[244:247], v228 offset:9280
  ds_read_b128 a[248:251], v228 offset:9344
  ds_read_b64_tr_b16 v[26:27], v230
  ds_read_b32 v208, v239 offset:48
  ds_read_b64_tr_b16 v[50:51], v230 offset:72
  ds_read_b64_tr_b16 v[34:35], v230 offset:8
  ds_read_b64_tr_b16 v[58:59], v230 offset:128
  ds_read_b64_tr_b16 v[42:43], v230 offset:64
  ds_read_b64_tr_b16 v[66:67], v230 offset:136
  s_waitcnt lgkmcnt(15)
  v_mfma_f32_16x16x32_bf16 v[80:83], a[0:3], a[144:147], 0
  v_mfma_f32_16x16x32_bf16 v[80:83], a[4:7], a[148:151], v[80:83]
  v_mfma_f32_16x16x32_bf16 v[84:87], a[12:15], a[144:147], 0
  v_mfma_f32_16x16x32_bf16 v[68:71], a[24:27], a[144:147], 0
  v_mfma_f32_16x16x32_bf16 v[80:83], a[8:11], a[152:155], v[80:83]
  s_waitcnt lgkmcnt(10)
  v_mul_f32 v200, s59, v200
  v_mfma_f32_16x16x32_bf16 v[84:87], a[16:19], a[148:151], v[84:87]
  v_mfma_f32_16x16x32_bf16 v[68:71], a[28:31], a[148:151], v[68:71]
  s_waitcnt lgkmcnt(5)
  v_mul_f32 v208, s59, v208
  v_mfma_f32_16x16x32_bf16 v[84:87], a[20:23], a[152:155], v[84:87]
  v_mfma_f32_16x16x32_bf16 v[68:71], a[32:35], a[152:155], v[68:71]
  v_mfma_f32_16x16x32_bf16 v[72:75], a[36:39], a[144:147], 0
  v_cvt_pk_bf16_f32 v100, v80, v81
  v_mfma_f32_16x16x32_bf16 v[72:75], a[40:43], a[148:151], v[72:75]
  v_cvt_pk_bf16_f32 v101, v82, v83
  v_mfma_f32_16x16x32_bf16 v[76:79], a[48:51], a[144:147], 0
  s_nop 1
  v_cvt_pk_bf16_f32 v102, v84, v85
  v_mfma_f32_16x16x32_bf16 v[80:83], a[60:63], a[144:147], 0
  v_cvt_pk_bf16_f32 v103, v86, v87
  v_cvt_pk_bf16_f32 v104, v68, v69
  v_mfma_f32_16x16x32_bf16 v[72:75], a[44:47], a[152:155], v[72:75]
  v_cvt_pk_bf16_f32 v105, v70, v71
  v_mfma_f32_16x16x32_bf16 v[76:79], a[52:55], a[148:151], v[76:79]
  v_mfma_f32_16x16x32_bf16 v[80:83], a[64:67], a[148:151], v[80:83]
  v_mfma_f32_16x16x32_bf16 v[84:87], a[0:3], a[156:159], 0
  v_mfma_f32_16x16x32_bf16 v[68:71], a[12:15], a[156:159], 0
  v_mfma_f32_16x16x32_bf16 v[76:79], a[56:59], a[152:155], v[76:79]
  v_mfma_f32_16x16x32_bf16 v[80:83], a[68:71], a[152:155], v[80:83]
  s_nop 0
  v_cvt_pk_bf16_f32 v106, v72, v73
  v_mfma_f32_16x16x32_bf16 v[84:87], a[4:7], a[160:163], v[84:87]
  v_cvt_pk_bf16_f32 v107, v74, v75
  v_mfma_f32_16x16x32_bf16 v[68:71], a[16:19], a[160:163], v[68:71]
  v_mfma_f32_16x16x32_bf16 v[84:87], a[8:11], a[164:167], v[84:87]
  s_nop 0
  v_cvt_pk_bf16_f32 v108, v76, v77
  v_mfma_f32_16x16x32_bf16 v[68:71], a[20:23], a[164:167], v[68:71]
  v_cvt_pk_bf16_f32 v109, v78, v79
  v_cvt_pk_bf16_f32 v110, v80, v81
  v_mfma_f32_16x16x32_bf16 v[72:75], a[24:27], a[156:159], 0
  v_cvt_pk_bf16_f32 v111, v82, v83
  v_mfma_f32_16x16x32_bf16 v[72:75], a[28:31], a[160:163], v[72:75]
  v_cvt_pk_bf16_f32 v112, v84, v85
  v_cvt_pk_bf16_f32 v113, v86, v87
  v_mfma_f32_16x16x32_bf16 v[76:79], a[36:39], a[156:159], 0
  v_cvt_pk_bf16_f32 v114, v68, v69
  v_cvt_pk_bf16_f32 v115, v70, v71
  v_mfma_f32_16x16x32_bf16 v[80:83], a[48:51], a[156:159], 0
  v_mfma_f32_16x16x32_bf16 v[72:75], a[32:35], a[164:167], v[72:75]
  v_mfma_f32_16x16x32_bf16 v[76:79], a[40:43], a[160:163], v[76:79]
  v_mfma_f32_16x16x32_bf16 v[80:83], a[52:55], a[160:163], v[80:83]
  v_mfma_f32_16x16x32_bf16 v[84:87], a[60:63], a[156:159], 0
  v_mfma_f32_16x16x32_bf16 v[68:71], a[0:3], a[168:171], 0
  v_mfma_f32_16x16x32_bf16 v[76:79], a[44:47], a[164:167], v[76:79]
  v_mfma_f32_16x16x32_bf16 v[80:83], a[56:59], a[164:167], v[80:83]
  v_mfma_f32_16x16x32_bf16 v[84:87], a[64:67], a[160:163], v[84:87]
  s_nop 0
  v_cvt_pk_bf16_f32 v116, v72, v73
  v_mfma_f32_16x16x32_bf16 v[68:71], a[4:7], a[172:175], v[68:71]
  v_cvt_pk_bf16_f32 v117, v74, v75
  v_mfma_f32_16x16x32_bf16 v[84:87], a[68:71], a[164:167], v[84:87]
  s_nop 0
  v_cvt_pk_bf16_f32 v118, v76, v77
  v_mfma_f32_16x16x32_bf16 v[68:71], a[8:11], a[176:179], v[68:71]
  v_cvt_pk_bf16_f32 v119, v78, v79
  v_cvt_pk_bf16_f32 v120, v80, v81
  v_mfma_f32_16x16x32_bf16 v[72:75], a[12:15], a[168:171], 0
  v_cvt_pk_bf16_f32 v121, v82, v83
  v_mfma_f32_16x16x32_bf16 v[72:75], a[16:19], a[172:175], v[72:75]
  v_cvt_pk_bf16_f32 v122, v84, v85
  v_cvt_pk_bf16_f32 v123, v86, v87
  v_mfma_f32_16x16x32_bf16 v[76:79], a[24:27], a[168:171], 0
  v_cvt_pk_bf16_f32 v124, v68, v69
  v_cvt_pk_bf16_f32 v125, v70, v71
  v_mfma_f32_16x16x32_bf16 v[80:83], a[36:39], a[168:171], 0
  v_xor_b32 v249, 16, v228
  ds_read_b128 a[180:183], v249 offset:768
  v_mfma_f32_16x16x32_bf16 v[72:75], a[20:23], a[176:179], v[72:75]
  ds_read_b128 a[184:187], v249 offset:832
  ds_read_b128 a[188:191], v249 offset:896
  v_mfma_f32_16x16x32_bf16 v[76:79], a[28:31], a[172:175], v[76:79]
  ds_read_b128 a[192:195], v249 offset:13056
  v_mfma_f32_16x16x32_bf16 v[80:83], a[40:43], a[172:175], v[80:83]
  v_mfma_f32_16x16x32_bf16 v[84:87], a[48:51], a[168:171], 0
  v_mfma_f32_16x16x32_bf16 v[68:71], a[60:63], a[168:171], 0
  s_nop 0
  v_cvt_pk_bf16_f32 v126, v72, v73
  v_mfma_f32_16x16x32_bf16 v[76:79], a[32:35], a[176:179], v[76:79]
  v_cvt_pk_bf16_f32 v127, v74, v75
  ds_read_b128 a[196:199], v249 offset:13120
  v_mfma_f32_16x16x32_bf16 v[80:83], a[44:47], a[176:179], v[80:83]
  ds_read_b128 a[200:203], v249 offset:13184
  ds_read_b128 a[204:207], v249 offset:25344
  v_mfma_f32_16x16x32_bf16 v[84:87], a[52:55], a[172:175], v[84:87]
  ds_read_b128 a[208:211], v249 offset:25408
  ds_read_b128 a[212:215], v249 offset:25472
  v_mfma_f32_16x16x32_bf16 v[68:71], a[64:67], a[172:175], v[68:71]
  v_cvt_pk_bf16_f32 v128, v76, v77
  v_cvt_pk_bf16_f32 v129, v78, v79
  v_mfma_f32_16x16x32_bf16 v[84:87], a[56:59], a[176:179], v[84:87]
  v_cvt_pk_bf16_f32 v130, v80, v81
  v_cvt_pk_bf16_f32 v131, v82, v83
  v_mfma_f32_16x16x32_bf16 v[68:71], a[68:71], a[176:179], v[68:71]
  v_mfma_f32_16x16x32_bf16 v[136:139], v[100:103], a[228:231], 0
  v_mfma_f32_16x16x32_bf16 v[140:143], v[112:115], a[228:231], 0
  v_mfma_f32_16x16x32_bf16 v[144:147], v[124:127], a[228:231], 0
  v_mfma_f32_16x16x32_bf16 v[148:151], a[216:219], a[228:231], v[244:247]
  ds_read_b128 a[228:231], v228 offset:18432
  v_cvt_pk_bf16_f32 v132, v84, v85
  v_mfma_f32_16x16x32_bf16 v[136:139], v[104:107], a[232:235], v[136:139]
  v_cvt_pk_bf16_f32 v133, v86, v87
  v_cvt_pk_bf16_f32 v134, v68, v69
  v_mfma_f32_16x16x32_bf16 v[140:143], v[116:119], a[232:235], v[140:143]
  v_cvt_pk_bf16_f32 v135, v70, v71
  v_mfma_f32_16x16x32_bf16 v[144:147], v[128:131], a[232:235], v[144:147]
  v_mfma_f32_16x16x32_bf16 v[148:151], a[220:223], a[232:235], v[148:151]
  ds_read_b128 a[232:235], v228 offset:18496
  v_mfma_f32_16x16x32_bf16 v[136:139], v[108:111], a[236:239], v[136:139]
  v_mfma_f32_16x16x32_bf16 v[140:143], v[120:123], a[236:239], v[140:143]
  v_mfma_f32_16x16x32_bf16 v[144:147], v[132:135], a[236:239], v[144:147]
  v_mfma_f32_16x16x32_bf16 v[148:151], a[224:227], a[236:239], v[148:151]
  ds_read_b128 a[236:239], v228 offset:18560
  v_mfma_f32_16x16x32_bf16 v[92:95], a[144:147], a[72:75], 0
  v_mfma_f32_16x16x32_bf16 v[92:95], a[148:151], a[76:79], v[92:95]
  v_mfma_f32_16x16x32_bf16 v[92:95], a[152:155], a[80:83], v[92:95]
  s_nop 0
  v_mul_f32 v136, v136, v184
  v_mfma_f32_16x16x32_bf16 v[96:99], a[144:147], a[84:87], 0
  v_mul_f32 v137, v137, v185
  v_mul_f32 v138, v138, v186
  v_mfma_f32_16x16x32_bf16 v[96:99], a[148:151], a[88:91], v[96:99]
  v_mul_f32 v139, v139, v187
  v_mul_f32 v140, v140, v188
  v_mfma_f32_16x16x32_bf16 v[96:99], a[152:155], a[92:95], v[96:99]
  v_cvt_pk_bf16_f32 v20, v92, v93
  v_cvt_pk_bf16_f32 v21, v94, v95
  v_mfma_f32_16x16x32_bf16 v[92:95], a[144:147], a[108:111], 0
  v_mul_f32 v141, v141, v189
  v_mul_f32 v142, v142, v190
  v_mfma_f32_16x16x32_bf16 v[92:95], a[148:151], a[112:115], v[92:95]
  v_mul_f32 v143, v143, v191
  v_mul_f32 v144, v144, v192
  v_mfma_f32_16x16x32_bf16 v[92:95], a[152:155], a[116:119], v[92:95]
  v_cvt_pk_bf16_f32 v28, v96, v97
  v_cvt_pk_bf16_f32 v29, v98, v99
  v_mfma_f32_16x16x32_bf16 v[96:99], a[144:147], a[120:123], 0
  v_mul_f32 v145, v145, v193
  v_mul_f32 v146, v146, v194
  v_mfma_f32_16x16x32_bf16 v[88:91], a[144:147], a[96:99], 0
  v_mul_f32 v147, v147, v195
  v_max3_f32 v201, v136, v137, v138
  v_mfma_f32_16x16x32_bf16 v[96:99], a[148:151], a[124:127], v[96:99]
  v_cvt_pk_bf16_f32 v44, v92, v93
  v_cvt_pk_bf16_f32 v45, v94, v95
  v_mfma_f32_16x16x32_bf16 v[92:95], a[156:159], a[72:75], 0
  v_max3_f32 v202, v139, v140, v141
  v_max3_f32 v203, v142, v143, v144
  v_mfma_f32_16x16x32_bf16 v[92:95], a[160:163], a[76:79], v[92:95]
  v_mul_f32 v148, v148, v196
  v_max3_f32 v204, v145, v146, v147
  v_mfma_f32_16x16x32_bf16 v[92:95], a[164:167], a[80:83], v[92:95]
  v_max3_f32 v201, v201, v202, v203
  v_max3_f32 v201, v201, v204, v148
  v_mfma_f32_16x16x32_bf16 v[88:91], a[148:151], a[100:103], v[88:91]
  v_mov_b32 v202, v201
  v_mfma_f32_16x16x32_bf16 v[96:99], a[152:155], a[128:131], v[96:99]
  s_nop 0
  v_permlane32_swap_b32 v201, v202
  v_mfma_f32_16x16x32_bf16 v[88:91], a[152:155], a[104:107], v[88:91]
  v_cvt_pk_bf16_f32 v22, v92, v93
  v_cvt_pk_bf16_f32 v23, v94, v95
  v_mfma_f32_16x16x32_bf16 v[92:95], a[156:159], a[108:111], 0
  v_max_f32 v201, v201, v202
  v_mov_b32 v202, v201
  v_mfma_f32_16x16x32_bf16 v[92:95], a[160:163], a[112:115], v[92:95]
  v_cvt_pk_bf16_f32 v52, v96, v97
  v_cvt_pk_bf16_f32 v53, v98, v99
  v_mfma_f32_16x16x32_bf16 v[96:99], a[156:159], a[84:87], 0
  v_cvt_pk_bf16_f32 v36, v88, v89
  v_cvt_pk_bf16_f32 v37, v90, v91
  v_mfma_f32_16x16x32_bf16 v[88:91], a[144:147], a[132:135], 0
  v_permlane16_swap_b32 v201, v202
  v_mfma_f32_16x16x32_bf16 v[96:99], a[160:163], a[88:91], v[96:99]
  v_max_f32 v201, v201, v202
  v_mul_f32_e64 v203, -v201, v200
  v_mfma_f32_16x16x32_bf16 v[92:95], a[164:167], a[116:119], v[92:95]
  v_fma_f32 v136, v136, v200, v203
  v_fma_f32 v137, v137, v200, v203
  v_mfma_f32_16x16x32_bf16 v[88:91], a[148:151], a[136:139], v[88:91]
  v_fma_f32 v138, v138, v200, v203
  v_fma_f32 v139, v139, v200, v203
  v_mfma_f32_16x16x32_bf16 v[96:99], a[164:167], a[92:95], v[96:99]
  v_fma_f32 v140, v140, v200, v203
  v_fma_f32 v141, v141, v200, v203
  v_mfma_f32_16x16x32_bf16 v[88:91], a[152:155], a[140:143], v[88:91]
  v_cvt_pk_bf16_f32 v46, v92, v93
  v_cvt_pk_bf16_f32 v47, v94, v95
  v_mfma_f32_16x16x32_bf16 v[92:95], a[168:171], a[72:75], 0
  v_fma_f32 v142, v142, v200, v203
  v_fma_f32 v143, v143, v200, v203
  v_mfma_f32_16x16x32_bf16 v[92:95], a[172:175], a[76:79], v[92:95]
  v_cvt_pk_bf16_f32 v30, v96, v97
  v_cvt_pk_bf16_f32 v31, v98, v99
  v_mfma_f32_16x16x32_bf16 v[96:99], a[156:159], a[120:123], 0
  v_cvt_pk_bf16_f32 v60, v88, v89
  v_cvt_pk_bf16_f32 v61, v90, v91
  v_mfma_f32_16x16x32_bf16 v[88:91], a[156:159], a[96:99], 0
  v_exp_f32 v136, v136
  v_mfma_f32_16x16x32_bf16 v[96:99], a[160:163], a[124:127], v[96:99]
  v_exp_f32 v137, v137
  v_mfma_f32_16x16x32_bf16 v[92:95], a[176:179], a[80:83], v[92:95]
  v_exp_f32 v138, v138
  v_mfma_f32_16x16x32_bf16 v[88:91], a[160:163], a[100:103], v[88:91]
  v_exp_f32 v139, v139
  v_mfma_f32_16x16x32_bf16 v[96:99], a[164:167], a[128:131], v[96:99]
  v_exp_f32 v140, v140
  v_mfma_f32_16x16x32_bf16 v[88:91], a[164:167], a[104:107], v[88:91]
  v_exp_f32 v141, v141
  v_mfma_f32_16x16x32_bf16 v[152:155], v[100:103], a[240:243], 0
  v_cvt_pk_bf16_f32 v24, v92, v93
  v_cvt_pk_bf16_f32 v25, v94, v95
  v_mfma_f32_16x16x32_bf16 v[92:95], a[168:171], a[108:111], 0
  v_exp_f32 v142, v142
  v_mfma_f32_16x16x32_bf16 v[92:95], a[172:175], a[112:115], v[92:95]
  v_cvt_pk_bf16_f32 v54, v96, v97
  v_cvt_pk_bf16_f32 v55, v98, v99
  v_mfma_f32_16x16x32_bf16 v[96:99], a[168:171], a[84:87], 0
  v_cvt_pk_bf16_f32 v38, v88, v89
  v_cvt_pk_bf16_f32 v39, v90, v91
  v_mfma_f32_16x16x32_bf16 v[88:91], a[156:159], a[132:135], 0
  v_exp_f32 v143, v143
  v_mfma_f32_16x16x32_bf16 v[96:99], a[172:175], a[88:91], v[96:99]
  v_fma_f32 v144, v144, v200, v203
  v_fma_f32 v145, v145, v200, v203
  v_mfma_f32_16x16x32_bf16 v[92:95], a[176:179], a[116:119], v[92:95]
  v_fma_f32 v146, v146, v200, v203
  v_fma_f32 v147, v147, v200, v203
  v_mfma_f32_16x16x32_bf16 v[88:91], a[160:163], a[136:139], v[88:91]
  v_fma_f32 v148, v148, v200, v203
  v_exp_f32 v144, v144
  v_mfma_f32_16x16x32_bf16 v[96:99], a[176:179], a[92:95], v[96:99]
  v_exp_f32 v145, v145
  v_mfma_f32_16x16x32_bf16 v[88:91], a[164:167], a[140:143], v[88:91]
  v_exp_f32 v146, v146
  v_mfma_f32_16x16x32_bf16 v[156:159], v[112:115], a[240:243], 0
  v_exp_f32 v147, v147
  v_mfma_f32_16x16x32_bf16 v[160:163], v[124:127], a[240:243], 0
  v_exp_f32 v148, v148
  v_mfma_f32_16x16x32_bf16 v[152:155], v[104:107], a[244:247], v[152:155]
  v_cvt_pk_bf16_f32 v4, v136, v137
  v_cvt_pk_bf16_f32 v5, v138, v139
  v_mfma_f32_16x16x32_bf16 v[156:159], v[116:119], a[244:247], v[156:159]
  v_cvt_pk_bf16_f32 v6, v140, v141
  v_cvt_pk_bf16_f32 v7, v142, v143
  v_mfma_f32_16x16x32_bf16 v[160:163], v[128:131], a[244:247], v[160:163]
  v_cvt_pk_bf16_f32 v48, v92, v93
  v_cvt_pk_bf16_f32 v49, v94, v95
  v_mfma_f32_16x16x32_bf16 v[92:95], v[16:19], v[4:7], 0
  v_cvt_pk_bf16_f32 v32, v96, v97
  v_cvt_pk_bf16_f32 v33, v98, v99
  v_mfma_f32_16x16x32_bf16 v[96:99], a[168:171], a[120:123], 0
  v_cvt_pk_bf16_f32 v8, v144, v145
  v_cvt_pk_bf16_f32 v9, v146, v147
  v_mfma_f32_16x16x32_bf16 v[164:167], a[216:219], a[240:243], v[244:247]
  v_cvt_pk_bf16_f32 v10, v148, v15
  v_cvt_pk_bf16_f32 v62, v88, v89
  v_mfma_f32_16x16x32_bf16 v[96:99], a[172:175], a[124:127], v[96:99]
  v_cvt_pk_bf16_f32 v63, v90, v91
  v_mul_f32 v136, v136, v184
  v_mfma_f32_16x16x32_bf16 v[92:95], v[16:19], v[8:11], v[92:95]
  v_mul_f32 v137, v137, v185
  v_mul_f32 v138, v138, v186
  v_mfma_f32_16x16x32_bf16 v[88:91], a[168:171], a[96:99], 0
  v_mul_f32 v139, v139, v187
  v_mul_f32 v140, v140, v188
  v_mfma_f32_16x16x32_bf16 v[152:155], v[108:111], a[248:251], v[152:155]
  v_mul_f32 v141, v141, v189
  v_mul_f32 v142, v142, v190
  v_mfma_f32_16x16x32_bf16 v[156:159], v[120:123], a[248:251], v[156:159]
  v_rcp_f32 v204, v92
  v_mfma_f32_16x16x32_bf16 v[160:163], v[132:135], a[248:251], v[160:163]
  v_mul_f32 v143, v143, v191
  v_mul_f32 v136, v136, v204
  v_mfma_f32_16x16x32_bf16 v[164:167], a[220:223], a[244:247], v[164:167]
  v_mul_f32 v137, v137, v204
  v_mul_f32 v138, v138, v204
  v_mfma_f32_16x16x32_bf16 v[88:91], a[172:175], a[100:103], v[88:91]
  v_mul_f32 v139, v139, v204
  v_mul_f32 v140, v140, v204
  v_mfma_f32_16x16x32_bf16 v[96:99], a[176:179], a[128:131], v[96:99]
  v_mul_f32 v141, v141, v204
  v_mul_f32 v142, v142, v204
  v_mfma_f32_16x16x32_bf16 v[164:167], a[224:227], a[248:251], v[164:167]
  v_mul_f32 v143, v143, v204
  v_mul_f32 v152, v152, v184
  v_mfma_f32_16x16x32_bf16 v[88:91], a[176:179], a[104:107], v[88:91]
  v_mul_f32 v153, v153, v185
  v_mul_f32 v154, v154, v186
  s_waitcnt lgkmcnt(0)
  v_mfma_f32_16x16x32_bf16 v[72:75], a[0:3], a[180:183], 0
  v_mul_f32 v155, v155, v187
  v_mul_f32 v156, v156, v188
  v_mfma_f32_16x16x32_bf16 v[72:75], a[4:7], a[184:187], v[72:75]
  v_mul_f32 v157, v157, v189
  v_mul_f32 v158, v158, v190
  v_mfma_f32_16x16x32_bf16 v[76:79], a[12:15], a[180:183], 0
  v_mul_f32 v159, v159, v191
  v_mul_f32 v160, v160, v192
  v_mfma_f32_16x16x32_bf16 v[80:83], a[24:27], a[180:183], 0
  v_mul_f32 v144, v144, v192
  v_mul_f32 v145, v145, v193
  v_mfma_f32_16x16x32_bf16 v[72:75], a[8:11], a[188:191], v[72:75]
  v_mul_f32 v146, v146, v194
  v_mul_f32 v147, v147, v195
  v_mfma_f32_16x16x32_bf16 v[76:79], a[16:19], a[184:187], v[76:79]
  v_mul_f32 v148, v148, v196
  v_cvt_pk_bf16_f32 v168, v136, v137
  v_mfma_f32_16x16x32_bf16 v[80:83], a[28:31], a[184:187], v[80:83]
  v_cvt_pk_bf16_f32 v169, v138, v139
  v_cvt_pk_bf16_f32 v170, v140, v141
  v_mfma_f32_16x16x32_bf16 v[136:139], v[100:103], a[228:231], 0
  v_cvt_pk_bf16_f32 v171, v142, v143
  v_mul_f32 v161, v161, v193
  v_mfma_f32_16x16x32_bf16 v[140:143], v[112:115], a[228:231], 0
  v_mul_f32 v162, v162, v194
  v_mul_f32 v163, v163, v195
  v_mfma_f32_16x16x32_bf16 v[136:139], v[104:107], a[232:235], v[136:139]
  v_max3_f32 v209, v152, v153, v154
  v_max3_f32 v210, v155, v156, v157
  v_mfma_f32_16x16x32_bf16 v[140:143], v[116:119], a[232:235], v[140:143]
  v_max3_f32 v211, v158, v159, v160
  v_cvt_pk_bf16_f32 v56, v96, v97
  v_mfma_f32_16x16x32_bf16 v[136:139], v[108:111], a[236:239], v[136:139]
  v_cvt_pk_bf16_f32 v57, v98, v99
  v_mul_f32 v144, v144, v204
  v_mfma_f32_16x16x32_bf16 v[96:99], v[20:23], v[168:171], 0
  v_mul_f32 v145, v145, v204
  v_mul_f32 v146, v146, v204
  v_mfma_f32_16x16x32_bf16 v[140:143], v[120:123], a[236:239], v[140:143]
  v_mul_f32 v147, v147, v204
  v_fma_f32 v148, v148, v204, v242
  v_mfma_f32_16x16x32_bf16 v[92:95], v[36:39], v[168:171], 0
  v_mul_f32 v164, v164, v196
  v_max3_f32 v212, v161, v162, v163
  v_mfma_f32_16x16x32_bf16 v[76:79], a[20:23], a[188:191], v[76:79]
  v_max3_f32 v209, v209, v210, v211
  v_cvt_pk_bf16_f32 v40, v88, v89
  v_mfma_f32_16x16x32_bf16 v[80:83], a[32:35], a[188:191], v[80:83]
  v_cvt_pk_bf16_f32 v41, v90, v91
  v_cvt_pk_bf16_f32 v172, v144, v145
  v_mfma_f32_16x16x32_bf16 v[88:91], a[168:171], a[132:135], 0
  v_cvt_pk_bf16_f32 v173, v146, v147
  v_cvt_pk_bf16_f32 v174, v148, v243
  v_mfma_f32_16x16x32_bf16 v[88:91], a[172:175], a[136:139], v[88:91]
  v_max3_f32 v209, v209, v212, v164
  v_mov_b32 v210, v209
  v_mfma_f32_16x16x32_bf16 v[96:99], v[24:27], v[172:175], v[96:99]
  ds_read_b64_tr_b16 v[26:27], v231
  v_permlane32_swap_b32 v209, v210
  v_mfma_f32_16x16x32_bf16 v[88:91], a[176:179], a[140:143], v[88:91]
  v_max_f32 v209, v209, v210
  v_mov_b32 v210, v209
  v_mfma_f32_16x16x32_bf16 v[144:147], v[124:127], a[228:231], 0
  ds_read_b32 v200, v239 offset:96
  v_permlane16_swap_b32 v209, v210
  v_mfma_f32_16x16x32_bf16 v[144:147], v[128:131], a[232:235], v[144:147]
  v_cvt_pk_bf16_f32 v216, v96, v97
  v_cvt_pk_bf16_f32 v217, v98, v99
  v_mfma_f32_16x16x32_bf16 v[96:99], v[44:47], v[168:171], 0
  v_max_f32 v209, v209, v210
  v_mul_f32_e64 v211, -v209, v208
  v_mfma_f32_16x16x32_bf16 v[96:99], v[48:51], v[172:175], v[96:99]
  v_cvt_pk_bf16_f32 v64, v88, v89
  v_cvt_pk_bf16_f32 v65, v90, v91
  v_mfma_f32_16x16x32_bf16 v[88:91], v[28:31], v[168:171], 0
  v_fma_f32 v152, v152, v208, v211
  v_fma_f32 v153, v153, v208, v211
  v_mfma_f32_16x16x32_bf16 v[88:91], v[32:35], v[172:175], v[88:91]
  v_fma_f32 v154, v154, v208, v211
  v_fma_f32 v155, v155, v208, v211
  v_mfma_f32_16x16x32_bf16 v[148:151], a[216:219], a[228:231], v[244:247]
  v_fma_f32 v156, v156, v208, v211
  v_fma_f32 v157, v157, v208, v211
  v_mfma_f32_16x16x32_bf16 v[144:147], v[132:135], a[236:239], v[144:147]
  v_fma_f32 v158, v158, v208, v211
  v_fma_f32 v159, v159, v208, v211
  v_mfma_f32_16x16x32_bf16 v[148:151], a[220:223], a[232:235], v[148:151]
  v_exp_f32 v152, v152
  v_mfma_f32_16x16x32_bf16 v[148:151], a[224:227], a[236:239], v[148:151]
  v_exp_f32 v153, v153
  v_mfma_f32_16x16x32_bf16 v[92:95], v[40:43], v[172:175], v[92:95]
  v_exp_f32 v154, v154
  v_mfma_f32_16x16x32_bf16 v[84:87], a[36:39], a[180:183], 0
  v_exp_f32 v155, v155
  v_mfma_f32_16x16x32_bf16 v[84:87], a[40:43], a[184:187], v[84:87]
  v_exp_f32 v156, v156
  v_mfma_f32_16x16x32_bf16 v[68:71], a[48:51], a[180:183], 0
  v_exp_f32 v157, v157
  v_mfma_f32_16x16x32_bf16 v[84:87], a[44:47], a[188:191], v[84:87]
  v_exp_f32 v158, v158
  v_mfma_f32_16x16x32_bf16 v[68:71], a[52:55], a[184:187], v[68:71]
  v_exp_f32 v159, v159
  v_mfma_f32_16x16x32_bf16 v[68:71], a[56:59], a[188:191], v[68:71]
  v_fma_f32 v160, v160, v208, v211
  v_fma_f32 v161, v161, v208, v211
  v_fma_f32 v162, v162, v208, v211
  v_fma_f32 v163, v163, v208, v211
  v_fma_f32 v164, v164, v208, v211
  v_exp_f32 v160, v160
  v_exp_f32 v161, v161
  v_exp_f32 v162, v162
  v_exp_f32 v163, v163
  v_exp_f32 v164, v164
  v_cvt_pk_bf16_f32 v4, v152, v153
  v_cvt_pk_bf16_f32 v5, v154, v155
  v_cvt_pk_bf16_f32 v6, v156, v157
  v_cvt_pk_bf16_f32 v7, v158, v159
  v_cvt_pk_bf16_f32 v222, v96, v97
  v_cvt_pk_bf16_f32 v223, v98, v99
  v_mfma_f32_16x16x32_bf16 v[96:99], v[16:19], v[4:7], 0
  v_cvt_pk_bf16_f32 v8, v160, v161
  v_cvt_pk_bf16_f32 v9, v162, v163
  v_cvt_pk_bf16_f32 v10, v164, v15
  v_cvt_pk_bf16_f32 v218, v88, v89
  v_cvt_pk_bf16_f32 v219, v90, v91
  v_mfma_f32_16x16x32_bf16 v[96:99], v[16:19], v[8:11], v[96:99]
  ds_read_b64_tr_b16 v[50:51], v231 offset:72
  ds_read_b64_tr_b16 v[34:35], v231 offset:8
  v_mfma_f32_16x16x32_bf16 v[88:91], v[52:55], v[168:171], 0
  v_mul_f32 v152, v152, v184
  v_mul_f32 v153, v153, v185
  v_mfma_f32_16x16x32_bf16 v[88:91], v[56:59], v[172:175], v[88:91]
  v_mul_f32 v154, v154, v186
  v_mul_f32 v155, v155, v187
  v_rcp_f32 v212, v96
  v_mul_f32 v156, v156, v188
  v_mul_f32 v157, v157, v189
  v_mul_f32 v158, v158, v190
  v_mul_f32 v159, v159, v191
  v_mul_f32 v152, v152, v212
  v_mul_f32 v153, v153, v212
  v_mul_f32 v154, v154, v212
  v_mul_f32 v155, v155, v212
  v_mul_f32 v156, v156, v212
  v_mul_f32 v157, v157, v212
  v_mul_f32 v158, v158, v212
  v_mul_f32 v159, v159, v212
  v_mul_f32 v136, v136, v184
  v_mul_f32 v137, v137, v185
  v_mul_f32 v138, v138, v186
  v_mul_f32 v139, v139, v187
  v_mul_f32 v140, v140, v188
  v_mul_f32 v141, v141, v189
  v_mul_f32 v142, v142, v190
  v_mul_f32 v143, v143, v191
  v_mul_f32 v144, v144, v192
  v_mul_f32 v160, v160, v192
  v_mul_f32 v161, v161, v193
  v_mul_f32 v162, v162, v194
  v_mul_f32 v163, v163, v195
  v_mul_f32 v164, v164, v196
  v_cvt_pk_bf16_f32 v176, v152, v153
  v_cvt_pk_bf16_f32 v177, v154, v155
  v_cvt_pk_bf16_f32 v178, v156, v157
  v_cvt_pk_bf16_f32 v179, v158, v159
  v_mul_f32 v145, v145, v193
  v_mul_f32 v146, v146, v194
  v_mfma_f32_16x16x32_bf16 v[96:99], v[36:39], v[176:179], 0
  v_mul_f32 v147, v147, v195
  v_max3_f32 v201, v136, v137, v138
  v_max3_f32 v202, v139, v140, v141
  v_max3_f32 v203, v142, v143, v144
  ds_read_b128 a[240:243], v229
  v_cvt_pk_bf16_f32 v224, v88, v89
  v_cvt_pk_bf16_f32 v225, v90, v91
  v_mfma_f32_16x16x32_bf16 v[88:91], v[20:23], v[176:179], 0
  v_mul_f32 v160, v160, v212
  v_mul_f32 v161, v161, v212
  v_mul_f32 v162, v162, v212
  v_mul_f32 v163, v163, v212
  v_fma_f32 v164, v164, v212, v242
  v_mul_f32 v148, v148, v196
  v_max3_f32 v204, v145, v146, v147
  v_max3_f32 v201, v201, v202, v203
  v_cvt_pk_bf16_f32 v180, v160, v161
  v_cvt_pk_bf16_f32 v181, v162, v163
  v_cvt_pk_bf16_f32 v182, v164, v243
  v_max3_f32 v201, v201, v204, v148
  ds_read_b128 a[244:247], v229 offset:64
  s_waitcnt lgkmcnt(2)
  v_mfma_f32_16x16x32_bf16 v[88:91], v[24:27], v[180:183], v[88:91]
  v_mov_b32 v202, v201
  v_cvt_pk_bf16_f32 v220, v92, v93
  v_cvt_pk_bf16_f32 v221, v94, v95
  v_mfma_f32_16x16x32_bf16 v[92:95], v[60:63], v[168:171], 0
  v_permlane32_swap_b32 v201, v202
  v_mfma_f32_16x16x32_bf16 v[92:95], v[64:67], v[172:175], v[92:95]
  ds_read_b128 a[248:251], v229 offset:128
  ds_read_b64_tr_b16 v[58:59], v231 offset:128
  v_max_f32 v201, v201, v202
  s_waitcnt lgkmcnt(3)
  v_mfma_f32_16x16x32_bf16 v[152:155], v[100:103], a[240:243], 0
  buffer_store_dwordx4 v[216:219], v234, s[8:11], s61 offen sc1
  v_mov_b32 v202, v201
  v_mfma_f32_16x16x32_bf16 v[156:159], v[112:115], a[240:243], 0
  v_cvt_pk_bf16_f32 v216, v88, v89
  v_cvt_pk_bf16_f32 v217, v90, v91
  v_mfma_f32_16x16x32_bf16 v[88:91], v[44:47], v[176:179], 0
  v_permlane16_swap_b32 v201, v202
  v_mfma_f32_16x16x32_bf16 v[88:91], v[48:51], v[180:183], v[88:91]
  ds_read_b64_tr_b16 v[42:43], v231 offset:64
  v_mul_f32 v200, s59, v200
  v_mfma_f32_16x16x32_bf16 v[160:163], v[124:127], a[240:243], 0
  v_max_f32 v201, v201, v202
  v_mul_f32_e64 v203, -v201, v200
  s_waitcnt lgkmcnt(1)
  v_mfma_f32_16x16x32_bf16 v[152:155], v[104:107], a[244:247], v[152:155]
  v_cvt_pk_bf16_f32 v226, v92, v93
  v_cvt_pk_bf16_f32 v227, v94, v95
  v_mfma_f32_16x16x32_bf16 v[92:95], v[28:31], v[176:179], 0
  v_fma_f32 v136, v136, v200, v203
  v_fma_f32 v137, v137, v200, v203
  v_mfma_f32_16x16x32_bf16 v[92:95], v[32:35], v[180:183], v[92:95]
  v_fma_f32 v138, v138, v200, v203
  v_fma_f32 v139, v139, v200, v203
  v_mfma_f32_16x16x32_bf16 v[156:159], v[116:119], a[244:247], v[156:159]
  v_fma_f32 v140, v140, v200, v203
  v_fma_f32 v141, v141, v200, v203
  v_mfma_f32_16x16x32_bf16 v[160:163], v[128:131], a[244:247], v[160:163]
  v_fma_f32 v142, v142, v200, v203
  v_fma_f32 v143, v143, v200, v203
  v_mfma_f32_16x16x32_bf16 v[164:167], a[216:219], a[240:243], v[244:247]
  ds_read_b64_tr_b16 v[26:27], v232
  v_exp_f32 v136, v136
  v_mfma_f32_16x16x32_bf16 v[152:155], v[108:111], a[248:251], v[152:155]
  v_exp_f32 v137, v137
  v_mfma_f32_16x16x32_bf16 v[156:159], v[120:123], a[248:251], v[156:159]
  v_exp_f32 v138, v138
  v_mfma_f32_16x16x32_bf16 v[160:163], v[132:135], a[248:251], v[160:163]
  v_exp_f32 v139, v139
  v_mfma_f32_16x16x32_bf16 v[164:167], a[220:223], a[244:247], v[164:167]
  v_exp_f32 v140, v140
  v_mfma_f32_16x16x32_bf16 v[164:167], a[224:227], a[248:251], v[164:167]
  v_exp_f32 v141, v141
  s_waitcnt lgkmcnt(1)
  v_mfma_f32_16x16x32_bf16 v[96:99], v[40:43], v[180:183], v[96:99]
  v_exp_f32 v142, v142
  v_exp_f32 v143, v143
  v_fma_f32 v144, v144, v200, v203
  v_fma_f32 v145, v145, v200, v203
  v_fma_f32 v146, v146, v200, v203
  v_fma_f32 v147, v147, v200, v203
  v_fma_f32 v148, v148, v200, v203
  buffer_store_dwordx4 v[220:223], v234, s[8:11], s61 offen offset:64 sc1
  v_exp_f32 v144, v144
  v_exp_f32 v145, v145
  v_exp_f32 v146, v146
  v_exp_f32 v147, v147
  v_exp_f32 v148, v148
  v_cvt_pk_bf16_f32 v4, v136, v137
  v_cvt_pk_bf16_f32 v5, v138, v139
  v_cvt_pk_bf16_f32 v6, v140, v141
  v_cvt_pk_bf16_f32 v7, v142, v143
  v_cvt_pk_bf16_f32 v222, v88, v89
  v_cvt_pk_bf16_f32 v223, v90, v91
  v_mfma_f32_16x16x32_bf16 v[88:91], v[16:19], v[4:7], 0
  ds_read_b64_tr_b16 v[66:67], v231 offset:136
  v_cvt_pk_bf16_f32 v8, v144, v145
  v_cvt_pk_bf16_f32 v9, v146, v147
  v_cvt_pk_bf16_f32 v10, v148, v15
  v_cvt_pk_bf16_f32 v218, v92, v93
  v_cvt_pk_bf16_f32 v219, v94, v95
  v_mfma_f32_16x16x32_bf16 v[88:91], v[16:19], v[8:11], v[88:91]
  ds_read_b32 v208, v13
  ds_read_b64_tr_b16 v[50:51], v232 offset:72
  v_mfma_f32_16x16x32_bf16 v[92:95], v[52:55], v[176:179], 0
  ds_read_b64_tr_b16 v[34:35], v232 offset:8
  v_mul_f32 v136, v136, v184
  v_mfma_f32_16x16x32_bf16 v[92:95], v[56:59], v[180:183], v[92:95]
  v_mul_f32 v137, v137, v185
  v_mul_f32 v138, v138, v186
  v_rcp_f32 v204, v88
  v_mul_f32 v139, v139, v187
  v_mul_f32 v140, v140, v188
  v_mul_f32 v141, v141, v189
  v_mul_f32 v142, v142, v190
  v_mul_f32 v143, v143, v191
  v_mul_f32 v136, v136, v204
  v_mul_f32 v137, v137, v204
  v_mul_f32 v138, v138, v204
  v_mul_f32 v139, v139, v204
  v_mul_f32 v140, v140, v204
  v_mul_f32 v141, v141, v204
  v_mul_f32 v142, v142, v204
  v_mul_f32 v143, v143, v204
  v_mul_f32 v152, v152, v184
  v_mul_f32 v153, v153, v185
  v_mul_f32 v154, v154, v186
  v_mul_f32 v155, v155, v187
  v_mul_f32 v156, v156, v188
  v_mul_f32 v157, v157, v189
  v_mul_f32 v158, v158, v190
  v_mul_f32 v159, v159, v191
  v_mul_f32 v160, v160, v192
  buffer_store_dwordx4 v[224:227], v234, s[8:11], s61 offen offset:128 sc1
  v_mul_f32 v144, v144, v192
  v_mul_f32 v145, v145, v193
  v_mul_f32 v146, v146, v194
  v_mul_f32 v147, v147, v195
  v_mul_f32 v148, v148, v196
  v_cvt_pk_bf16_f32 v168, v136, v137
  v_cvt_pk_bf16_f32 v169, v138, v139
  v_cvt_pk_bf16_f32 v170, v140, v141
  v_cvt_pk_bf16_f32 v171, v142, v143
  v_mul_f32 v161, v161, v193
  v_mul_f32 v162, v162, v194
  v_mfma_f32_16x16x32_bf16 v[88:91], v[36:39], v[168:171], 0
  v_mul_f32 v163, v163, v195
  v_max3_f32 v209, v152, v153, v154
  v_max3_f32 v210, v155, v156, v157
  v_max3_f32 v211, v158, v159, v160
  v_cvt_pk_bf16_f32 v224, v92, v93
  v_cvt_pk_bf16_f32 v225, v94, v95
  v_mfma_f32_16x16x32_bf16 v[92:95], v[20:23], v[168:171], 0
  v_mul_f32 v144, v144, v204
  v_mul_f32 v145, v145, v204
  v_mul_f32 v146, v146, v204
  v_mul_f32 v147, v147, v204
  v_fma_f32 v148, v148, v204, v242
  v_mul_f32 v164, v164, v196
  v_max3_f32 v212, v161, v162, v163
  v_max3_f32 v209, v209, v210, v211
  v_cvt_pk_bf16_f32 v172, v144, v145
  v_cvt_pk_bf16_f32 v173, v146, v147
  v_cvt_pk_bf16_f32 v174, v148, v243
  v_max3_f32 v209, v209, v212, v164
  v_mov_b32 v210, v209
  s_waitcnt lgkmcnt(0)
  v_mfma_f32_16x16x32_bf16 v[92:95], v[24:27], v[172:175], v[92:95]
  v_cvt_pk_bf16_f32 v220, v96, v97
  v_cvt_pk_bf16_f32 v221, v98, v99
  v_mfma_f32_16x16x32_bf16 v[96:99], v[60:63], v[176:179], 0
  v_permlane32_swap_b32 v209, v210
  v_mfma_f32_16x16x32_bf16 v[96:99], v[64:67], v[180:183], v[96:99]
  ds_read_b64_tr_b16 v[58:59], v232 offset:128
  v_max_f32 v209, v209, v210
  buffer_store_dwordx4 v[216:219], v235, s[8:11], s61 offen sc1
  v_mov_b32 v210, v209
  ds_read_b64_tr_b16 v[42:43], v232 offset:64
  v_cvt_pk_bf16_f32 v216, v92, v93
  v_cvt_pk_bf16_f32 v217, v94, v95
  v_mfma_f32_16x16x32_bf16 v[92:95], v[44:47], v[168:171], 0
  v_permlane16_swap_b32 v209, v210
  v_mfma_f32_16x16x32_bf16 v[92:95], v[48:51], v[172:175], v[92:95]
  v_cvt_pk_bf16_f32 v100, v72, v73
  v_cvt_pk_bf16_f32 v101, v74, v75
  v_mfma_f32_16x16x32_bf16 v[72:75], a[60:63], a[180:183], 0
  v_mul_f32 v208, s59, v208
  v_max_f32 v209, v209, v210
  v_mfma_f32_16x16x32_bf16 v[72:75], a[64:67], a[184:187], v[72:75]
  v_mul_f32_e64 v211, -v209, v208
  v_cvt_pk_bf16_f32 v102, v76, v77
  v_mfma_f32_16x16x32_bf16 v[72:75], a[68:71], a[188:191], v[72:75]
  v_cvt_pk_bf16_f32 v103, v78, v79
  v_cvt_pk_bf16_f32 v104, v80, v81
  v_mfma_f32_16x16x32_bf16 v[76:79], a[0:3], a[192:195], 0
  v_cvt_pk_bf16_f32 v105, v82, v83
  v_cvt_pk_bf16_f32 v226, v96, v97
  v_mfma_f32_16x16x32_bf16 v[80:83], a[12:15], a[192:195], 0
  v_cvt_pk_bf16_f32 v227, v98, v99
  v_fma_f32 v152, v152, v208, v211
  v_mfma_f32_16x16x32_bf16 v[96:99], v[28:31], v[168:171], 0
  v_fma_f32 v153, v153, v208, v211
  v_fma_f32 v154, v154, v208, v211
  v_mfma_f32_16x16x32_bf16 v[76:79], a[4:7], a[196:199], v[76:79]
  v_fma_f32 v155, v155, v208, v211
  v_fma_f32 v156, v156, v208, v211
  v_mfma_f32_16x16x32_bf16 v[80:83], a[16:19], a[196:199], v[80:83]
  v_fma_f32 v157, v157, v208, v211
  v_fma_f32 v158, v158, v208, v211
  v_mfma_f32_16x16x32_bf16 v[96:99], v[32:35], v[172:175], v[96:99]
  v_fma_f32 v159, v159, v208, v211
  ds_read_b64_tr_b16 v[26:27], v233
  v_mfma_f32_16x16x32_bf16 v[76:79], a[8:11], a[200:203], v[76:79]
  v_exp_f32 v152, v152
  v_mfma_f32_16x16x32_bf16 v[80:83], a[20:23], a[200:203], v[80:83]
  v_exp_f32 v153, v153
  s_waitcnt lgkmcnt(1)
  v_mfma_f32_16x16x32_bf16 v[88:91], v[40:43], v[172:175], v[88:91]
  v_exp_f32 v154, v154
  v_exp_f32 v155, v155
  v_exp_f32 v156, v156
  v_exp_f32 v157, v157
  v_exp_f32 v158, v158
  v_exp_f32 v159, v159
  v_fma_f32 v160, v160, v208, v211
  v_fma_f32 v161, v161, v208, v211
  v_fma_f32 v162, v162, v208, v211
  v_fma_f32 v163, v163, v208, v211
  v_fma_f32 v164, v164, v208, v211
  buffer_store_dwordx4 v[220:223], v235, s[8:11], s61 offen offset:64 sc1
  v_exp_f32 v160, v160
  v_exp_f32 v161, v161
  v_exp_f32 v162, v162
  v_exp_f32 v163, v163
  v_exp_f32 v164, v164
  v_cvt_pk_bf16_f32 v4, v152, v153
  v_cvt_pk_bf16_f32 v5, v154, v155
  v_cvt_pk_bf16_f32 v6, v156, v157
  v_cvt_pk_bf16_f32 v7, v158, v159
  v_cvt_pk_bf16_f32 v222, v92, v93
  v_cvt_pk_bf16_f32 v223, v94, v95
  v_mfma_f32_16x16x32_bf16 v[92:95], v[16:19], v[4:7], 0
  ds_read_b64_tr_b16 v[66:67], v232 offset:136
  v_cvt_pk_bf16_f32 v106, v84, v85
  v_cvt_pk_bf16_f32 v107, v86, v87
  v_mfma_f32_16x16x32_bf16 v[84:87], a[24:27], a[192:195], 0
  v_cvt_pk_bf16_f32 v8, v160, v161
  v_cvt_pk_bf16_f32 v9, v162, v163
  v_mfma_f32_16x16x32_bf16 v[84:87], a[28:31], a[196:199], v[84:87]
  v_cvt_pk_bf16_f32 v10, v164, v15
  v_cvt_pk_bf16_f32 v108, v68, v69
  v_mfma_f32_16x16x32_bf16 v[84:87], a[32:35], a[200:203], v[84:87]
  v_cvt_pk_bf16_f32 v109, v70, v71
  v_cvt_pk_bf16_f32 v110, v72, v73
  v_mfma_f32_16x16x32_bf16 v[92:95], v[16:19], v[8:11], v[92:95]
  v_cvt_pk_bf16_f32 v111, v74, v75
  v_cvt_pk_bf16_f32 v218, v96, v97
  v_mfma_f32_16x16x32_bf16 v[68:71], a[36:39], a[192:195], 0
  v_cvt_pk_bf16_f32 v219, v98, v99
  ds_read_b64_tr_b16 v[50:51], v233 offset:72
  v_mfma_f32_16x16x32_bf16 v[72:75], a[48:51], a[192:195], 0
  ds_read_b128 a[216:219], v250 offset:192
  v_cvt_pk_bf16_f32 v112, v76, v77
  v_mfma_f32_16x16x32_bf16 v[96:99], v[52:55], v[168:171], 0
  v_cvt_pk_bf16_f32 v113, v78, v79
  v_cvt_pk_bf16_f32 v114, v80, v81
  v_mfma_f32_16x16x32_bf16 v[68:71], a[40:43], a[196:199], v[68:71]
  v_cvt_pk_bf16_f32 v115, v82, v83
  ds_read_b128 a[228:231], v249 offset:768
  v_mfma_f32_16x16x32_bf16 v[72:75], a[52:55], a[196:199], v[72:75]
  ds_read_b128 a[220:223], v250 offset:256
  ds_read_b128 a[232:235], v249 offset:832
  v_mfma_f32_16x16x32_bf16 v[76:79], a[60:63], a[192:195], 0
  v_rcp_f32 v212, v92
  v_mfma_f32_16x16x32_bf16 v[80:83], a[0:3], a[204:207], 0
  ds_read_b64_tr_b16 v[34:35], v233 offset:8
  v_mul_f32 v152, v152, v184
  v_mfma_f32_16x16x32_bf16 v[96:99], v[56:59], v[172:175], v[96:99]
  v_mul_f32 v153, v153, v185
  v_mul_f32 v154, v154, v186
  v_mfma_f32_16x16x32_bf16 v[68:71], a[44:47], a[200:203], v[68:71]
  v_mul_f32 v155, v155, v187
  v_mul_f32 v156, v156, v188
  v_mfma_f32_16x16x32_bf16 v[72:75], a[56:59], a[200:203], v[72:75]
  v_mul_f32 v157, v157, v189
  v_mul_f32 v158, v158, v190
  v_mfma_f32_16x16x32_bf16 v[76:79], a[64:67], a[196:199], v[76:79]
  v_mul_f32 v159, v159, v191
  ds_read_b128 a[224:227], v250 offset:320
  v_mfma_f32_16x16x32_bf16 v[80:83], a[4:7], a[208:211], v[80:83]
  ds_read_b128 a[236:239], v249 offset:896
  v_mul_f32 v152, v152, v212
  v_mfma_f32_16x16x32_bf16 v[76:79], a[68:71], a[200:203], v[76:79]
  v_mul_f32 v153, v153, v212
  v_mul_f32 v154, v154, v212
  v_mfma_f32_16x16x32_bf16 v[80:83], a[8:11], a[212:215], v[80:83]
  v_mul_f32 v155, v155, v212
  v_mul_f32 v156, v156, v212
  s_waitcnt lgkmcnt(2)
  v_mfma_f32_16x16x32_bf16 v[136:139], v[100:103], a[228:231], 0
  v_mul_f32 v157, v157, v212
  v_mul_f32 v158, v158, v212
  v_mfma_f32_16x16x32_bf16 v[140:143], v[112:115], a[228:231], 0
  v_mul_f32 v159, v159, v212
  buffer_store_dwordx4 v[224:227], v235, s[8:11], s61 offen offset:128 sc1
  v_mfma_f32_16x16x32_bf16 v[148:151], a[216:219], a[228:231], v[244:247]
  v_mul_f32 v160, v160, v192
  v_mul_f32 v161, v161, v193
  v_mfma_f32_16x16x32_bf16 v[136:139], v[104:107], a[232:235], v[136:139]
  v_mul_f32 v162, v162, v194
  v_mul_f32 v163, v163, v195
  v_mfma_f32_16x16x32_bf16 v[148:151], a[220:223], a[232:235], v[148:151]
  v_mul_f32 v164, v164, v196
  v_cvt_pk_bf16_f32 v176, v152, v153
  v_cvt_pk_bf16_f32 v177, v154, v155
  v_cvt_pk_bf16_f32 v178, v156, v157
  s_waitcnt lgkmcnt(0)
  v_mfma_f32_16x16x32_bf16 v[136:139], v[108:111], a[236:239], v[136:139]
  v_cvt_pk_bf16_f32 v179, v158, v159
  v_cvt_pk_bf16_f32 v116, v84, v85
  v_mfma_f32_16x16x32_bf16 v[148:151], a[224:227], a[236:239], v[148:151]
  v_cvt_pk_bf16_f32 v117, v86, v87
  v_cvt_pk_bf16_f32 v224, v96, v97
  v_mfma_f32_16x16x32_bf16 v[84:87], a[12:15], a[204:207], 0
  v_cvt_pk_bf16_f32 v225, v98, v99
  v_mul_f32 v160, v160, v212
  v_mfma_f32_16x16x32_bf16 v[96:99], v[20:23], v[176:179], 0
  v_mul_f32 v161, v161, v212
  v_mul_f32 v162, v162, v212
  v_mfma_f32_16x16x32_bf16 v[84:87], a[16:19], a[208:211], v[84:87]
  v_mul_f32 v163, v163, v212
  v_fma_f32 v164, v164, v212, v242
  v_mfma_f32_16x16x32_bf16 v[84:87], a[20:23], a[212:215], v[84:87]
  v_cvt_pk_bf16_f32 v180, v160, v161
  v_cvt_pk_bf16_f32 v181, v162, v163
  v_mfma_f32_16x16x32_bf16 v[92:95], v[36:39], v[176:179], 0
  v_cvt_pk_bf16_f32 v182, v164, v243
  v_cvt_pk_bf16_f32 v118, v68, v69
  v_cvt_pk_bf16_f32 v119, v70, v71
  v_mfma_f32_16x16x32_bf16 v[68:71], a[24:27], a[204:207], 0
  v_cvt_pk_bf16_f32 v120, v72, v73
  v_cvt_pk_bf16_f32 v121, v74, v75
  v_mfma_f32_16x16x32_bf16 v[72:75], a[36:39], a[204:207], 0
  v_cvt_pk_bf16_f32 v220, v88, v89
  v_cvt_pk_bf16_f32 v221, v90, v91
  v_mfma_f32_16x16x32_bf16 v[96:99], v[24:27], v[180:183], v[96:99]
  v_cvt_pk_bf16_f32 v122, v76, v77
  v_cvt_pk_bf16_f32 v123, v78, v79
  v_mfma_f32_16x16x32_bf16 v[88:91], v[60:63], v[168:171], 0
  v_cvt_pk_bf16_f32 v124, v80, v81
  v_cvt_pk_bf16_f32 v125, v82, v83
  v_mfma_f32_16x16x32_bf16 v[68:71], a[28:31], a[208:211], v[68:71]
  ds_read_b64_tr_b16 v[58:59], v233 offset:128
  buffer_store_dwordx4 v[216:219], v236, s[8:11], s61 offen sc1
  v_mfma_f32_16x16x32_bf16 v[72:75], a[40:43], a[208:211], v[72:75]
  ds_read_b64_tr_b16 v[42:43], v233 offset:64
  v_cvt_pk_bf16_f32 v216, v96, v97
  v_mfma_f32_16x16x32_bf16 v[76:79], a[48:51], a[204:207], 0
  v_cvt_pk_bf16_f32 v217, v98, v99
  v_cvt_pk_bf16_f32 v126, v84, v85
  v_mfma_f32_16x16x32_bf16 v[80:83], a[60:63], a[204:207], 0
  v_cvt_pk_bf16_f32 v127, v86, v87
  buffer_store_dwordx4 v[220:223], v236, s[8:11], s61 offen offset:64 sc1
  v_mfma_f32_16x16x32_bf16 v[88:91], v[64:67], v[172:175], v[88:91]
  ds_read_b64_tr_b16 v[66:67], v233 offset:136
  ds_read_b128 v[184:187], v238 offset:768
  v_mfma_f32_16x16x32_bf16 v[68:71], a[32:35], a[212:215], v[68:71]
  ds_read_b128 v[188:191], v238 offset:832
  ds_read_b128 v[192:195], v238 offset:896
  v_mfma_f32_16x16x32_bf16 v[72:75], a[44:47], a[212:215], v[72:75]
  ds_read_b32 v196, v240 offset:1344
  ds_read_b32 v200, v239 offset:768
  v_mfma_f32_16x16x32_bf16 v[76:79], a[52:55], a[208:211], v[76:79]
  v_cvt_pk_bf16_f32 v226, v88, v89
  v_cvt_pk_bf16_f32 v227, v90, v91
  v_mfma_f32_16x16x32_bf16 v[80:83], a[64:67], a[208:211], v[80:83]
  v_cvt_pk_bf16_f32 v128, v68, v69
  v_cvt_pk_bf16_f32 v129, v70, v71
  v_mfma_f32_16x16x32_bf16 v[96:99], v[44:47], v[176:179], 0
  v_cvt_pk_bf16_f32 v130, v72, v73
  v_cvt_pk_bf16_f32 v131, v74, v75
  v_mfma_f32_16x16x32_bf16 v[76:79], a[56:59], a[212:215], v[76:79]
  buffer_store_dwordx4 v[224:227], v236, s[8:11], s61 offen offset:128 sc1
  ds_read_b128 a[240:243], v249 offset:9984
  v_mfma_f32_16x16x32_bf16 v[80:83], a[68:71], a[212:215], v[80:83]
  ds_read_b128 a[244:247], v249 offset:10048
  ds_read_b128 a[248:251], v249 offset:10112
  v_mfma_f32_16x16x32_bf16 v[96:99], v[48:51], v[180:183], v[96:99]
  v_xor_b32 v253, 16, v230
  s_waitcnt lgkmcnt(3)
  v_mul_f32 v136, v136, v184
  v_mfma_f32_16x16x32_bf16 v[144:147], v[124:127], a[228:231], 0
  v_cvt_pk_bf16_f32 v132, v76, v77
  v_cvt_pk_bf16_f32 v133, v78, v79
  v_mfma_f32_16x16x32_bf16 v[88:91], v[28:31], v[176:179], 0
  v_cvt_pk_bf16_f32 v134, v80, v81
  v_cvt_pk_bf16_f32 v135, v82, v83
  v_mfma_f32_16x16x32_bf16 v[140:143], v[116:119], a[232:235], v[140:143]
  v_cvt_pk_bf16_f32 v222, v96, v97
  v_cvt_pk_bf16_f32 v223, v98, v99
  v_mfma_f32_16x16x32_bf16 v[144:147], v[128:131], a[232:235], v[144:147]
  v_mul_f32 v137, v137, v185
  v_mul_f32 v138, v138, v186
  v_mfma_f32_16x16x32_bf16 v[88:91], v[32:35], v[180:183], v[88:91]
  v_mul_f32 v139, v139, v187
  v_max3_f32 v201, v136, v137, v138
  v_mfma_f32_16x16x32_bf16 v[140:143], v[120:123], a[236:239], v[140:143]
  v_mul_f32 v148, v148, v196
  v_mul_f32 v200, s59, v200
  v_mfma_f32_16x16x32_bf16 v[144:147], v[132:135], a[236:239], v[144:147]
  ds_read_b64_tr_b16 v[26:27], v253 offset:768
  ds_read_b32 v208, v239 offset:816
  v_mfma_f32_16x16x32_bf16 v[96:99], a[180:183], a[72:75], 0
  v_cvt_pk_bf16_f32 v218, v88, v89
  v_cvt_pk_bf16_f32 v219, v90, v91
  v_mfma_f32_16x16x32_bf16 v[96:99], a[184:187], a[76:79], v[96:99]
  v_mul_f32 v140, v140, v188
  v_mul_f32 v141, v141, v189
  v_mfma_f32_16x16x32_bf16 v[88:91], v[52:55], v[176:179], 0
  v_mul_f32 v142, v142, v190
  v_mul_f32 v143, v143, v191
  v_mfma_f32_16x16x32_bf16 v[96:99], a[188:191], a[80:83], v[96:99]
  v_mul_f32 v144, v144, v192
  v_mul_f32 v145, v145, v193
  v_mfma_f32_16x16x32_bf16 v[88:91], v[56:59], v[180:183], v[88:91]
  v_mul_f32 v146, v146, v194
  v_mul_f32 v147, v147, v195
  v_mfma_f32_16x16x32_bf16 v[92:95], v[40:43], v[180:183], v[92:95]
  v_max3_f32 v202, v139, v140, v141
  v_max3_f32 v203, v142, v143, v144
  s_waitcnt lgkmcnt(1)
  v_mfma_f32_16x16x32_bf16 v[152:155], v[100:103], a[240:243], 0
  v_cvt_pk_bf16_f32 v20, v96, v97
  v_cvt_pk_bf16_f32 v21, v98, v99
  v_mfma_f32_16x16x32_bf16 v[96:99], a[180:183], a[108:111], 0
  v_cvt_pk_bf16_f32 v224, v88, v89
  v_cvt_pk_bf16_f32 v225, v90, v91
  v_mfma_f32_16x16x32_bf16 v[88:91], a[180:183], a[84:87], 0
  v_cvt_pk_bf16_f32 v220, v92, v93
  v_cvt_pk_bf16_f32 v221, v94, v95
  v_mfma_f32_16x16x32_bf16 v[96:99], a[184:187], a[112:115], v[96:99]
  v_max3_f32 v204, v145, v146, v147
  v_max3_f32 v201, v201, v202, v203
  v_mfma_f32_16x16x32_bf16 v[88:91], a[184:187], a[88:91], v[88:91]
  v_max3_f32 v201, v201, v204, v148
  v_mov_b32 v202, v201
  v_mfma_f32_16x16x32_bf16 v[96:99], a[188:191], a[116:119], v[96:99]
  ds_read_b64_tr_b16 v[50:51], v253 offset:840
  v_permlane32_swap_b32 v201, v202
  v_mfma_f32_16x16x32_bf16 v[92:95], v[60:63], v[176:179], 0
  v_max_f32 v201, v201, v202
  v_mov_b32 v202, v201
  v_mfma_f32_16x16x32_bf16 v[88:91], a[188:191], a[92:95], v[88:91]
  ds_read_b64_tr_b16 v[34:35], v253 offset:776
  v_permlane16_swap_b32 v201, v202
  v_mfma_f32_16x16x32_bf16 v[92:95], v[64:67], v[180:183], v[92:95]
  v_cvt_pk_bf16_f32 v44, v96, v97
  v_cvt_pk_bf16_f32 v45, v98, v99
  v_mfma_f32_16x16x32_bf16 v[96:99], a[192:195], a[72:75], 0
  v_max_f32 v201, v201, v202
  v_mul_f32_e64 v203, -v201, v200
  v_mfma_f32_16x16x32_bf16 v[96:99], a[196:199], a[76:79], v[96:99]
  v_cvt_pk_bf16_f32 v28, v88, v89
  v_cvt_pk_bf16_f32 v29, v90, v91
  v_mfma_f32_16x16x32_bf16 v[88:91], a[180:183], a[120:123], 0
  v_cvt_pk_bf16_f32 v226, v92, v93
  v_cvt_pk_bf16_f32 v227, v94, v95
  v_mfma_f32_16x16x32_bf16 v[92:95], a[180:183], a[96:99], 0
  v_fma_f32 v136, v136, v200, v203
  v_fma_f32 v137, v137, v200, v203
  v_mfma_f32_16x16x32_bf16 v[88:91], a[184:187], a[124:127], v[88:91]
  v_fma_f32 v138, v138, v200, v203
  v_fma_f32 v139, v139, v200, v203
  v_mfma_f32_16x16x32_bf16 v[96:99], a[200:203], a[80:83], v[96:99]
  v_fma_f32 v140, v140, v200, v203
  v_fma_f32 v141, v141, v200, v203
  v_mfma_f32_16x16x32_bf16 v[92:95], a[184:187], a[100:103], v[92:95]
  v_fma_f32 v142, v142, v200, v203
  v_fma_f32 v143, v143, v200, v203
  v_mfma_f32_16x16x32_bf16 v[88:91], a[188:191], a[128:131], v[88:91]
  v_exp_f32 v136, v136
  v_mfma_f32_16x16x32_bf16 v[92:95], a[188:191], a[104:107], v[92:95]
  v_cvt_pk_bf16_f32 v22, v96, v97
  v_cvt_pk_bf16_f32 v23, v98, v99
  v_mfma_f32_16x16x32_bf16 v[96:99], a[192:195], a[108:111], 0
  v_exp_f32 v137, v137
  v_mfma_f32_16x16x32_bf16 v[96:99], a[196:199], a[112:115], v[96:99]
  v_exp_f32 v138, v138
  v_mfma_f32_16x16x32_bf16 v[96:99], a[200:203], a[116:119], v[96:99]
  v_cvt_pk_bf16_f32 v52, v88, v89
  v_cvt_pk_bf16_f32 v53, v90, v91
  v_mfma_f32_16x16x32_bf16 v[88:91], a[192:195], a[84:87], 0
  v_cvt_pk_bf16_f32 v36, v92, v93
  v_cvt_pk_bf16_f32 v37, v94, v95
  v_mfma_f32_16x16x32_bf16 v[92:95], a[180:183], a[132:135], 0
  v_exp_f32 v139, v139
  v_mfma_f32_16x16x32_bf16 v[88:91], a[196:199], a[88:91], v[88:91]
  v_cvt_pk_bf16_f32 v46, v96, v97
  v_cvt_pk_bf16_f32 v47, v98, v99
  v_mfma_f32_16x16x32_bf16 v[92:95], a[184:187], a[136:139], v[92:95]
  v_exp_f32 v140, v140
  v_mfma_f32_16x16x32_bf16 v[88:91], a[200:203], a[92:95], v[88:91]
  v_exp_f32 v141, v141
  v_mfma_f32_16x16x32_bf16 v[92:95], a[188:191], a[140:143], v[92:95]
  v_exp_f32 v142, v142
  v_mfma_f32_16x16x32_bf16 v[96:99], a[204:207], a[72:75], 0
  v_exp_f32 v143, v143
  v_mfma_f32_16x16x32_bf16 v[96:99], a[208:211], a[76:79], v[96:99]
  v_fma_f32 v144, v144, v200, v203
  v_fma_f32 v145, v145, v200, v203
  v_mfma_f32_16x16x32_bf16 v[96:99], a[212:215], a[80:83], v[96:99]
  v_cvt_pk_bf16_f32 v30, v88, v89
  v_cvt_pk_bf16_f32 v31, v90, v91
  v_mfma_f32_16x16x32_bf16 v[88:91], a[192:195], a[120:123], 0
  v_cvt_pk_bf16_f32 v60, v92, v93
  v_cvt_pk_bf16_f32 v61, v94, v95
  v_mfma_f32_16x16x32_bf16 v[92:95], a[192:195], a[96:99], 0
  v_fma_f32 v146, v146, v200, v203
  v_fma_f32 v147, v147, v200, v203
  v_mfma_f32_16x16x32_bf16 v[88:91], a[196:199], a[124:127], v[88:91]
  v_cvt_pk_bf16_f32 v24, v96, v97
  v_cvt_pk_bf16_f32 v25, v98, v99
  v_mfma_f32_16x16x32_bf16 v[92:95], a[196:199], a[100:103], v[92:95]
  v_fma_f32 v148, v148, v200, v203
  v_exp_f32 v144, v144
  v_mfma_f32_16x16x32_bf16 v[88:91], a[200:203], a[128:131], v[88:91]
  v_exp_f32 v145, v145
  v_mfma_f32_16x16x32_bf16 v[92:95], a[200:203], a[104:107], v[92:95]
  v_exp_f32 v146, v146
  v_mfma_f32_16x16x32_bf16 v[96:99], a[204:207], a[108:111], 0
  v_exp_f32 v147, v147
  v_mfma_f32_16x16x32_bf16 v[96:99], a[208:211], a[112:115], v[96:99]
  v_exp_f32 v148, v148
  v_mfma_f32_16x16x32_bf16 v[96:99], a[212:215], a[116:119], v[96:99]
  v_cvt_pk_bf16_f32 v54, v88, v89
  v_cvt_pk_bf16_f32 v55, v90, v91
  v_mfma_f32_16x16x32_bf16 v[88:91], a[204:207], a[84:87], 0
  v_cvt_pk_bf16_f32 v38, v92, v93
  v_cvt_pk_bf16_f32 v39, v94, v95
  v_mfma_f32_16x16x32_bf16 v[92:95], a[192:195], a[132:135], 0
  v_cvt_pk_bf16_f32 v4, v136, v137
  v_cvt_pk_bf16_f32 v5, v138, v139
  v_mfma_f32_16x16x32_bf16 v[88:91], a[208:211], a[88:91], v[88:91]
  v_cvt_pk_bf16_f32 v6, v140, v141
  v_cvt_pk_bf16_f32 v7, v142, v143
  v_mfma_f32_16x16x32_bf16 v[92:95], a[196:199], a[136:139], v[92:95]
  v_cvt_pk_bf16_f32 v48, v96, v97
  v_cvt_pk_bf16_f32 v49, v98, v99
  v_mfma_f32_16x16x32_bf16 v[88:91], a[212:215], a[92:95], v[88:91]
  v_cvt_pk_bf16_f32 v8, v144, v145
  v_cvt_pk_bf16_f32 v9, v146, v147
  v_mfma_f32_16x16x32_bf16 v[92:95], a[200:203], a[140:143], v[92:95]
  v_cvt_pk_bf16_f32 v10, v148, v15
  v_mul_f32 v136, v136, v184
  v_mfma_f32_16x16x32_bf16 v[96:99], v[16:19], v[4:7], 0
  v_mul_f32 v137, v137, v185
  v_mul_f32 v138, v138, v186
  v_mfma_f32_16x16x32_bf16 v[156:159], v[112:115], a[240:243], 0
  v_cvt_pk_bf16_f32 v32, v88, v89
  v_cvt_pk_bf16_f32 v33, v90, v91
  v_mfma_f32_16x16x32_bf16 v[160:163], v[124:127], a[240:243], 0
  v_cvt_pk_bf16_f32 v62, v92, v93
  v_cvt_pk_bf16_f32 v63, v94, v95
  v_mfma_f32_16x16x32_bf16 v[88:91], a[204:207], a[120:123], 0
  v_mul_f32 v139, v139, v187
  v_mul_f32 v140, v140, v188
  v_mfma_f32_16x16x32_bf16 v[96:99], v[16:19], v[8:11], v[96:99]
  v_mul_f32 v141, v141, v189
  v_mul_f32 v142, v142, v190
  v_mfma_f32_16x16x32_bf16 v[152:155], v[104:107], a[244:247], v[152:155]
  v_mul_f32 v143, v143, v191
  v_mul_f32 v144, v144, v192
  v_mfma_f32_16x16x32_bf16 v[156:159], v[116:119], a[244:247], v[156:159]
  v_mul_f32 v145, v145, v193
  v_mul_f32 v146, v146, v194
  v_mfma_f32_16x16x32_bf16 v[160:163], v[128:131], a[244:247], v[160:163]
  v_rcp_f32 v204, v96
  v_mfma_f32_16x16x32_bf16 v[164:167], a[216:219], a[240:243], v[244:247]
  v_mul_f32 v136, v136, v204
  v_mul_f32 v137, v137, v204
  v_mfma_f32_16x16x32_bf16 v[92:95], a[204:207], a[96:99], 0
  v_mul_f32 v138, v138, v204
  v_mul_f32 v139, v139, v204
  v_mfma_f32_16x16x32_bf16 v[88:91], a[208:211], a[124:127], v[88:91]
  v_mul_f32 v140, v140, v204
  v_mul_f32 v141, v141, v204
  v_mfma_f32_16x16x32_bf16 v[152:155], v[108:111], a[248:251], v[152:155]
  v_mul_f32 v142, v142, v204
  v_mul_f32 v143, v143, v204
  v_mfma_f32_16x16x32_bf16 v[156:159], v[120:123], a[248:251], v[156:159]
  v_mul_f32 v147, v147, v195
  v_mul_f32 v148, v148, v196
  v_mfma_f32_16x16x32_bf16 v[160:163], v[132:135], a[248:251], v[160:163]
  v_cvt_pk_bf16_f32 v168, v136, v137
  v_cvt_pk_bf16_f32 v169, v138, v139
  v_mfma_f32_16x16x32_bf16 v[164:167], a[220:223], a[244:247], v[164:167]
  v_mul_f32 v152, v152, v184
  v_mul_f32 v153, v153, v185
  v_mfma_f32_16x16x32_bf16 v[92:95], a[208:211], a[100:103], v[92:95]
  v_mul_f32 v154, v154, v186
  v_mul_f32 v155, v155, v187
  v_mfma_f32_16x16x32_bf16 v[88:91], a[212:215], a[128:131], v[88:91]
  v_mul_f32 v156, v156, v188
  v_mul_f32 v157, v157, v189
  v_mfma_f32_16x16x32_bf16 v[164:167], a[224:227], a[248:251], v[164:167]
  v_mul_f32 v158, v158, v190
  v_mul_f32 v159, v159, v191
  v_mfma_f32_16x16x32_bf16 v[92:95], a[212:215], a[104:107], v[92:95]
  v_mul_f32 v160, v160, v192
  v_cvt_pk_bf16_f32 v170, v140, v141
  v_cvt_pk_bf16_f32 v171, v142, v143
  v_mul_f32 v161, v161, v193
  v_mul_f32 v162, v162, v194
  v_mfma_f32_16x16x32_bf16 v[96:99], v[36:39], v[168:171], 0
  v_mul_f32 v163, v163, v195
  v_max3_f32 v209, v152, v153, v154
  v_max3_f32 v210, v155, v156, v157
  v_max3_f32 v211, v158, v159, v160
  ds_read_b128 a[228:231], v249 offset:19200
  v_cvt_pk_bf16_f32 v56, v88, v89
  v_cvt_pk_bf16_f32 v57, v90, v91
  v_mfma_f32_16x16x32_bf16 v[88:91], v[20:23], v[168:171], 0
  v_mul_f32 v144, v144, v204
  v_mul_f32 v145, v145, v204
  v_mul_f32 v146, v146, v204
  v_mul_f32 v147, v147, v204
  v_fma_f32 v148, v148, v204, v242
  v_mul_f32 v164, v164, v196
  v_max3_f32 v212, v161, v162, v163
  v_max3_f32 v209, v209, v210, v211
  v_cvt_pk_bf16_f32 v40, v92, v93
  v_cvt_pk_bf16_f32 v41, v94, v95
  v_mfma_f32_16x16x32_bf16 v[92:95], a[204:207], a[132:135], 0
  v_cvt_pk_bf16_f32 v172, v144, v145
  v_cvt_pk_bf16_f32 v173, v146, v147
  v_mfma_f32_16x16x32_bf16 v[92:95], a[208:211], a[136:139], v[92:95]
  v_cvt_pk_bf16_f32 v174, v148, v243
  v_max3_f32 v209, v209, v212, v164
  v_mfma_f32_16x16x32_bf16 v[92:95], a[212:215], a[140:143], v[92:95]
  ds_read_b128 a[232:235], v249 offset:19264
  v_mov_b32 v210, v209
  v_mfma_f32_16x16x32_bf16 v[88:91], v[24:27], v[172:175], v[88:91]
  ds_read_b128 a[236:239], v249 offset:19328
  v_permlane32_swap_b32 v209, v210
  s_waitcnt lgkmcnt(2)
  v_mfma_f32_16x16x32_bf16 v[136:139], v[100:103], a[228:231], 0
  ds_read_b64_tr_b16 v[58:59], v253 offset:896
  v_max_f32 v209, v209, v210
  v_mfma_f32_16x16x32_bf16 v[140:143], v[112:115], a[228:231], 0
  buffer_store_dwordx4 v[216:219], v237, s[8:11], s61 offen sc1
  v_mov_b32 v210, v209
  v_mfma_f32_16x16x32_bf16 v[144:147], v[124:127], a[228:231], 0
  v_cvt_pk_bf16_f32 v216, v88, v89
  v_cvt_pk_bf16_f32 v217, v90, v91
  v_mfma_f32_16x16x32_bf16 v[88:91], v[44:47], v[168:171], 0
  v_permlane16_swap_b32 v209, v210
  v_mfma_f32_16x16x32_bf16 v[88:91], v[48:51], v[172:175], v[88:91]
  ds_read_b64_tr_b16 v[42:43], v253 offset:832
  v_mul_f32 v208, s59, v208
  v_mfma_f32_16x16x32_bf16 v[148:151], a[216:219], a[228:231], v[244:247]
  v_max_f32 v209, v209, v210
  v_mul_f32_e64 v211, -v209, v208
  v_cvt_pk_bf16_f32 v64, v92, v93
  s_waitcnt lgkmcnt(1)
  v_mfma_f32_16x16x32_bf16 v[136:139], v[104:107], a[232:235], v[136:139]
  v_cvt_pk_bf16_f32 v65, v94, v95
  v_xor_b32 v254, 16, v231
  v_mfma_f32_16x16x32_bf16 v[92:95], v[28:31], v[168:171], 0
  v_fma_f32 v152, v152, v208, v211
  v_fma_f32 v153, v153, v208, v211
  v_mfma_f32_16x16x32_bf16 v[92:95], v[32:35], v[172:175], v[92:95]
  v_fma_f32 v154, v154, v208, v211
  v_fma_f32 v155, v155, v208, v211
  v_mfma_f32_16x16x32_bf16 v[140:143], v[116:119], a[232:235], v[140:143]
  v_fma_f32 v156, v156, v208, v211
  v_fma_f32 v157, v157, v208, v211
  v_mfma_f32_16x16x32_bf16 v[144:147], v[128:131], a[232:235], v[144:147]
  v_fma_f32 v158, v158, v208, v211
  v_fma_f32 v159, v159, v208, v211
  v_mfma_f32_16x16x32_bf16 v[136:139], v[108:111], a[236:239], v[136:139]
  ds_read_b64_tr_b16 v[26:27], v254 offset:768
  v_exp_f32 v152, v152
  v_mfma_f32_16x16x32_bf16 v[140:143], v[120:123], a[236:239], v[140:143]
  v_exp_f32 v153, v153
  v_mfma_f32_16x16x32_bf16 v[144:147], v[132:135], a[236:239], v[144:147]
  v_exp_f32 v154, v154
  v_mfma_f32_16x16x32_bf16 v[148:151], a[220:223], a[232:235], v[148:151]
  v_exp_f32 v155, v155
  v_mfma_f32_16x16x32_bf16 v[148:151], a[224:227], a[236:239], v[148:151]
  v_exp_f32 v156, v156
  s_waitcnt lgkmcnt(1)
  v_mfma_f32_16x16x32_bf16 v[96:99], v[40:43], v[172:175], v[96:99]
  v_exp_f32 v157, v157
  v_exp_f32 v158, v158
  v_exp_f32 v159, v159
  v_fma_f32 v160, v160, v208, v211
  v_fma_f32 v161, v161, v208, v211
  v_fma_f32 v162, v162, v208, v211
  v_fma_f32 v163, v163, v208, v211
  v_fma_f32 v164, v164, v208, v211
  buffer_store_dwordx4 v[220:223], v237, s[8:11], s61 offen offset:64 sc1
  v_exp_f32 v160, v160
  v_exp_f32 v161, v161
  v_exp_f32 v162, v162
  v_exp_f32 v163, v163
  v_exp_f32 v164, v164
  v_cvt_pk_bf16_f32 v4, v152, v153
  v_cvt_pk_bf16_f32 v5, v154, v155
  v_cvt_pk_bf16_f32 v6, v156, v157
  v_cvt_pk_bf16_f32 v7, v158, v159
  v_cvt_pk_bf16_f32 v222, v88, v89
  v_cvt_pk_bf16_f32 v223, v90, v91
  v_mfma_f32_16x16x32_bf16 v[88:91], v[16:19], v[4:7], 0
  ds_read_b64_tr_b16 v[66:67], v253 offset:904
  v_cvt_pk_bf16_f32 v8, v160, v161
  v_cvt_pk_bf16_f32 v9, v162, v163
  v_cvt_pk_bf16_f32 v10, v164, v15
  v_cvt_pk_bf16_f32 v218, v92, v93
  v_cvt_pk_bf16_f32 v219, v94, v95
  v_mfma_f32_16x16x32_bf16 v[88:91], v[16:19], v[8:11], v[88:91]
  ds_read_b32 v200, v239 offset:864
  ds_read_b64_tr_b16 v[50:51], v254 offset:840
  v_mfma_f32_16x16x32_bf16 v[92:95], v[52:55], v[168:171], 0
  ds_read_b64_tr_b16 v[34:35], v254 offset:776
  v_mul_f32 v152, v152, v184
  v_mfma_f32_16x16x32_bf16 v[92:95], v[56:59], v[172:175], v[92:95]
  v_mul_f32 v153, v153, v185
  v_mul_f32 v154, v154, v186
  v_rcp_f32 v212, v88
  v_mul_f32 v155, v155, v187
  v_mul_f32 v156, v156, v188
  v_mul_f32 v157, v157, v189
  v_mul_f32 v158, v158, v190
  v_mul_f32 v159, v159, v191
  v_mul_f32 v152, v152, v212
  v_mul_f32 v153, v153, v212
  v_mul_f32 v154, v154, v212
  v_mul_f32 v155, v155, v212
  v_mul_f32 v156, v156, v212
  v_mul_f32 v157, v157, v212
  v_mul_f32 v158, v158, v212
  v_mul_f32 v159, v159, v212
  v_mul_f32 v136, v136, v184
  v_mul_f32 v137, v137, v185
  v_mul_f32 v138, v138, v186
  v_mul_f32 v139, v139, v187
  v_mul_f32 v140, v140, v188
  v_mul_f32 v141, v141, v189
  v_mul_f32 v142, v142, v190
  v_mul_f32 v143, v143, v191
  v_mul_f32 v144, v144, v192
  v_xor_b32 v252, 16, v229
  buffer_store_dwordx4 v[224:227], v237, s[8:11], s61 offen offset:128 sc1
  v_mul_f32 v160, v160, v192
  v_mul_f32 v161, v161, v193
  v_mul_f32 v162, v162, v194
  v_mul_f32 v163, v163, v195
  v_mul_f32 v164, v164, v196
  v_cvt_pk_bf16_f32 v176, v152, v153
  v_cvt_pk_bf16_f32 v177, v154, v155
  v_cvt_pk_bf16_f32 v178, v156, v157
  v_cvt_pk_bf16_f32 v179, v158, v159
  v_mul_f32 v145, v145, v193
  v_mul_f32 v146, v146, v194
  v_mfma_f32_16x16x32_bf16 v[88:91], v[36:39], v[176:179], 0
  v_mul_f32 v147, v147, v195
  v_max3_f32 v201, v136, v137, v138
  v_max3_f32 v202, v139, v140, v141
  v_max3_f32 v203, v142, v143, v144
  ds_read_b128 a[240:243], v252 offset:768
  v_cvt_pk_bf16_f32 v224, v92, v93
  v_cvt_pk_bf16_f32 v225, v94, v95
  v_mfma_f32_16x16x32_bf16 v[92:95], v[20:23], v[176:179], 0
  v_mul_f32 v160, v160, v212
  v_mul_f32 v161, v161, v212
  v_mul_f32 v162, v162, v212
  v_mul_f32 v163, v163, v212
  v_fma_f32 v164, v164, v212, v242
  v_mul_f32 v148, v148, v196
  v_max3_f32 v204, v145, v146, v147
  v_max3_f32 v201, v201, v202, v203
  v_cvt_pk_bf16_f32 v180, v160, v161
  v_cvt_pk_bf16_f32 v181, v162, v163
  v_cvt_pk_bf16_f32 v182, v164, v243
  v_max3_f32 v201, v201, v204, v148
  ds_read_b128 a[244:247], v252 offset:832
  s_waitcnt lgkmcnt(2)
  v_mfma_f32_16x16x32_bf16 v[92:95], v[24:27], v[180:183], v[92:95]
  v_mov_b32 v202, v201
  v_cvt_pk_bf16_f32 v220, v96, v97
  v_cvt_pk_bf16_f32 v221, v98, v99
  v_mfma_f32_16x16x32_bf16 v[96:99], v[60:63], v[168:171], 0
  v_permlane32_swap_b32 v201, v202
  v_mfma_f32_16x16x32_bf16 v[96:99], v[64:67], v[172:175], v[96:99]
  ds_read_b128 a[248:251], v252 offset:896
  ds_read_b64_tr_b16 v[58:59], v254 offset:896
  v_max_f32 v201, v201, v202
  s_waitcnt lgkmcnt(3)
  v_mfma_f32_16x16x32_bf16 v[152:155], v[100:103], a[240:243], 0
  buffer_store_dwordx4 v[216:219], v234, s[8:11], s62 offen sc1
  v_mov_b32 v202, v201
  v_mfma_f32_16x16x32_bf16 v[156:159], v[112:115], a[240:243], 0
  v_cvt_pk_bf16_f32 v216, v92, v93
  v_cvt_pk_bf16_f32 v217, v94, v95
  v_mfma_f32_16x16x32_bf16 v[92:95], v[44:47], v[176:179], 0
  v_permlane16_swap_b32 v201, v202
  v_mfma_f32_16x16x32_bf16 v[92:95], v[48:51], v[180:183], v[92:95]
  ds_read_b64_tr_b16 v[42:43], v254 offset:832
  v_xor_b32 v248, 32, v228
  v_mfma_f32_16x16x32_bf16 v[160:163], v[124:127], a[240:243], 0
  v_mul_f32 v200, s59, v200
  v_max_f32 v201, v201, v202
  s_waitcnt lgkmcnt(1)
  v_mfma_f32_16x16x32_bf16 v[152:155], v[104:107], a[244:247], v[152:155]
  ds_read_b128 a[144:147], v248 offset:1536
  v_mul_f32_e64 v203, -v201, v200
  v_mfma_f32_16x16x32_bf16 v[156:159], v[116:119], a[244:247], v[156:159]
  v_cvt_pk_bf16_f32 v226, v96, v97
  v_cvt_pk_bf16_f32 v227, v98, v99
  v_mfma_f32_16x16x32_bf16 v[96:99], v[28:31], v[176:179], 0
  v_xor_b32 v253, 16, v232
  v_fma_f32 v136, v136, v200, v203
  v_mfma_f32_16x16x32_bf16 v[96:99], v[32:35], v[180:183], v[96:99]
  v_fma_f32 v137, v137, v200, v203
  v_fma_f32 v138, v138, v200, v203
  v_mfma_f32_16x16x32_bf16 v[160:163], v[128:131], a[244:247], v[160:163]
  v_fma_f32 v139, v139, v200, v203
  v_fma_f32 v140, v140, v200, v203
  v_mfma_f32_16x16x32_bf16 v[164:167], a[216:219], a[240:243], v[244:247]
  v_fma_f32 v141, v141, v200, v203
  v_fma_f32 v142, v142, v200, v203
  v_mfma_f32_16x16x32_bf16 v[152:155], v[108:111], a[248:251], v[152:155]
  v_fma_f32 v143, v143, v200, v203
  ds_read_b128 a[148:151], v248 offset:1600
  v_mfma_f32_16x16x32_bf16 v[156:159], v[120:123], a[248:251], v[156:159]
  ds_read_b64_tr_b16 v[26:27], v253 offset:768
  v_exp_f32 v136, v136
  v_mfma_f32_16x16x32_bf16 v[160:163], v[132:135], a[248:251], v[160:163]
  v_exp_f32 v137, v137
  v_mfma_f32_16x16x32_bf16 v[164:167], a[220:223], a[244:247], v[164:167]
  v_exp_f32 v138, v138
  v_mfma_f32_16x16x32_bf16 v[164:167], a[224:227], a[248:251], v[164:167]
  v_exp_f32 v139, v139
  s_waitcnt lgkmcnt(2)
  v_mfma_f32_16x16x32_bf16 v[88:91], v[40:43], v[180:183], v[88:91]
  v_exp_f32 v140, v140
  v_mfma_f32_16x16x32_bf16 v[84:87], a[0:3], a[144:147], 0
  v_exp_f32 v141, v141
  v_mfma_f32_16x16x32_bf16 v[68:71], a[12:15], a[144:147], 0
  v_exp_f32 v142, v142
  v_mfma_f32_16x16x32_bf16 v[72:75], a[24:27], a[144:147], 0
  v_exp_f32 v143, v143
  s_waitcnt lgkmcnt(0)
  v_mfma_f32_16x16x32_bf16 v[84:87], a[4:7], a[148:151], v[84:87]
  v_fma_f32 v144, v144, v200, v203
  v_fma_f32 v145, v145, v200, v203
  v_mfma_f32_16x16x32_bf16 v[68:71], a[16:19], a[148:151], v[68:71]
  v_fma_f32 v146, v146, v200, v203
  v_fma_f32 v147, v147, v200, v203
  v_mfma_f32_16x16x32_bf16 v[72:75], a[28:31], a[148:151], v[72:75]
  v_fma_f32 v148, v148, v200, v203
  ds_read_b128 a[152:155], v248 offset:1664
  v_mfma_f32_16x16x32_bf16 v[76:79], a[36:39], a[144:147], 0
  buffer_store_dwordx4 v[220:223], v234, s[8:11], s62 offen offset:64 sc1
  v_exp_f32 v144, v144
  v_mfma_f32_16x16x32_bf16 v[76:79], a[40:43], a[148:151], v[76:79]
  v_exp_f32 v145, v145
  v_mfma_f32_16x16x32_bf16 v[80:83], a[48:51], a[144:147], 0
  v_exp_f32 v146, v146
  v_mfma_f32_16x16x32_bf16 v[80:83], a[52:55], a[148:151], v[80:83]
  v_exp_f32 v147, v147
  v_exp_f32 v148, v148
  v_cvt_pk_bf16_f32 v4, v136, v137
  v_cvt_pk_bf16_f32 v5, v138, v139
  v_cvt_pk_bf16_f32 v6, v140, v141
  v_cvt_pk_bf16_f32 v7, v142, v143
  v_cvt_pk_bf16_f32 v222, v92, v93
  v_cvt_pk_bf16_f32 v223, v94, v95
  v_mfma_f32_16x16x32_bf16 v[92:95], v[16:19], v[4:7], 0
  ds_read_b64_tr_b16 v[66:67], v254 offset:904
  v_cvt_pk_bf16_f32 v8, v144, v145
  v_cvt_pk_bf16_f32 v9, v146, v147
  v_cvt_pk_bf16_f32 v10, v148, v15
  s_waitcnt lgkmcnt(1)
  v_mfma_f32_16x16x32_bf16 v[84:87], a[8:11], a[152:155], v[84:87]
  v_cvt_pk_bf16_f32 v218, v96, v97
  v_cvt_pk_bf16_f32 v219, v98, v99
  v_mfma_f32_16x16x32_bf16 v[92:95], v[16:19], v[8:11], v[92:95]
  ds_read_b32 v208, v13 offset:768
  ds_read_b64_tr_b16 v[50:51], v253 offset:840
  v_mfma_f32_16x16x32_bf16 v[96:99], v[52:55], v[176:179], 0
  ds_read_b128 a[156:159], v248 offset:13824
  ds_read_b128 a[160:163], v248 offset:13888
  v_mfma_f32_16x16x32_bf16 v[96:99], v[56:59], v[180:183], v[96:99]
  ds_read_b64_tr_b16 v[34:35], v253 offset:776
  v_mul_f32 v136, v136, v184
  v_mfma_f32_16x16x32_bf16 v[68:71], a[20:23], a[152:155], v[68:71]
  v_rcp_f32 v204, v92
  v_mfma_f32_16x16x32_bf16 v[72:75], a[32:35], a[152:155], v[72:75]
  v_mul_f32 v137, v137, v185
  v_mul_f32 v138, v138, v186
  v_mfma_f32_16x16x32_bf16 v[76:79], a[44:47], a[152:155], v[76:79]
  v_mul_f32 v139, v139, v187
  v_mul_f32 v140, v140, v188
  v_mfma_f32_16x16x32_bf16 v[80:83], a[56:59], a[152:155], v[80:83]
  v_mul_f32 v141, v141, v189
  v_mul_f32 v142, v142, v190
  v_mul_f32 v143, v143, v191
  v_mul_f32 v136, v136, v204
  v_mul_f32 v137, v137, v204
  v_mul_f32 v138, v138, v204
  v_mul_f32 v139, v139, v204
  v_mul_f32 v140, v140, v204
  v_mul_f32 v141, v141, v204
  v_mul_f32 v142, v142, v204
  v_mul_f32 v143, v143, v204
  v_mul_f32 v152, v152, v184
  v_mul_f32 v153, v153, v185
  v_mul_f32 v154, v154, v186
  v_mul_f32 v155, v155, v187
  v_mul_f32 v156, v156, v188
  v_mul_f32 v157, v157, v189
  v_mul_f32 v158, v158, v190
  v_mul_f32 v159, v159, v191
  v_mul_f32 v160, v160, v192
  buffer_store_dwordx4 v[224:227], v234, s[8:11], s62 offen offset:128 sc1
  ds_read_b128 a[164:167], v248 offset:13952
  v_mul_f32 v144, v144, v192
  v_mul_f32 v145, v145, v193
  v_mul_f32 v146, v146, v194
  v_mul_f32 v147, v147, v195
  v_mul_f32 v148, v148, v196
  v_cvt_pk_bf16_f32 v168, v136, v137
  v_cvt_pk_bf16_f32 v169, v138, v139
  v_cvt_pk_bf16_f32 v170, v140, v141
  v_cvt_pk_bf16_f32 v171, v142, v143
  v_mul_f32 v161, v161, v193
  v_mul_f32 v162, v162, v194
  v_mfma_f32_16x16x32_bf16 v[92:95], v[36:39], v[168:171], 0
  v_mul_f32 v163, v163, v195
  v_max3_f32 v209, v152, v153, v154
  v_max3_f32 v210, v155, v156, v157
  v_max3_f32 v211, v158, v159, v160
  v_cvt_pk_bf16_f32 v224, v96, v97
  v_cvt_pk_bf16_f32 v225, v98, v99
  v_mfma_f32_16x16x32_bf16 v[96:99], v[20:23], v[168:171], 0
  v_mul_f32 v144, v144, v204
  v_mul_f32 v145, v145, v204
  v_mul_f32 v146, v146, v204
  v_mul_f32 v147, v147, v204
  v_fma_f32 v148, v148, v204, v242
  v_mul_f32 v164, v164, v196
  v_max3_f32 v212, v161, v162, v163
  v_max3_f32 v209, v209, v210, v211
  v_cvt_pk_bf16_f32 v172, v144, v145
  v_cvt_pk_bf16_f32 v173, v146, v147
  v_cvt_pk_bf16_f32 v174, v148, v243
  v_max3_f32 v209, v209, v212, v164
  v_mov_b32 v210, v209
  v_mfma_f32_16x16x32_bf16 v[96:99], v[24:27], v[172:175], v[96:99]
  v_cvt_pk_bf16_f32 v220, v88, v89
  v_cvt_pk_bf16_f32 v221, v90, v91
  v_mfma_f32_16x16x32_bf16 v[88:91], v[60:63], v[176:179], 0
  v_permlane32_swap_b32 v209, v210
  s_waitcnt lgkmcnt(0)
  v_mfma_f32_16x16x32_bf16 v[88:91], v[64:67], v[180:183], v[88:91]
  ds_read_b128 a[168:171], v248 offset:26112
  ds_read_b64_tr_b16 v[58:59], v253 offset:896
  v_max_f32 v209, v209, v210
  buffer_store_dwordx4 v[216:219], v235, s[8:11], s62 offen sc1
  v_mov_b32 v210, v209
  ds_read_b128 a[172:175], v248 offset:26176
  v_cvt_pk_bf16_f32 v216, v96, v97
  v_cvt_pk_bf16_f32 v217, v98, v99
  v_mfma_f32_16x16x32_bf16 v[96:99], v[44:47], v[168:171], 0
  v_permlane16_swap_b32 v209, v210
  v_mfma_f32_16x16x32_bf16 v[96:99], v[48:51], v[172:175], v[96:99]
  ds_read_b64_tr_b16 v[42:43], v253 offset:832
  ds_read_b128 a[176:179], v248 offset:26240
  v_cvt_pk_bf16_f32 v100, v84, v85
  v_cvt_pk_bf16_f32 v101, v86, v87
  v_mfma_f32_16x16x32_bf16 v[84:87], a[60:63], a[144:147], 0
  v_mul_f32 v208, s59, v208
  v_max_f32 v209, v209, v210
  v_mfma_f32_16x16x32_bf16 v[84:87], a[64:67], a[148:151], v[84:87]
  v_mul_f32_e64 v211, -v209, v208
  v_cvt_pk_bf16_f32 v102, v68, v69
  v_mfma_f32_16x16x32_bf16 v[84:87], a[68:71], a[152:155], v[84:87]
  v_cvt_pk_bf16_f32 v103, v70, v71
  v_cvt_pk_bf16_f32 v104, v72, v73
  v_mfma_f32_16x16x32_bf16 v[68:71], a[0:3], a[156:159], 0
  v_cvt_pk_bf16_f32 v105, v74, v75
  v_cvt_pk_bf16_f32 v226, v88, v89
  v_mfma_f32_16x16x32_bf16 v[72:75], a[12:15], a[156:159], 0
  v_cvt_pk_bf16_f32 v227, v90, v91
  v_xor_b32 v254, 16, v233
  v_mfma_f32_16x16x32_bf16 v[88:91], v[28:31], v[168:171], 0
  v_fma_f32 v152, v152, v208, v211
  v_fma_f32 v153, v153, v208, v211
  v_mfma_f32_16x16x32_bf16 v[68:71], a[4:7], a[160:163], v[68:71]
  v_fma_f32 v154, v154, v208, v211
  v_fma_f32 v155, v155, v208, v211
  v_mfma_f32_16x16x32_bf16 v[72:75], a[16:19], a[160:163], v[72:75]
  v_fma_f32 v156, v156, v208, v211
  v_fma_f32 v157, v157, v208, v211
  v_mfma_f32_16x16x32_bf16 v[88:91], v[32:35], v[172:175], v[88:91]
  v_fma_f32 v158, v158, v208, v211
  v_fma_f32 v159, v159, v208, v211
  v_mfma_f32_16x16x32_bf16 v[68:71], a[8:11], a[164:167], v[68:71]
  ds_read_b64_tr_b16 v[26:27], v254 offset:768
  v_exp_f32 v152, v152
  v_mfma_f32_16x16x32_bf16 v[72:75], a[20:23], a[164:167], v[72:75]
  v_exp_f32 v153, v153
  s_waitcnt lgkmcnt(1)
  v_mfma_f32_16x16x32_bf16 v[92:95], v[40:43], v[172:175], v[92:95]
  v_exp_f32 v154, v154
  v_exp_f32 v155, v155
  v_exp_f32 v156, v156
  v_exp_f32 v157, v157
  v_exp_f32 v158, v158
  v_exp_f32 v159, v159
  v_fma_f32 v160, v160, v208, v211
  v_fma_f32 v161, v161, v208, v211
  v_fma_f32 v162, v162, v208, v211
  v_fma_f32 v163, v163, v208, v211
  v_fma_f32 v164, v164, v208, v211
  buffer_store_dwordx4 v[220:223], v235, s[8:11], s62 offen offset:64 sc1
  v_exp_f32 v160, v160
  v_exp_f32 v161, v161
  v_exp_f32 v162, v162
  v_exp_f32 v163, v163
  v_exp_f32 v164, v164
  v_cvt_pk_bf16_f32 v4, v152, v153
  v_cvt_pk_bf16_f32 v5, v154, v155
  v_cvt_pk_bf16_f32 v6, v156, v157
  v_cvt_pk_bf16_f32 v7, v158, v159
  v_cvt_pk_bf16_f32 v222, v96, v97
  v_cvt_pk_bf16_f32 v223, v98, v99
  v_mfma_f32_16x16x32_bf16 v[96:99], v[16:19], v[4:7], 0
  ds_read_b64_tr_b16 v[66:67], v253 offset:904
  v_cvt_pk_bf16_f32 v106, v76, v77
  v_cvt_pk_bf16_f32 v107, v78, v79
  v_mfma_f32_16x16x32_bf16 v[76:79], a[24:27], a[156:159], 0
  v_cvt_pk_bf16_f32 v8, v160, v161
  v_cvt_pk_bf16_f32 v9, v162, v163
  v_mfma_f32_16x16x32_bf16 v[76:79], a[28:31], a[160:163], v[76:79]
  v_cvt_pk_bf16_f32 v10, v164, v15
  v_cvt_pk_bf16_f32 v108, v80, v81
  v_mfma_f32_16x16x32_bf16 v[76:79], a[32:35], a[164:167], v[76:79]
  v_cvt_pk_bf16_f32 v109, v82, v83
  v_cvt_pk_bf16_f32 v110, v84, v85
  v_mfma_f32_16x16x32_bf16 v[96:99], v[16:19], v[8:11], v[96:99]
  v_cvt_pk_bf16_f32 v111, v86, v87
  v_cvt_pk_bf16_f32 v218, v88, v89
  v_mfma_f32_16x16x32_bf16 v[80:83], a[36:39], a[156:159], 0
  v_cvt_pk_bf16_f32 v219, v90, v91
  ds_read_b64_tr_b16 v[50:51], v254 offset:840
  v_mfma_f32_16x16x32_bf16 v[84:87], a[48:51], a[156:159], 0
  ds_read_b128 a[216:219], v250 offset:384
  v_cvt_pk_bf16_f32 v112, v68, v69
  v_mfma_f32_16x16x32_bf16 v[88:91], v[52:55], v[168:171], 0
  v_cvt_pk_bf16_f32 v113, v70, v71
  v_cvt_pk_bf16_f32 v114, v72, v73
  v_mfma_f32_16x16x32_bf16 v[80:83], a[40:43], a[160:163], v[80:83]
  v_cvt_pk_bf16_f32 v115, v74, v75
  ds_read_b128 a[228:231], v248 offset:1536
  v_mfma_f32_16x16x32_bf16 v[84:87], a[52:55], a[160:163], v[84:87]
  ds_read_b128 a[220:223], v250 offset:448
  ds_read_b128 a[232:235], v248 offset:1600
  v_mfma_f32_16x16x32_bf16 v[68:71], a[60:63], a[156:159], 0
  v_rcp_f32 v212, v96
  v_mfma_f32_16x16x32_bf16 v[72:75], a[0:3], a[168:171], 0
  ds_read_b64_tr_b16 v[34:35], v254 offset:776
  v_mul_f32 v152, v152, v184
  v_mfma_f32_16x16x32_bf16 v[88:91], v[56:59], v[172:175], v[88:91]
  v_mul_f32 v153, v153, v185
  v_mul_f32 v154, v154, v186
  v_mfma_f32_16x16x32_bf16 v[80:83], a[44:47], a[164:167], v[80:83]
  v_mul_f32 v155, v155, v187
  v_mul_f32 v156, v156, v188
  v_mfma_f32_16x16x32_bf16 v[84:87], a[56:59], a[164:167], v[84:87]
  v_mul_f32 v157, v157, v189
  v_mul_f32 v158, v158, v190
  v_mfma_f32_16x16x32_bf16 v[68:71], a[64:67], a[160:163], v[68:71]
  v_mul_f32 v159, v159, v191
  ds_read_b128 a[224:227], v250 offset:512
  v_mfma_f32_16x16x32_bf16 v[72:75], a[4:7], a[172:175], v[72:75]
  ds_read_b128 a[236:239], v248 offset:1664
  v_mul_f32 v152, v152, v212
  v_mfma_f32_16x16x32_bf16 v[68:71], a[68:71], a[164:167], v[68:71]
  v_mul_f32 v153, v153, v212
  v_mul_f32 v154, v154, v212
  v_mfma_f32_16x16x32_bf16 v[72:75], a[8:11], a[176:179], v[72:75]
  v_mul_f32 v155, v155, v212
  v_mul_f32 v156, v156, v212
  s_waitcnt lgkmcnt(2)
  v_mfma_f32_16x16x32_bf16 v[136:139], v[100:103], a[228:231], 0
  v_mul_f32 v157, v157, v212
  v_mul_f32 v158, v158, v212
  v_mfma_f32_16x16x32_bf16 v[140:143], v[112:115], a[228:231], 0
  v_mul_f32 v159, v159, v212
  buffer_store_dwordx4 v[224:227], v235, s[8:11], s62 offen offset:128 sc1
  v_mfma_f32_16x16x32_bf16 v[148:151], a[216:219], a[228:231], v[244:247]
  v_mul_f32 v160, v160, v192
  v_mul_f32 v161, v161, v193
  v_mfma_f32_16x16x32_bf16 v[136:139], v[104:107], a[232:235], v[136:139]
  v_mul_f32 v162, v162, v194
  v_mul_f32 v163, v163, v195
  v_mfma_f32_16x16x32_bf16 v[148:151], a[220:223], a[232:235], v[148:151]
  v_mul_f32 v164, v164, v196
  v_cvt_pk_bf16_f32 v176, v152, v153
  v_cvt_pk_bf16_f32 v177, v154, v155
  v_cvt_pk_bf16_f32 v178, v156, v157
  s_waitcnt lgkmcnt(0)
  v_mfma_f32_16x16x32_bf16 v[136:139], v[108:111], a[236:239], v[136:139]
  v_cvt_pk_bf16_f32 v179, v158, v159
  v_cvt_pk_bf16_f32 v116, v76, v77
  v_mfma_f32_16x16x32_bf16 v[148:151], a[224:227], a[236:239], v[148:151]
  v_cvt_pk_bf16_f32 v117, v78, v79
  v_cvt_pk_bf16_f32 v224, v88, v89
  v_mfma_f32_16x16x32_bf16 v[76:79], a[12:15], a[168:171], 0
  v_cvt_pk_bf16_f32 v225, v90, v91
  v_mul_f32 v160, v160, v212
  v_mfma_f32_16x16x32_bf16 v[88:91], v[20:23], v[176:179], 0
  v_mul_f32 v161, v161, v212
  v_mul_f32 v162, v162, v212
  v_mfma_f32_16x16x32_bf16 v[76:79], a[16:19], a[172:175], v[76:79]
  v_mul_f32 v163, v163, v212
  v_fma_f32 v164, v164, v212, v242
  v_mfma_f32_16x16x32_bf16 v[76:79], a[20:23], a[176:179], v[76:79]
  v_cvt_pk_bf16_f32 v180, v160, v161
  v_cvt_pk_bf16_f32 v181, v162, v163
  v_mfma_f32_16x16x32_bf16 v[96:99], v[36:39], v[176:179], 0
  v_cvt_pk_bf16_f32 v182, v164, v243
  v_cvt_pk_bf16_f32 v118, v80, v81
  v_cvt_pk_bf16_f32 v119, v82, v83
  v_mfma_f32_16x16x32_bf16 v[80:83], a[24:27], a[168:171], 0
  v_cvt_pk_bf16_f32 v120, v84, v85
  v_cvt_pk_bf16_f32 v121, v86, v87
  v_mfma_f32_16x16x32_bf16 v[84:87], a[36:39], a[168:171], 0
  v_cvt_pk_bf16_f32 v220, v92, v93
  v_cvt_pk_bf16_f32 v221, v94, v95
  v_mfma_f32_16x16x32_bf16 v[88:91], v[24:27], v[180:183], v[88:91]
  v_cvt_pk_bf16_f32 v122, v68, v69
  v_cvt_pk_bf16_f32 v123, v70, v71
  v_mfma_f32_16x16x32_bf16 v[92:95], v[60:63], v[168:171], 0
  v_cvt_pk_bf16_f32 v124, v72, v73
  v_cvt_pk_bf16_f32 v125, v74, v75
  v_mfma_f32_16x16x32_bf16 v[80:83], a[28:31], a[172:175], v[80:83]
  ds_read_b64_tr_b16 v[58:59], v254 offset:896
  buffer_store_dwordx4 v[216:219], v236, s[8:11], s62 offen sc1
  v_mfma_f32_16x16x32_bf16 v[84:87], a[40:43], a[172:175], v[84:87]
  ds_read_b64_tr_b16 v[42:43], v254 offset:832
  v_cvt_pk_bf16_f32 v216, v88, v89
  v_mfma_f32_16x16x32_bf16 v[68:71], a[48:51], a[168:171], 0
  v_cvt_pk_bf16_f32 v217, v90, v91
  v_cvt_pk_bf16_f32 v126, v76, v77
  v_mfma_f32_16x16x32_bf16 v[72:75], a[60:63], a[168:171], 0
  v_cvt_pk_bf16_f32 v127, v78, v79
  buffer_store_dwordx4 v[220:223], v236, s[8:11], s62 offen offset:64 sc1
  v_mfma_f32_16x16x32_bf16 v[92:95], v[64:67], v[172:175], v[92:95]
  ds_read_b64_tr_b16 v[66:67], v254 offset:904
  ds_read_b128 v[184:187], v238 offset:1536
  v_mfma_f32_16x16x32_bf16 v[80:83], a[32:35], a[176:179], v[80:83]
  ds_read_b128 v[188:191], v238 offset:1600
  ds_read_b128 v[192:195], v238 offset:1664
  v_mfma_f32_16x16x32_bf16 v[84:87], a[44:47], a[176:179], v[84:87]
  ds_read_b32 v196, v240 offset:2112
  ds_read_b32 v200, v239 offset:1536
  v_mfma_f32_16x16x32_bf16 v[68:71], a[52:55], a[172:175], v[68:71]
  v_cvt_pk_bf16_f32 v226, v92, v93
  v_cvt_pk_bf16_f32 v227, v94, v95
  v_mfma_f32_16x16x32_bf16 v[72:75], a[64:67], a[172:175], v[72:75]
  v_cvt_pk_bf16_f32 v128, v80, v81
  v_cvt_pk_bf16_f32 v129, v82, v83
  v_mfma_f32_16x16x32_bf16 v[88:91], v[44:47], v[176:179], 0
  v_cvt_pk_bf16_f32 v130, v84, v85
  v_cvt_pk_bf16_f32 v131, v86, v87
  v_mfma_f32_16x16x32_bf16 v[68:71], a[56:59], a[176:179], v[68:71]
  buffer_store_dwordx4 v[224:227], v236, s[8:11], s62 offen offset:128 sc1
  ds_read_b128 a[240:243], v248 offset:10752
  v_mfma_f32_16x16x32_bf16 v[72:75], a[68:71], a[176:179], v[72:75]
  ds_read_b128 a[244:247], v248 offset:10816
  ds_read_b128 a[248:251], v248 offset:10880
  v_mfma_f32_16x16x32_bf16 v[88:91], v[48:51], v[180:183], v[88:91]
  v_xor_b32 v253, 32, v230
  s_waitcnt lgkmcnt(3)
  v_mul_f32 v136, v136, v184
  v_mfma_f32_16x16x32_bf16 v[144:147], v[124:127], a[228:231], 0
  v_cvt_pk_bf16_f32 v132, v68, v69
  v_cvt_pk_bf16_f32 v133, v70, v71
  v_mfma_f32_16x16x32_bf16 v[92:95], v[28:31], v[176:179], 0
  v_cvt_pk_bf16_f32 v134, v72, v73
  v_cvt_pk_bf16_f32 v135, v74, v75
  v_mfma_f32_16x16x32_bf16 v[140:143], v[116:119], a[232:235], v[140:143]
  v_cvt_pk_bf16_f32 v222, v88, v89
  v_cvt_pk_bf16_f32 v223, v90, v91
  v_mfma_f32_16x16x32_bf16 v[144:147], v[128:131], a[232:235], v[144:147]
  v_mul_f32 v137, v137, v185
  v_mul_f32 v138, v138, v186
  v_mfma_f32_16x16x32_bf16 v[92:95], v[32:35], v[180:183], v[92:95]
  v_mul_f32 v139, v139, v187
  v_max3_f32 v201, v136, v137, v138
  v_mfma_f32_16x16x32_bf16 v[140:143], v[120:123], a[236:239], v[140:143]
  v_mul_f32 v148, v148, v196
  v_mul_f32 v200, s59, v200
  v_mfma_f32_16x16x32_bf16 v[144:147], v[132:135], a[236:239], v[144:147]
  ds_read_b64_tr_b16 v[26:27], v253 offset:1536
  ds_read_b32 v208, v239 offset:1584
  v_mfma_f32_16x16x32_bf16 v[88:91], a[144:147], a[72:75], 0
  v_cvt_pk_bf16_f32 v218, v92, v93
  v_cvt_pk_bf16_f32 v219, v94, v95
  v_mfma_f32_16x16x32_bf16 v[88:91], a[148:151], a[76:79], v[88:91]
  v_mul_f32 v140, v140, v188
  v_mul_f32 v141, v141, v189
  v_mfma_f32_16x16x32_bf16 v[92:95], v[52:55], v[176:179], 0
  v_mul_f32 v142, v142, v190
  v_mul_f32 v143, v143, v191
  v_mfma_f32_16x16x32_bf16 v[88:91], a[152:155], a[80:83], v[88:91]
  v_mul_f32 v144, v144, v192
  v_mul_f32 v145, v145, v193
  v_mfma_f32_16x16x32_bf16 v[92:95], v[56:59], v[180:183], v[92:95]
  v_mul_f32 v146, v146, v194
  v_mul_f32 v147, v147, v195
  v_mfma_f32_16x16x32_bf16 v[96:99], v[40:43], v[180:183], v[96:99]
  v_max3_f32 v202, v139, v140, v141
  v_max3_f32 v203, v142, v143, v144
  s_waitcnt lgkmcnt(1)
  v_mfma_f32_16x16x32_bf16 v[152:155], v[100:103], a[240:243], 0
  v_cvt_pk_bf16_f32 v20, v88, v89
  v_cvt_pk_bf16_f32 v21, v90, v91
  v_mfma_f32_16x16x32_bf16 v[88:91], a[144:147], a[108:111], 0
  v_cvt_pk_bf16_f32 v224, v92, v93
  v_cvt_pk_bf16_f32 v225, v94, v95
  v_mfma_f32_16x16x32_bf16 v[92:95], a[144:147], a[84:87], 0
  v_cvt_pk_bf16_f32 v220, v96, v97
  v_cvt_pk_bf16_f32 v221, v98, v99
  v_mfma_f32_16x16x32_bf16 v[88:91], a[148:151], a[112:115], v[88:91]
  v_max3_f32 v204, v145, v146, v147
  v_max3_f32 v201, v201, v202, v203
  v_mfma_f32_16x16x32_bf16 v[92:95], a[148:151], a[88:91], v[92:95]
  v_max3_f32 v201, v201, v204, v148
  v_mov_b32 v202, v201
  v_mfma_f32_16x16x32_bf16 v[88:91], a[152:155], a[116:119], v[88:91]
  ds_read_b64_tr_b16 v[50:51], v253 offset:1608
  v_permlane32_swap_b32 v201, v202
  v_mfma_f32_16x16x32_bf16 v[96:99], v[60:63], v[176:179], 0
  v_max_f32 v201, v201, v202
  v_mov_b32 v202, v201
  v_mfma_f32_16x16x32_bf16 v[92:95], a[152:155], a[92:95], v[92:95]
  ds_read_b64_tr_b16 v[34:35], v253 offset:1544
  v_permlane16_swap_b32 v201, v202
  v_mfma_f32_16x16x32_bf16 v[96:99], v[64:67], v[180:183], v[96:99]
  v_cvt_pk_bf16_f32 v44, v88, v89
  v_cvt_pk_bf16_f32 v45, v90, v91
  v_mfma_f32_16x16x32_bf16 v[88:91], a[156:159], a[72:75], 0
  v_max_f32 v201, v201, v202
  v_mul_f32_e64 v203, -v201, v200
  v_mfma_f32_16x16x32_bf16 v[88:91], a[160:163], a[76:79], v[88:91]
  v_cvt_pk_bf16_f32 v28, v92, v93
  v_cvt_pk_bf16_f32 v29, v94, v95
  v_mfma_f32_16x16x32_bf16 v[92:95], a[144:147], a[120:123], 0
  v_cvt_pk_bf16_f32 v226, v96, v97
  v_cvt_pk_bf16_f32 v227, v98, v99
  v_mfma_f32_16x16x32_bf16 v[96:99], a[144:147], a[96:99], 0
  v_fma_f32 v136, v136, v200, v203
  v_fma_f32 v137, v137, v200, v203
  v_mfma_f32_16x16x32_bf16 v[92:95], a[148:151], a[124:127], v[92:95]
  v_fma_f32 v138, v138, v200, v203
  v_fma_f32 v139, v139, v200, v203
  v_mfma_f32_16x16x32_bf16 v[88:91], a[164:167], a[80:83], v[88:91]
  v_fma_f32 v140, v140, v200, v203
  v_fma_f32 v141, v141, v200, v203
  v_mfma_f32_16x16x32_bf16 v[96:99], a[148:151], a[100:103], v[96:99]
  v_fma_f32 v142, v142, v200, v203
  v_fma_f32 v143, v143, v200, v203
  v_mfma_f32_16x16x32_bf16 v[92:95], a[152:155], a[128:131], v[92:95]
  v_exp_f32 v136, v136
  v_mfma_f32_16x16x32_bf16 v[96:99], a[152:155], a[104:107], v[96:99]
  v_cvt_pk_bf16_f32 v22, v88, v89
  v_cvt_pk_bf16_f32 v23, v90, v91
  v_mfma_f32_16x16x32_bf16 v[88:91], a[156:159], a[108:111], 0
  v_exp_f32 v137, v137
  v_mfma_f32_16x16x32_bf16 v[88:91], a[160:163], a[112:115], v[88:91]
  v_exp_f32 v138, v138
  v_mfma_f32_16x16x32_bf16 v[88:91], a[164:167], a[116:119], v[88:91]
  v_cvt_pk_bf16_f32 v52, v92, v93
  v_cvt_pk_bf16_f32 v53, v94, v95
  v_mfma_f32_16x16x32_bf16 v[92:95], a[156:159], a[84:87], 0
  v_cvt_pk_bf16_f32 v36, v96, v97
  v_cvt_pk_bf16_f32 v37, v98, v99
  v_mfma_f32_16x16x32_bf16 v[96:99], a[144:147], a[132:135], 0
  v_exp_f32 v139, v139
  v_mfma_f32_16x16x32_bf16 v[92:95], a[160:163], a[88:91], v[92:95]
  v_cvt_pk_bf16_f32 v46, v88, v89
  v_cvt_pk_bf16_f32 v47, v90, v91
  v_mfma_f32_16x16x32_bf16 v[96:99], a[148:151], a[136:139], v[96:99]
  v_exp_f32 v140, v140
  v_mfma_f32_16x16x32_bf16 v[92:95], a[164:167], a[92:95], v[92:95]
  v_exp_f32 v141, v141
  v_mfma_f32_16x16x32_bf16 v[96:99], a[152:155], a[140:143], v[96:99]
  v_exp_f32 v142, v142
  v_mfma_f32_16x16x32_bf16 v[88:91], a[168:171], a[72:75], 0
  v_exp_f32 v143, v143
  v_mfma_f32_16x16x32_bf16 v[88:91], a[172:175], a[76:79], v[88:91]
  v_fma_f32 v144, v144, v200, v203
  v_fma_f32 v145, v145, v200, v203
  v_mfma_f32_16x16x32_bf16 v[88:91], a[176:179], a[80:83], v[88:91]
  v_cvt_pk_bf16_f32 v30, v92, v93
  v_cvt_pk_bf16_f32 v31, v94, v95
  v_mfma_f32_16x16x32_bf16 v[92:95], a[156:159], a[120:123], 0
  v_cvt_pk_bf16_f32 v60, v96, v97
  v_cvt_pk_bf16_f32 v61, v98, v99
  v_mfma_f32_16x16x32_bf16 v[96:99], a[156:159], a[96:99], 0
  v_fma_f32 v146, v146, v200, v203
  v_fma_f32 v147, v147, v200, v203
  v_mfma_f32_16x16x32_bf16 v[92:95], a[160:163], a[124:127], v[92:95]
  v_cvt_pk_bf16_f32 v24, v88, v89
  v_cvt_pk_bf16_f32 v25, v90, v91
  v_mfma_f32_16x16x32_bf16 v[96:99], a[160:163], a[100:103], v[96:99]
  v_fma_f32 v148, v148, v200, v203
  v_exp_f32 v144, v144
  v_mfma_f32_16x16x32_bf16 v[92:95], a[164:167], a[128:131], v[92:95]
  v_exp_f32 v145, v145
  v_mfma_f32_16x16x32_bf16 v[96:99], a[164:167], a[104:107], v[96:99]
  v_exp_f32 v146, v146
  v_mfma_f32_16x16x32_bf16 v[88:91], a[168:171], a[108:111], 0
  v_exp_f32 v147, v147
  v_mfma_f32_16x16x32_bf16 v[88:91], a[172:175], a[112:115], v[88:91]
  v_exp_f32 v148, v148
  v_mfma_f32_16x16x32_bf16 v[88:91], a[176:179], a[116:119], v[88:91]
  v_cvt_pk_bf16_f32 v54, v92, v93
  v_cvt_pk_bf16_f32 v55, v94, v95
  v_mfma_f32_16x16x32_bf16 v[92:95], a[168:171], a[84:87], 0
  v_cvt_pk_bf16_f32 v38, v96, v97
  v_cvt_pk_bf16_f32 v39, v98, v99
  v_mfma_f32_16x16x32_bf16 v[96:99], a[156:159], a[132:135], 0
  v_cvt_pk_bf16_f32 v4, v136, v137
  v_cvt_pk_bf16_f32 v5, v138, v139
  v_mfma_f32_16x16x32_bf16 v[92:95], a[172:175], a[88:91], v[92:95]
  v_cvt_pk_bf16_f32 v6, v140, v141
  v_cvt_pk_bf16_f32 v7, v142, v143
  v_mfma_f32_16x16x32_bf16 v[96:99], a[160:163], a[136:139], v[96:99]
  v_cvt_pk_bf16_f32 v48, v88, v89
  v_cvt_pk_bf16_f32 v49, v90, v91
  v_mfma_f32_16x16x32_bf16 v[92:95], a[176:179], a[92:95], v[92:95]
  v_cvt_pk_bf16_f32 v8, v144, v145
  v_cvt_pk_bf16_f32 v9, v146, v147
  v_mfma_f32_16x16x32_bf16 v[96:99], a[164:167], a[140:143], v[96:99]
  v_cvt_pk_bf16_f32 v10, v148, v15
  v_mul_f32 v136, v136, v184
  v_mfma_f32_16x16x32_bf16 v[88:91], v[16:19], v[4:7], 0
  v_mul_f32 v137, v137, v185
  v_mul_f32 v138, v138, v186
  v_mfma_f32_16x16x32_bf16 v[156:159], v[112:115], a[240:243], 0
  v_cvt_pk_bf16_f32 v32, v92, v93
  v_cvt_pk_bf16_f32 v33, v94, v95
  v_mfma_f32_16x16x32_bf16 v[160:163], v[124:127], a[240:243], 0
  v_cvt_pk_bf16_f32 v62, v96, v97
  v_cvt_pk_bf16_f32 v63, v98, v99
  v_mfma_f32_16x16x32_bf16 v[92:95], a[168:171], a[120:123], 0
  v_mul_f32 v139, v139, v187
  v_mul_f32 v140, v140, v188
  v_mfma_f32_16x16x32_bf16 v[88:91], v[16:19], v[8:11], v[88:91]
  v_mul_f32 v141, v141, v189
  v_mul_f32 v142, v142, v190
  v_mfma_f32_16x16x32_bf16 v[152:155], v[104:107], a[244:247], v[152:155]
  v_mul_f32 v143, v143, v191
  v_mul_f32 v144, v144, v192
  v_mfma_f32_16x16x32_bf16 v[156:159], v[116:119], a[244:247], v[156:159]
  v_mul_f32 v145, v145, v193
  v_mul_f32 v146, v146, v194
  v_mfma_f32_16x16x32_bf16 v[160:163], v[128:131], a[244:247], v[160:163]
  v_rcp_f32 v204, v88
  v_mfma_f32_16x16x32_bf16 v[164:167], a[216:219], a[240:243], v[244:247]
  v_mul_f32 v136, v136, v204
  v_mul_f32 v137, v137, v204
  v_mfma_f32_16x16x32_bf16 v[96:99], a[168:171], a[96:99], 0
  v_mul_f32 v138, v138, v204
  v_mul_f32 v139, v139, v204
  v_mfma_f32_16x16x32_bf16 v[92:95], a[172:175], a[124:127], v[92:95]
  v_mul_f32 v140, v140, v204
  v_mul_f32 v141, v141, v204
  v_mfma_f32_16x16x32_bf16 v[152:155], v[108:111], a[248:251], v[152:155]
  v_mul_f32 v142, v142, v204
  v_mul_f32 v143, v143, v204
  v_mfma_f32_16x16x32_bf16 v[156:159], v[120:123], a[248:251], v[156:159]
  v_mul_f32 v147, v147, v195
  v_mul_f32 v148, v148, v196
  v_mfma_f32_16x16x32_bf16 v[160:163], v[132:135], a[248:251], v[160:163]
  v_cvt_pk_bf16_f32 v168, v136, v137
  v_cvt_pk_bf16_f32 v169, v138, v139
  v_mfma_f32_16x16x32_bf16 v[164:167], a[220:223], a[244:247], v[164:167]
  v_mul_f32 v152, v152, v184
  v_mul_f32 v153, v153, v185
  v_mfma_f32_16x16x32_bf16 v[96:99], a[172:175], a[100:103], v[96:99]
  v_mul_f32 v154, v154, v186
  v_mul_f32 v155, v155, v187
  v_mfma_f32_16x16x32_bf16 v[92:95], a[176:179], a[128:131], v[92:95]
  v_mul_f32 v156, v156, v188
  v_mul_f32 v157, v157, v189
  v_mfma_f32_16x16x32_bf16 v[164:167], a[224:227], a[248:251], v[164:167]
  v_mul_f32 v158, v158, v190
  v_mul_f32 v159, v159, v191
  v_mfma_f32_16x16x32_bf16 v[96:99], a[176:179], a[104:107], v[96:99]
  v_mul_f32 v160, v160, v192
  v_cvt_pk_bf16_f32 v170, v140, v141
  v_cvt_pk_bf16_f32 v171, v142, v143
  v_mul_f32 v161, v161, v193
  v_mul_f32 v162, v162, v194
  v_mfma_f32_16x16x32_bf16 v[88:91], v[36:39], v[168:171], 0
  v_mul_f32 v163, v163, v195
  v_max3_f32 v209, v152, v153, v154
  v_max3_f32 v210, v155, v156, v157
  v_max3_f32 v211, v158, v159, v160
  ds_read_b128 a[228:231], v248 offset:19968
  v_cvt_pk_bf16_f32 v56, v92, v93
  v_cvt_pk_bf16_f32 v57, v94, v95
  v_mfma_f32_16x16x32_bf16 v[92:95], v[20:23], v[168:171], 0
  v_mul_f32 v144, v144, v204
  v_mul_f32 v145, v145, v204
  v_mul_f32 v146, v146, v204
  v_mul_f32 v147, v147, v204
  v_fma_f32 v148, v148, v204, v242
  v_mul_f32 v164, v164, v196
  v_max3_f32 v212, v161, v162, v163
  v_max3_f32 v209, v209, v210, v211
  v_cvt_pk_bf16_f32 v40, v96, v97
  v_cvt_pk_bf16_f32 v41, v98, v99
  v_mfma_f32_16x16x32_bf16 v[96:99], a[168:171], a[132:135], 0
  v_cvt_pk_bf16_f32 v172, v144, v145
  v_cvt_pk_bf16_f32 v173, v146, v147
  v_mfma_f32_16x16x32_bf16 v[96:99], a[172:175], a[136:139], v[96:99]
  v_cvt_pk_bf16_f32 v174, v148, v243
  v_max3_f32 v209, v209, v212, v164
  v_mfma_f32_16x16x32_bf16 v[96:99], a[176:179], a[140:143], v[96:99]
  ds_read_b128 a[232:235], v248 offset:20032
  v_mov_b32 v210, v209
  v_mfma_f32_16x16x32_bf16 v[92:95], v[24:27], v[172:175], v[92:95]
  ds_read_b128 a[236:239], v248 offset:20096
  v_permlane32_swap_b32 v209, v210
  s_waitcnt lgkmcnt(2)
  v_mfma_f32_16x16x32_bf16 v[136:139], v[100:103], a[228:231], 0
  ds_read_b64_tr_b16 v[58:59], v253 offset:1664
  v_max_f32 v209, v209, v210
  v_mfma_f32_16x16x32_bf16 v[140:143], v[112:115], a[228:231], 0
  buffer_store_dwordx4 v[216:219], v237, s[8:11], s62 offen sc1
  v_mov_b32 v210, v209
  v_mfma_f32_16x16x32_bf16 v[144:147], v[124:127], a[228:231], 0
  v_cvt_pk_bf16_f32 v216, v92, v93
  v_cvt_pk_bf16_f32 v217, v94, v95
  v_mfma_f32_16x16x32_bf16 v[92:95], v[44:47], v[168:171], 0
  v_permlane16_swap_b32 v209, v210
  v_mfma_f32_16x16x32_bf16 v[92:95], v[48:51], v[172:175], v[92:95]
  ds_read_b64_tr_b16 v[42:43], v253 offset:1600
  v_mul_f32 v208, s59, v208
  v_mfma_f32_16x16x32_bf16 v[148:151], a[216:219], a[228:231], v[244:247]
  v_max_f32 v209, v209, v210
  v_mul_f32_e64 v211, -v209, v208
  v_cvt_pk_bf16_f32 v64, v96, v97
  s_waitcnt lgkmcnt(1)
  v_mfma_f32_16x16x32_bf16 v[136:139], v[104:107], a[232:235], v[136:139]
  v_cvt_pk_bf16_f32 v65, v98, v99
  v_xor_b32 v254, 32, v231
  v_mfma_f32_16x16x32_bf16 v[96:99], v[28:31], v[168:171], 0
  v_fma_f32 v152, v152, v208, v211
  v_fma_f32 v153, v153, v208, v211
  v_mfma_f32_16x16x32_bf16 v[96:99], v[32:35], v[172:175], v[96:99]
  v_fma_f32 v154, v154, v208, v211
  v_fma_f32 v155, v155, v208, v211
  v_mfma_f32_16x16x32_bf16 v[140:143], v[116:119], a[232:235], v[140:143]
  v_fma_f32 v156, v156, v208, v211
  v_fma_f32 v157, v157, v208, v211
  v_mfma_f32_16x16x32_bf16 v[144:147], v[128:131], a[232:235], v[144:147]
  v_fma_f32 v158, v158, v208, v211
  v_fma_f32 v159, v159, v208, v211
  v_mfma_f32_16x16x32_bf16 v[136:139], v[108:111], a[236:239], v[136:139]
  ds_read_b64_tr_b16 v[26:27], v254 offset:1536
  v_exp_f32 v152, v152
  v_mfma_f32_16x16x32_bf16 v[140:143], v[120:123], a[236:239], v[140:143]
  v_exp_f32 v153, v153
  v_mfma_f32_16x16x32_bf16 v[144:147], v[132:135], a[236:239], v[144:147]
  v_exp_f32 v154, v154
  v_mfma_f32_16x16x32_bf16 v[148:151], a[220:223], a[232:235], v[148:151]
  v_exp_f32 v155, v155
  v_mfma_f32_16x16x32_bf16 v[148:151], a[224:227], a[236:239], v[148:151]
  v_exp_f32 v156, v156
  s_waitcnt lgkmcnt(1)
  v_mfma_f32_16x16x32_bf16 v[88:91], v[40:43], v[172:175], v[88:91]
  v_exp_f32 v157, v157
  v_exp_f32 v158, v158
  v_exp_f32 v159, v159
  v_fma_f32 v160, v160, v208, v211
  v_fma_f32 v161, v161, v208, v211
  v_fma_f32 v162, v162, v208, v211
  v_fma_f32 v163, v163, v208, v211
  v_fma_f32 v164, v164, v208, v211
  buffer_store_dwordx4 v[220:223], v237, s[8:11], s62 offen offset:64 sc1
  v_exp_f32 v160, v160
  v_exp_f32 v161, v161
  v_exp_f32 v162, v162
  v_exp_f32 v163, v163
  v_exp_f32 v164, v164
  v_cvt_pk_bf16_f32 v4, v152, v153
  v_cvt_pk_bf16_f32 v5, v154, v155
  v_cvt_pk_bf16_f32 v6, v156, v157
  v_cvt_pk_bf16_f32 v7, v158, v159
  v_cvt_pk_bf16_f32 v222, v92, v93
  v_cvt_pk_bf16_f32 v223, v94, v95
  v_mfma_f32_16x16x32_bf16 v[92:95], v[16:19], v[4:7], 0
  ds_read_b64_tr_b16 v[66:67], v253 offset:1672
  v_cvt_pk_bf16_f32 v8, v160, v161
  v_cvt_pk_bf16_f32 v9, v162, v163
  v_cvt_pk_bf16_f32 v10, v164, v15
  v_cvt_pk_bf16_f32 v218, v96, v97
  v_cvt_pk_bf16_f32 v219, v98, v99
  v_mfma_f32_16x16x32_bf16 v[92:95], v[16:19], v[8:11], v[92:95]
  ds_read_b32 v200, v239 offset:1632
  ds_read_b64_tr_b16 v[50:51], v254 offset:1608
  v_mfma_f32_16x16x32_bf16 v[96:99], v[52:55], v[168:171], 0
  ds_read_b64_tr_b16 v[34:35], v254 offset:1544
  v_mul_f32 v152, v152, v184
  v_mfma_f32_16x16x32_bf16 v[96:99], v[56:59], v[172:175], v[96:99]
  v_mul_f32 v153, v153, v185
  v_mul_f32 v154, v154, v186
  v_rcp_f32 v212, v92
  v_mul_f32 v155, v155, v187
  v_mul_f32 v156, v156, v188
  v_mul_f32 v157, v157, v189
  v_mul_f32 v158, v158, v190
  v_mul_f32 v159, v159, v191
  v_mul_f32 v152, v152, v212
  v_mul_f32 v153, v153, v212
  v_mul_f32 v154, v154, v212
  v_mul_f32 v155, v155, v212
  v_mul_f32 v156, v156, v212
  v_mul_f32 v157, v157, v212
  v_mul_f32 v158, v158, v212
  v_mul_f32 v159, v159, v212
  v_mul_f32 v136, v136, v184
  v_mul_f32 v137, v137, v185
  v_mul_f32 v138, v138, v186
  v_mul_f32 v139, v139, v187
  v_mul_f32 v140, v140, v188
  v_mul_f32 v141, v141, v189
  v_mul_f32 v142, v142, v190
  v_mul_f32 v143, v143, v191
  v_mul_f32 v144, v144, v192
  v_xor_b32 v251, 32, v229
  buffer_store_dwordx4 v[224:227], v237, s[8:11], s62 offen offset:128 sc1
  v_mul_f32 v160, v160, v192
  v_mul_f32 v161, v161, v193
  v_mul_f32 v162, v162, v194
  v_mul_f32 v163, v163, v195
  v_mul_f32 v164, v164, v196
  v_cvt_pk_bf16_f32 v176, v152, v153
  v_cvt_pk_bf16_f32 v177, v154, v155
  v_cvt_pk_bf16_f32 v178, v156, v157
  v_cvt_pk_bf16_f32 v179, v158, v159
  v_mul_f32 v145, v145, v193
  v_mul_f32 v146, v146, v194
  v_mfma_f32_16x16x32_bf16 v[92:95], v[36:39], v[176:179], 0
  v_mul_f32 v147, v147, v195
  v_max3_f32 v201, v136, v137, v138
  v_max3_f32 v202, v139, v140, v141
  v_max3_f32 v203, v142, v143, v144
  ds_read_b128 a[240:243], v251 offset:1536
  v_cvt_pk_bf16_f32 v224, v96, v97
  v_cvt_pk_bf16_f32 v225, v98, v99
  v_mfma_f32_16x16x32_bf16 v[96:99], v[20:23], v[176:179], 0
  v_mul_f32 v160, v160, v212
  v_mul_f32 v161, v161, v212
  v_mul_f32 v162, v162, v212
  v_mul_f32 v163, v163, v212
  v_fma_f32 v164, v164, v212, v242
  v_mul_f32 v148, v148, v196
  v_max3_f32 v204, v145, v146, v147
  v_max3_f32 v201, v201, v202, v203
  v_cvt_pk_bf16_f32 v180, v160, v161
  v_cvt_pk_bf16_f32 v181, v162, v163
  v_cvt_pk_bf16_f32 v182, v164, v243
  v_max3_f32 v201, v201, v204, v148
  ds_read_b128 a[244:247], v251 offset:1600
  s_waitcnt lgkmcnt(2)
  v_mfma_f32_16x16x32_bf16 v[96:99], v[24:27], v[180:183], v[96:99]
  v_mov_b32 v202, v201
  v_cvt_pk_bf16_f32 v220, v88, v89
  v_cvt_pk_bf16_f32 v221, v90, v91
  v_mfma_f32_16x16x32_bf16 v[88:91], v[60:63], v[168:171], 0
  v_permlane32_swap_b32 v201, v202
  v_mfma_f32_16x16x32_bf16 v[88:91], v[64:67], v[172:175], v[88:91]
  ds_read_b128 a[248:251], v251 offset:1664
  ds_read_b64_tr_b16 v[58:59], v254 offset:1664
  v_max_f32 v201, v201, v202
  s_waitcnt lgkmcnt(3)
  v_mfma_f32_16x16x32_bf16 v[152:155], v[100:103], a[240:243], 0
  buffer_store_dwordx4 v[216:219], v234, s[8:11], s63 offen sc1
  v_mov_b32 v202, v201
  v_mfma_f32_16x16x32_bf16 v[156:159], v[112:115], a[240:243], 0
  v_cvt_pk_bf16_f32 v216, v96, v97
  v_cvt_pk_bf16_f32 v217, v98, v99
  v_mfma_f32_16x16x32_bf16 v[96:99], v[44:47], v[176:179], 0
  v_permlane16_swap_b32 v201, v202
  v_mfma_f32_16x16x32_bf16 v[96:99], v[48:51], v[180:183], v[96:99]
  ds_read_b64_tr_b16 v[42:43], v254 offset:1600
  v_xor_b32 v249, 48, v228
  v_mfma_f32_16x16x32_bf16 v[160:163], v[124:127], a[240:243], 0
  v_mul_f32 v200, s59, v200
  v_max_f32 v201, v201, v202
  s_waitcnt lgkmcnt(1)
  v_mfma_f32_16x16x32_bf16 v[152:155], v[104:107], a[244:247], v[152:155]
  ds_read_b128 a[180:183], v249 offset:2304
  v_mul_f32_e64 v203, -v201, v200
  v_mfma_f32_16x16x32_bf16 v[156:159], v[116:119], a[244:247], v[156:159]
  v_cvt_pk_bf16_f32 v226, v88, v89
  v_cvt_pk_bf16_f32 v227, v90, v91
  v_mfma_f32_16x16x32_bf16 v[88:91], v[28:31], v[176:179], 0
  v_xor_b32 v253, 32, v232
  v_fma_f32 v136, v136, v200, v203
  v_mfma_f32_16x16x32_bf16 v[88:91], v[32:35], v[180:183], v[88:91]
  v_fma_f32 v137, v137, v200, v203
  v_fma_f32 v138, v138, v200, v203
  v_mfma_f32_16x16x32_bf16 v[160:163], v[128:131], a[244:247], v[160:163]
  v_fma_f32 v139, v139, v200, v203
  v_fma_f32 v140, v140, v200, v203
  v_mfma_f32_16x16x32_bf16 v[164:167], a[216:219], a[240:243], v[244:247]
  v_fma_f32 v141, v141, v200, v203
  v_fma_f32 v142, v142, v200, v203
  v_mfma_f32_16x16x32_bf16 v[152:155], v[108:111], a[248:251], v[152:155]
  v_fma_f32 v143, v143, v200, v203
  ds_read_b128 a[184:187], v249 offset:2368
  v_mfma_f32_16x16x32_bf16 v[156:159], v[120:123], a[248:251], v[156:159]
  ds_read_b64_tr_b16 v[26:27], v253 offset:1536
  v_exp_f32 v136, v136
  v_mfma_f32_16x16x32_bf16 v[160:163], v[132:135], a[248:251], v[160:163]
  v_exp_f32 v137, v137
  v_mfma_f32_16x16x32_bf16 v[164:167], a[220:223], a[244:247], v[164:167]
  v_exp_f32 v138, v138
  v_mfma_f32_16x16x32_bf16 v[164:167], a[224:227], a[248:251], v[164:167]
  v_exp_f32 v139, v139
  s_waitcnt lgkmcnt(2)
  v_mfma_f32_16x16x32_bf16 v[92:95], v[40:43], v[180:183], v[92:95]
  v_exp_f32 v140, v140
  v_mfma_f32_16x16x32_bf16 v[76:79], a[0:3], a[180:183], 0
  v_exp_f32 v141, v141
  v_mfma_f32_16x16x32_bf16 v[80:83], a[12:15], a[180:183], 0
  v_exp_f32 v142, v142
  v_mfma_f32_16x16x32_bf16 v[84:87], a[24:27], a[180:183], 0
  v_exp_f32 v143, v143
  s_waitcnt lgkmcnt(0)
  v_mfma_f32_16x16x32_bf16 v[76:79], a[4:7], a[184:187], v[76:79]
  v_fma_f32 v144, v144, v200, v203
  v_fma_f32 v145, v145, v200, v203
  v_mfma_f32_16x16x32_bf16 v[80:83], a[16:19], a[184:187], v[80:83]
  v_fma_f32 v146, v146, v200, v203
  v_fma_f32 v147, v147, v200, v203
  v_mfma_f32_16x16x32_bf16 v[84:87], a[28:31], a[184:187], v[84:87]
  v_fma_f32 v148, v148, v200, v203
  ds_read_b128 a[188:191], v249 offset:2432
  v_mfma_f32_16x16x32_bf16 v[68:71], a[36:39], a[180:183], 0
  buffer_store_dwordx4 v[220:223], v234, s[8:11], s63 offen offset:64 sc1
  v_exp_f32 v144, v144
  v_mfma_f32_16x16x32_bf16 v[68:71], a[40:43], a[184:187], v[68:71]
  v_exp_f32 v145, v145
  v_mfma_f32_16x16x32_bf16 v[72:75], a[48:51], a[180:183], 0
  v_exp_f32 v146, v146
  v_mfma_f32_16x16x32_bf16 v[72:75], a[52:55], a[184:187], v[72:75]
  v_exp_f32 v147, v147
  v_exp_f32 v148, v148
  v_cvt_pk_bf16_f32 v4, v136, v137
  v_cvt_pk_bf16_f32 v5, v138, v139
  v_cvt_pk_bf16_f32 v6, v140, v141
  v_cvt_pk_bf16_f32 v7, v142, v143
  v_cvt_pk_bf16_f32 v222, v96, v97
  v_cvt_pk_bf16_f32 v223, v98, v99
  v_mfma_f32_16x16x32_bf16 v[96:99], v[16:19], v[4:7], 0
  ds_read_b64_tr_b16 v[66:67], v254 offset:1672
  v_cvt_pk_bf16_f32 v8, v144, v145
  v_cvt_pk_bf16_f32 v9, v146, v147
  v_cvt_pk_bf16_f32 v10, v148, v15
  s_waitcnt lgkmcnt(1)
  v_mfma_f32_16x16x32_bf16 v[76:79], a[8:11], a[188:191], v[76:79]
  v_cvt_pk_bf16_f32 v218, v88, v89
  v_cvt_pk_bf16_f32 v219, v90, v91
  v_mfma_f32_16x16x32_bf16 v[96:99], v[16:19], v[8:11], v[96:99]
  ds_read_b32 v208, v13 offset:1536
  ds_read_b64_tr_b16 v[50:51], v253 offset:1608
  v_mfma_f32_16x16x32_bf16 v[88:91], v[52:55], v[176:179], 0
  ds_read_b128 a[192:195], v249 offset:14592
  ds_read_b128 a[196:199], v249 offset:14656
  v_mfma_f32_16x16x32_bf16 v[88:91], v[56:59], v[180:183], v[88:91]
  ds_read_b64_tr_b16 v[34:35], v253 offset:1544
  v_mul_f32 v136, v136, v184
  v_mfma_f32_16x16x32_bf16 v[80:83], a[20:23], a[188:191], v[80:83]
  v_rcp_f32 v204, v96
  v_mfma_f32_16x16x32_bf16 v[84:87], a[32:35], a[188:191], v[84:87]
  v_mul_f32 v137, v137, v185
  v_mul_f32 v138, v138, v186
  v_mfma_f32_16x16x32_bf16 v[68:71], a[44:47], a[188:191], v[68:71]
  v_mul_f32 v139, v139, v187
  v_mul_f32 v140, v140, v188
  v_mfma_f32_16x16x32_bf16 v[72:75], a[56:59], a[188:191], v[72:75]
  v_mul_f32 v141, v141, v189
  v_mul_f32 v142, v142, v190
  v_mul_f32 v143, v143, v191
  v_mul_f32 v136, v136, v204
  v_mul_f32 v137, v137, v204
  v_mul_f32 v138, v138, v204
  v_mul_f32 v139, v139, v204
  v_mul_f32 v140, v140, v204
  v_mul_f32 v141, v141, v204
  v_mul_f32 v142, v142, v204
  v_mul_f32 v143, v143, v204
  v_mul_f32 v152, v152, v184
  v_mul_f32 v153, v153, v185
  v_mul_f32 v154, v154, v186
  v_mul_f32 v155, v155, v187
  v_mul_f32 v156, v156, v188
  v_mul_f32 v157, v157, v189
  v_mul_f32 v158, v158, v190
  v_mul_f32 v159, v159, v191
  v_mul_f32 v160, v160, v192
  buffer_store_dwordx4 v[224:227], v234, s[8:11], s63 offen offset:128 sc1
  ds_read_b128 a[200:203], v249 offset:14720
  v_mul_f32 v144, v144, v192
  v_mul_f32 v145, v145, v193
  v_mul_f32 v146, v146, v194
  v_mul_f32 v147, v147, v195
  v_mul_f32 v148, v148, v196
  v_cvt_pk_bf16_f32 v168, v136, v137
  v_cvt_pk_bf16_f32 v169, v138, v139
  v_cvt_pk_bf16_f32 v170, v140, v141
  v_cvt_pk_bf16_f32 v171, v142, v143
  v_mul_f32 v161, v161, v193
  v_mul_f32 v162, v162, v194
  v_mfma_f32_16x16x32_bf16 v[96:99], v[36:39], v[168:171], 0
  v_mul_f32 v163, v163, v195
  v_max3_f32 v209, v152, v153, v154
  v_max3_f32 v210, v155, v156, v157
  v_max3_f32 v211, v158, v159, v160
  v_cvt_pk_bf16_f32 v224, v88, v89
  v_cvt_pk_bf16_f32 v225, v90, v91
  v_mfma_f32_16x16x32_bf16 v[88:91], v[20:23], v[168:171], 0
  v_mul_f32 v144, v144, v204
  v_mul_f32 v145, v145, v204
  v_mul_f32 v146, v146, v204
  v_mul_f32 v147, v147, v204
  v_fma_f32 v148, v148, v204, v242
  v_mul_f32 v164, v164, v196
  v_max3_f32 v212, v161, v162, v163
  v_max3_f32 v209, v209, v210, v211
  v_cvt_pk_bf16_f32 v172, v144, v145
  v_cvt_pk_bf16_f32 v173, v146, v147
  v_cvt_pk_bf16_f32 v174, v148, v243
  v_max3_f32 v209, v209, v212, v164
  v_mov_b32 v210, v209
  v_mfma_f32_16x16x32_bf16 v[88:91], v[24:27], v[172:175], v[88:91]
  v_cvt_pk_bf16_f32 v220, v92, v93
  v_cvt_pk_bf16_f32 v221, v94, v95
  v_mfma_f32_16x16x32_bf16 v[92:95], v[60:63], v[176:179], 0
  v_permlane32_swap_b32 v209, v210
  s_waitcnt lgkmcnt(0)
  v_mfma_f32_16x16x32_bf16 v[92:95], v[64:67], v[180:183], v[92:95]
  ds_read_b128 a[204:207], v249 offset:26880
  ds_read_b64_tr_b16 v[58:59], v253 offset:1664
  v_max_f32 v209, v209, v210
  buffer_store_dwordx4 v[216:219], v235, s[8:11], s63 offen sc1
  v_mov_b32 v210, v209
  ds_read_b128 a[208:211], v249 offset:26944
  v_cvt_pk_bf16_f32 v216, v88, v89
  v_cvt_pk_bf16_f32 v217, v90, v91
  v_mfma_f32_16x16x32_bf16 v[88:91], v[44:47], v[168:171], 0
  v_permlane16_swap_b32 v209, v210
  v_mfma_f32_16x16x32_bf16 v[88:91], v[48:51], v[172:175], v[88:91]
  ds_read_b64_tr_b16 v[42:43], v253 offset:1600
  ds_read_b128 a[212:215], v249 offset:27008
  v_cvt_pk_bf16_f32 v100, v76, v77
  v_cvt_pk_bf16_f32 v101, v78, v79
  v_mfma_f32_16x16x32_bf16 v[76:79], a[60:63], a[180:183], 0
  v_mul_f32 v208, s59, v208
  v_max_f32 v209, v209, v210
  v_mfma_f32_16x16x32_bf16 v[76:79], a[64:67], a[184:187], v[76:79]
  v_mul_f32_e64 v211, -v209, v208
  v_cvt_pk_bf16_f32 v102, v80, v81
  v_mfma_f32_16x16x32_bf16 v[76:79], a[68:71], a[188:191], v[76:79]
  v_cvt_pk_bf16_f32 v103, v82, v83
  v_cvt_pk_bf16_f32 v104, v84, v85
  v_mfma_f32_16x16x32_bf16 v[80:83], a[0:3], a[192:195], 0
  v_cvt_pk_bf16_f32 v105, v86, v87
  v_cvt_pk_bf16_f32 v226, v92, v93
  v_mfma_f32_16x16x32_bf16 v[84:87], a[12:15], a[192:195], 0
  v_cvt_pk_bf16_f32 v227, v94, v95
  v_xor_b32 v254, 32, v233
  v_mfma_f32_16x16x32_bf16 v[92:95], v[28:31], v[168:171], 0
  v_fma_f32 v152, v152, v208, v211
  v_fma_f32 v153, v153, v208, v211
  v_mfma_f32_16x16x32_bf16 v[80:83], a[4:7], a[196:199], v[80:83]
  v_fma_f32 v154, v154, v208, v211
  v_fma_f32 v155, v155, v208, v211
  v_mfma_f32_16x16x32_bf16 v[84:87], a[16:19], a[196:199], v[84:87]
  v_fma_f32 v156, v156, v208, v211
  v_fma_f32 v157, v157, v208, v211
  v_mfma_f32_16x16x32_bf16 v[92:95], v[32:35], v[172:175], v[92:95]
  v_fma_f32 v158, v158, v208, v211
  v_fma_f32 v159, v159, v208, v211
  v_mfma_f32_16x16x32_bf16 v[80:83], a[8:11], a[200:203], v[80:83]
  ds_read_b64_tr_b16 v[26:27], v254 offset:1536
  v_exp_f32 v152, v152
  v_mfma_f32_16x16x32_bf16 v[84:87], a[20:23], a[200:203], v[84:87]
  v_exp_f32 v153, v153
  s_waitcnt lgkmcnt(1)
  v_mfma_f32_16x16x32_bf16 v[96:99], v[40:43], v[172:175], v[96:99]
  v_exp_f32 v154, v154
  v_exp_f32 v155, v155
  v_exp_f32 v156, v156
  v_exp_f32 v157, v157
  v_exp_f32 v158, v158
  v_exp_f32 v159, v159
  v_fma_f32 v160, v160, v208, v211
  v_fma_f32 v161, v161, v208, v211
  v_fma_f32 v162, v162, v208, v211
  v_fma_f32 v163, v163, v208, v211
  v_fma_f32 v164, v164, v208, v211
  buffer_store_dwordx4 v[220:223], v235, s[8:11], s63 offen offset:64 sc1
  v_exp_f32 v160, v160
  v_exp_f32 v161, v161
  v_exp_f32 v162, v162
  v_exp_f32 v163, v163
  v_exp_f32 v164, v164
  v_cvt_pk_bf16_f32 v4, v152, v153
  v_cvt_pk_bf16_f32 v5, v154, v155
  v_cvt_pk_bf16_f32 v6, v156, v157
  v_cvt_pk_bf16_f32 v7, v158, v159
  v_cvt_pk_bf16_f32 v222, v88, v89
  v_cvt_pk_bf16_f32 v223, v90, v91
  v_mfma_f32_16x16x32_bf16 v[88:91], v[16:19], v[4:7], 0
  ds_read_b64_tr_b16 v[66:67], v253 offset:1672
  v_cvt_pk_bf16_f32 v106, v68, v69
  v_cvt_pk_bf16_f32 v107, v70, v71
  v_mfma_f32_16x16x32_bf16 v[68:71], a[24:27], a[192:195], 0
  v_cvt_pk_bf16_f32 v8, v160, v161
  v_cvt_pk_bf16_f32 v9, v162, v163
  v_mfma_f32_16x16x32_bf16 v[68:71], a[28:31], a[196:199], v[68:71]
  v_cvt_pk_bf16_f32 v10, v164, v15
  v_cvt_pk_bf16_f32 v108, v72, v73
  v_mfma_f32_16x16x32_bf16 v[68:71], a[32:35], a[200:203], v[68:71]
  v_cvt_pk_bf16_f32 v109, v74, v75
  v_cvt_pk_bf16_f32 v110, v76, v77
  v_mfma_f32_16x16x32_bf16 v[88:91], v[16:19], v[8:11], v[88:91]
  v_cvt_pk_bf16_f32 v111, v78, v79
  v_cvt_pk_bf16_f32 v218, v92, v93
  v_mfma_f32_16x16x32_bf16 v[72:75], a[36:39], a[192:195], 0
  v_cvt_pk_bf16_f32 v219, v94, v95
  ds_read_b64_tr_b16 v[50:51], v254 offset:1608
  v_mfma_f32_16x16x32_bf16 v[76:79], a[48:51], a[192:195], 0
  ds_read_b128 a[216:219], v250 offset:576
  v_cvt_pk_bf16_f32 v112, v80, v81
  v_mfma_f32_16x16x32_bf16 v[92:95], v[52:55], v[168:171], 0
  v_cvt_pk_bf16_f32 v113, v82, v83
  v_cvt_pk_bf16_f32 v114, v84, v85
  v_mfma_f32_16x16x32_bf16 v[72:75], a[40:43], a[196:199], v[72:75]
  v_cvt_pk_bf16_f32 v115, v86, v87
  ds_read_b128 a[228:231], v249 offset:2304
  v_mfma_f32_16x16x32_bf16 v[76:79], a[52:55], a[196:199], v[76:79]
  ds_read_b128 a[220:223], v250 offset:640
  ds_read_b128 a[232:235], v249 offset:2368
  v_mfma_f32_16x16x32_bf16 v[80:83], a[60:63], a[192:195], 0
  v_rcp_f32 v212, v88
  v_mfma_f32_16x16x32_bf16 v[84:87], a[0:3], a[204:207], 0
  ds_read_b64_tr_b16 v[34:35], v254 offset:1544
  v_mul_f32 v152, v152, v184
  v_mfma_f32_16x16x32_bf16 v[92:95], v[56:59], v[172:175], v[92:95]
  v_mul_f32 v153, v153, v185
  v_mul_f32 v154, v154, v186
  v_mfma_f32_16x16x32_bf16 v[72:75], a[44:47], a[200:203], v[72:75]
  v_mul_f32 v155, v155, v187
  v_mul_f32 v156, v156, v188
  v_mfma_f32_16x16x32_bf16 v[76:79], a[56:59], a[200:203], v[76:79]
  v_mul_f32 v157, v157, v189
  v_mul_f32 v158, v158, v190
  v_mfma_f32_16x16x32_bf16 v[80:83], a[64:67], a[196:199], v[80:83]
  v_mul_f32 v159, v159, v191
  ds_read_b128 a[224:227], v250 offset:704
  v_mfma_f32_16x16x32_bf16 v[84:87], a[4:7], a[208:211], v[84:87]
  ds_read_b128 a[236:239], v249 offset:2432
  v_mul_f32 v152, v152, v212
  v_mfma_f32_16x16x32_bf16 v[80:83], a[68:71], a[200:203], v[80:83]
  v_mul_f32 v153, v153, v212
  v_mul_f32 v154, v154, v212
  v_mfma_f32_16x16x32_bf16 v[84:87], a[8:11], a[212:215], v[84:87]
  v_mul_f32 v155, v155, v212
  v_mul_f32 v156, v156, v212
  s_waitcnt lgkmcnt(2)
  v_mfma_f32_16x16x32_bf16 v[136:139], v[100:103], a[228:231], 0
  v_mul_f32 v157, v157, v212
  v_mul_f32 v158, v158, v212
  v_mfma_f32_16x16x32_bf16 v[140:143], v[112:115], a[228:231], 0
  v_mul_f32 v159, v159, v212
  buffer_store_dwordx4 v[224:227], v235, s[8:11], s63 offen offset:128 sc1
  v_mfma_f32_16x16x32_bf16 v[148:151], a[216:219], a[228:231], v[244:247]
  v_mul_f32 v160, v160, v192
  v_mul_f32 v161, v161, v193
  v_mfma_f32_16x16x32_bf16 v[136:139], v[104:107], a[232:235], v[136:139]
  v_mul_f32 v162, v162, v194
  v_mul_f32 v163, v163, v195
  v_mfma_f32_16x16x32_bf16 v[148:151], a[220:223], a[232:235], v[148:151]
  v_mul_f32 v164, v164, v196
  v_cvt_pk_bf16_f32 v176, v152, v153
  v_cvt_pk_bf16_f32 v177, v154, v155
  v_cvt_pk_bf16_f32 v178, v156, v157
  s_waitcnt lgkmcnt(0)
  v_mfma_f32_16x16x32_bf16 v[136:139], v[108:111], a[236:239], v[136:139]
  v_cvt_pk_bf16_f32 v179, v158, v159
  v_cvt_pk_bf16_f32 v116, v68, v69
  v_mfma_f32_16x16x32_bf16 v[148:151], a[224:227], a[236:239], v[148:151]
  v_cvt_pk_bf16_f32 v117, v70, v71
  v_cvt_pk_bf16_f32 v224, v92, v93
  v_mfma_f32_16x16x32_bf16 v[68:71], a[12:15], a[204:207], 0
  v_cvt_pk_bf16_f32 v225, v94, v95
  v_mul_f32 v160, v160, v212
  v_mfma_f32_16x16x32_bf16 v[92:95], v[20:23], v[176:179], 0
  v_mul_f32 v161, v161, v212
  v_mul_f32 v162, v162, v212
  v_mfma_f32_16x16x32_bf16 v[68:71], a[16:19], a[208:211], v[68:71]
  v_mul_f32 v163, v163, v212
  v_fma_f32 v164, v164, v212, v242
  v_mfma_f32_16x16x32_bf16 v[68:71], a[20:23], a[212:215], v[68:71]
  v_cvt_pk_bf16_f32 v180, v160, v161
  v_cvt_pk_bf16_f32 v181, v162, v163
  v_mfma_f32_16x16x32_bf16 v[88:91], v[36:39], v[176:179], 0
  v_cvt_pk_bf16_f32 v182, v164, v243
  v_cvt_pk_bf16_f32 v118, v72, v73
  v_cvt_pk_bf16_f32 v119, v74, v75
  v_mfma_f32_16x16x32_bf16 v[72:75], a[24:27], a[204:207], 0
  v_cvt_pk_bf16_f32 v120, v76, v77
  v_cvt_pk_bf16_f32 v121, v78, v79
  v_mfma_f32_16x16x32_bf16 v[76:79], a[36:39], a[204:207], 0
  v_cvt_pk_bf16_f32 v220, v96, v97
  v_cvt_pk_bf16_f32 v221, v98, v99
  v_mfma_f32_16x16x32_bf16 v[92:95], v[24:27], v[180:183], v[92:95]
  v_cvt_pk_bf16_f32 v122, v80, v81
  v_cvt_pk_bf16_f32 v123, v82, v83
  v_mfma_f32_16x16x32_bf16 v[96:99], v[60:63], v[168:171], 0
  v_cvt_pk_bf16_f32 v124, v84, v85
  v_cvt_pk_bf16_f32 v125, v86, v87
  v_mfma_f32_16x16x32_bf16 v[72:75], a[28:31], a[208:211], v[72:75]
  ds_read_b64_tr_b16 v[58:59], v254 offset:1664
  buffer_store_dwordx4 v[216:219], v236, s[8:11], s63 offen sc1
  v_mfma_f32_16x16x32_bf16 v[76:79], a[40:43], a[208:211], v[76:79]
  ds_read_b64_tr_b16 v[42:43], v254 offset:1600
  v_cvt_pk_bf16_f32 v216, v92, v93
  v_mfma_f32_16x16x32_bf16 v[80:83], a[48:51], a[204:207], 0
  v_cvt_pk_bf16_f32 v217, v94, v95
  v_cvt_pk_bf16_f32 v126, v68, v69
  v_mfma_f32_16x16x32_bf16 v[84:87], a[60:63], a[204:207], 0
  v_cvt_pk_bf16_f32 v127, v70, v71
  buffer_store_dwordx4 v[220:223], v236, s[8:11], s63 offen offset:64 sc1
  v_mfma_f32_16x16x32_bf16 v[96:99], v[64:67], v[172:175], v[96:99]
  ds_read_b64_tr_b16 v[66:67], v254 offset:1672
  ds_read_b128 v[184:187], v238 offset:2304
  v_mfma_f32_16x16x32_bf16 v[72:75], a[32:35], a[212:215], v[72:75]
  ds_read_b128 v[188:191], v238 offset:2368
  ds_read_b128 v[192:195], v238 offset:2432
  v_mfma_f32_16x16x32_bf16 v[76:79], a[44:47], a[212:215], v[76:79]
  ds_read_b32 v196, v240 offset:2880
  ds_read_b32 v200, v239 offset:2304
  v_mfma_f32_16x16x32_bf16 v[80:83], a[52:55], a[208:211], v[80:83]
  v_cvt_pk_bf16_f32 v226, v96, v97
  v_cvt_pk_bf16_f32 v227, v98, v99
  v_mfma_f32_16x16x32_bf16 v[84:87], a[64:67], a[208:211], v[84:87]
  v_cvt_pk_bf16_f32 v128, v72, v73
  v_cvt_pk_bf16_f32 v129, v74, v75
  v_mfma_f32_16x16x32_bf16 v[92:95], v[44:47], v[176:179], 0
  v_cvt_pk_bf16_f32 v130, v76, v77
  v_cvt_pk_bf16_f32 v131, v78, v79
  v_mfma_f32_16x16x32_bf16 v[80:83], a[56:59], a[212:215], v[80:83]
  buffer_store_dwordx4 v[224:227], v236, s[8:11], s63 offen offset:128 sc1
  ds_read_b128 a[240:243], v249 offset:11520
  v_mfma_f32_16x16x32_bf16 v[84:87], a[68:71], a[212:215], v[84:87]
  ds_read_b128 a[244:247], v249 offset:11584
  ds_read_b128 a[248:251], v249 offset:11648
  v_mfma_f32_16x16x32_bf16 v[92:95], v[48:51], v[180:183], v[92:95]
  v_xor_b32 v253, 48, v230
  s_waitcnt lgkmcnt(3)
  v_mul_f32 v136, v136, v184
  v_mfma_f32_16x16x32_bf16 v[144:147], v[124:127], a[228:231], 0
  v_cvt_pk_bf16_f32 v132, v80, v81
  v_cvt_pk_bf16_f32 v133, v82, v83
  v_mfma_f32_16x16x32_bf16 v[96:99], v[28:31], v[176:179], 0
  v_cvt_pk_bf16_f32 v134, v84, v85
  v_cvt_pk_bf16_f32 v135, v86, v87
  v_mfma_f32_16x16x32_bf16 v[140:143], v[116:119], a[232:235], v[140:143]
  v_cvt_pk_bf16_f32 v222, v92, v93
  v_cvt_pk_bf16_f32 v223, v94, v95
  v_mfma_f32_16x16x32_bf16 v[144:147], v[128:131], a[232:235], v[144:147]
  v_mul_f32 v137, v137, v185
  v_mul_f32 v138, v138, v186
  v_mfma_f32_16x16x32_bf16 v[96:99], v[32:35], v[180:183], v[96:99]
  v_mul_f32 v139, v139, v187
  v_max3_f32 v201, v136, v137, v138
  v_mfma_f32_16x16x32_bf16 v[140:143], v[120:123], a[236:239], v[140:143]
  v_mul_f32 v148, v148, v196
  v_mul_f32 v200, s59, v200
  v_mfma_f32_16x16x32_bf16 v[144:147], v[132:135], a[236:239], v[144:147]
  ds_read_b64_tr_b16 v[26:27], v253 offset:2304
  ds_read_b32 v208, v239 offset:2352
  v_mfma_f32_16x16x32_bf16 v[92:95], a[180:183], a[72:75], 0
  v_cvt_pk_bf16_f32 v218, v96, v97
  v_cvt_pk_bf16_f32 v219, v98, v99
  v_mfma_f32_16x16x32_bf16 v[92:95], a[184:187], a[76:79], v[92:95]
  v_mul_f32 v140, v140, v188
  v_mul_f32 v141, v141, v189
  v_mfma_f32_16x16x32_bf16 v[96:99], v[52:55], v[176:179], 0
  v_mul_f32 v142, v142, v190
  v_mul_f32 v143, v143, v191
  v_mfma_f32_16x16x32_bf16 v[92:95], a[188:191], a[80:83], v[92:95]
  v_mul_f32 v144, v144, v192
  v_mul_f32 v145, v145, v193
  v_mfma_f32_16x16x32_bf16 v[96:99], v[56:59], v[180:183], v[96:99]
  v_mul_f32 v146, v146, v194
  v_mul_f32 v147, v147, v195
  v_mfma_f32_16x16x32_bf16 v[88:91], v[40:43], v[180:183], v[88:91]
  v_max3_f32 v202, v139, v140, v141
  v_max3_f32 v203, v142, v143, v144
  s_waitcnt lgkmcnt(1)
  v_mfma_f32_16x16x32_bf16 v[152:155], v[100:103], a[240:243], 0
  v_cvt_pk_bf16_f32 v20, v92, v93
  v_cvt_pk_bf16_f32 v21, v94, v95
  v_mfma_f32_16x16x32_bf16 v[92:95], a[180:183], a[108:111], 0
  v_cvt_pk_bf16_f32 v224, v96, v97
  v_cvt_pk_bf16_f32 v225, v98, v99
  v_mfma_f32_16x16x32_bf16 v[96:99], a[180:183], a[84:87], 0
  v_cvt_pk_bf16_f32 v220, v88, v89
  v_cvt_pk_bf16_f32 v221, v90, v91
  v_mfma_f32_16x16x32_bf16 v[92:95], a[184:187], a[112:115], v[92:95]
  v_max3_f32 v204, v145, v146, v147
  v_max3_f32 v201, v201, v202, v203
  v_mfma_f32_16x16x32_bf16 v[96:99], a[184:187], a[88:91], v[96:99]
  v_max3_f32 v201, v201, v204, v148
  v_mov_b32 v202, v201
  v_mfma_f32_16x16x32_bf16 v[92:95], a[188:191], a[116:119], v[92:95]
  ds_read_b64_tr_b16 v[50:51], v253 offset:2376
  v_permlane32_swap_b32 v201, v202
  v_mfma_f32_16x16x32_bf16 v[88:91], v[60:63], v[176:179], 0
  v_max_f32 v201, v201, v202
  v_mov_b32 v202, v201
  v_mfma_f32_16x16x32_bf16 v[96:99], a[188:191], a[92:95], v[96:99]
  ds_read_b64_tr_b16 v[34:35], v253 offset:2312
  v_permlane16_swap_b32 v201, v202
  v_mfma_f32_16x16x32_bf16 v[88:91], v[64:67], v[180:183], v[88:91]
  v_cvt_pk_bf16_f32 v44, v92, v93
  v_cvt_pk_bf16_f32 v45, v94, v95
  v_mfma_f32_16x16x32_bf16 v[92:95], a[192:195], a[72:75], 0
  v_max_f32 v201, v201, v202
  v_mul_f32_e64 v203, -v201, v200
  v_mfma_f32_16x16x32_bf16 v[92:95], a[196:199], a[76:79], v[92:95]
  v_cvt_pk_bf16_f32 v28, v96, v97
  v_cvt_pk_bf16_f32 v29, v98, v99
  v_mfma_f32_16x16x32_bf16 v[96:99], a[180:183], a[120:123], 0
  v_cvt_pk_bf16_f32 v226, v88, v89
  v_cvt_pk_bf16_f32 v227, v90, v91
  v_mfma_f32_16x16x32_bf16 v[88:91], a[180:183], a[96:99], 0
  v_fma_f32 v136, v136, v200, v203
  v_fma_f32 v137, v137, v200, v203
  v_mfma_f32_16x16x32_bf16 v[96:99], a[184:187], a[124:127], v[96:99]
  v_fma_f32 v138, v138, v200, v203
  v_fma_f32 v139, v139, v200, v203
  v_mfma_f32_16x16x32_bf16 v[92:95], a[200:203], a[80:83], v[92:95]
  v_fma_f32 v140, v140, v200, v203
  v_fma_f32 v141, v141, v200, v203
  v_mfma_f32_16x16x32_bf16 v[88:91], a[184:187], a[100:103], v[88:91]
  v_fma_f32 v142, v142, v200, v203
  v_fma_f32 v143, v143, v200, v203
  v_mfma_f32_16x16x32_bf16 v[96:99], a[188:191], a[128:131], v[96:99]
  v_exp_f32 v136, v136
  v_mfma_f32_16x16x32_bf16 v[88:91], a[188:191], a[104:107], v[88:91]
  v_cvt_pk_bf16_f32 v22, v92, v93
  v_cvt_pk_bf16_f32 v23, v94, v95
  v_mfma_f32_16x16x32_bf16 v[92:95], a[192:195], a[108:111], 0
  v_exp_f32 v137, v137
  v_mfma_f32_16x16x32_bf16 v[92:95], a[196:199], a[112:115], v[92:95]
  v_exp_f32 v138, v138
  v_mfma_f32_16x16x32_bf16 v[92:95], a[200:203], a[116:119], v[92:95]
  v_cvt_pk_bf16_f32 v52, v96, v97
  v_cvt_pk_bf16_f32 v53, v98, v99
  v_mfma_f32_16x16x32_bf16 v[96:99], a[192:195], a[84:87], 0
  v_cvt_pk_bf16_f32 v36, v88, v89
  v_cvt_pk_bf16_f32 v37, v90, v91
  v_mfma_f32_16x16x32_bf16 v[88:91], a[180:183], a[132:135], 0
  v_exp_f32 v139, v139
  v_mfma_f32_16x16x32_bf16 v[96:99], a[196:199], a[88:91], v[96:99]
  v_cvt_pk_bf16_f32 v46, v92, v93
  v_cvt_pk_bf16_f32 v47, v94, v95
  v_mfma_f32_16x16x32_bf16 v[88:91], a[184:187], a[136:139], v[88:91]
  v_exp_f32 v140, v140
  v_mfma_f32_16x16x32_bf16 v[96:99], a[200:203], a[92:95], v[96:99]
  v_exp_f32 v141, v141
  v_mfma_f32_16x16x32_bf16 v[88:91], a[188:191], a[140:143], v[88:91]
  v_exp_f32 v142, v142
  v_mfma_f32_16x16x32_bf16 v[92:95], a[204:207], a[72:75], 0
  v_exp_f32 v143, v143
  v_mfma_f32_16x16x32_bf16 v[92:95], a[208:211], a[76:79], v[92:95]
  v_fma_f32 v144, v144, v200, v203
  v_fma_f32 v145, v145, v200, v203
  v_mfma_f32_16x16x32_bf16 v[92:95], a[212:215], a[80:83], v[92:95]
  v_cvt_pk_bf16_f32 v30, v96, v97
  v_cvt_pk_bf16_f32 v31, v98, v99
  v_mfma_f32_16x16x32_bf16 v[96:99], a[192:195], a[120:123], 0
  v_cvt_pk_bf16_f32 v60, v88, v89
  v_cvt_pk_bf16_f32 v61, v90, v91
  v_mfma_f32_16x16x32_bf16 v[88:91], a[192:195], a[96:99], 0
  v_fma_f32 v146, v146, v200, v203
  v_fma_f32 v147, v147, v200, v203
  v_mfma_f32_16x16x32_bf16 v[96:99], a[196:199], a[124:127], v[96:99]
  v_cvt_pk_bf16_f32 v24, v92, v93
  v_cvt_pk_bf16_f32 v25, v94, v95
  v_mfma_f32_16x16x32_bf16 v[88:91], a[196:199], a[100:103], v[88:91]
  v_fma_f32 v148, v148, v200, v203
  v_exp_f32 v144, v144
  v_mfma_f32_16x16x32_bf16 v[96:99], a[200:203], a[128:131], v[96:99]
  v_exp_f32 v145, v145
  v_mfma_f32_16x16x32_bf16 v[88:91], a[200:203], a[104:107], v[88:91]
  v_exp_f32 v146, v146
  v_mfma_f32_16x16x32_bf16 v[92:95], a[204:207], a[108:111], 0
  v_exp_f32 v147, v147
  v_mfma_f32_16x16x32_bf16 v[92:95], a[208:211], a[112:115], v[92:95]
  v_exp_f32 v148, v148
  v_mfma_f32_16x16x32_bf16 v[92:95], a[212:215], a[116:119], v[92:95]
  v_cvt_pk_bf16_f32 v54, v96, v97
  v_cvt_pk_bf16_f32 v55, v98, v99
  v_mfma_f32_16x16x32_bf16 v[96:99], a[204:207], a[84:87], 0
  v_cvt_pk_bf16_f32 v38, v88, v89
  v_cvt_pk_bf16_f32 v39, v90, v91
  v_mfma_f32_16x16x32_bf16 v[88:91], a[192:195], a[132:135], 0
  v_cvt_pk_bf16_f32 v4, v136, v137
  v_cvt_pk_bf16_f32 v5, v138, v139
  v_mfma_f32_16x16x32_bf16 v[96:99], a[208:211], a[88:91], v[96:99]
  v_cvt_pk_bf16_f32 v6, v140, v141
  v_cvt_pk_bf16_f32 v7, v142, v143
  v_mfma_f32_16x16x32_bf16 v[88:91], a[196:199], a[136:139], v[88:91]
  v_cvt_pk_bf16_f32 v48, v92, v93
  v_cvt_pk_bf16_f32 v49, v94, v95
  v_mfma_f32_16x16x32_bf16 v[96:99], a[212:215], a[92:95], v[96:99]
  v_cvt_pk_bf16_f32 v8, v144, v145
  v_cvt_pk_bf16_f32 v9, v146, v147
  v_mfma_f32_16x16x32_bf16 v[88:91], a[200:203], a[140:143], v[88:91]
  v_cvt_pk_bf16_f32 v10, v148, v15
  v_mul_f32 v136, v136, v184
  v_mfma_f32_16x16x32_bf16 v[92:95], v[16:19], v[4:7], 0
  v_mul_f32 v137, v137, v185
  v_mul_f32 v138, v138, v186
  v_mfma_f32_16x16x32_bf16 v[156:159], v[112:115], a[240:243], 0
  v_cvt_pk_bf16_f32 v32, v96, v97
  v_cvt_pk_bf16_f32 v33, v98, v99
  v_mfma_f32_16x16x32_bf16 v[160:163], v[124:127], a[240:243], 0
  v_cvt_pk_bf16_f32 v62, v88, v89
  v_cvt_pk_bf16_f32 v63, v90, v91
  v_mfma_f32_16x16x32_bf16 v[96:99], a[204:207], a[120:123], 0
  v_mul_f32 v139, v139, v187
  v_mul_f32 v140, v140, v188
  v_mfma_f32_16x16x32_bf16 v[92:95], v[16:19], v[8:11], v[92:95]
  v_mul_f32 v141, v141, v189
  v_mul_f32 v142, v142, v190
  v_mfma_f32_16x16x32_bf16 v[152:155], v[104:107], a[244:247], v[152:155]
  v_mul_f32 v143, v143, v191
  v_mul_f32 v144, v144, v192
  v_mfma_f32_16x16x32_bf16 v[156:159], v[116:119], a[244:247], v[156:159]
  v_mul_f32 v145, v145, v193
  v_mul_f32 v146, v146, v194
  v_mfma_f32_16x16x32_bf16 v[160:163], v[128:131], a[244:247], v[160:163]
  v_rcp_f32 v204, v92
  v_mfma_f32_16x16x32_bf16 v[164:167], a[216:219], a[240:243], v[244:247]
  v_mul_f32 v136, v136, v204
  v_mul_f32 v137, v137, v204
  v_mfma_f32_16x16x32_bf16 v[88:91], a[204:207], a[96:99], 0
  v_mul_f32 v138, v138, v204
  v_mul_f32 v139, v139, v204
  v_mfma_f32_16x16x32_bf16 v[96:99], a[208:211], a[124:127], v[96:99]
  v_mul_f32 v140, v140, v204
  v_mul_f32 v141, v141, v204
  v_mfma_f32_16x16x32_bf16 v[152:155], v[108:111], a[248:251], v[152:155]
  v_mul_f32 v142, v142, v204
  v_mul_f32 v143, v143, v204
  v_mfma_f32_16x16x32_bf16 v[156:159], v[120:123], a[248:251], v[156:159]
  v_mul_f32 v147, v147, v195
  v_mul_f32 v148, v148, v196
  v_mfma_f32_16x16x32_bf16 v[160:163], v[132:135], a[248:251], v[160:163]
  v_cvt_pk_bf16_f32 v168, v136, v137
  v_cvt_pk_bf16_f32 v169, v138, v139
  v_mfma_f32_16x16x32_bf16 v[164:167], a[220:223], a[244:247], v[164:167]
  v_mul_f32 v152, v152, v184
  v_mul_f32 v153, v153, v185
  v_mfma_f32_16x16x32_bf16 v[88:91], a[208:211], a[100:103], v[88:91]
  v_mul_f32 v154, v154, v186
  v_mul_f32 v155, v155, v187
  v_mfma_f32_16x16x32_bf16 v[96:99], a[212:215], a[128:131], v[96:99]
  v_mul_f32 v156, v156, v188
  v_mul_f32 v157, v157, v189
  v_mfma_f32_16x16x32_bf16 v[164:167], a[224:227], a[248:251], v[164:167]
  v_mul_f32 v158, v158, v190
  v_mul_f32 v159, v159, v191
  v_mfma_f32_16x16x32_bf16 v[88:91], a[212:215], a[104:107], v[88:91]
  v_mul_f32 v160, v160, v192
  v_cvt_pk_bf16_f32 v170, v140, v141
  v_cvt_pk_bf16_f32 v171, v142, v143
  v_mul_f32 v161, v161, v193
  v_mul_f32 v162, v162, v194
  v_mfma_f32_16x16x32_bf16 v[92:95], v[36:39], v[168:171], 0
  v_mul_f32 v163, v163, v195
  v_max3_f32 v209, v152, v153, v154
  v_max3_f32 v210, v155, v156, v157
  v_max3_f32 v211, v158, v159, v160
  ds_read_b128 a[228:231], v249 offset:20736
  v_cvt_pk_bf16_f32 v56, v96, v97
  v_cvt_pk_bf16_f32 v57, v98, v99
  v_mfma_f32_16x16x32_bf16 v[96:99], v[20:23], v[168:171], 0
  v_mul_f32 v144, v144, v204
  v_mul_f32 v145, v145, v204
  v_mul_f32 v146, v146, v204
  v_mul_f32 v147, v147, v204
  v_fma_f32 v148, v148, v204, v242
  v_mul_f32 v164, v164, v196
  v_max3_f32 v212, v161, v162, v163
  v_max3_f32 v209, v209, v210, v211
  v_cvt_pk_bf16_f32 v40, v88, v89
  v_cvt_pk_bf16_f32 v41, v90, v91
  v_mfma_f32_16x16x32_bf16 v[88:91], a[204:207], a[132:135], 0
  v_cvt_pk_bf16_f32 v172, v144, v145
  v_cvt_pk_bf16_f32 v173, v146, v147
  v_mfma_f32_16x16x32_bf16 v[88:91], a[208:211], a[136:139], v[88:91]
  v_cvt_pk_bf16_f32 v174, v148, v243
  v_max3_f32 v209, v209, v212, v164
  v_mfma_f32_16x16x32_bf16 v[88:91], a[212:215], a[140:143], v[88:91]
  ds_read_b128 a[232:235], v249 offset:20800
  v_mov_b32 v210, v209
  v_mfma_f32_16x16x32_bf16 v[96:99], v[24:27], v[172:175], v[96:99]
  ds_read_b128 a[236:239], v249 offset:20864
  v_permlane32_swap_b32 v209, v210
  s_waitcnt lgkmcnt(2)
  v_mfma_f32_16x16x32_bf16 v[136:139], v[100:103], a[228:231], 0
  ds_read_b64_tr_b16 v[58:59], v253 offset:2432
  v_max_f32 v209, v209, v210
  v_mfma_f32_16x16x32_bf16 v[140:143], v[112:115], a[228:231], 0
  buffer_store_dwordx4 v[216:219], v237, s[8:11], s63 offen sc1
  v_mov_b32 v210, v209
  v_mfma_f32_16x16x32_bf16 v[144:147], v[124:127], a[228:231], 0
  v_cvt_pk_bf16_f32 v216, v96, v97
  v_cvt_pk_bf16_f32 v217, v98, v99
  v_mfma_f32_16x16x32_bf16 v[96:99], v[44:47], v[168:171], 0
  v_permlane16_swap_b32 v209, v210
  v_mfma_f32_16x16x32_bf16 v[96:99], v[48:51], v[172:175], v[96:99]
  ds_read_b64_tr_b16 v[42:43], v253 offset:2368
  v_mul_f32 v208, s59, v208
  v_mfma_f32_16x16x32_bf16 v[148:151], a[216:219], a[228:231], v[244:247]
  v_max_f32 v209, v209, v210
  v_mul_f32_e64 v211, -v209, v208
  v_cvt_pk_bf16_f32 v64, v88, v89
  s_waitcnt lgkmcnt(1)
  v_mfma_f32_16x16x32_bf16 v[136:139], v[104:107], a[232:235], v[136:139]
  v_cvt_pk_bf16_f32 v65, v90, v91
  v_xor_b32 v254, 48, v231
  v_mfma_f32_16x16x32_bf16 v[88:91], v[28:31], v[168:171], 0
  v_fma_f32 v152, v152, v208, v211
  v_fma_f32 v153, v153, v208, v211
  v_mfma_f32_16x16x32_bf16 v[88:91], v[32:35], v[172:175], v[88:91]
  v_fma_f32 v154, v154, v208, v211
  v_fma_f32 v155, v155, v208, v211
  v_mfma_f32_16x16x32_bf16 v[140:143], v[116:119], a[232:235], v[140:143]
  v_fma_f32 v156, v156, v208, v211
  v_fma_f32 v157, v157, v208, v211
  v_mfma_f32_16x16x32_bf16 v[144:147], v[128:131], a[232:235], v[144:147]
  v_fma_f32 v158, v158, v208, v211
  v_fma_f32 v159, v159, v208, v211
  v_mfma_f32_16x16x32_bf16 v[136:139], v[108:111], a[236:239], v[136:139]
  ds_read_b64_tr_b16 v[26:27], v254 offset:2304
  v_exp_f32 v152, v152
  v_mfma_f32_16x16x32_bf16 v[140:143], v[120:123], a[236:239], v[140:143]
  v_exp_f32 v153, v153
  v_mfma_f32_16x16x32_bf16 v[144:147], v[132:135], a[236:239], v[144:147]
  v_exp_f32 v154, v154
  v_mfma_f32_16x16x32_bf16 v[148:151], a[220:223], a[232:235], v[148:151]
  v_exp_f32 v155, v155
  v_mfma_f32_16x16x32_bf16 v[148:151], a[224:227], a[236:239], v[148:151]
  v_exp_f32 v156, v156
  s_waitcnt lgkmcnt(1)
  v_mfma_f32_16x16x32_bf16 v[92:95], v[40:43], v[172:175], v[92:95]
  v_exp_f32 v157, v157
  v_exp_f32 v158, v158
  v_exp_f32 v159, v159
  v_fma_f32 v160, v160, v208, v211
  v_fma_f32 v161, v161, v208, v211
  v_fma_f32 v162, v162, v208, v211
  v_fma_f32 v163, v163, v208, v211
  v_fma_f32 v164, v164, v208, v211
  buffer_store_dwordx4 v[220:223], v237, s[8:11], s63 offen offset:64 sc1
  v_exp_f32 v160, v160
  v_exp_f32 v161, v161
  v_exp_f32 v162, v162
  v_exp_f32 v163, v163
  v_exp_f32 v164, v164
  v_cvt_pk_bf16_f32 v4, v152, v153
  v_cvt_pk_bf16_f32 v5, v154, v155
  v_cvt_pk_bf16_f32 v6, v156, v157
  v_cvt_pk_bf16_f32 v7, v158, v159
  v_cvt_pk_bf16_f32 v222, v96, v97
  v_cvt_pk_bf16_f32 v223, v98, v99
  v_mfma_f32_16x16x32_bf16 v[96:99], v[16:19], v[4:7], 0
  ds_read_b64_tr_b16 v[66:67], v253 offset:2440
  v_cvt_pk_bf16_f32 v8, v160, v161
  v_cvt_pk_bf16_f32 v9, v162, v163
  v_cvt_pk_bf16_f32 v10, v164, v15
  v_cvt_pk_bf16_f32 v218, v88, v89
  v_cvt_pk_bf16_f32 v219, v90, v91
  v_mfma_f32_16x16x32_bf16 v[96:99], v[16:19], v[8:11], v[96:99]
  ds_read_b32 v200, v239 offset:2400
  ds_read_b64_tr_b16 v[50:51], v254 offset:2376
  v_mfma_f32_16x16x32_bf16 v[88:91], v[52:55], v[168:171], 0
  ds_read_b64_tr_b16 v[34:35], v254 offset:2312
  v_mul_f32 v152, v152, v184
  v_mfma_f32_16x16x32_bf16 v[88:91], v[56:59], v[172:175], v[88:91]
  v_mul_f32 v153, v153, v185
  v_mul_f32 v154, v154, v186
  v_rcp_f32 v212, v96
  v_mul_f32 v155, v155, v187
  v_mul_f32 v156, v156, v188
  v_mul_f32 v157, v157, v189
  v_mul_f32 v158, v158, v190
  v_mul_f32 v159, v159, v191
  v_mul_f32 v152, v152, v212
  v_mul_f32 v153, v153, v212
  v_mul_f32 v154, v154, v212
  v_mul_f32 v155, v155, v212
  v_mul_f32 v156, v156, v212
  v_mul_f32 v157, v157, v212
  v_mul_f32 v158, v158, v212
  v_mul_f32 v159, v159, v212
  v_mul_f32 v136, v136, v184
  v_mul_f32 v137, v137, v185
  v_mul_f32 v138, v138, v186
  v_mul_f32 v139, v139, v187
  v_mul_f32 v140, v140, v188
  v_mul_f32 v141, v141, v189
  v_mul_f32 v142, v142, v190
  v_mul_f32 v143, v143, v191
  v_mul_f32 v144, v144, v192
  v_xor_b32 v252, 48, v229
  buffer_store_dwordx4 v[224:227], v237, s[8:11], s63 offen offset:128 sc1
  v_mul_f32 v160, v160, v192
  v_mul_f32 v161, v161, v193
  v_mul_f32 v162, v162, v194
  v_mul_f32 v163, v163, v195
  v_mul_f32 v164, v164, v196
  v_cvt_pk_bf16_f32 v176, v152, v153
  v_cvt_pk_bf16_f32 v177, v154, v155
  v_cvt_pk_bf16_f32 v178, v156, v157
  v_cvt_pk_bf16_f32 v179, v158, v159
  v_mul_f32 v145, v145, v193
  v_mul_f32 v146, v146, v194
  v_mfma_f32_16x16x32_bf16 v[96:99], v[36:39], v[176:179], 0
  v_mul_f32 v147, v147, v195
  v_max3_f32 v201, v136, v137, v138
  v_max3_f32 v202, v139, v140, v141
  v_max3_f32 v203, v142, v143, v144
  ds_read_b128 a[240:243], v252 offset:2304
  v_cvt_pk_bf16_f32 v224, v88, v89
  v_cvt_pk_bf16_f32 v225, v90, v91
  v_mfma_f32_16x16x32_bf16 v[88:91], v[20:23], v[176:179], 0
  v_mul_f32 v160, v160, v212
  v_mul_f32 v161, v161, v212
  v_mul_f32 v162, v162, v212
  v_mul_f32 v163, v163, v212
  v_fma_f32 v164, v164, v212, v242
  v_mul_f32 v148, v148, v196
  v_max3_f32 v204, v145, v146, v147
  v_max3_f32 v201, v201, v202, v203
  v_cvt_pk_bf16_f32 v180, v160, v161
  v_cvt_pk_bf16_f32 v181, v162, v163
  v_cvt_pk_bf16_f32 v182, v164, v243
  v_max3_f32 v201, v201, v204, v148
  ds_read_b128 a[244:247], v252 offset:2368
  s_waitcnt lgkmcnt(2)
  v_mfma_f32_16x16x32_bf16 v[88:91], v[24:27], v[180:183], v[88:91]
  ds_read_b64_tr_b16 v[42:43], v254 offset:2368
  v_mov_b32 v202, v201
  v_cvt_pk_bf16_f32 v220, v92, v93
  v_cvt_pk_bf16_f32 v221, v94, v95
  v_mfma_f32_16x16x32_bf16 v[92:95], v[60:63], v[168:171], 0
  v_permlane32_swap_b32 v201, v202
  v_mfma_f32_16x16x32_bf16 v[92:95], v[64:67], v[172:175], v[92:95]
  ds_read_b128 a[248:251], v252 offset:2432
  ds_read_b64_tr_b16 v[58:59], v254 offset:2432
  s_waitcnt lgkmcnt(4)
  v_mfma_f32_16x16x32_bf16 v[152:155], v[100:103], a[240:243], 0
  v_max_f32 v201, v201, v202
  buffer_store_dwordx4 v[216:219], v234, s[8:11], s64 offen sc1
  v_mfma_f32_16x16x32_bf16 v[156:159], v[112:115], a[240:243], 0
  v_mov_b32 v202, v201
  v_cvt_pk_bf16_f32 v216, v88, v89
  v_mfma_f32_16x16x32_bf16 v[160:163], v[124:127], a[240:243], 0
  v_cvt_pk_bf16_f32 v217, v90, v91
  v_permlane16_swap_b32 v201, v202
  v_mfma_f32_16x16x32_bf16 v[88:91], v[44:47], v[176:179], 0
  v_mul_f32 v200, s59, v200
  v_max_f32 v201, v201, v202
  v_mfma_f32_16x16x32_bf16 v[88:91], v[48:51], v[180:183], v[88:91]
  ds_read_b64_tr_b16 v[66:67], v254 offset:2440
  v_mul_f32_e64 v203, -v201, v200
  s_waitcnt lgkmcnt(1)
  v_mfma_f32_16x16x32_bf16 v[152:155], v[104:107], a[244:247], v[152:155]
  v_cvt_pk_bf16_f32 v226, v92, v93
  v_cvt_pk_bf16_f32 v227, v94, v95
  v_mfma_f32_16x16x32_bf16 v[92:95], v[28:31], v[176:179], 0
  v_xor_b32 v253, 48, v232
  v_fma_f32 v136, v136, v200, v203
  v_mfma_f32_16x16x32_bf16 v[92:95], v[32:35], v[180:183], v[92:95]
  v_fma_f32 v137, v137, v200, v203
  v_fma_f32 v138, v138, v200, v203
  v_mfma_f32_16x16x32_bf16 v[156:159], v[116:119], a[244:247], v[156:159]
  v_fma_f32 v139, v139, v200, v203
  v_fma_f32 v140, v140, v200, v203
  v_mfma_f32_16x16x32_bf16 v[160:163], v[128:131], a[244:247], v[160:163]
  v_fma_f32 v141, v141, v200, v203
  v_fma_f32 v142, v142, v200, v203
  v_mfma_f32_16x16x32_bf16 v[164:167], a[216:219], a[240:243], v[244:247]
  v_fma_f32 v143, v143, v200, v203
  ds_read_b64_tr_b16 v[26:27], v253 offset:2304
  v_mfma_f32_16x16x32_bf16 v[96:99], v[40:43], v[180:183], v[96:99]
  v_exp_f32 v136, v136
  v_mfma_f32_16x16x32_bf16 v[152:155], v[108:111], a[248:251], v[152:155]
  v_exp_f32 v137, v137
  v_mfma_f32_16x16x32_bf16 v[156:159], v[120:123], a[248:251], v[156:159]
  v_exp_f32 v138, v138
  v_mfma_f32_16x16x32_bf16 v[160:163], v[132:135], a[248:251], v[160:163]
  v_exp_f32 v139, v139
  v_mfma_f32_16x16x32_bf16 v[164:167], a[220:223], a[244:247], v[164:167]
  v_exp_f32 v140, v140
  v_mfma_f32_16x16x32_bf16 v[164:167], a[224:227], a[248:251], v[164:167]
  v_exp_f32 v141, v141
  v_exp_f32 v142, v142
  v_exp_f32 v143, v143
  v_fma_f32 v144, v144, v200, v203
  v_fma_f32 v145, v145, v200, v203
  v_fma_f32 v146, v146, v200, v203
  v_fma_f32 v147, v147, v200, v203
  v_fma_f32 v148, v148, v200, v203
  buffer_store_dwordx4 v[220:223], v234, s[8:11], s64 offen offset:64 sc1
  v_exp_f32 v144, v144
  v_exp_f32 v145, v145
  v_exp_f32 v146, v146
  v_exp_f32 v147, v147
  v_exp_f32 v148, v148
  v_cvt_pk_bf16_f32 v4, v136, v137
  v_cvt_pk_bf16_f32 v5, v138, v139
  v_cvt_pk_bf16_f32 v6, v140, v141
  v_cvt_pk_bf16_f32 v7, v142, v143
  v_cvt_pk_bf16_f32 v222, v88, v89
  v_cvt_pk_bf16_f32 v223, v90, v91
  v_mfma_f32_16x16x32_bf16 v[88:91], v[16:19], v[4:7], 0
  v_cvt_pk_bf16_f32 v8, v144, v145
  v_cvt_pk_bf16_f32 v9, v146, v147
  v_cvt_pk_bf16_f32 v10, v148, v15
  v_cvt_pk_bf16_f32 v218, v92, v93
  v_cvt_pk_bf16_f32 v219, v94, v95
  v_mfma_f32_16x16x32_bf16 v[88:91], v[16:19], v[8:11], v[88:91]
  ds_read_b32 v208, v13 offset:2304
  ds_read_b64_tr_b16 v[50:51], v253 offset:2376
  v_mfma_f32_16x16x32_bf16 v[92:95], v[52:55], v[176:179], 0
  ds_read_b64_tr_b16 v[34:35], v253 offset:2312
  ds_read_b64_tr_b16 v[42:43], v253 offset:2368
  v_mfma_f32_16x16x32_bf16 v[92:95], v[56:59], v[180:183], v[92:95]
  v_cvt_pk_bf16_f32 v220, v96, v97
  v_cvt_pk_bf16_f32 v221, v98, v99
  v_mfma_f32_16x16x32_bf16 v[96:99], v[60:63], v[176:179], 0
  v_rcp_f32 v204, v88
  s_waitcnt lgkmcnt(4)
  v_mfma_f32_16x16x32_bf16 v[96:99], v[64:67], v[180:183], v[96:99]
  v_mul_f32 v136, v136, v184
  v_mul_f32 v137, v137, v185
  v_mul_f32 v138, v138, v186
  v_mul_f32 v139, v139, v187
  v_mul_f32 v140, v140, v188
  v_mul_f32 v141, v141, v189
  v_mul_f32 v142, v142, v190
  v_mul_f32 v143, v143, v191
  v_mul_f32 v136, v136, v204
  v_mul_f32 v137, v137, v204
  v_mul_f32 v138, v138, v204
  v_mul_f32 v139, v139, v204
  v_mul_f32 v140, v140, v204
  v_mul_f32 v141, v141, v204
  v_mul_f32 v142, v142, v204
  v_mul_f32 v143, v143, v204
  v_mul_f32 v152, v152, v184
  v_mul_f32 v153, v153, v185
  v_mul_f32 v154, v154, v186
  v_mul_f32 v155, v155, v187
  v_mul_f32 v156, v156, v188
  v_mul_f32 v157, v157, v189
  v_mul_f32 v158, v158, v190
  v_mul_f32 v159, v159, v191
  v_mul_f32 v160, v160, v192
  buffer_store_dwordx4 v[224:227], v234, s[8:11], s64 offen offset:128 sc1
  v_mul_f32 v144, v144, v192
  v_mul_f32 v145, v145, v193
  v_mul_f32 v146, v146, v194
  v_mul_f32 v147, v147, v195
  v_mul_f32 v148, v148, v196
  v_cvt_pk_bf16_f32 v168, v136, v137
  v_cvt_pk_bf16_f32 v169, v138, v139
  v_cvt_pk_bf16_f32 v170, v140, v141
  v_cvt_pk_bf16_f32 v171, v142, v143
  v_mul_f32 v161, v161, v193
  v_mul_f32 v162, v162, v194
  v_mfma_f32_16x16x32_bf16 v[88:91], v[36:39], v[168:171], 0
  v_mul_f32 v163, v163, v195
  v_max3_f32 v209, v152, v153, v154
  v_max3_f32 v210, v155, v156, v157
  v_max3_f32 v211, v158, v159, v160
  v_cvt_pk_bf16_f32 v224, v92, v93
  v_cvt_pk_bf16_f32 v225, v94, v95
  v_mfma_f32_16x16x32_bf16 v[92:95], v[20:23], v[168:171], 0
  v_mul_f32 v144, v144, v204
  v_mul_f32 v145, v145, v204
  v_mul_f32 v146, v146, v204
  v_mul_f32 v147, v147, v204
  v_fma_f32 v148, v148, v204, v242
  v_mul_f32 v164, v164, v196
  v_max3_f32 v212, v161, v162, v163
  v_max3_f32 v209, v209, v210, v211
  v_cvt_pk_bf16_f32 v172, v144, v145
  v_cvt_pk_bf16_f32 v173, v146, v147
  v_cvt_pk_bf16_f32 v174, v148, v243
  v_max3_f32 v209, v209, v212, v164
  ds_read_b64_tr_b16 v[58:59], v253 offset:2432
  v_mfma_f32_16x16x32_bf16 v[92:95], v[24:27], v[172:175], v[92:95]
  ds_read_b64_tr_b16 v[66:67], v253 offset:2440
  v_mov_b32 v210, v209
  s_waitcnt lgkmcnt(2)
  v_mfma_f32_16x16x32_bf16 v[88:91], v[40:43], v[172:175], v[88:91]
  buffer_store_dwordx4 v[216:219], v235, s[8:11], s64 offen sc1
  v_permlane32_swap_b32 v209, v210
  v_max_f32 v209, v209, v210
  v_mov_b32 v210, v209
  v_cvt_pk_bf16_f32 v226, v96, v97
  v_cvt_pk_bf16_f32 v216, v92, v93
  v_cvt_pk_bf16_f32 v217, v94, v95
  v_mfma_f32_16x16x32_bf16 v[92:95], v[44:47], v[168:171], 0
  v_permlane16_swap_b32 v209, v210
  v_mfma_f32_16x16x32_bf16 v[92:95], v[48:51], v[172:175], v[92:95]
  v_cvt_pk_bf16_f32 v227, v98, v99
  v_mul_f32 v208, s59, v208
  v_mfma_f32_16x16x32_bf16 v[96:99], v[28:31], v[168:171], 0
  v_max_f32 v209, v209, v210
  v_mul_f32_e64 v211, -v209, v208
  v_mfma_f32_16x16x32_bf16 v[96:99], v[32:35], v[172:175], v[96:99]
  v_xor_b32 v254, 48, v233
  v_fma_f32 v152, v152, v208, v211
  v_fma_f32 v153, v153, v208, v211
  v_fma_f32 v154, v154, v208, v211
  v_fma_f32 v155, v155, v208, v211
  v_fma_f32 v156, v156, v208, v211
  v_fma_f32 v157, v157, v208, v211
  v_fma_f32 v158, v158, v208, v211
  v_fma_f32 v159, v159, v208, v211
  ds_read_b64_tr_b16 v[26:27], v254 offset:2304
  v_exp_f32 v152, v152
  v_exp_f32 v153, v153
  v_exp_f32 v154, v154
  v_exp_f32 v155, v155
  v_exp_f32 v156, v156
  v_exp_f32 v157, v157
  v_exp_f32 v158, v158
  v_exp_f32 v159, v159
  ds_read_b64_tr_b16 v[34:35], v254 offset:2312
  ds_read_b64_tr_b16 v[42:43], v254 offset:2368
  v_fma_f32 v160, v160, v208, v211
  v_fma_f32 v161, v161, v208, v211
  v_fma_f32 v162, v162, v208, v211
  v_fma_f32 v163, v163, v208, v211
  v_fma_f32 v164, v164, v208, v211
  buffer_store_dwordx4 v[220:223], v235, s[8:11], s64 offen offset:64 sc1
  v_exp_f32 v160, v160
  v_exp_f32 v161, v161
  v_exp_f32 v162, v162
  v_exp_f32 v163, v163
  v_exp_f32 v164, v164
  v_cvt_pk_bf16_f32 v4, v152, v153
  v_cvt_pk_bf16_f32 v5, v154, v155
  v_cvt_pk_bf16_f32 v6, v156, v157
  v_cvt_pk_bf16_f32 v7, v158, v159
  v_cvt_pk_bf16_f32 v222, v92, v93
  v_cvt_pk_bf16_f32 v223, v94, v95
  v_mfma_f32_16x16x32_bf16 v[92:95], v[16:19], v[4:7], 0
  v_cvt_pk_bf16_f32 v218, v96, v97
  v_cvt_pk_bf16_f32 v219, v98, v99
  v_mfma_f32_16x16x32_bf16 v[96:99], v[52:55], v[168:171], 0
  v_cvt_pk_bf16_f32 v220, v88, v89
  v_cvt_pk_bf16_f32 v221, v90, v91
  v_mfma_f32_16x16x32_bf16 v[88:91], v[60:63], v[168:171], 0
  v_cvt_pk_bf16_f32 v8, v160, v161
  v_cvt_pk_bf16_f32 v9, v162, v163
  s_waitcnt lgkmcnt(0)
  v_mfma_f32_16x16x32_bf16 v[96:99], v[56:59], v[172:175], v[96:99]
  v_cvt_pk_bf16_f32 v10, v164, v15
  ds_read_b64_tr_b16 v[50:51], v254 offset:2376
  v_mfma_f32_16x16x32_bf16 v[88:91], v[64:67], v[172:175], v[88:91]
  ds_read_b64_tr_b16 v[58:59], v254 offset:2432
  ds_read_b64_tr_b16 v[66:67], v254 offset:2440
  v_mfma_f32_16x16x32_bf16 v[92:95], v[16:19], v[8:11], v[92:95]
  v_mul_f32 v152, v152, v184
  v_mul_f32 v153, v153, v185
  v_mul_f32 v154, v154, v186
  v_mul_f32 v155, v155, v187
  v_mul_f32 v156, v156, v188
  v_mul_f32 v157, v157, v189
  v_mul_f32 v158, v158, v190
  v_mul_f32 v159, v159, v191
  v_rcp_f32 v212, v92
  buffer_store_dwordx4 v[224:227], v235, s[8:11], s64 offen offset:128 sc1
  v_mul_f32 v152, v152, v212
  v_mul_f32 v153, v153, v212
  v_mul_f32 v154, v154, v212
  v_mul_f32 v155, v155, v212
  v_mul_f32 v156, v156, v212
  v_mul_f32 v157, v157, v212
  v_mul_f32 v158, v158, v212
  v_mul_f32 v159, v159, v212
  v_mul_f32 v160, v160, v192
  v_mul_f32 v161, v161, v193
  v_mul_f32 v162, v162, v194
  v_mul_f32 v163, v163, v195
  v_mul_f32 v164, v164, v196
  v_cvt_pk_bf16_f32 v176, v152, v153
  v_cvt_pk_bf16_f32 v177, v154, v155
  v_cvt_pk_bf16_f32 v178, v156, v157
  v_cvt_pk_bf16_f32 v179, v158, v159
  v_cvt_pk_bf16_f32 v224, v96, v97
  v_cvt_pk_bf16_f32 v225, v98, v99
  v_mfma_f32_16x16x32_bf16 v[96:99], v[20:23], v[176:179], 0
  v_mul_f32 v160, v160, v212
  v_mul_f32 v161, v161, v212
  v_mfma_f32_16x16x32_bf16 v[92:95], v[36:39], v[176:179], 0
  v_mul_f32 v162, v162, v212
  v_mul_f32 v163, v163, v212
  v_fma_f32 v164, v164, v212, v242
  v_cvt_pk_bf16_f32 v226, v88, v89
  v_cvt_pk_bf16_f32 v227, v90, v91
  v_mfma_f32_16x16x32_bf16 v[88:91], v[28:31], v[176:179], 0
  v_cvt_pk_bf16_f32 v180, v160, v161
  v_cvt_pk_bf16_f32 v181, v162, v163
  v_cvt_pk_bf16_f32 v182, v164, v243
  buffer_store_dwordx4 v[216:219], v236, s[8:11], s64 offen sc1
  buffer_store_dwordx4 v[220:223], v236, s[8:11], s64 offen offset:64 sc1
  v_mfma_f32_16x16x32_bf16 v[96:99], v[24:27], v[180:183], v[96:99]
  buffer_store_dwordx4 v[224:227], v236, s[8:11], s64 offen offset:128 sc1
  v_mfma_f32_16x16x32_bf16 v[88:91], v[32:35], v[180:183], v[88:91]
  v_mfma_f32_16x16x32_bf16 v[92:95], v[40:43], v[180:183], v[92:95]
  s_nop 4
  v_cvt_pk_bf16_f32 v216, v96, v97
  v_cvt_pk_bf16_f32 v217, v98, v99
  v_mfma_f32_16x16x32_bf16 v[96:99], v[44:47], v[176:179], 0
  v_cvt_pk_bf16_f32 v218, v88, v89
  v_cvt_pk_bf16_f32 v219, v90, v91
  v_mfma_f32_16x16x32_bf16 v[88:91], v[52:55], v[176:179], 0
  v_cvt_pk_bf16_f32 v220, v92, v93
  v_cvt_pk_bf16_f32 v221, v94, v95
  v_mfma_f32_16x16x32_bf16 v[92:95], v[60:63], v[176:179], 0
  buffer_store_dwordx4 v[216:219], v237, s[8:11], s64 offen sc1
  s_waitcnt lgkmcnt(0)
  v_mfma_f32_16x16x32_bf16 v[96:99], v[48:51], v[180:183], v[96:99]
  v_mfma_f32_16x16x32_bf16 v[88:91], v[56:59], v[180:183], v[88:91]
  v_mfma_f32_16x16x32_bf16 v[92:95], v[64:67], v[180:183], v[92:95]
  s_nop 5
  v_cvt_pk_bf16_f32 v222, v96, v97
  v_cvt_pk_bf16_f32 v223, v98, v99
  v_cvt_pk_bf16_f32 v224, v88, v89
  v_cvt_pk_bf16_f32 v225, v90, v91
  v_cvt_pk_bf16_f32 v226, v92, v93
  v_cvt_pk_bf16_f32 v227, v94, v95
  buffer_store_dwordx4 v[220:223], v237, s[8:11], s64 offen offset:64 sc1
  buffer_store_dwordx4 v[224:227], v237, s[8:11], s64 offen offset:128 sc1
  s_endpgm
.section .rodata,"a"
.p2align 6
.amdhsa_kernel standalone__video_video_swin__vision_kernel
  .amdhsa_next_free_vgpr 512
  .amdhsa_next_free_sgpr 102
  .amdhsa_accum_offset 256
  .amdhsa_group_segment_fixed_size 0
  .amdhsa_kernarg_size 64
  .amdhsa_user_sgpr_count 2
  .amdhsa_user_sgpr_kernarg_segment_ptr 1
  .amdhsa_system_sgpr_workgroup_id_x 1
.end_amdhsa_kernel
```
